```python
import torch

def _softmax(x, axis=-1):
    return torch.softmax(x, dim=axis)

def _gelu(x):
    return torch.nn.functional.gelu(x, approximate='tanh')

def _silu(x):
    return torch.nn.functional.silu(x)

def _sigmoid(x):
    return torch.sigmoid(x)

def _layernorm(x, axis=-1, eps=1e-05):
    m = x.mean(dim=axis, keepdim=True)
    v = x.var(dim=axis, keepdim=True, unbiased=False)
    return (x - m) / torch.sqrt(v + eps)

def _scatter_add(tgt, idx, src, axis=0):
    return tgt.clone().index_add_(axis, idx, src)

def _segment_sum(src, seg, n):
    out = torch.zeros((n,) + src.shape[1:], dtype=src.dtype)
    return out.index_add_(0, seg, src)

def _pad(x, pw):
    flat = tuple((v for pair in reversed(pw) for v in pair))
    return torch.nn.functional.pad(x, flat)
kernel_name = 'recurrent_scan__memory_aug_recurrent_mem_tr__geglu_ffn__prompt'

def setup_inputs():

    _w = lambda a: (lambda t: t.to(torch.bfloat16) if t.is_floating_point() else t)(torch.as_tensor(a))

    def _A_setup():
        B, S, Dm = (1, 2048, 512)
        H, Dh = (32, 128)
        M, seg = (8, 32)
        seg = min(seg, S)
        S = S // seg * seg
        return {'x': _w((lambda *s: torch.randn(*s, dtype=torch.bfloat16) * 0.05)(B, S, Dm)), 'mem0': _w((lambda *s: torch.randn(*s, dtype=torch.bfloat16) * 0.2)(B, M, Dm)), 'Wq': _w((lambda *s: torch.randn(*s, dtype=torch.bfloat16) * 1.6)(Dm, H, Dh) * Dm ** (-0.5)), 'Wk': _w((lambda *s: torch.randn(*s, dtype=torch.bfloat16) * 1.6)(Dm, H, Dh) * Dm ** (-0.5)), 'Wv': _w((lambda *s: torch.randn(*s, dtype=torch.bfloat16) * 0.2)(Dm, H, Dh) * Dm ** (-0.5)), 'Wo': _w((lambda *s: torch.randn(*s, dtype=torch.bfloat16) * 0.2)(H, Dh, Dm) * (H * Dh) ** (-0.5)), 'seg_len': seg}
    _A_in = _A_setup()

    def _B_setup():
        B, S, D, F = (1, 2048, 512, 1376)
        return {'x': _w((lambda *s: torch.randn(*s, dtype=torch.bfloat16) * 0.05)(B, S, D)), 'w_gate': _w((lambda *s: torch.randn(*s, dtype=torch.bfloat16) * 0.1)(D, F)), 'w_up': _w((lambda *s: torch.randn(*s, dtype=torch.bfloat16) * 0.1)(D, F)), 'w_down': _w((lambda *s: torch.randn(*s, dtype=torch.bfloat16) * 0.1)(F, D))}
    _B_in = _B_setup()
    return {'A_x': _A_in['x'], 'A_mem0': _A_in['mem0'], 'A_Wq': _A_in['Wq'], 'A_Wk': _A_in['Wk'], 'A_Wv': _A_in['Wv'], 'A_Wo': _A_in['Wo'], 'A_seg_len': _A_in['seg_len'], 'B_x': _B_in['x'], 'B_w_gate': _B_in['w_gate'], 'B_w_up': _B_in['w_up'], 'B_w_down': _B_in['w_down']}

def reference(A_x, A_mem0, A_Wq, A_Wk, A_Wv, A_Wo, A_seg_len, B_x, B_w_gate, B_w_up, B_w_down):

    def _A_ref(x, mem0, Wq, Wk, Wv, Wo, seg_len):
        B, S, Dm = x.shape
        H, Dh = (Wq.shape[1], Wq.shape[2])
        M = mem0.shape[1]
        scale = Dh ** (-0.5)
        n_seg = S // seg_len
        L = M + seg_len
        idx = torch.arange(L)
        mask = (idx[:, None] < M) | (idx[:, None] >= idx[None, :])
        mem = mem0
        outs = []
        for s in range(n_seg):
            xs = x[:, s * seg_len:(s + 1) * seg_len, :].clone()
            h = torch.concatenate([mem, xs], axis=1)
            q = torch.einsum('btd,dhe->bhte', h, Wq)
            k = torch.einsum('btd,dhe->bhte', h, Wk)
            v = torch.einsum('btd,dhe->bhte', h, Wv)
            scores = torch.einsum('bhqe,bhke->bhqk', q, k) * scale
            scores = torch.where(mask[None, None], scores, -1000000000.0)
            p = _softmax(scores, axis=-1)
            o = torch.einsum('bhqk,bhke->bhqe', p, v)
            o = torch.einsum('bhte,hed->btd', o, Wo)
            mem = o[:, :M, :].clone()
            outs.append(o[:, M:, :])
        return torch.concatenate(outs, axis=1)

    def _B_ref(x, w_gate, w_up, w_down):
        return _gelu(x @ w_gate) * (x @ w_up) @ w_down
    x = A_x
    xn = _layernorm(x, axis=-1)
    s = _A_ref(xn, A_mem0, A_Wq, A_Wk, A_Wv, A_Wo, A_seg_len)
    g = _silu(_B_ref(xn, B_w_gate, B_w_up, B_w_down))
    return x + s * g
```

```asm
; @launch grid=(256,1,1) block=(256,1,1) lds=163840
.amdgcn_target "amdgcn-amd-amdhsa--gfx950"
.text
.globl recurrent_scan__memory_aug_recurrent_mem_tr__geglu_ffn__prompt_kernel
.p2align 8
.type recurrent_scan__memory_aug_recurrent_mem_tr__geglu_ffn__prompt_kernel,@function
recurrent_scan__memory_aug_recurrent_mem_tr__geglu_ffn__prompt_kernel:
    s_cmp_ge_u32 s2, 256
    s_cbranch_scc1 L_end
    s_load_dwordx16 s[64:79], s[0:1], 0
    s_load_dwordx8 s[80:87], s[0:1], 64
    s_load_dwordx4 s[88:91], s[0:1], 96
    s_getreg_b32 s20, hwreg(HW_REG_XCC_ID, 0, 3)
    s_lshl_b32 s20, s20, 2
    s_lshr_b32 s20, 0x14360725, s20
    s_and_b32 s20, s20, 7
    v_lshrrev_b32 v1, 6, v0
    s_mov_b32 s23, 0
    s_mov_b32 s24, 1048576
    v_readfirstlane_b32 s22, v1
    v_mov_b32 v2, 0
    s_waitcnt lgkmcnt(0)
    s_mov_b32 s4, s90
    s_mov_b32 s5, s91
    s_mov_b32 s6, 0x4000000
    s_mov_b32 s7, 0x20000
    s_mov_b32 s12, s88
    s_mov_b32 s13, s89
    s_mov_b32 s14, 0x100
    s_mov_b32 s15, 0x20000
    s_lshr_b32 s21, s2, 3
    s_lshl_b32 s63, s2, 2
    s_add_u32 s63, s63, s21
    s_mov_b32 s2, 0
L_dispatch:
    s_cmp_lt_u32 s20, 1
    s_cbranch_scc1 L_team
    s_cmp_lt_u32 s20, 4
    s_cbranch_scc1 L_proj
    s_cmp_lt_u32 s20, 8
    s_cbranch_scc1 L_ffn
L_exit:
L_end:
    s_endpgm
L_search:
    s_waitcnt vmcnt(0) lgkmcnt(0)
    v_mov_b32 v2, 0
    s_barrier
    s_cmp_lg_u32 s22, 0
    s_cbranch_scc1 L_claimed
    s_mov_b64 exec, 1
L_claim:
    s_cmp_lg_u32 s3, -1
    s_cbranch_scc1 L_try
    s_add_u32 s20, s20, 1
    s_and_b32 s20, s20, 7
    s_add_u32 s23, s23, 1
    s_mov_b32 s3, 0
    s_cmp_lt_u32 s23, 8
    s_cbranch_scc1 L_try
    s_mov_b32 s20, 8
    s_branch L_got
L_try:
    s_mov_b32 s26, s3
    s_mov_b32 s27, s3
    s_add_u32 s63, s63, 5
    s_and_b32 s63, s63, 31
    s_lshr_b64 s[26:27], s[26:27], s63
    s_ff0_i32_b32 s21, s26
    s_add_u32 s21, s21, s63
    s_and_b32 s21, s21, 31
    s_lshl_b32 s3, 1, s21
    v_mov_b32 v98, s3
    v_mov_b32 v99, s23
    s_add_u32 s3, s20, 4
    s_lshr_b32 s3, s3, 2
    s_lshl_b32 s3, s3, 3
    s_add_u32 s3, s3, s20
    s_lshl_b32 s3, s3, 3
    s_cmp_eq_u32 s20, 0
    s_cselect_b32 s3, 0, s3
    buffer_atomic_or_x2 v[98:99], off, s[12:15], s3 sc0 sc1
    s_waitcnt vmcnt(0)
    v_readfirstlane_b32 s3, v98
    s_nop 0
    s_bitcmp1_b32 s3, s21
    s_cbranch_scc1 L_claim
L_got:
    s_lshl_b32 s3, s20, 8
    s_or_b32 s3, s3, s21
    s_lshl_b32 s23, s23, 16
    s_or_b32 s3, s3, s23
    v_mov_b32 v1, s3
    ds_write_b32 v2, v1
    s_mov_b64 exec, -1
    s_waitcnt lgkmcnt(0)
L_claimed:
    s_barrier
    ds_read_b32 v1, v2
    s_waitcnt lgkmcnt(0)
    v_readfirstlane_b32 s3, v1
    s_nop 0
    s_and_b32 s21, s3, 31
    s_bfe_u32 s20, s3, 0x40008
    s_lshr_b32 s23, s3, 16
    s_mov_b32 s2, 1
    s_branch L_dispatch
L_timeout:
    s_mov_b64 exec, 1
    v_mov_b32 v1, s3
    v_mov_b32 v2, 0
    buffer_store_dword v1, v2, s[12:15], 0 offen offset:8
    s_endpgm
L_team:
    s_or_b32 s3, s2, s22
    s_cbranch_scc1 L_asked_1
    s_mov_b64 exec, 1
    s_lshl_b32 s3, 1, s21
    v_mov_b32 v98, s3
    v_mov_b32 v99, s23
    s_add_u32 s3, s20, 4
    s_lshr_b32 s3, s3, 2
    s_lshl_b32 s3, s3, 3
    s_add_u32 s3, s3, s20
    s_lshl_b32 s3, s3, 3
    s_cmp_eq_u32 s20, 0
    s_cselect_b32 s3, 0, s3
    buffer_atomic_or_x2 v[98:99], off, s[12:15], s3 sc0 sc1
    s_mov_b64 exec, -1
L_asked_1:
    s_getpc_b64 s[98:99]
L_pc_2:
    v_lshlrev_b32 v104, 7, v0
    v_add_u32 v104, 0, v104
    v_min_u32 v104, L_team_code-L_pc_2-4, v104
    v_mov_b32 v105, s99
    v_add_co_u32 v104, vcc, s98, v104
    s_nop 1
    v_addc_co_u32 v105, vcc, 0, v105, vcc
    global_load_dword v134, v[104:105], off
    s_lshr_b32 s3, s21, 2
    s_lshl_b32 s57, s22, 1
    s_xor_b32 s54, s57, s3
    s_xor_b32 s55, s54, 1
    s_lshl_b32 s57, s21, 8
    s_lshl_b32 s16, s54, 19
    s_add_u32 s16, s16, s57
    s_lshl_b32 s17, s55, 19
    s_add_u32 s17, s17, s57
    s_lshl_b32 s18, s22, 12
    s_mul_i32 s49, s22, 36864
    v_bfe_u32 v2, v0, 0, 4
    v_mul_u32_u24 v2, 16, v2
    v_bfe_u32 v16, v0, 4, 2
    v_mul_u32_u24 v16, 32, v16
    v_xor_b32 v2, v2, v16
    v_bfe_u32 v16, v0, 4, 1
    v_mul_u32_u24 v16, 131072, v16
    v_add_u32 v2, v2, v16
    v_bfe_u32 v16, v0, 5, 1
    v_mul_u32_u24 v16, 8192, v16
    v_add_u32 v2, v2, v16
    v_bfe_u32 v3, v0, 0, 4
    v_mul_u32_u24 v3, 16, v3
    v_bfe_u32 v16, v0, 4, 2
    v_mul_u32_u24 v16, 32, v16
    v_xor_b32 v3, v3, v16
    v_xor_b32 v3, 128, v3
    v_bfe_u32 v16, v0, 4, 1
    v_mul_u32_u24 v16, 131072, v16
    v_add_u32 v3, v3, v16
    v_bfe_u32 v16, v0, 5, 1
    v_mul_u32_u24 v16, 8192, v16
    v_add_u32 v3, v3, v16
    s_waitcnt lgkmcnt(0)
    s_barrier
    s_mov_b32 s8, s68
    s_mov_b32 s9, s69
    s_mov_b32 s10, 0x400000
    s_mov_b32 s11, 0x20000
    s_add_u32 m0, s18, 0
    s_add_u32 s57, s16, 0x0
    buffer_load_dwordx4 v2, s[8:11], s57 offen nt lds
    s_add_u32 m0, s18, 1024
    s_add_u32 s57, s16, 0x8000
    buffer_load_dwordx4 v3, s[8:11], s57 offen nt lds
    s_add_u32 m0, s18, 2048
    s_add_u32 s57, s16, 0x10000
    buffer_load_dwordx4 v2, s[8:11], s57 offen nt lds
    s_add_u32 m0, s18, 3072
    s_add_u32 s57, s16, 0x18000
    buffer_load_dwordx4 v3, s[8:11], s57 offen nt lds
    s_add_u32 m0, s49, 45056
    s_add_u32 s57, s16, 0x4000
    buffer_load_dwordx4 v2, s[8:11], s57 offen nt lds
    s_add_u32 m0, s49, 46080
    s_add_u32 s57, s16, 0xc000
    buffer_load_dwordx4 v3, s[8:11], s57 offen nt lds
    s_add_u32 m0, s49, 47104
    s_add_u32 s57, s16, 0x14000
    buffer_load_dwordx4 v2, s[8:11], s57 offen nt lds
    s_add_u32 m0, s49, 48128
    s_add_u32 s57, s16, 0x1c000
    buffer_load_dwordx4 v3, s[8:11], s57 offen nt lds
    s_add_u32 m0, s49, 49152
    s_add_u32 s57, s16, 0x40000
    buffer_load_dwordx4 v2, s[8:11], s57 offen nt lds
    s_add_u32 m0, s49, 50176
    s_add_u32 s57, s16, 0x48000
    buffer_load_dwordx4 v3, s[8:11], s57 offen nt lds
    s_add_u32 m0, s49, 51200
    s_add_u32 s57, s16, 0x50000
    buffer_load_dwordx4 v2, s[8:11], s57 offen nt lds
    s_add_u32 m0, s49, 52224
    s_add_u32 s57, s16, 0x58000
    buffer_load_dwordx4 v3, s[8:11], s57 offen nt lds
    v_bfe_u32 v4, v0, 0, 1
    v_mul_u32_u24 v4, 8, v4
    v_bfe_u32 v45, v0, 1, 1
    v_mul_u32_u24 v45, 16, v45
    v_xor_b32 v4, v4, v45
    v_bfe_u32 v45, v0, 2, 2
    v_mul_u32_u24 v45, 256, v45
    v_xor_b32 v4, v4, v45
    v_bfe_u32 v45, v0, 2, 2
    v_mul_u32_u24 v45, 32, v45
    v_xor_b32 v4, v4, v45
    v_bfe_u32 v45, v0, 4, 1
    v_mul_u32_u24 v45, 128, v45
    v_xor_b32 v4, v4, v45
    v_bfe_u32 v45, v0, 4, 2
    v_mul_u32_u24 v45, 1024, v45
    v_xor_b32 v4, v4, v45
    v_bfe_u32 v45, v0, 6, 2
    v_mul_u32_u24 v45, 64, v45
    v_xor_b32 v4, v4, v45
    v_bfe_u32 v45, v0, 6, 2
    v_mul_u32_u24 v45, 4096, v45
    v_xor_b32 v4, v4, v45
    v_xor_b32 v5, 32, v4
    v_xor_b32 v6, 4096, v4
    v_xor_b32 v7, 4128, v4
    v_xor_b32 v8, 8192, v4
    v_xor_b32 v9, 8224, v4
    v_xor_b32 v10, 12288, v4
    v_xor_b32 v11, 12320, v4
    s_xor_b32 s3, s22, 0
    s_mul_i32 s3, s3, 32768
    s_add_u32 s3, s3, 16384
    v_add_u32 v32, s3, v4
    v_add_u32 v33, s3, v5
    s_xor_b32 s3, s22, 1
    s_mul_i32 s3, s3, 32768
    s_add_u32 s3, s3, 16384
    v_add_u32 v34, s3, v6
    v_add_u32 v35, s3, v7
    s_xor_b32 s3, s22, 2
    s_mul_i32 s3, s3, 32768
    s_add_u32 s3, s3, 16384
    v_add_u32 v36, s3, v8
    v_add_u32 v37, s3, v9
    s_xor_b32 s3, s22, 3
    s_mul_i32 s3, s3, 32768
    s_add_u32 s3, s3, 16384
    v_add_u32 v38, s3, v10
    v_add_u32 v39, s3, v11
    s_lshl_b32 s54, s54, 10
    s_lshl_b32 s55, s55, 10
    v_bfe_u32 v133, v0, 0, 6
    v_mul_u32_u24 v133, 16, v133
    v_bfe_u32 v138, v0, 0, 6
    v_mul_u32_u24 v138, 16, v138
    v_bfe_u32 v45, v0, 6, 2
    v_mul_u32_u24 v45, 36864, v45
    v_add_u32 v138, v138, v45
    v_add_u32 v138, 16384, v138
    v_mov_b32 v129, 0
    s_cmp_lg_u32 s2, 0
    s_cbranch_scc1 L_sure_4
    v_mov_b32 v45, 16384
    s_cmp_lg_u32 s22, 0
    s_cbranch_scc1 L_told_3
    s_waitcnt vmcnt(13)
    s_mov_b64 exec, 1
    ds_write_b32 v45, v98
    s_mov_b64 exec, -1
    s_waitcnt lgkmcnt(0)
L_told_3:
    s_barrier
    ds_read_b32 v1, v45
    s_waitcnt lgkmcnt(0)
    v_readfirstlane_b32 s3, v1
    s_nop 0
    s_bitcmp1_b32 s3, s21
    s_cbranch_scc1 L_search
L_sure_4:
    s_waitcnt vmcnt(8)
    s_barrier
    ds_read_b64_tr_b16 v[16:17], v4 offset:0
    ds_read_b64_tr_b16 v[18:19], v5 offset:0
    ds_read_b64_tr_b16 v[192:193], v6 offset:0
    ds_read_b64_tr_b16 v[240:241], v7 offset:0
    ds_read_b64_tr_b16 v[208:209], v8 offset:0
    ds_read_b64_tr_b16 a[0:1], v9 offset:0
    ds_read_b64_tr_b16 v[224:225], v10 offset:0
    ds_read_b64_tr_b16 a[16:17], v11 offset:0
    s_waitcnt lgkmcnt(0)
    s_barrier
    s_add_u32 m0, s18, 0
    s_add_u32 s57, s16, 0x44000
    buffer_load_dwordx4 v2, s[8:11], s57 offen nt lds
    s_add_u32 m0, s18, 1024
    s_add_u32 s57, s16, 0x4c000
    buffer_load_dwordx4 v3, s[8:11], s57 offen nt lds
    s_add_u32 m0, s18, 2048
    s_add_u32 s57, s16, 0x54000
    buffer_load_dwordx4 v2, s[8:11], s57 offen nt lds
    s_add_u32 m0, s18, 3072
    s_add_u32 s57, s16, 0x5c000
    buffer_load_dwordx4 v3, s[8:11], s57 offen nt lds
    v_bfe_u32 v44, v0, 0, 4
    v_mul_u32_u24 v44, 16, v44
    v_bfe_u32 v45, v0, 4, 2
    v_mul_u32_u24 v45, 64, v45
    v_xor_b32 v44, v44, v45
    v_bfe_u32 v45, v0, 4, 1
    v_mul_u32_u24 v45, 16384, v45
    v_add_u32 v44, v44, v45
    v_bfe_u32 v45, v0, 5, 1
    v_mul_u32_u24 v45, 2048, v45
    v_add_u32 v44, v44, v45
    v_bfe_u32 v12, v0, 0, 1
    v_mul_u32_u24 v12, 8, v12
    v_bfe_u32 v45, v0, 1, 1
    v_mul_u32_u24 v45, 16, v45
    v_xor_b32 v12, v12, v45
    v_bfe_u32 v45, v0, 3, 1
    v_mul_u32_u24 v45, 32, v45
    v_xor_b32 v12, v12, v45
    v_bfe_u32 v45, v0, 2, 1
    v_mul_u32_u24 v45, 320, v45
    v_xor_b32 v12, v12, v45
    v_bfe_u32 v45, v0, 4, 1
    v_mul_u32_u24 v45, 640, v45
    v_xor_b32 v12, v12, v45
    v_bfe_u32 v45, v0, 5, 1
    v_mul_u32_u24 v45, 1024, v45
    v_xor_b32 v12, v12, v45
    v_bfe_u32 v45, v0, 6, 2
    v_mul_u32_u24 v45, 4096, v45
    v_xor_b32 v12, v12, v45
    s_lshr_b32 s3, s21, 3
    s_lshl_b32 s3, s3, 6
    v_xor_b32 v12, s3, v12
    v_xor_b32 v13, 64, v12
    v_xor_b32 v14, 128, v12
    v_xor_b32 v15, 192, v12
    s_sub_u32 s3, s49, s18
    s_add_u32 s3, s3, 16384
    v_add_u32 v40, s3, v12
    v_add_u32 v41, s3, v13
    v_add_u32 v42, s3, v14
    v_add_u32 v43, s3, v15
    v_bfe_u32 v140, v0, 0, 2
    v_mul_u32_u24 v140, 4, v140
    v_bfe_u32 v45, v0, 2, 1
    v_mul_u32_u24 v45, 256, v45
    v_add_u32 v140, v140, v45
    v_bfe_u32 v45, v0, 3, 1
    v_mul_u32_u24 v45, 64, v45
    v_add_u32 v140, v140, v45
    v_bfe_u32 v45, v0, 4, 2
    v_mul_u32_u24 v45, 16, v45
    v_add_u32 v140, v140, v45
    s_lshr_b32 s3, s21, 1
    s_lshl_b32 s3, s3, 9
    s_and_b32 s57, s21, 1
    s_lshl_b32 s57, s57, 7
    s_add_u32 s3, s3, s57
    v_add_u32 v140, s3, v140
    v_bfe_u32 v135, v0, 0, 5
    v_mul_u32_u24 v135, 4, v135
    v_bfe_u32 v46, v0, 0, 3
    v_mul_u32_u24 v46, 128, v46
    v_bfe_u32 v45, v0, 3, 3
    v_mul_u32_u24 v45, 8388608, v45
    v_add_u32 v46, v46, v45
    v_lshlrev_b32 v47, 4, v46
    v_cmp_lt_u32 vcc, 1023, v46
    s_nop 1
    v_cndmask_b32 v46, v46, v47, vcc
    v_cmp_lt_u32 vcc, 191, v0
    s_nop 1
    v_cndmask_b32 v140, v140, v46, vcc
    v_mov_b32 v128, 0
    v_mov_b32 v136, 0
    v_mov_b32 v143, 0
    v_bfe_u32 v139, v0, 0, 5
    v_mul_u32_u24 v139, 8, v139
    v_bfe_u32 v45, v0, 5, 1
    v_mul_u32_u24 v45, 8192, v45
    v_add_u32 v139, v139, v45
    v_bfe_u32 v141, v0, 0, 4
    v_mul_u32_u24 v141, 4, v141
    v_bfe_u32 v45, v0, 4, 2
    v_mul_u32_u24 v45, 1088, v45
    v_add_u32 v141, v141, v45
    v_bfe_u32 v45, v0, 6, 2
    v_mul_u32_u24 v45, 64, v45
    v_add_u32 v141, v141, v45
    v_add_u32 v141, 8192, v141
    v_bfe_u32 v142, v0, 0, 1
    v_mul_u32_u24 v142, 544, v142
    v_bfe_u32 v45, v0, 2, 2
    v_mul_u32_u24 v45, 1088, v45
    v_add_u32 v142, v142, v45
    v_bfe_u32 v45, v0, 4, 2
    v_mul_u32_u24 v45, 16, v45
    v_add_u32 v142, v142, v45
    v_add_u32 v142, 8192, v142
    v_bfe_u32 v137, v0, 0, 1
    v_mul_u32_u24 v137, 544, v137
    v_bfe_u32 v45, v0, 1, 1
    v_mul_u32_u24 v45, 128, v45
    v_add_u32 v137, v137, v45
    v_bfe_u32 v45, v0, 2, 2
    v_mul_u32_u24 v45, 1088, v45
    v_add_u32 v137, v137, v45
    v_bfe_u32 v45, v0, 4, 2
    v_mul_u32_u24 v45, 16, v45
    v_add_u32 v137, v137, v45
    v_add_u32 v137, 8192, v137
    s_mov_b32 s58, 0xcccccccc
    s_mov_b32 s59, 0xcccccccc
    v_mov_b32 v131, 0x444400e8
    v_mov_b32 v45, 0xeeee00e9
    v_cndmask_b32 v131, v131, v45, s[58:59]
    v_mov_b32 v120, 0x3f803f80
    v_mov_b32 v121, 0x3f803f80
    v_mov_b32 v122, 0x3f803f80
    v_mov_b32 v123, 0x3f803f80
    ds_write_b64 v138, v[16:17] offset:0
    ds_write_b64 v138, v[18:19] offset:2048
    s_waitcnt vmcnt(8)
    s_barrier
    ds_read_b64_tr_b16 v[16:17], v32 offset:28672
    ds_read_b64_tr_b16 v[18:19], v33 offset:28672
    ds_read_b64_tr_b16 v[194:195], v34 offset:28672
    ds_read_b64_tr_b16 v[242:243], v35 offset:28672
    ds_read_b64_tr_b16 v[210:211], v36 offset:28672
    ds_read_b64_tr_b16 a[2:3], v37 offset:28672
    ds_read_b64_tr_b16 v[226:227], v38 offset:28672
    ds_read_b64_tr_b16 a[18:19], v39 offset:28672
    s_waitcnt lgkmcnt(0)
    s_barrier
    s_add_u32 m0, s49, 45056
    s_add_u32 s57, s17, 0x0
    buffer_load_dwordx4 v2, s[8:11], s57 offen nt lds
    s_add_u32 m0, s49, 46080
    s_add_u32 s57, s17, 0x8000
    buffer_load_dwordx4 v3, s[8:11], s57 offen nt lds
    s_add_u32 m0, s49, 47104
    s_add_u32 s57, s17, 0x10000
    buffer_load_dwordx4 v2, s[8:11], s57 offen nt lds
    s_add_u32 m0, s49, 48128
    s_add_u32 s57, s17, 0x18000
    buffer_load_dwordx4 v3, s[8:11], s57 offen nt lds
    ds_write_b64 v138, v[16:17] offset:8
    ds_write_b64 v138, v[18:19] offset:2056
    s_waitcnt vmcnt(8)
    s_barrier
    ds_read_b64_tr_b16 v[16:17], v32 offset:32768
    ds_read_b64_tr_b16 v[18:19], v33 offset:32768
    ds_read_b64_tr_b16 v[196:197], v34 offset:32768
    ds_read_b64_tr_b16 v[244:245], v35 offset:32768
    ds_read_b64_tr_b16 v[212:213], v36 offset:32768
    ds_read_b64_tr_b16 a[4:5], v37 offset:32768
    ds_read_b64_tr_b16 v[228:229], v38 offset:32768
    ds_read_b64_tr_b16 a[20:21], v39 offset:32768
    s_waitcnt lgkmcnt(0)
    s_barrier
    s_add_u32 m0, s49, 49152
    s_add_u32 s57, s17, 0x4000
    buffer_load_dwordx4 v2, s[8:11], s57 offen nt lds
    s_add_u32 m0, s49, 50176
    s_add_u32 s57, s17, 0xc000
    buffer_load_dwordx4 v3, s[8:11], s57 offen nt lds
    s_add_u32 m0, s49, 51200
    s_add_u32 s57, s17, 0x14000
    buffer_load_dwordx4 v2, s[8:11], s57 offen nt lds
    s_add_u32 m0, s49, 52224
    s_add_u32 s57, s17, 0x1c000
    buffer_load_dwordx4 v3, s[8:11], s57 offen nt lds
    v_bfe_u32 v46, v0, 3, 1
    v_bfe_u32 v45, v0, 1, 1
    v_mul_u32_u24 v45, 2, v45
    v_add_u32 v46, v46, v45
    v_bfe_u32 v47, v0, 0, 1
    v_mul_u32_u24 v47, 16, v47
    v_mov_b32 v45, 0x3f80
    v_lshlrev_b32 v47, v47, v45
    v_cmp_eq_u32 vcc, 0, v46
    s_nop 1
    v_cndmask_b32 v48, 0, v47, vcc
    v_cmp_eq_u32 vcc, 1, v46
    s_nop 1
    v_cndmask_b32 v49, 0, v47, vcc
    v_cmp_eq_u32 vcc, 0, v46
    s_nop 1
    v_cndmask_b32 v50, 0, v47, vcc
    v_cmp_eq_u32 vcc, 1, v46
    s_nop 1
    v_cndmask_b32 v51, 0, v47, vcc
    v_bfe_u32 v52, v0, 2, 1
    v_mul_u32_u24 v52, 43690, v52
    v_add_u32 v52, 17476, v52
    s_mov_b32 s56, 0x3e0293ee
    s_lshr_b32 s3, s21, 3
    s_xor_b32 s57, s3, 0
    s_lshl_b32 s57, s57, 14
    s_lshl_b32 s30, s22, 16
    s_add_u32 s30, s30, s57
    s_lshl_b32 s57, s21, 8
    s_add_u32 s30, s30, s57
    s_add_u32 s30, s30, 0xe00000
    s_xor_b32 s57, s3, 1
    s_lshl_b32 s57, s57, 14
    s_lshl_b32 s31, s22, 16
    s_add_u32 s31, s31, s57
    s_lshl_b32 s57, s21, 8
    s_add_u32 s31, s31, s57
    s_add_u32 s31, s31, 0xe00000
    s_xor_b32 s57, s3, 2
    s_lshl_b32 s57, s57, 14
    s_lshl_b32 s32, s22, 16
    s_add_u32 s32, s32, s57
    s_lshl_b32 s57, s21, 8
    s_add_u32 s32, s32, s57
    s_add_u32 s32, s32, 0xe00000
    s_xor_b32 s57, s3, 3
    s_lshl_b32 s57, s57, 14
    s_lshl_b32 s33, s22, 16
    s_add_u32 s33, s33, s57
    s_lshl_b32 s57, s21, 8
    s_add_u32 s33, s33, s57
    s_add_u32 s33, s33, 0xe00000
    s_bfe_u32 s3, s21, 0x20001
    s_xor_b32 s57, s3, 0
    s_lshl_b32 s57, s57, 11
    s_lshl_b32 s38, s21, 13
    s_add_u32 s38, s38, s57
    s_add_u32 s38, s38, 0xe00000
    s_xor_b32 s57, s3, 1
    s_lshl_b32 s57, s57, 11
    s_lshl_b32 s39, s21, 13
    s_add_u32 s39, s39, s57
    s_add_u32 s39, s39, 0xe00000
    s_xor_b32 s57, s3, 2
    s_lshl_b32 s57, s57, 11
    s_lshl_b32 s40, s21, 13
    s_add_u32 s40, s40, s57
    s_add_u32 s40, s40, 0xe00000
    s_xor_b32 s57, s3, 3
    s_lshl_b32 s57, s57, 11
    s_lshl_b32 s41, s21, 13
    s_add_u32 s41, s41, s57
    s_add_u32 s41, s41, 0xe00000
    s_lshl_b32 s3, s21, 2
    s_add_u32 s47, s3, 0x8f800
    s_mov_b32 s42, 0x01010101
    s_mov_b32 s43, 0x01010101
    s_and_b32 s3, s21, 7
    s_lshl_b32 s3, s3, 7
    s_add_u32 s53, s3, 0x8f800
    s_lshl_b32 s51, s21, 8
    s_add_u32 s51, s51, 0x90000
    s_add_u32 s26, s54, 0x100000
    s_add_u32 s27, s55, 0x100000
    s_mov_b32 s50, 0x4000000
    s_mov_b32 s29, 0x82000
    s_mov_b32 s25, 0
    s_mov_b32 s52, 0
    v_lshrrev_b32 v46, 2, v133
    v_min_u32 v46, 4, v46
    v_lshlrev_b32 v47, 3, v133
    ds_write_b64 v138, v[16:17] offset:1024
    ds_write_b64 v138, v[18:19] offset:3072
    s_waitcnt vmcnt(8)
    s_barrier
    ds_read_b64_tr_b16 v[16:17], v4 offset:0
    ds_read_b64_tr_b16 v[18:19], v5 offset:0
    ds_read_b64_tr_b16 v[198:199], v6 offset:0
    ds_read_b64_tr_b16 v[246:247], v7 offset:0
    ds_read_b64_tr_b16 v[214:215], v8 offset:0
    ds_read_b64_tr_b16 a[6:7], v9 offset:0
    ds_read_b64_tr_b16 v[230:231], v10 offset:0
    ds_read_b64_tr_b16 a[22:23], v11 offset:0
    s_waitcnt lgkmcnt(0)
    s_barrier
    s_add_u32 m0, s18, 0
    s_add_u32 s57, s17, 0x40000
    buffer_load_dwordx4 v2, s[8:11], s57 offen nt lds
    s_add_u32 m0, s18, 1024
    s_add_u32 s57, s17, 0x48000
    buffer_load_dwordx4 v3, s[8:11], s57 offen nt lds
    s_add_u32 m0, s18, 2048
    s_add_u32 s57, s17, 0x50000
    buffer_load_dwordx4 v2, s[8:11], s57 offen nt lds
    s_add_u32 m0, s18, 3072
    s_add_u32 s57, s17, 0x58000
    buffer_load_dwordx4 v3, s[8:11], s57 offen nt lds
    ds_write_b64 v138, v[16:17] offset:1032
    ds_write_b64 v138, v[18:19] offset:3080
    s_waitcnt vmcnt(8)
    s_barrier
    ds_read_b64_tr_b16 v[16:17], v32 offset:28672
    ds_read_b64_tr_b16 v[18:19], v33 offset:28672
    ds_read_b64_tr_b16 v[200:201], v34 offset:28672
    ds_read_b64_tr_b16 v[248:249], v35 offset:28672
    ds_read_b64_tr_b16 v[216:217], v36 offset:28672
    ds_read_b64_tr_b16 a[8:9], v37 offset:28672
    ds_read_b64_tr_b16 v[232:233], v38 offset:28672
    ds_read_b64_tr_b16 v[20:21], v39 offset:28672
    s_waitcnt lgkmcnt(0)
    s_barrier
    s_add_u32 m0, s49, 45056
    s_add_u32 s57, s17, 0x44000
    buffer_load_dwordx4 v2, s[8:11], s57 offen nt lds
    s_add_u32 m0, s49, 46080
    s_add_u32 s57, s17, 0x4c000
    buffer_load_dwordx4 v3, s[8:11], s57 offen nt lds
    s_add_u32 m0, s49, 47104
    s_add_u32 s57, s17, 0x54000
    buffer_load_dwordx4 v2, s[8:11], s57 offen nt lds
    s_add_u32 m0, s49, 48128
    s_add_u32 s57, s17, 0x5c000
    buffer_load_dwordx4 v3, s[8:11], s57 offen nt lds
    ds_write_b64 v138, v[16:17] offset:4096
    ds_write_b64 v138, v[18:19] offset:6144
    ds_write_b64 v138, v[20:21] offset:8192
    s_waitcnt vmcnt(8)
    s_barrier
    ds_read_b64_tr_b16 v[16:17], v32 offset:32768
    ds_read_b64_tr_b16 v[18:19], v33 offset:32768
    ds_read_b64_tr_b16 v[202:203], v34 offset:32768
    ds_read_b64_tr_b16 v[250:251], v35 offset:32768
    ds_read_b64_tr_b16 v[218:219], v36 offset:32768
    ds_read_b64_tr_b16 a[10:11], v37 offset:32768
    ds_read_b64_tr_b16 v[234:235], v38 offset:32768
    ds_read_b64_tr_b16 v[20:21], v39 offset:32768
    s_waitcnt lgkmcnt(0)
    s_barrier
    s_mov_b32 s8, s74
    s_mov_b32 s9, s75
    s_mov_b32 s10, 0x400000
    s_mov_b32 s11, 0x20000
    s_xor_b32 s3, s22, 0
    s_lshl_b32 s3, s3, 15
    s_lshl_b32 s48, s21, 17
    s_add_u32 s48, s48, s3
    s_lshl_b32 s3, s22, 8
    s_add_u32 s48, s48, s3
    s_add_u32 m0, s49, 49152
    s_add_u32 s57, s48, 0x0
    buffer_load_dwordx4 v44, s[8:11], s57 offen nt lds
    s_add_u32 m0, s49, 50176
    s_add_u32 s57, s48, 0x1000
    buffer_load_dwordx4 v44, s[8:11], s57 offen nt lds
    s_add_u32 m0, s49, 51200
    s_add_u32 s57, s48, 0x400
    buffer_load_dwordx4 v44, s[8:11], s57 offen nt lds
    s_add_u32 m0, s49, 52224
    s_add_u32 s57, s48, 0x1400
    buffer_load_dwordx4 v44, s[8:11], s57 offen nt lds
    ds_write_b64 v138, v[16:17] offset:4104
    ds_write_b64 v138, v[18:19] offset:6152
    ds_write_b64 v138, v[20:21] offset:8200
    s_waitcnt vmcnt(8)
    s_barrier
    ds_read_b64_tr_b16 v[16:17], v4 offset:0
    ds_read_b64_tr_b16 v[18:19], v5 offset:0
    ds_read_b64_tr_b16 v[204:205], v6 offset:0
    ds_read_b64_tr_b16 v[252:253], v7 offset:0
    ds_read_b64_tr_b16 v[220:221], v8 offset:0
    ds_read_b64_tr_b16 a[12:13], v9 offset:0
    ds_read_b64_tr_b16 v[236:237], v10 offset:0
    ds_read_b64_tr_b16 v[20:21], v11 offset:0
    s_waitcnt lgkmcnt(0)
    s_barrier
    s_add_u32 m0, s18, 0
    s_add_u32 s57, s48, 0x2000
    buffer_load_dwordx4 v44, s[8:11], s57 offen nt lds
    s_add_u32 m0, s18, 1024
    s_add_u32 s57, s48, 0x3000
    buffer_load_dwordx4 v44, s[8:11], s57 offen nt lds
    s_add_u32 m0, s18, 2048
    s_add_u32 s57, s48, 0x2400
    buffer_load_dwordx4 v44, s[8:11], s57 offen nt lds
    s_add_u32 m0, s18, 3072
    s_add_u32 s57, s48, 0x3400
    buffer_load_dwordx4 v44, s[8:11], s57 offen nt lds
    ds_write_b64 v138, v[16:17] offset:5120
    ds_write_b64 v138, v[18:19] offset:7168
    ds_write_b64 v138, v[20:21] offset:9216
    s_waitcnt vmcnt(8)
    s_barrier
    ds_read_b64_tr_b16 v[16:17], v32 offset:28672
    ds_read_b64_tr_b16 v[18:19], v33 offset:28672
    ds_read_b64_tr_b16 v[206:207], v34 offset:28672
    ds_read_b64_tr_b16 v[254:255], v35 offset:28672
    ds_read_b64_tr_b16 v[222:223], v36 offset:28672
    ds_read_b64_tr_b16 a[14:15], v37 offset:28672
    ds_read_b64_tr_b16 v[238:239], v38 offset:28672
    ds_read_b64_tr_b16 v[20:21], v39 offset:28672
    s_waitcnt lgkmcnt(0)
    s_barrier
    s_xor_b32 s3, s22, 1
    s_lshl_b32 s3, s3, 15
    s_lshl_b32 s48, s21, 17
    s_add_u32 s48, s48, s3
    s_lshl_b32 s3, s22, 8
    s_add_u32 s48, s48, s3
    s_add_u32 m0, s49, 45056
    s_add_u32 s57, s48, 0x0
    buffer_load_dwordx4 v44, s[8:11], s57 offen nt lds
    s_add_u32 m0, s49, 46080
    s_add_u32 s57, s48, 0x1000
    buffer_load_dwordx4 v44, s[8:11], s57 offen nt lds
    s_add_u32 m0, s49, 47104
    s_add_u32 s57, s48, 0x400
    buffer_load_dwordx4 v44, s[8:11], s57 offen nt lds
    s_add_u32 m0, s49, 48128
    s_add_u32 s57, s48, 0x1400
    buffer_load_dwordx4 v44, s[8:11], s57 offen nt lds
    ds_write_b64 v138, v[16:17] offset:5128
    ds_write_b64 v138, v[18:19] offset:7176
    ds_write_b64 v138, v[20:21] offset:9224
    s_waitcnt vmcnt(8)
    s_barrier
    ds_read_b64_tr_b16 v[16:17], v40 offset:32768
    ds_read_b64_tr_b16 v[18:19], v41 offset:32768
    ds_read_b64_tr_b16 v[20:21], v42 offset:32768
    ds_read_b64_tr_b16 v[184:185], v43 offset:32768
    ds_read_b64_tr_b16 v[22:23], v40 offset:34816
    ds_read_b64_tr_b16 v[24:25], v41 offset:34816
    ds_read_b64_tr_b16 v[26:27], v42 offset:34816
    ds_read_b64_tr_b16 v[186:187], v43 offset:34816
    s_waitcnt lgkmcnt(0)
    s_barrier
    s_add_u32 m0, s49, 49152
    s_add_u32 s57, s48, 0x2000
    buffer_load_dwordx4 v44, s[8:11], s57 offen nt lds
    s_add_u32 m0, s49, 50176
    s_add_u32 s57, s48, 0x3000
    buffer_load_dwordx4 v44, s[8:11], s57 offen nt lds
    s_add_u32 m0, s49, 51200
    s_add_u32 s57, s48, 0x2400
    buffer_load_dwordx4 v44, s[8:11], s57 offen nt lds
    s_add_u32 m0, s49, 52224
    s_add_u32 s57, s48, 0x3400
    buffer_load_dwordx4 v44, s[8:11], s57 offen nt lds
    ds_write_b64 v138, v[16:17] offset:16384
    ds_write_b64 v138, v[18:19] offset:18432
    ds_write_b64 v138, v[20:21] offset:20480
    ds_write_b64 v138, v[22:23] offset:16392
    ds_write_b64 v138, v[24:25] offset:18440
    ds_write_b64 v138, v[26:27] offset:20488
    s_waitcnt vmcnt(8)
    s_barrier
    ds_read_b64_tr_b16 v[16:17], v12 offset:0
    ds_read_b64_tr_b16 v[18:19], v13 offset:0
    ds_read_b64_tr_b16 v[20:21], v14 offset:0
    ds_read_b64_tr_b16 v[188:189], v15 offset:0
    ds_read_b64_tr_b16 v[22:23], v12 offset:2048
    ds_read_b64_tr_b16 v[24:25], v13 offset:2048
    ds_read_b64_tr_b16 v[26:27], v14 offset:2048
    ds_read_b64_tr_b16 v[190:191], v15 offset:2048
    s_waitcnt lgkmcnt(0)
    s_barrier
    s_xor_b32 s3, s22, 2
    s_lshl_b32 s3, s3, 15
    s_lshl_b32 s48, s21, 17
    s_add_u32 s48, s48, s3
    s_lshl_b32 s3, s22, 8
    s_add_u32 s48, s48, s3
    s_add_u32 m0, s18, 0
    s_add_u32 s57, s48, 0x0
    buffer_load_dwordx4 v44, s[8:11], s57 offen nt lds
    s_add_u32 m0, s18, 1024
    s_add_u32 s57, s48, 0x1000
    buffer_load_dwordx4 v44, s[8:11], s57 offen nt lds
    s_add_u32 m0, s18, 2048
    s_add_u32 s57, s48, 0x400
    buffer_load_dwordx4 v44, s[8:11], s57 offen nt lds
    s_add_u32 m0, s18, 3072
    s_add_u32 s57, s48, 0x1400
    buffer_load_dwordx4 v44, s[8:11], s57 offen nt lds
    ds_write_b64 v138, v[16:17] offset:17408
    ds_write_b64 v138, v[18:19] offset:19456
    ds_write_b64 v138, v[20:21] offset:21504
    ds_write_b64 v138, v[22:23] offset:17416
    ds_write_b64 v138, v[24:25] offset:19464
    ds_write_b64 v138, v[26:27] offset:21512
    s_waitcnt vmcnt(8)
    s_barrier
    ds_read_b64_tr_b16 v[144:145], v40 offset:28672
    ds_read_b64_tr_b16 v[16:17], v41 offset:28672
    ds_read_b64_tr_b16 v[18:19], v42 offset:28672
    ds_read_b64_tr_b16 v[64:65], v43 offset:28672
    ds_read_b64_tr_b16 v[146:147], v40 offset:30720
    ds_read_b64_tr_b16 v[20:21], v41 offset:30720
    ds_read_b64_tr_b16 v[22:23], v42 offset:30720
    ds_read_b64_tr_b16 v[66:67], v43 offset:30720
    s_waitcnt lgkmcnt(0)
    s_barrier
    s_add_u32 m0, s49, 45056
    s_add_u32 s57, s48, 0x2000
    buffer_load_dwordx4 v44, s[8:11], s57 offen nt lds
    s_add_u32 m0, s49, 46080
    s_add_u32 s57, s48, 0x3000
    buffer_load_dwordx4 v44, s[8:11], s57 offen nt lds
    s_add_u32 m0, s49, 47104
    s_add_u32 s57, s48, 0x2400
    buffer_load_dwordx4 v44, s[8:11], s57 offen nt lds
    s_add_u32 m0, s49, 48128
    s_add_u32 s57, s48, 0x3400
    buffer_load_dwordx4 v44, s[8:11], s57 offen nt lds
    ds_write_b64 v138, v[16:17] offset:22528
    ds_write_b64 v138, v[18:19] offset:26624
    ds_write_b64 v138, v[20:21] offset:22536
    ds_write_b64 v138, v[22:23] offset:26632
    s_waitcnt vmcnt(8)
    s_barrier
    ds_read_b64_tr_b16 v[148:149], v40 offset:32768
    ds_read_b64_tr_b16 v[16:17], v41 offset:32768
    ds_read_b64_tr_b16 v[18:19], v42 offset:32768
    ds_read_b64_tr_b16 v[68:69], v43 offset:32768
    ds_read_b64_tr_b16 v[150:151], v40 offset:34816
    ds_read_b64_tr_b16 v[20:21], v41 offset:34816
    ds_read_b64_tr_b16 v[22:23], v42 offset:34816
    ds_read_b64_tr_b16 v[70:71], v43 offset:34816
    s_waitcnt lgkmcnt(0)
    s_barrier
    s_xor_b32 s3, s22, 3
    s_lshl_b32 s3, s3, 15
    s_lshl_b32 s48, s21, 17
    s_add_u32 s48, s48, s3
    s_lshl_b32 s3, s22, 8
    s_add_u32 s48, s48, s3
    s_add_u32 m0, s49, 49152
    s_add_u32 s57, s48, 0x0
    buffer_load_dwordx4 v44, s[8:11], s57 offen nt lds
    s_add_u32 m0, s49, 50176
    s_add_u32 s57, s48, 0x1000
    buffer_load_dwordx4 v44, s[8:11], s57 offen nt lds
    s_add_u32 m0, s49, 51200
    s_add_u32 s57, s48, 0x400
    buffer_load_dwordx4 v44, s[8:11], s57 offen nt lds
    s_add_u32 m0, s49, 52224
    s_add_u32 s57, s48, 0x1400
    buffer_load_dwordx4 v44, s[8:11], s57 offen nt lds
    buffer_load_dword v53, v129, s[12:15], 0 offen offset:192 sc1
    buffer_load_dwordx2 v[54:55], v129, s[12:15], 0 offen offset:0 sc1
    ds_write_b64 v138, v[16:17] offset:23552
    ds_write_b64 v138, v[18:19] offset:27648
    ds_write_b64 v138, v[20:21] offset:23560
    ds_write_b64 v138, v[22:23] offset:27656
    s_waitcnt vmcnt(10)
    s_barrier
    ds_read_b64_tr_b16 v[152:153], v12 offset:0
    ds_read_b64_tr_b16 v[16:17], v13 offset:0
    ds_read_b64_tr_b16 v[176:177], v14 offset:0
    ds_read_b64_tr_b16 v[72:73], v15 offset:0
    ds_read_b64_tr_b16 v[154:155], v12 offset:2048
    ds_read_b64_tr_b16 v[18:19], v13 offset:2048
    ds_read_b64_tr_b16 v[178:179], v14 offset:2048
    ds_read_b64_tr_b16 v[74:75], v15 offset:2048
    s_waitcnt lgkmcnt(0)
    s_barrier
    s_add_u32 m0, s18, 0
    s_add_u32 s57, s48, 0x2000
    buffer_load_dwordx4 v44, s[8:11], s57 offen nt lds
    s_add_u32 m0, s18, 1024
    s_add_u32 s57, s48, 0x3000
    buffer_load_dwordx4 v44, s[8:11], s57 offen nt lds
    s_add_u32 m0, s18, 2048
    s_add_u32 s57, s48, 0x2400
    buffer_load_dwordx4 v44, s[8:11], s57 offen nt lds
    s_add_u32 m0, s18, 3072
    s_add_u32 s57, s48, 0x3400
    buffer_load_dwordx4 v44, s[8:11], s57 offen nt lds
    ds_write_b64 v138, v[16:17] offset:24576
    ds_write_b64 v138, v[18:19] offset:24584
    s_waitcnt vmcnt(10)
    s_barrier
    ds_read_b64_tr_b16 v[156:157], v40 offset:28672
    ds_read_b64_tr_b16 v[16:17], v41 offset:28672
    ds_read_b64_tr_b16 v[180:181], v42 offset:28672
    ds_read_b64_tr_b16 v[76:77], v43 offset:28672
    ds_read_b64_tr_b16 v[158:159], v40 offset:30720
    ds_read_b64_tr_b16 v[18:19], v41 offset:30720
    ds_read_b64_tr_b16 v[182:183], v42 offset:30720
    ds_read_b64_tr_b16 v[78:79], v43 offset:30720
    s_waitcnt lgkmcnt(0)
    s_barrier
    s_mov_b32 s8, s70
    s_mov_b32 s9, s71
    s_mov_b32 s10, 0x400000
    s_mov_b32 s11, 0x20000
    s_add_u32 m0, s49, 45056
    s_add_u32 s57, s16, 0x0
    buffer_load_dwordx4 v2, s[8:11], s57 offen nt lds
    s_add_u32 m0, s49, 46080
    s_add_u32 s57, s16, 0x8000
    buffer_load_dwordx4 v3, s[8:11], s57 offen nt lds
    s_add_u32 m0, s49, 47104
    s_add_u32 s57, s16, 0x10000
    buffer_load_dwordx4 v2, s[8:11], s57 offen nt lds
    s_add_u32 m0, s49, 48128
    s_add_u32 s57, s16, 0x18000
    buffer_load_dwordx4 v3, s[8:11], s57 offen nt lds
    ds_write_b64 v138, v[16:17] offset:25600
    ds_write_b64 v138, v[18:19] offset:25608
    s_waitcnt vmcnt(10)
    s_barrier
    ds_read_b64_tr_b16 v[160:161], v40 offset:32768
    ds_read_b64_tr_b16 v[168:169], v41 offset:32768
    ds_read_b64_tr_b16 v[56:57], v42 offset:32768
    ds_read_b64_tr_b16 v[80:81], v43 offset:32768
    ds_read_b64_tr_b16 v[162:163], v40 offset:34816
    ds_read_b64_tr_b16 v[170:171], v41 offset:34816
    ds_read_b64_tr_b16 v[58:59], v42 offset:34816
    ds_read_b64_tr_b16 v[82:83], v43 offset:34816
    s_waitcnt lgkmcnt(0)
    s_barrier
    s_add_u32 m0, s49, 49152
    s_add_u32 s57, s16, 0x4000
    buffer_load_dwordx4 v2, s[8:11], s57 offen nt lds
    s_add_u32 m0, s49, 50176
    s_add_u32 s57, s16, 0xc000
    buffer_load_dwordx4 v3, s[8:11], s57 offen nt lds
    s_add_u32 m0, s49, 51200
    s_add_u32 s57, s16, 0x14000
    buffer_load_dwordx4 v2, s[8:11], s57 offen nt lds
    s_add_u32 m0, s49, 52224
    s_add_u32 s57, s16, 0x1c000
    buffer_load_dwordx4 v3, s[8:11], s57 offen nt lds
    s_waitcnt vmcnt(8)
    s_barrier
    ds_read_b64_tr_b16 v[164:165], v12 offset:0
    ds_read_b64_tr_b16 v[172:173], v13 offset:0
    ds_read_b64_tr_b16 v[60:61], v14 offset:0
    ds_read_b64_tr_b16 v[84:85], v15 offset:0
    ds_read_b64_tr_b16 v[166:167], v12 offset:2048
    ds_read_b64_tr_b16 v[174:175], v13 offset:2048
    ds_read_b64_tr_b16 v[62:63], v14 offset:2048
    ds_read_b64_tr_b16 v[86:87], v15 offset:2048
    v_cmp_gt_u32 vcc, 128, v53
    s_nop 0
    s_mov_b32 s19, vcc_lo
    v_cmp_ne_u32 vcc, -1, v54
    s_nop 0
    s_or_b32 s19, s19, vcc_lo
    s_waitcnt lgkmcnt(0)
    s_barrier
    s_add_u32 m0, s18, 0
    s_add_u32 s57, s16, 0x40000
    buffer_load_dwordx4 v2, s[8:11], s57 offen nt lds
    s_add_u32 m0, s18, 1024
    s_add_u32 s57, s16, 0x48000
    buffer_load_dwordx4 v3, s[8:11], s57 offen nt lds
    s_add_u32 m0, s18, 2048
    s_add_u32 s57, s16, 0x50000
    buffer_load_dwordx4 v2, s[8:11], s57 offen nt lds
    s_add_u32 m0, s18, 3072
    s_add_u32 s57, s16, 0x58000
    buffer_load_dwordx4 v3, s[8:11], s57 offen nt lds
    s_waitcnt vmcnt(8)
    s_barrier
    ds_read_b64_tr_b16 a[24:25], v32 offset:28672
    ds_read_b64_tr_b16 a[64:65], v33 offset:28672
    ds_read_b64_tr_b16 a[40:41], v34 offset:28672
    ds_read_b64_tr_b16 a[80:81], v35 offset:28672
    ds_read_b64_tr_b16 a[48:49], v36 offset:28672
    ds_read_b64_tr_b16 a[96:97], v37 offset:28672
    ds_read_b64_tr_b16 a[56:57], v38 offset:28672
    ds_read_b64_tr_b16 a[112:113], v39 offset:28672
    s_waitcnt lgkmcnt(0)
    s_barrier
    s_add_u32 m0, s49, 45056
    s_add_u32 s57, s16, 0x44000
    buffer_load_dwordx4 v2, s[8:11], s57 offen nt lds
    s_add_u32 m0, s49, 46080
    s_add_u32 s57, s16, 0x4c000
    buffer_load_dwordx4 v3, s[8:11], s57 offen nt lds
    s_add_u32 m0, s49, 47104
    s_add_u32 s57, s16, 0x54000
    buffer_load_dwordx4 v2, s[8:11], s57 offen nt lds
    s_add_u32 m0, s49, 48128
    s_add_u32 s57, s16, 0x5c000
    buffer_load_dwordx4 v3, s[8:11], s57 offen nt lds
    s_waitcnt vmcnt(8)
    s_barrier
    ds_read_b64_tr_b16 a[26:27], v32 offset:32768
    ds_read_b64_tr_b16 a[66:67], v33 offset:32768
    ds_read_b64_tr_b16 a[42:43], v34 offset:32768
    ds_read_b64_tr_b16 a[82:83], v35 offset:32768
    ds_read_b64_tr_b16 a[50:51], v36 offset:32768
    ds_read_b64_tr_b16 a[98:99], v37 offset:32768
    ds_read_b64_tr_b16 a[58:59], v38 offset:32768
    ds_read_b64_tr_b16 a[114:115], v39 offset:32768
    s_waitcnt lgkmcnt(0)
    s_barrier
    s_add_u32 m0, s49, 49152
    s_add_u32 s57, s17, 0x0
    buffer_load_dwordx4 v2, s[8:11], s57 offen nt lds
    s_add_u32 m0, s49, 50176
    s_add_u32 s57, s17, 0x8000
    buffer_load_dwordx4 v3, s[8:11], s57 offen nt lds
    s_add_u32 m0, s49, 51200
    s_add_u32 s57, s17, 0x10000
    buffer_load_dwordx4 v2, s[8:11], s57 offen nt lds
    s_add_u32 m0, s49, 52224
    s_add_u32 s57, s17, 0x18000
    buffer_load_dwordx4 v3, s[8:11], s57 offen nt lds
    s_getpc_b64 s[98:99]
L_pc_5:
    s_add_u32 s98, s98, L_team_code-L_pc_5
    s_addc_u32 s99, s99, 0
    v_lshlrev_b32 v104, 7, v0
    v_add_u32 v104, 0, v104
    v_min_u32 v104, L_team_fast_end-L_team_code-4, v104
    v_mov_b32 v105, s99
    v_add_co_u32 v104, vcc, s98, v104
    s_nop 1
    v_addc_co_u32 v105, vcc, 0, v105, vcc
    global_load_dword v134, v[104:105], off
    s_waitcnt vmcnt(9)
    s_barrier
    ds_read_b64_tr_b16 a[28:29], v4 offset:0
    ds_read_b64_tr_b16 a[68:69], v5 offset:0
    ds_read_b64_tr_b16 a[44:45], v6 offset:0
    ds_read_b64_tr_b16 a[84:85], v7 offset:0
    ds_read_b64_tr_b16 a[52:53], v8 offset:0
    ds_read_b64_tr_b16 a[100:101], v9 offset:0
    ds_read_b64_tr_b16 a[60:61], v10 offset:0
    ds_read_b64_tr_b16 a[116:117], v11 offset:0
    s_waitcnt lgkmcnt(0)
    s_barrier
    s_add_u32 m0, s18, 0
    s_add_u32 s57, s17, 0x4000
    buffer_load_dwordx4 v2, s[8:11], s57 offen nt lds
    s_add_u32 m0, s18, 1024
    s_add_u32 s57, s17, 0xc000
    buffer_load_dwordx4 v3, s[8:11], s57 offen nt lds
    s_add_u32 m0, s18, 2048
    s_add_u32 s57, s17, 0x14000
    buffer_load_dwordx4 v2, s[8:11], s57 offen nt lds
    s_add_u32 m0, s18, 3072
    s_add_u32 s57, s17, 0x1c000
    buffer_load_dwordx4 v3, s[8:11], s57 offen nt lds
    s_waitcnt vmcnt(9)
    s_barrier
    ds_read_b64_tr_b16 a[30:31], v32 offset:28672
    ds_read_b64_tr_b16 a[70:71], v33 offset:28672
    ds_read_b64_tr_b16 a[46:47], v34 offset:28672
    ds_read_b64_tr_b16 a[86:87], v35 offset:28672
    ds_read_b64_tr_b16 a[54:55], v36 offset:28672
    ds_read_b64_tr_b16 a[102:103], v37 offset:28672
    ds_read_b64_tr_b16 a[62:63], v38 offset:28672
    ds_read_b64_tr_b16 a[118:119], v39 offset:28672
    s_waitcnt lgkmcnt(0)
    s_barrier
    s_add_u32 m0, s49, 45056
    s_add_u32 s57, s17, 0x40000
    buffer_load_dwordx4 v2, s[8:11], s57 offen nt lds
    s_add_u32 m0, s49, 46080
    s_add_u32 s57, s17, 0x48000
    buffer_load_dwordx4 v3, s[8:11], s57 offen nt lds
    s_add_u32 m0, s49, 47104
    s_add_u32 s57, s17, 0x50000
    buffer_load_dwordx4 v2, s[8:11], s57 offen nt lds
    s_add_u32 m0, s49, 48128
    s_add_u32 s57, s17, 0x58000
    buffer_load_dwordx4 v3, s[8:11], s57 offen nt lds
    s_waitcnt vmcnt(9)
    s_barrier
    ds_read_b64_tr_b16 a[32:33], v32 offset:32768
    ds_read_b64_tr_b16 a[72:73], v33 offset:32768
    ds_read_b64_tr_b16 v[16:17], v34 offset:32768
    ds_read_b64_tr_b16 a[88:89], v35 offset:32768
    ds_read_b64_tr_b16 v[18:19], v36 offset:32768
    ds_read_b64_tr_b16 a[104:105], v37 offset:32768
    ds_read_b64_tr_b16 v[20:21], v38 offset:32768
    ds_read_b64_tr_b16 a[120:121], v39 offset:32768
    s_waitcnt lgkmcnt(0)
    s_barrier
    s_add_u32 m0, s49, 49152
    s_add_u32 s57, s17, 0x44000
    buffer_load_dwordx4 v2, s[8:11], s57 offen nt lds
    s_add_u32 m0, s49, 50176
    s_add_u32 s57, s17, 0x4c000
    buffer_load_dwordx4 v3, s[8:11], s57 offen nt lds
    s_add_u32 m0, s49, 51200
    s_add_u32 s57, s17, 0x54000
    buffer_load_dwordx4 v2, s[8:11], s57 offen nt lds
    s_add_u32 m0, s49, 52224
    s_add_u32 s57, s17, 0x5c000
    buffer_load_dwordx4 v3, s[8:11], s57 offen nt lds
    ds_write_b64 v138, v[16:17] offset:10240
    ds_write_b64 v138, v[18:19] offset:12288
    ds_write_b64 v138, v[20:21] offset:14336
    s_waitcnt vmcnt(8)
    s_barrier
    ds_read_b64_tr_b16 a[34:35], v4 offset:0
    ds_read_b64_tr_b16 a[74:75], v5 offset:0
    ds_read_b64_tr_b16 v[16:17], v6 offset:0
    ds_read_b64_tr_b16 a[90:91], v7 offset:0
    ds_read_b64_tr_b16 v[18:19], v8 offset:0
    ds_read_b64_tr_b16 a[106:107], v9 offset:0
    ds_read_b64_tr_b16 v[20:21], v10 offset:0
    ds_read_b64_tr_b16 a[122:123], v11 offset:0
    s_waitcnt lgkmcnt(0)
    s_barrier
    s_mov_b32 s8, s72
    s_mov_b32 s9, s73
    s_mov_b32 s10, 0x400000
    s_mov_b32 s11, 0x20000
    s_add_u32 m0, s18, 0
    s_add_u32 s57, s16, 0x0
    buffer_load_dwordx4 v2, s[8:11], s57 offen nt lds
    s_add_u32 m0, s18, 1024
    s_add_u32 s57, s16, 0x8000
    buffer_load_dwordx4 v3, s[8:11], s57 offen nt lds
    s_add_u32 m0, s18, 2048
    s_add_u32 s57, s16, 0x10000
    buffer_load_dwordx4 v2, s[8:11], s57 offen nt lds
    s_add_u32 m0, s18, 3072
    s_add_u32 s57, s16, 0x18000
    buffer_load_dwordx4 v3, s[8:11], s57 offen nt lds
    ds_write_b64 v138, v[16:17] offset:10248
    ds_write_b64 v138, v[18:19] offset:12296
    ds_write_b64 v138, v[20:21] offset:14344
    s_waitcnt vmcnt(8)
    s_barrier
    ds_read_b64_tr_b16 a[36:37], v32 offset:28672
    ds_read_b64_tr_b16 a[76:77], v33 offset:28672
    ds_read_b64_tr_b16 v[16:17], v34 offset:28672
    ds_read_b64_tr_b16 a[92:93], v35 offset:28672
    ds_read_b64_tr_b16 v[18:19], v36 offset:28672
    ds_read_b64_tr_b16 a[108:109], v37 offset:28672
    ds_read_b64_tr_b16 v[20:21], v38 offset:28672
    ds_read_b64_tr_b16 a[124:125], v39 offset:28672
    s_waitcnt lgkmcnt(0)
    s_barrier
    s_add_u32 m0, s49, 45056
    s_add_u32 s57, s16, 0x4000
    buffer_load_dwordx4 v2, s[8:11], s57 offen nt lds
    s_add_u32 m0, s49, 46080
    s_add_u32 s57, s16, 0xc000
    buffer_load_dwordx4 v3, s[8:11], s57 offen nt lds
    s_add_u32 m0, s49, 47104
    s_add_u32 s57, s16, 0x14000
    buffer_load_dwordx4 v2, s[8:11], s57 offen nt lds
    s_add_u32 m0, s49, 48128
    s_add_u32 s57, s16, 0x1c000
    buffer_load_dwordx4 v3, s[8:11], s57 offen nt lds
    ds_write_b64 v138, v[16:17] offset:11264
    ds_write_b64 v138, v[18:19] offset:13312
    ds_write_b64 v138, v[20:21] offset:15360
    s_waitcnt vmcnt(8)
    s_barrier
    ds_read_b64_tr_b16 a[38:39], v32 offset:32768
    ds_read_b64_tr_b16 a[78:79], v33 offset:32768
    ds_read_b64_tr_b16 v[16:17], v34 offset:32768
    ds_read_b64_tr_b16 a[94:95], v35 offset:32768
    ds_read_b64_tr_b16 v[18:19], v36 offset:32768
    ds_read_b64_tr_b16 a[110:111], v37 offset:32768
    ds_read_b64_tr_b16 v[20:21], v38 offset:32768
    ds_read_b64_tr_b16 a[126:127], v39 offset:32768
    s_waitcnt lgkmcnt(0)
    s_barrier
    s_add_u32 m0, s49, 49152
    s_add_u32 s57, s16, 0x40000
    buffer_load_dwordx4 v2, s[8:11], s57 offen nt lds
    s_add_u32 m0, s49, 50176
    s_add_u32 s57, s16, 0x48000
    buffer_load_dwordx4 v3, s[8:11], s57 offen nt lds
    s_add_u32 m0, s49, 51200
    s_add_u32 s57, s16, 0x50000
    buffer_load_dwordx4 v2, s[8:11], s57 offen nt lds
    s_add_u32 m0, s49, 52224
    s_add_u32 s57, s16, 0x58000
    buffer_load_dwordx4 v3, s[8:11], s57 offen nt lds
    s_lshl_b32 s3, s22, 13
    s_add_u32 s3, s3, 0x80000
    s_lshl_b32 s57, s21, 13
    s_add_u32 s57, s57, 0xe00000
    s_cmp_eq_u32 s22, 0
    s_cselect_b32 s57, s57, 0x8e000
    s_cmp_eq_u32 s22, 1
    s_cselect_b32 s57, 0x100000, s57
    s_cmp_eq_u32 s19, 0
    s_cselect_b32 s3, s3, s50
    s_cselect_b32 s57, s57, s50
    buffer_load_dword v132, v47, s[4:7], s3 offen sc1
    buffer_load_dword v130, v47, s[4:7], s57 offen sc1
    ds_write_b64 v138, v[16:17] offset:11272
    ds_write_b64 v138, v[18:19] offset:13320
    ds_write_b64 v138, v[20:21] offset:15368
    s_waitcnt vmcnt(10)
    s_barrier
    ds_read_b64_tr_b16 a[128:129], v4 offset:0
    ds_read_b64_tr_b16 a[192:193], v5 offset:0
    ds_read_b64_tr_b16 a[144:145], v6 offset:0
    ds_read_b64_tr_b16 a[208:209], v7 offset:0
    ds_read_b64_tr_b16 a[160:161], v8 offset:0
    ds_read_b64_tr_b16 a[224:225], v9 offset:0
    ds_read_b64_tr_b16 a[176:177], v10 offset:0
    ds_read_b64_tr_b16 a[240:241], v11 offset:0
    s_waitcnt lgkmcnt(0)
    s_barrier
    s_add_u32 m0, s18, 0
    s_add_u32 s57, s16, 0x44000
    buffer_load_dwordx4 v2, s[8:11], s57 offen nt lds
    s_add_u32 m0, s18, 1024
    s_add_u32 s57, s16, 0x4c000
    buffer_load_dwordx4 v3, s[8:11], s57 offen nt lds
    s_add_u32 m0, s18, 2048
    s_add_u32 s57, s16, 0x54000
    buffer_load_dwordx4 v2, s[8:11], s57 offen nt lds
    s_add_u32 m0, s18, 3072
    s_add_u32 s57, s16, 0x5c000
    buffer_load_dwordx4 v3, s[8:11], s57 offen nt lds
    s_waitcnt vmcnt(10)
    s_barrier
    ds_read_b64_tr_b16 a[130:131], v32 offset:28672
    ds_read_b64_tr_b16 a[194:195], v33 offset:28672
    ds_read_b64_tr_b16 a[146:147], v34 offset:28672
    ds_read_b64_tr_b16 a[210:211], v35 offset:28672
    ds_read_b64_tr_b16 a[162:163], v36 offset:28672
    ds_read_b64_tr_b16 a[226:227], v37 offset:28672
    ds_read_b64_tr_b16 a[178:179], v38 offset:28672
    ds_read_b64_tr_b16 a[242:243], v39 offset:28672
    s_waitcnt lgkmcnt(0)
    s_barrier
    s_add_u32 m0, s49, 45056
    s_add_u32 s57, s17, 0x0
    buffer_load_dwordx4 v2, s[8:11], s57 offen nt lds
    s_add_u32 m0, s49, 46080
    s_add_u32 s57, s17, 0x8000
    buffer_load_dwordx4 v3, s[8:11], s57 offen nt lds
    s_add_u32 m0, s49, 47104
    s_add_u32 s57, s17, 0x10000
    buffer_load_dwordx4 v2, s[8:11], s57 offen nt lds
    s_add_u32 m0, s49, 48128
    s_add_u32 s57, s17, 0x18000
    buffer_load_dwordx4 v3, s[8:11], s57 offen nt lds
    s_waitcnt vmcnt(10)
    s_barrier
    ds_read_b64_tr_b16 a[132:133], v32 offset:32768
    ds_read_b64_tr_b16 a[196:197], v33 offset:32768
    ds_read_b64_tr_b16 a[148:149], v34 offset:32768
    ds_read_b64_tr_b16 a[212:213], v35 offset:32768
    ds_read_b64_tr_b16 a[164:165], v36 offset:32768
    ds_read_b64_tr_b16 a[228:229], v37 offset:32768
    ds_read_b64_tr_b16 a[180:181], v38 offset:32768
    ds_read_b64_tr_b16 a[244:245], v39 offset:32768
    s_waitcnt lgkmcnt(0)
    s_barrier
    s_add_u32 m0, s49, 49152
    s_add_u32 s57, s17, 0x4000
    buffer_load_dwordx4 v2, s[8:11], s57 offen nt lds
    s_add_u32 m0, s49, 50176
    s_add_u32 s57, s17, 0xc000
    buffer_load_dwordx4 v3, s[8:11], s57 offen nt lds
    s_add_u32 m0, s49, 51200
    s_add_u32 s57, s17, 0x14000
    buffer_load_dwordx4 v2, s[8:11], s57 offen nt lds
    s_add_u32 m0, s49, 52224
    s_add_u32 s57, s17, 0x1c000
    buffer_load_dwordx4 v3, s[8:11], s57 offen nt lds
    s_cmp_eq_u32 s19, 0
    s_cselect_b32 s3, s51, s50
    buffer_load_dword v53, v46, s[4:7], s3 offen sc1
    s_waitcnt vmcnt(9)
    s_barrier
    ds_read_b64_tr_b16 a[134:135], v4 offset:0
    ds_read_b64_tr_b16 a[198:199], v5 offset:0
    ds_read_b64_tr_b16 a[150:151], v6 offset:0
    ds_read_b64_tr_b16 a[214:215], v7 offset:0
    ds_read_b64_tr_b16 a[166:167], v8 offset:0
    ds_read_b64_tr_b16 a[230:231], v9 offset:0
    ds_read_b64_tr_b16 a[182:183], v10 offset:0
    ds_read_b64_tr_b16 a[246:247], v11 offset:0
    s_waitcnt lgkmcnt(0)
    s_barrier
    s_add_u32 m0, s18, 0
    s_add_u32 s57, s17, 0x40000
    buffer_load_dwordx4 v2, s[8:11], s57 offen nt lds
    s_add_u32 m0, s18, 1024
    s_add_u32 s57, s17, 0x48000
    buffer_load_dwordx4 v3, s[8:11], s57 offen nt lds
    s_add_u32 m0, s18, 2048
    s_add_u32 s57, s17, 0x50000
    buffer_load_dwordx4 v2, s[8:11], s57 offen nt lds
    s_add_u32 m0, s18, 3072
    s_add_u32 s57, s17, 0x58000
    buffer_load_dwordx4 v3, s[8:11], s57 offen nt lds
    s_waitcnt vmcnt(9)
    s_barrier
    ds_read_b64_tr_b16 a[136:137], v32 offset:28672
    ds_read_b64_tr_b16 a[200:201], v33 offset:28672
    ds_read_b64_tr_b16 a[152:153], v34 offset:28672
    ds_read_b64_tr_b16 a[216:217], v35 offset:28672
    ds_read_b64_tr_b16 a[168:169], v36 offset:28672
    ds_read_b64_tr_b16 a[232:233], v37 offset:28672
    ds_read_b64_tr_b16 a[184:185], v38 offset:28672
    ds_read_b64_tr_b16 a[248:249], v39 offset:28672
    s_waitcnt lgkmcnt(0)
    s_barrier
    s_add_u32 m0, s49, 45056
    s_add_u32 s57, s17, 0x44000
    buffer_load_dwordx4 v2, s[8:11], s57 offen nt lds
    s_add_u32 m0, s49, 46080
    s_add_u32 s57, s17, 0x4c000
    buffer_load_dwordx4 v3, s[8:11], s57 offen nt lds
    s_add_u32 m0, s49, 47104
    s_add_u32 s57, s17, 0x54000
    buffer_load_dwordx4 v2, s[8:11], s57 offen nt lds
    s_add_u32 m0, s49, 48128
    s_add_u32 s57, s17, 0x5c000
    buffer_load_dwordx4 v3, s[8:11], s57 offen nt lds
    s_waitcnt vmcnt(9)
    s_barrier
    ds_read_b64_tr_b16 a[138:139], v32 offset:32768
    ds_read_b64_tr_b16 a[202:203], v33 offset:32768
    ds_read_b64_tr_b16 a[154:155], v34 offset:32768
    ds_read_b64_tr_b16 a[218:219], v35 offset:32768
    ds_read_b64_tr_b16 a[170:171], v36 offset:32768
    ds_read_b64_tr_b16 a[234:235], v37 offset:32768
    ds_read_b64_tr_b16 a[186:187], v38 offset:32768
    ds_read_b64_tr_b16 a[250:251], v39 offset:32768
    s_waitcnt lgkmcnt(0)
    s_waitcnt vmcnt(4)
    s_barrier
    ds_read_b64_tr_b16 a[140:141], v4 offset:0
    ds_read_b64_tr_b16 a[204:205], v5 offset:0
    ds_read_b64_tr_b16 a[156:157], v6 offset:0
    ds_read_b64_tr_b16 a[220:221], v7 offset:0
    ds_read_b64_tr_b16 a[172:173], v8 offset:0
    ds_read_b64_tr_b16 a[236:237], v9 offset:0
    ds_read_b64_tr_b16 a[188:189], v10 offset:0
    ds_read_b64_tr_b16 a[252:253], v11 offset:0
    v_cmp_ne_u32 vcc, 0x1010101, v53
    s_nop 0
    s_or_b32 s19, s19, vcc_lo
    s_lshl_b32 s34, s25, 5
    s_add_u32 s34, s34, s21
    s_lshl_b32 s34, s34, 14
    s_add_u32 s34, s34, 0x2000000
    s_lshl_b32 s3, s22, 10
    s_add_u32 s34, s34, s3
    s_cmp_eq_u32 s19, 0
    s_cselect_b32 s34, s34, s50
    s_add_u32 s35, s34, 8192
    s_add_u32 s36, s34, 4096
    s_add_u32 s37, s34, 12288
    buffer_load_dwordx4 v[88:91], v133, s[4:7], s34 offen sc1
    buffer_load_dwordx4 v[92:95], v133, s[4:7], s35 offen sc1
    buffer_load_dwordx4 v[96:99], v133, s[4:7], s36 offen sc1
    buffer_load_dwordx4 v[100:103], v133, s[4:7], s37 offen sc1
    s_waitcnt lgkmcnt(0)
    s_waitcnt vmcnt(4)
    s_barrier
    ds_read_b64_tr_b16 a[142:143], v32 offset:28672
    ds_read_b64_tr_b16 a[206:207], v33 offset:28672
    ds_read_b64_tr_b16 a[158:159], v34 offset:28672
    ds_read_b64_tr_b16 a[222:223], v35 offset:28672
    ds_read_b64_tr_b16 a[174:175], v36 offset:28672
    ds_read_b64_tr_b16 a[238:239], v37 offset:28672
    ds_read_b64_tr_b16 a[190:191], v38 offset:28672
    ds_read_b64_tr_b16 a[254:255], v39 offset:28672
    s_waitcnt lgkmcnt(0)
    s_waitcnt lgkmcnt(0)
    s_barrier
    ds_write_b128 v138, v[56:59] offset:28672
    ds_write_b128 v138, v[60:63] offset:29696
    ds_write_b128 v138, v[64:67] offset:30720
    ds_write_b128 v138, v[68:71] offset:31744
    ds_write_b128 v138, v[72:75] offset:32768
    ds_write_b128 v138, v[76:79] offset:33792
    ds_write_b128 v138, v[80:83] offset:34816
    ds_write_b128 v138, v[84:87] offset:35840
L_team_code:
    ds_write_b128 v133, v[48:51] offset:14592
    ds_write_b32 v135, v52 offset:15616
    s_cmp_eq_u32 s19, 0
    s_cbranch_scc1 L_team_ready
    s_waitcnt vmcnt(0)
L_poll_6:
    buffer_load_dword v53, v129, s[12:15], 0 offen offset:192 sc1
    s_movk_i32 s3, 1
    s_sub_u32 s24, s24, 1
    s_cbranch_scc1 L_timeout
    s_waitcnt vmcnt(0)
    v_cmp_gt_u32 vcc, 128, v53
    s_cbranch_vccnz L_poll_6
    s_waitcnt vmcnt(0)
L_poll_7:
    buffer_load_dword v54, v129, s[12:15], 0 offen offset:0 sc1
    s_movk_i32 s3, 2
    s_sub_u32 s24, s24, 1
    s_cbranch_scc1 L_timeout
    s_waitcnt vmcnt(0)
    v_cmp_gt_u32 vcc, -1, v54
    s_cbranch_vccnz L_poll_7
    buffer_load_dword v55, v129, s[12:15], 0 offen offset:4 sc1
    s_lshl_b32 s3, s22, 13
    s_add_u32 s3, s3, 0x80000
    s_lshl_b32 s57, s21, 13
    s_add_u32 s57, s57, 0xe00000
    s_cmp_eq_u32 s22, 0
    s_cselect_b32 s57, s57, 0x8e000
    s_cmp_eq_u32 s22, 1
    s_cselect_b32 s57, 0x100000, s57
    buffer_load_dword v132, v47, s[4:7], s3 offen sc1
    buffer_load_dword v130, v47, s[4:7], s57 offen sc1
    s_waitcnt vmcnt(0)
L_poll_8:
    buffer_load_dword v53, v46, s[4:7], s51 offen offset:0 sc1
    s_movk_i32 s3, 3
    s_sub_u32 s24, s24, 1
    s_cbranch_scc1 L_timeout
    s_waitcnt vmcnt(0)
    v_cmp_gt_u32 vcc, 16843009, v53
    s_cbranch_vccnz L_poll_8
    s_lshl_b32 s34, s25, 5
    s_add_u32 s34, s34, s21
    s_lshl_b32 s34, s34, 14
    s_add_u32 s34, s34, 0x2000000
    s_lshl_b32 s3, s22, 10
    s_add_u32 s34, s34, s3
    s_add_u32 s35, s34, 8192
    s_add_u32 s36, s34, 4096
    s_add_u32 s37, s34, 12288
    buffer_load_dwordx4 v[88:91], v133, s[4:7], s34 offen sc1
    buffer_load_dwordx4 v[92:95], v133, s[4:7], s35 offen sc1
    buffer_load_dwordx4 v[96:99], v133, s[4:7], s36 offen sc1
    buffer_load_dwordx4 v[100:103], v133, s[4:7], s37 offen sc1
L_team_ready:
    v_readfirstlane_b32 s23, v55
    s_lshl_b32 s3, s22, 11
    s_add_u32 m0, s3, 1024
    buffer_load_dwordx4 v[0:3], v133, s[4:7], s26 offen sc1
    buffer_load_dwordx4 v133, s[4:7], s27 offen sc1 lds
    s_add_u32 s51, s51, 8
    s_waitcnt lgkmcnt(0)
    ds_read_b128 v[32:35], v138 offset:0
    ds_read_b128 v[36:39], v138 offset:1024
    ds_read_b128 v[40:43], v138 offset:2048
    ds_read_b128 v[44:47], v138 offset:3072
    ds_read_b128 v[48:51], v138 offset:4096
    ds_read_b128 v[52:55], v138 offset:5120
    ds_read_b128 v[56:59], v138 offset:6144
    ds_read_b128 v[60:63], v138 offset:7168
    v_mov_b64 v[64:65], 0
    v_mov_b64 v[66:67], 0
    v_mov_b64 v[68:69], 0
    v_mov_b64 v[70:71], 0
    v_mov_b64 v[72:73], 0
    v_mov_b64 v[74:75], 0
    v_mov_b64 v[76:77], 0
    v_mov_b64 v[78:79], 0
    v_mov_b64 v[80:81], 0
    v_mov_b64 v[82:83], 0
    v_mov_b64 v[84:85], 0
    v_mov_b64 v[86:87], 0
    s_cmp_lt_u32 s25, 62
    s_cselect_b32 s57, 0x80000, 0
    s_add_u32 s34, s34, s57
    s_add_u32 s35, s35, s57
    s_add_u32 s36, s36, s57
    s_add_u32 s37, s37, s57
    s_mov_b32 s28, s29
    s_add_u32 s29, s29, 0x2000
    s_bitset0_b32 s29, 15
    s_mov_b64 s[16:17], -1
    v_mov_b32 v124, -1
    s_barrier
    buffer_load_dword v143, v129, s[4:7], s51 offen sc1
    buffer_load_dwordx4 v[104:107], v133, s[4:7], s34 offen sc1
    buffer_load_dwordx4 v[108:111], v133, s[4:7], s35 offen sc1
    buffer_load_dwordx4 v[112:115], v133, s[4:7], s36 offen sc1
    buffer_load_dwordx4 v[116:119], v133, s[4:7], s37 offen sc1
    s_waitcnt lgkmcnt(0)
    s_cmp_lg_u32 s23, 0
    s_cbranch_scc1 L_team_slow
L_team_fast:
    s_cmp_eq_u32 s22, 1
    s_cbranch_scc1 L_tfast10_again
    s_cmp_eq_u32 s22, 2
    s_cbranch_scc1 L_tfast20_again
    s_cmp_eq_u32 s22, 3
    s_cbranch_scc1 L_tfast30_again
.p2align 6
L_tfast00_again:
    s_waitcnt vmcnt(6) lgkmcnt(0)
    v_smfmac_f32_16x16x64_bf16 v[72:75], v[0:3], v[32:39], v131 abid:1
    ds_write_b128 v133, v[0:3] offset:0
    v_smfmac_f32_16x16x64_bf16 v[76:79], v[0:3], v[40:47], v131 abid:1
    v_smfmac_f32_16x16x64_bf16 v[80:83], v[0:3], a[24:31], v131 abid:1
    v_smfmac_f32_16x16x64_bf16 v[84:87], v[0:3], a[64:71], v131 abid:1
    s_waitcnt vmcnt(5)
    ds_read_b128 v[4:7], v133 offset:1024
    v_smfmac_f32_16x16x64_bf16 v[64:67], v[0:3], a[128:135], v131 abid:1
    v_smfmac_f32_16x16x64_bf16 v[68:71], v[0:3], a[192:199], v131 abid:1
    s_waitcnt lgkmcnt(1)
    s_barrier
    s_waitcnt lgkmcnt(0)
    v_smfmac_f32_16x16x64_bf16 v[72:75], v[4:7], v[48:55], v131 abid:1
    ds_read_b128 v[8:11], v133 offset:2048
    v_smfmac_f32_16x16x64_bf16 v[76:79], v[4:7], v[56:63], v131 abid:1
    ds_read_b128 v[12:15], v133 offset:3072
    v_smfmac_f32_16x16x64_bf16 v[80:83], v[4:7], a[32:39], v131 abid:1
    ds_read_b128 v[16:19], v133 offset:4096
    v_smfmac_f32_16x16x64_bf16 v[84:87], v[4:7], a[72:79], v131 abid:1
    ds_read_b128 v[20:23], v133 offset:5120
    s_waitcnt lgkmcnt(3)
    v_smfmac_f32_16x16x64_bf16 v[72:75], v[8:11], v[192:199], v131 abid:1
    ds_read_b128 v[24:27], v133 offset:6144
    v_smfmac_f32_16x16x64_bf16 v[76:79], v[8:11], v[240:247], v131 abid:1
    ds_read_b128 v[28:31], v133 offset:7168
    s_waitcnt lgkmcnt(4)
    v_smfmac_f32_16x16x64_bf16 v[72:75], v[12:15], v[200:207], v131 abid:1
    ds_read_b128 v[32:35], v138 offset:8192
    v_smfmac_f32_16x16x64_bf16 v[76:79], v[12:15], v[248:255], v131 abid:1
    ds_read_b128 v[36:39], v138 offset:9216
    s_waitcnt lgkmcnt(5)
    v_smfmac_f32_16x16x64_bf16 v[72:75], v[16:19], v[208:215], v131 abid:1
    ds_read_b128 v[40:43], v138 offset:10240
    s_waitcnt lgkmcnt(5)
    v_smfmac_f32_16x16x64_bf16 v[72:75], v[20:23], v[216:223], v131 abid:1
    ds_read_b128 v[44:47], v138 offset:11264
    s_waitcnt lgkmcnt(5)
    v_smfmac_f32_16x16x64_bf16 v[72:75], v[24:27], v[224:231], v131 abid:1
    ds_read_b128 v[48:51], v138 offset:12288
    s_waitcnt lgkmcnt(5)
    v_smfmac_f32_16x16x64_bf16 v[72:75], v[28:31], v[232:239], v131 abid:1
    s_nop 1
    ds_read_b128 v[52:55], v138 offset:13312
    v_smfmac_f32_16x16x64_bf16 v[76:79], v[16:19], a[0:7], v131 abid:1
    s_nop 1
    ds_read_b128 v[56:59], v138 offset:14336
    v_smfmac_f32_16x16x64_bf16 v[76:79], v[20:23], a[8:15], v131 abid:1
    ds_read_b128 v[60:63], v138 offset:15360
    v_add_f32 v72, v72, v74
    v_smfmac_f32_16x16x64_bf16 v[76:79], v[24:27], a[16:23], v131 abid:1
    s_waitcnt lgkmcnt(3)
    v_add_f32 v73, v73, v75
    v_smfmac_f32_16x16x64_bf16 v[76:79], v[28:31], v[32:39], v131 abid:1
    s_nop 2
    v_smfmac_f32_16x16x64_bf16 v[80:83], v[8:11], a[40:47], v131 abid:1
    s_nop 1
    v_cmp_u_f32 vcc, v72, v73
    v_smfmac_f32_16x16x64_bf16 v[80:83], v[12:15], v[40:47], v131 abid:1
    v_add_f32 v76, v76, v78
    v_add_f32 v77, v77, v79
    v_smfmac_f32_16x16x64_bf16 v[80:83], v[16:19], a[48:55], v131 abid:1
    s_waitcnt lgkmcnt(1)
    v_cvt_pk_bf16_f32 v76, v72, v76
    v_cvt_pk_bf16_f32 v77, v73, v77
    v_smfmac_f32_16x16x64_bf16 v[80:83], v[20:23], v[48:55], v131 abid:1
    ds_write2_b32 v141, v76, v77 offset0:0 offset1:136
    v_smfmac_f32_16x16x64_bf16 v[80:83], v[24:27], a[56:63], v131 abid:1
    s_waitcnt lgkmcnt(1)
    v_mov_b64 v[52:53], 0
    v_smfmac_f32_16x16x64_bf16 v[80:83], v[28:31], v[56:63], v131 abid:1
    s_nop 1
    v_mov_b64 v[54:55], 0
    v_smfmac_f32_16x16x64_bf16 v[84:87], v[8:11], a[80:87], v131 abid:1
    s_nop 1
    v_mov_b64 v[56:57], 0
    v_smfmac_f32_16x16x64_bf16 v[84:87], v[12:15], a[88:95], v131 abid:1
    s_and_b64 vcc, vcc, s[16:17]
    v_add_f32 v80, v80, v82
    v_smfmac_f32_16x16x64_bf16 v[84:87], v[16:19], a[96:103], v131 abid:1
    s_waitcnt lgkmcnt(0)
    s_barrier
    v_smfmac_f32_16x16x64_bf16 v[84:87], v[20:23], a[104:111], v131 abid:1
    ds_read_b128 v[32:35], v137 offset:0
    v_add_f32 v81, v81, v83
    v_smfmac_f32_16x16x64_bf16 v[84:87], v[24:27], a[112:119], v131 abid:1
    ds_read_b128 v[36:39], v137 offset:64
    v_mov_b64 v[58:59], 0
    v_smfmac_f32_16x16x64_bf16 v[84:87], v[28:31], a[120:127], v131 abid:1
    s_cbranch_scc1 L_tfast00_miss
    s_add_u32 s26, s28, s54
    v_smfmac_f32_16x16x64_bf16 v[64:67], v[4:7], a[136:143], v131 abid:1
    s_add_u32 s25, s25, 1
    s_add_u32 s27, s28, s55
    s_waitcnt lgkmcnt(1)
    v_mfma_f32_16x16x32_bf16 v[72:75], v[88:91], v[32:35], 0
    s_waitcnt lgkmcnt(0)
    v_add_f32 v84, v84, v86
    v_add_f32 v85, v85, v87
    v_mfma_f32_16x16x32_bf16 v[72:75], v[92:95], v[36:39], v[72:75]
    s_nop 0
    v_cvt_pk_bf16_f32 v84, v80, v84
    v_cvt_pk_bf16_f32 v85, v81, v85
    v_smfmac_f32_16x16x64_bf16 v[64:67], v[8:11], a[144:151], v131 abid:1
    ds_write2_b32 v141, v84, v85 offset0:64 offset1:200
    v_smfmac_f32_16x16x64_bf16 v[64:67], v[12:15], a[152:159], v131 abid:1
    s_nop 1
    v_cndmask_b32 v73, v73, v74, s[58:59]
    v_cndmask_b32 v72, v72, v75, s[58:59]
    v_smfmac_f32_16x16x64_bf16 v[64:67], v[16:19], a[160:167], v131 abid:1
    ds_read_b128 v[88:91], v138 offset:16384
    v_add_f32_dpp v72, v73, v72 quad_perm:[2,3,0,1] row_mask:0xf bank_mask:0xf
    v_mul_f32 v72, s56, v72
    v_smfmac_f32_16x16x64_bf16 v[64:67], v[20:23], a[168:175], v131 abid:1
    ds_read_b128 v[92:95], v138 offset:17408
    v_exp_f32 v73, v72
    v_smfmac_f32_16x16x64_bf16 v[64:67], v[24:27], a[176:183], v131 abid:1
    ds_write_b32 v133, v73 offset:12544
    v_smfmac_f32_16x16x64_bf16 v[64:67], v[28:31], a[184:191], v131 abid:1
    s_waitcnt lgkmcnt(3)
    s_barrier
    v_smfmac_f32_16x16x64_bf16 v[68:71], v[4:7], a[200:207], v131 abid:1
    ds_read_b128 v[40:43], v137 offset:256
    v_mov_b32 v63, 0
    v_smfmac_f32_16x16x64_bf16 v[68:71], v[8:11], a[208:215], v131 abid:1
    ds_read_b128 v[44:47], v137 offset:320
    v_smfmac_f32_16x16x64_bf16 v[68:71], v[12:15], a[216:223], v131 abid:1
    ds_read_b128 v[0:3], v138 offset:18432
    v_add_f32 v64, v64, v66
    v_smfmac_f32_16x16x64_bf16 v[68:71], v[16:19], a[224:231], v131 abid:1
    s_waitcnt lgkmcnt(3)
    s_barrier
    s_waitcnt lgkmcnt(2)
    v_mfma_f32_16x16x32_bf16 v[124:127], v[40:43], v[32:35], 0
    ds_read_b128 v[80:83], v133 offset:12544
    s_waitcnt lgkmcnt(2)
    v_mfma_f32_16x16x32_bf16 v[124:127], v[44:47], v[36:39], v[124:127]
    s_nop 0
    v_add_f32 v65, v65, v67
    v_cvt_pk_bf16_f32 v130, v64, v65
    v_smfmac_f32_16x16x64_bf16 v[68:71], v[20:23], a[232:239], v131 abid:1
    ds_read_b128 v[4:7], v138 offset:19456
    ds_read_b128 v[8:11], v138 offset:20480
    v_smfmac_f32_16x16x64_bf16 v[68:71], v[24:27], a[240:247], v131 abid:1
    ds_read_b128 v[12:15], v138 offset:21504
    v_cndmask_b32 v125, v125, v126, s[58:59]
    v_cndmask_b32 v124, v124, v127, s[58:59]
    v_smfmac_f32_16x16x64_bf16 v[68:71], v[28:31], a[248:255], v131 abid:1
    s_waitcnt lgkmcnt(3)
    v_cvt_pk_bf16_f32 v60, v80, v81
    v_cvt_pk_bf16_f32 v61, v82, v83
    v_add_f32_dpp v124, v125, v124 quad_perm:[2,3,0,1] row_mask:0xf bank_mask:0xf
    v_mul_f32 v124, s56, v124
    v_smfmac_f32_16x16x32_bf16 v[52:55], v[60:61], v[96:99], v131 abid:2
    v_exp_f32 v125, v124
    v_smfmac_f32_16x16x32_bf16 v[56:59], v[60:61], v[100:103], v131 abid:2
    v_cvt_pk_bf16_f32 v62, v125, 0
    v_add_f32 v68, v68, v70
    v_add_f32 v69, v69, v71
    v_mfma_f32_16x16x32_bf16 v[48:51], v[60:63], v[120:123], 0
    ds_read_b128 v[32:35], v138 offset:22528
    v_cvt_pk_bf16_f32 v134, v68, v69
    v_smfmac_f32_16x16x32_bf16 v[52:55], v[62:63], v[130:133], v131
    s_nop 0
    ds_read_b128 v[36:39], v138 offset:23552
    ds_read_b128 v[40:43], v138 offset:24576
    v_smfmac_f32_16x16x32_bf16 v[56:59], v[62:63], v[134:137], v131
    s_nop 0
    v_add_f32 v48, v48, v50
    v_add_f32 v49, v49, v51
    v_rcp_f32 v50, v48
    v_rcp_f32 v51, v49
    v_pk_add_f32 v[52:53], v[52:53], v[54:55]
    v_pk_mul_f32 v[52:53], v[52:53], v[50:51]
    v_max3_f32 v126, v48, v49, v50
    v_pk_add_f32 v[56:57], v[56:57], v[58:59]
    v_pk_mul_f32 v[56:57], v[56:57], v[50:51]
    v_cvt_pk_bf16_f32 v52, v52, v56
    v_cvt_pk_bf16_f32 v53, v53, v57
    v_mfma_f32_16x16x16_bf16 v[80:83], v[128:129], v[128:129], 0
    ds_write2_b32 v141, v52, v53 offset0:0 offset1:136
    v_mfma_f32_16x16x16_bf16 v[84:87], v[128:129], v[128:129], 0
    v_max_f32 v126, v126, v51
    v_cmp_nge_f32 vcc, 0x4f800000, v126
    v_mfma_f32_16x16x16_bf16 v[76:79], v[128:129], v[128:129], 0
    ds_read_b128 v[48:51], v142 offset:0
    s_cbranch_vccnz L_tfast00_big
L_tfast00_back:
    v_mfma_f32_16x16x16_bf16 v[72:75], v[128:129], v[128:129], 0
    s_waitcnt lgkmcnt(1)
    s_barrier
    ds_read_b128 v[52:55], v142 offset:64
    s_waitcnt lgkmcnt(1)
    v_smfmac_f32_16x16x64_bf16 v[80:83], v[48:51], v[88:95], v131 abid:1
    ds_read_b128 v[56:59], v142 offset:128
    v_smfmac_f32_16x16x64_bf16 v[84:87], v[48:51], v[0:7], v131 abid:1
    ds_read_b128 v[60:63], v142 offset:192
    v_smfmac_f32_16x16x64_bf16 v[76:79], v[48:51], v[8:15], v131 abid:1
    ds_read_b128 v[44:47], v138 offset:25600
    s_waitcnt lgkmcnt(3)
    v_smfmac_f32_16x16x64_bf16 v[80:83], v[52:55], v[144:151], v131 abid:1
    ds_read_b128 v[16:19], v138 offset:26624
    s_waitcnt lgkmcnt(3)
    v_smfmac_f32_16x16x64_bf16 v[80:83], v[56:59], v[152:159], v131 abid:1
    ds_read_b128 v[20:23], v138 offset:27648
    s_waitcnt lgkmcnt(3)
    v_smfmac_f32_16x16x64_bf16 v[80:83], v[60:63], v[160:167], v131 abid:1
    s_nop 1
    ds_read_b128 v[24:27], v138 offset:28672
    v_smfmac_f32_16x16x64_bf16 v[84:87], v[52:55], v[32:39], v131 abid:1
    ds_read_b128 v[28:31], v138 offset:29696
    s_waitcnt lgkmcnt(4)
    v_smfmac_f32_16x16x64_bf16 v[84:87], v[56:59], v[40:47], v131 abid:1
    ds_read_b128 v[64:67], v138 offset:30720
    v_cvt_pk_bf16_f32 v80, v80, v82
    v_cvt_pk_bf16_f32 v81, v81, v83
    v_and_b32 v80, -2, v80
    v_smfmac_f32_16x16x64_bf16 v[84:87], v[60:63], v[168:175], v131 abid:1
    buffer_store_dwordx2 v[80:81], v139, s[4:7], s30 offen
    ds_read_b128 v[68:71], v138 offset:31744
    s_waitcnt lgkmcnt(4)
    v_smfmac_f32_16x16x64_bf16 v[76:79], v[52:55], v[16:23], v131 abid:1
    buffer_load_dword v136, v135, s[4:7], s53 offen offset:0 sc1
    ds_read_b128 v[0:3], v138 offset:32768
    s_waitcnt lgkmcnt(3)
    v_smfmac_f32_16x16x64_bf16 v[76:79], v[56:59], v[176:183], v131 abid:1
    ds_read_b128 v[4:7], v138 offset:33792
    v_cvt_pk_bf16_f32 v84, v84, v86
    v_cvt_pk_bf16_f32 v85, v85, v87
    v_and_b32 v84, -2, v84
    v_smfmac_f32_16x16x64_bf16 v[76:79], v[60:63], v[24:31], v131 abid:1
    buffer_store_dwordx2 v[84:85], v139, s[4:7], s31 offen
    ds_read_b128 v[8:11], v138 offset:34816
    s_nop 0
    v_smfmac_f32_16x16x64_bf16 v[72:75], v[48:51], v[184:191], v131 abid:1
    ds_read_b128 v[12:15], v138 offset:35840
    s_waitcnt lgkmcnt(4)
    v_smfmac_f32_16x16x64_bf16 v[72:75], v[52:55], v[64:71], v131 abid:1
    s_waitcnt lgkmcnt(2)
    v_cvt_pk_bf16_f32 v76, v76, v78
    v_cvt_pk_bf16_f32 v77, v77, v79
    v_and_b32 v76, -2, v76
    v_smfmac_f32_16x16x64_bf16 v[72:75], v[56:59], v[0:7], v131 abid:1
    buffer_store_dwordx2 v[76:77], v139, s[4:7], s32 offen
    s_waitcnt lgkmcnt(0)
    v_smfmac_f32_16x16x64_bf16 v[72:75], v[60:63], v[8:15], v131 abid:1
    s_nop 7
    v_cvt_pk_bf16_f32 v72, v72, v74
    v_cvt_pk_bf16_f32 v73, v73, v75
    v_and_b32 v72, -2, v72
    buffer_store_dwordx2 v[72:73], v139, s[4:7], s33 offen
    ds_read_b128 v[96:99], v133 offset:14592
    ds_read_b32 v100, v135 offset:15616
    ds_read_b128 v[32:35], v138 offset:0
    ds_read_b128 v[36:39], v138 offset:1024
    ds_read_b128 v[40:43], v138 offset:2048
    ds_read_b128 v[44:47], v138 offset:3072
    ds_read_b128 v[48:51], v138 offset:4096
    ds_read_b128 v[52:55], v138 offset:5120
    ds_read_b128 v[56:59], v138 offset:6144
    ds_read_b128 v[60:63], v138 offset:7168
    v_mov_b64 v[64:65], 0
    v_mov_b64 v[66:67], 0
    v_mov_b64 v[68:69], 0
    v_mov_b64 v[70:71], 0
    v_mov_b64 v[72:73], 0
    v_mov_b64 v[74:75], 0
    v_mov_b64 v[76:77], 0
    v_mov_b64 v[78:79], 0
    v_mov_b64 v[80:81], 0
    v_mov_b64 v[82:83], 0
    v_mov_b64 v[84:85], 0
    v_mov_b64 v[86:87], 0
    v_mov_b64 v[124:125], 0
    v_mov_b64 v[126:127], 0
    v_mov_b32 v134, s25
    s_lshl_b32 s50, s25, 13
    s_add_u32 s50, s50, 0x100000
    s_cmp_eq_u32 s25, 63
    s_cselect_b32 s61, s50, 0x4000000
    s_cmp_le_u32 s25, 2
    s_cbranch_scc1 L_tfast00_late
    s_waitcnt vmcnt(3)
    v_cmp_gt_u32 vcc, s25, v136
    s_cbranch_vccnz L_tfast00_late
L_tfast00_fetch:
    s_waitcnt vmcnt(3)
    buffer_load_dwordx4 v[0:3], v133, s[4:7], s38 offen offset:0 sc1
    buffer_load_dwordx4 v[4:7], v133, s[4:7], s38 offen offset:1024 sc1
    s_waitcnt vmcnt(4)
    buffer_load_dwordx4 v[8:11], v133, s[4:7], s39 offen offset:0 sc1
    buffer_load_dwordx4 v[12:15], v133, s[4:7], s39 offen offset:1024 sc1
    s_waitcnt vmcnt(5)
    buffer_load_dwordx4 v[16:19], v133, s[4:7], s40 offen offset:0 sc1
    buffer_load_dwordx4 v[20:23], v133, s[4:7], s40 offen offset:1024 sc1
    s_waitcnt vmcnt(6)
    buffer_load_dwordx4 v[24:27], v133, s[4:7], s41 offen offset:0 sc1
    buffer_load_dwordx4 v[28:31], v133, s[4:7], s41 offen offset:1024 sc1
    s_barrier
    s_mov_b64 exec, s[42:43]
    buffer_store_dword v134, v133, s[4:7], s47 offen offset:1024
    s_mov_b64 exec, -1
    s_waitcnt vmcnt(7) lgkmcnt(8)
    v_smfmac_f32_16x16x64_bf16 v[124:127], v[96:99], v[0:7], v100
    v_bitop3_b32 v130, -2, v0, v2 bitop3:0xfe
    v_bitop3_b32 v130, v130, v4, v6 bitop3:0xfe
    s_waitcnt vmcnt(5)
    v_smfmac_f32_16x16x64_bf16 v[124:127], v[96:99], v[8:15], v100
    v_bitop3_b32 v130, v130, v8, v10 bitop3:0xfe
    v_bitop3_b32 v130, v130, v12, v14 bitop3:0xfe
    s_waitcnt vmcnt(3)
    v_smfmac_f32_16x16x64_bf16 v[124:127], v[96:99], v[16:23], v100
    v_bitop3_b32 v130, v130, v16, v18 bitop3:0xfe
    v_bitop3_b32 v130, v130, v20, v22 bitop3:0xfe
    s_waitcnt vmcnt(2)
    v_bitop3_b32 v130, v130, v24, v26 bitop3:0xfe
    s_waitcnt vmcnt(1)
    v_bitop3_b32 v130, v130, v28, v30 bitop3:0xfe
    v_smfmac_f32_16x16x64_bf16 v[124:127], v[96:99], v[24:31], v100
    s_nop 1
    v_cmp_eq_u32 vcc, -1, v130
    s_nop 3
    s_cbranch_vccnz L_tfast00_retry
L_tfast00_good:
    v_cvt_pk_bf16_f32 v143, v124, v125
    buffer_store_dword v143, v140, s[4:7], s28 offen
    buffer_store_dword v143, v140, s[4:7], s61 offen sc1
    s_cmp_eq_u32 s25, 63
    s_cbranch_scc1 L_exit
    s_cmp_lt_u32 s25, 62
    s_cselect_b32 s57, 0x80000, 0
    s_add_u32 s34, s34, s57
    s_add_u32 s35, s35, s57
    s_add_u32 s36, s36, s57
    s_add_u32 s37, s37, s57
    s_mov_b32 s28, s29
    s_add_u32 s29, s29, 0x2000
    s_bitset0_b32 s29, 15
    s_mov_b64 s[16:17], -1
    s_barrier
    buffer_load_dwordx4 v[0:3], v133, s[4:7], s26 offen sc1
    s_barrier
    buffer_load_dwordx4 v133, s[4:7], s27 offen sc1 lds
    s_barrier
    buffer_store_dword v143, v140, s[4:7], s50 offen sc1
    buffer_load_dwordx4 v[88:91], v133, s[4:7], s34 offen sc1
    buffer_load_dwordx4 v[92:95], v133, s[4:7], s35 offen sc1
    buffer_load_dwordx4 v[96:99], v133, s[4:7], s36 offen sc1
    buffer_load_dwordx4 v[100:103], v133, s[4:7], s37 offen sc1
L_tfast01_again:
    s_waitcnt vmcnt(6) lgkmcnt(0)
    v_smfmac_f32_16x16x64_bf16 v[72:75], v[0:3], v[32:39], v131 abid:1
    ds_write_b128 v133, v[0:3] offset:0
    v_smfmac_f32_16x16x64_bf16 v[76:79], v[0:3], v[40:47], v131 abid:1
    v_smfmac_f32_16x16x64_bf16 v[80:83], v[0:3], a[24:31], v131 abid:1
    v_smfmac_f32_16x16x64_bf16 v[84:87], v[0:3], a[64:71], v131 abid:1
    s_waitcnt vmcnt(5)
    ds_read_b128 v[4:7], v133 offset:1024
    v_smfmac_f32_16x16x64_bf16 v[64:67], v[0:3], a[128:135], v131 abid:1
    v_smfmac_f32_16x16x64_bf16 v[68:71], v[0:3], a[192:199], v131 abid:1
    s_waitcnt lgkmcnt(1)
    s_barrier
    s_waitcnt lgkmcnt(0)
    v_smfmac_f32_16x16x64_bf16 v[72:75], v[4:7], v[48:55], v131 abid:1
    ds_read_b128 v[8:11], v133 offset:2048
    v_smfmac_f32_16x16x64_bf16 v[76:79], v[4:7], v[56:63], v131 abid:1
    ds_read_b128 v[12:15], v133 offset:3072
    v_smfmac_f32_16x16x64_bf16 v[80:83], v[4:7], a[32:39], v131 abid:1
    ds_read_b128 v[16:19], v133 offset:4096
    v_smfmac_f32_16x16x64_bf16 v[84:87], v[4:7], a[72:79], v131 abid:1
    ds_read_b128 v[20:23], v133 offset:5120
    s_waitcnt lgkmcnt(3)
    v_smfmac_f32_16x16x64_bf16 v[72:75], v[8:11], v[192:199], v131 abid:1
    ds_read_b128 v[24:27], v133 offset:6144
    v_smfmac_f32_16x16x64_bf16 v[76:79], v[8:11], v[240:247], v131 abid:1
    ds_read_b128 v[28:31], v133 offset:7168
    s_waitcnt lgkmcnt(4)
    v_smfmac_f32_16x16x64_bf16 v[72:75], v[12:15], v[200:207], v131 abid:1
    ds_read_b128 v[32:35], v138 offset:8192
    v_smfmac_f32_16x16x64_bf16 v[76:79], v[12:15], v[248:255], v131 abid:1
    ds_read_b128 v[36:39], v138 offset:9216
    s_waitcnt lgkmcnt(5)
    v_smfmac_f32_16x16x64_bf16 v[72:75], v[16:19], v[208:215], v131 abid:1
    ds_read_b128 v[40:43], v138 offset:10240
    s_waitcnt lgkmcnt(5)
    v_smfmac_f32_16x16x64_bf16 v[72:75], v[20:23], v[216:223], v131 abid:1
    ds_read_b128 v[44:47], v138 offset:11264
    s_waitcnt lgkmcnt(5)
    v_smfmac_f32_16x16x64_bf16 v[72:75], v[24:27], v[224:231], v131 abid:1
    ds_read_b128 v[48:51], v138 offset:12288
    s_waitcnt lgkmcnt(5)
    v_smfmac_f32_16x16x64_bf16 v[72:75], v[28:31], v[232:239], v131 abid:1
    s_nop 1
    ds_read_b128 v[52:55], v138 offset:13312
    v_smfmac_f32_16x16x64_bf16 v[76:79], v[16:19], a[0:7], v131 abid:1
    s_nop 1
    ds_read_b128 v[56:59], v138 offset:14336
    v_smfmac_f32_16x16x64_bf16 v[76:79], v[20:23], a[8:15], v131 abid:1
    ds_read_b128 v[60:63], v138 offset:15360
    v_add_f32 v72, v72, v74
    v_smfmac_f32_16x16x64_bf16 v[76:79], v[24:27], a[16:23], v131 abid:1
    s_waitcnt lgkmcnt(3)
    v_add_f32 v73, v73, v75
    v_smfmac_f32_16x16x64_bf16 v[76:79], v[28:31], v[32:39], v131 abid:1
    s_nop 2
    v_smfmac_f32_16x16x64_bf16 v[80:83], v[8:11], a[40:47], v131 abid:1
    s_nop 1
    v_cmp_u_f32 vcc, v72, v73
    v_smfmac_f32_16x16x64_bf16 v[80:83], v[12:15], v[40:47], v131 abid:1
    v_add_f32 v76, v76, v78
    v_add_f32 v77, v77, v79
    v_smfmac_f32_16x16x64_bf16 v[80:83], v[16:19], a[48:55], v131 abid:1
    s_waitcnt lgkmcnt(1)
    v_cvt_pk_bf16_f32 v76, v72, v76
    v_cvt_pk_bf16_f32 v77, v73, v77
    v_smfmac_f32_16x16x64_bf16 v[80:83], v[20:23], v[48:55], v131 abid:1
    ds_write2_b32 v141, v76, v77 offset0:0 offset1:136
    v_smfmac_f32_16x16x64_bf16 v[80:83], v[24:27], a[56:63], v131 abid:1
    s_waitcnt lgkmcnt(1)
    v_mov_b64 v[52:53], 0
    v_smfmac_f32_16x16x64_bf16 v[80:83], v[28:31], v[56:63], v131 abid:1
    s_nop 1
    v_mov_b64 v[54:55], 0
    v_smfmac_f32_16x16x64_bf16 v[84:87], v[8:11], a[80:87], v131 abid:1
    s_nop 1
    v_mov_b64 v[56:57], 0
    v_smfmac_f32_16x16x64_bf16 v[84:87], v[12:15], a[88:95], v131 abid:1
    s_and_b64 vcc, vcc, s[16:17]
    v_add_f32 v80, v80, v82
    v_smfmac_f32_16x16x64_bf16 v[84:87], v[16:19], a[96:103], v131 abid:1
    s_waitcnt lgkmcnt(0)
    s_barrier
    v_smfmac_f32_16x16x64_bf16 v[84:87], v[20:23], a[104:111], v131 abid:1
    ds_read_b128 v[32:35], v137 offset:0
    v_add_f32 v81, v81, v83
    v_smfmac_f32_16x16x64_bf16 v[84:87], v[24:27], a[112:119], v131 abid:1
    ds_read_b128 v[36:39], v137 offset:64
    v_mov_b64 v[58:59], 0
    v_smfmac_f32_16x16x64_bf16 v[84:87], v[28:31], a[120:127], v131 abid:1
    s_cbranch_scc1 L_tfast01_miss
    s_add_u32 s26, s28, s54
    v_smfmac_f32_16x16x64_bf16 v[64:67], v[4:7], a[136:143], v131 abid:1
    s_add_u32 s25, s25, 1
    s_add_u32 s27, s28, s55
    s_waitcnt lgkmcnt(1)
    v_mfma_f32_16x16x32_bf16 v[72:75], v[104:107], v[32:35], 0
    s_waitcnt lgkmcnt(0)
    v_add_f32 v84, v84, v86
    v_add_f32 v85, v85, v87
    v_mfma_f32_16x16x32_bf16 v[72:75], v[108:111], v[36:39], v[72:75]
    s_nop 0
    v_cvt_pk_bf16_f32 v84, v80, v84
    v_cvt_pk_bf16_f32 v85, v81, v85
    v_smfmac_f32_16x16x64_bf16 v[64:67], v[8:11], a[144:151], v131 abid:1
    ds_write2_b32 v141, v84, v85 offset0:64 offset1:200
    v_smfmac_f32_16x16x64_bf16 v[64:67], v[12:15], a[152:159], v131 abid:1
    s_nop 1
    v_cndmask_b32 v73, v73, v74, s[58:59]
    v_cndmask_b32 v72, v72, v75, s[58:59]
    v_smfmac_f32_16x16x64_bf16 v[64:67], v[16:19], a[160:167], v131 abid:1
    ds_read_b128 v[104:107], v138 offset:16384
    v_add_f32_dpp v72, v73, v72 quad_perm:[2,3,0,1] row_mask:0xf bank_mask:0xf
    v_mul_f32 v72, s56, v72
    v_smfmac_f32_16x16x64_bf16 v[64:67], v[20:23], a[168:175], v131 abid:1
    ds_read_b128 v[108:111], v138 offset:17408
    v_exp_f32 v73, v72
    v_smfmac_f32_16x16x64_bf16 v[64:67], v[24:27], a[176:183], v131 abid:1
    ds_write_b32 v133, v73 offset:12544
    v_smfmac_f32_16x16x64_bf16 v[64:67], v[28:31], a[184:191], v131 abid:1
    s_waitcnt lgkmcnt(3)
    s_barrier
    v_smfmac_f32_16x16x64_bf16 v[68:71], v[4:7], a[200:207], v131 abid:1
    ds_read_b128 v[40:43], v137 offset:256
    v_mov_b32 v63, 0
    v_smfmac_f32_16x16x64_bf16 v[68:71], v[8:11], a[208:215], v131 abid:1
    ds_read_b128 v[44:47], v137 offset:320
    v_smfmac_f32_16x16x64_bf16 v[68:71], v[12:15], a[216:223], v131 abid:1
    ds_read_b128 v[0:3], v138 offset:18432
    v_add_f32 v64, v64, v66
    v_smfmac_f32_16x16x64_bf16 v[68:71], v[16:19], a[224:231], v131 abid:1
    s_waitcnt lgkmcnt(3)
    s_barrier
    s_waitcnt lgkmcnt(2)
    v_mfma_f32_16x16x32_bf16 v[124:127], v[40:43], v[32:35], 0
    ds_read_b128 v[80:83], v133 offset:12544
    s_waitcnt lgkmcnt(2)
    v_mfma_f32_16x16x32_bf16 v[124:127], v[44:47], v[36:39], v[124:127]
    s_nop 0
    v_add_f32 v65, v65, v67
    v_cvt_pk_bf16_f32 v130, v64, v65
    v_smfmac_f32_16x16x64_bf16 v[68:71], v[20:23], a[232:239], v131 abid:1
    ds_read_b128 v[4:7], v138 offset:19456
    ds_read_b128 v[8:11], v138 offset:20480
    v_smfmac_f32_16x16x64_bf16 v[68:71], v[24:27], a[240:247], v131 abid:1
    ds_read_b128 v[12:15], v138 offset:21504
    v_cndmask_b32 v125, v125, v126, s[58:59]
    v_cndmask_b32 v124, v124, v127, s[58:59]
    v_smfmac_f32_16x16x64_bf16 v[68:71], v[28:31], a[248:255], v131 abid:1
    s_waitcnt lgkmcnt(3)
    v_cvt_pk_bf16_f32 v60, v80, v81
    v_cvt_pk_bf16_f32 v61, v82, v83
    v_add_f32_dpp v124, v125, v124 quad_perm:[2,3,0,1] row_mask:0xf bank_mask:0xf
    v_mul_f32 v124, s56, v124
    v_smfmac_f32_16x16x32_bf16 v[52:55], v[60:61], v[112:115], v131 abid:2
    v_exp_f32 v125, v124
    v_smfmac_f32_16x16x32_bf16 v[56:59], v[60:61], v[116:119], v131 abid:2
    v_cvt_pk_bf16_f32 v62, v125, 0
    v_add_f32 v68, v68, v70
    v_add_f32 v69, v69, v71
    v_mfma_f32_16x16x32_bf16 v[48:51], v[60:63], v[120:123], 0
    ds_read_b128 v[32:35], v138 offset:22528
    v_cvt_pk_bf16_f32 v134, v68, v69
    v_smfmac_f32_16x16x32_bf16 v[52:55], v[62:63], v[130:133], v131
    s_nop 0
    ds_read_b128 v[36:39], v138 offset:23552
    ds_read_b128 v[40:43], v138 offset:24576
    v_smfmac_f32_16x16x32_bf16 v[56:59], v[62:63], v[134:137], v131
    s_nop 0
    v_add_f32 v48, v48, v50
    v_add_f32 v49, v49, v51
    v_rcp_f32 v50, v48
    v_rcp_f32 v51, v49
    v_pk_add_f32 v[52:53], v[52:53], v[54:55]
    v_pk_mul_f32 v[52:53], v[52:53], v[50:51]
    v_max3_f32 v126, v48, v49, v50
    v_pk_add_f32 v[56:57], v[56:57], v[58:59]
    v_pk_mul_f32 v[56:57], v[56:57], v[50:51]
    v_cvt_pk_bf16_f32 v52, v52, v56
    v_cvt_pk_bf16_f32 v53, v53, v57
    v_mfma_f32_16x16x16_bf16 v[80:83], v[128:129], v[128:129], 0
    ds_write2_b32 v141, v52, v53 offset0:0 offset1:136
    v_mfma_f32_16x16x16_bf16 v[84:87], v[128:129], v[128:129], 0
    v_max_f32 v126, v126, v51
    v_cmp_nge_f32 vcc, 0x4f800000, v126
    v_mfma_f32_16x16x16_bf16 v[76:79], v[128:129], v[128:129], 0
    ds_read_b128 v[48:51], v142 offset:0
    s_cbranch_vccnz L_tfast01_big
L_tfast01_back:
    v_mfma_f32_16x16x16_bf16 v[72:75], v[128:129], v[128:129], 0
    s_waitcnt lgkmcnt(1)
    s_barrier
    ds_read_b128 v[52:55], v142 offset:64
    s_waitcnt lgkmcnt(1)
    v_smfmac_f32_16x16x64_bf16 v[80:83], v[48:51], v[104:111], v131 abid:1
    ds_read_b128 v[56:59], v142 offset:128
    v_smfmac_f32_16x16x64_bf16 v[84:87], v[48:51], v[0:7], v131 abid:1
    ds_read_b128 v[60:63], v142 offset:192
    v_smfmac_f32_16x16x64_bf16 v[76:79], v[48:51], v[8:15], v131 abid:1
    ds_read_b128 v[44:47], v138 offset:25600
    s_waitcnt lgkmcnt(3)
    v_smfmac_f32_16x16x64_bf16 v[80:83], v[52:55], v[144:151], v131 abid:1
    ds_read_b128 v[16:19], v138 offset:26624
    s_waitcnt lgkmcnt(3)
    v_smfmac_f32_16x16x64_bf16 v[80:83], v[56:59], v[152:159], v131 abid:1
    ds_read_b128 v[20:23], v138 offset:27648
    s_waitcnt lgkmcnt(3)
    v_smfmac_f32_16x16x64_bf16 v[80:83], v[60:63], v[160:167], v131 abid:1
    s_nop 1
    ds_read_b128 v[24:27], v138 offset:28672
    v_smfmac_f32_16x16x64_bf16 v[84:87], v[52:55], v[32:39], v131 abid:1
    ds_read_b128 v[28:31], v138 offset:29696
    s_waitcnt lgkmcnt(4)
    v_smfmac_f32_16x16x64_bf16 v[84:87], v[56:59], v[40:47], v131 abid:1
    ds_read_b128 v[64:67], v138 offset:30720
    v_cvt_pk_bf16_f32 v80, v80, v82
    v_cvt_pk_bf16_f32 v81, v81, v83
    v_or_b32 v80, 1, v80
    v_smfmac_f32_16x16x64_bf16 v[84:87], v[60:63], v[168:175], v131 abid:1
    buffer_store_dwordx2 v[80:81], v139, s[4:7], s30 offen
    ds_read_b128 v[68:71], v138 offset:31744
    s_waitcnt lgkmcnt(4)
    v_smfmac_f32_16x16x64_bf16 v[76:79], v[52:55], v[16:23], v131 abid:1
    buffer_load_dword v136, v135, s[4:7], s53 offen offset:0 sc1
    ds_read_b128 v[0:3], v138 offset:32768
    s_waitcnt lgkmcnt(3)
    v_smfmac_f32_16x16x64_bf16 v[76:79], v[56:59], v[176:183], v131 abid:1
    ds_read_b128 v[4:7], v138 offset:33792
    v_cvt_pk_bf16_f32 v84, v84, v86
    v_cvt_pk_bf16_f32 v85, v85, v87
    v_or_b32 v84, 1, v84
    v_smfmac_f32_16x16x64_bf16 v[76:79], v[60:63], v[24:31], v131 abid:1
    buffer_store_dwordx2 v[84:85], v139, s[4:7], s31 offen
    ds_read_b128 v[8:11], v138 offset:34816
    s_nop 0
    v_smfmac_f32_16x16x64_bf16 v[72:75], v[48:51], v[184:191], v131 abid:1
    ds_read_b128 v[12:15], v138 offset:35840
    s_waitcnt lgkmcnt(4)
    v_smfmac_f32_16x16x64_bf16 v[72:75], v[52:55], v[64:71], v131 abid:1
    s_waitcnt lgkmcnt(2)
    v_cvt_pk_bf16_f32 v76, v76, v78
    v_cvt_pk_bf16_f32 v77, v77, v79
    v_or_b32 v76, 1, v76
    v_smfmac_f32_16x16x64_bf16 v[72:75], v[56:59], v[0:7], v131 abid:1
    buffer_store_dwordx2 v[76:77], v139, s[4:7], s32 offen
    s_waitcnt lgkmcnt(0)
    v_smfmac_f32_16x16x64_bf16 v[72:75], v[60:63], v[8:15], v131 abid:1
    s_nop 7
    v_cvt_pk_bf16_f32 v72, v72, v74
    v_cvt_pk_bf16_f32 v73, v73, v75
    v_or_b32 v72, 1, v72
    buffer_store_dwordx2 v[72:73], v139, s[4:7], s33 offen
    ds_read_b128 v[112:115], v133 offset:14592
    ds_read_b32 v116, v135 offset:15616
    ds_read_b128 v[32:35], v138 offset:0
    ds_read_b128 v[36:39], v138 offset:1024
    ds_read_b128 v[40:43], v138 offset:2048
    ds_read_b128 v[44:47], v138 offset:3072
    ds_read_b128 v[48:51], v138 offset:4096
    ds_read_b128 v[52:55], v138 offset:5120
    ds_read_b128 v[56:59], v138 offset:6144
    ds_read_b128 v[60:63], v138 offset:7168
    v_mov_b64 v[64:65], 0
    v_mov_b64 v[66:67], 0
    v_mov_b64 v[68:69], 0
    v_mov_b64 v[70:71], 0
    v_mov_b64 v[72:73], 0
    v_mov_b64 v[74:75], 0
    v_mov_b64 v[76:77], 0
    v_mov_b64 v[78:79], 0
    v_mov_b64 v[80:81], 0
    v_mov_b64 v[82:83], 0
    v_mov_b64 v[84:85], 0
    v_mov_b64 v[86:87], 0
    v_mov_b64 v[124:125], 0
    v_mov_b64 v[126:127], 0
    v_mov_b32 v134, s25
    s_lshl_b32 s50, s25, 13
    s_add_u32 s50, s50, 0x100000
    s_cmp_le_u32 s25, 2
    s_cbranch_scc1 L_tfast01_late
    s_waitcnt vmcnt(3)
    v_cmp_gt_u32 vcc, s25, v136
    s_cbranch_vccnz L_tfast01_late
L_tfast01_fetch:
    s_waitcnt vmcnt(3)
    buffer_load_dwordx4 v[0:3], v133, s[4:7], s38 offen offset:0 sc1
    buffer_load_dwordx4 v[4:7], v133, s[4:7], s38 offen offset:1024 sc1
    s_waitcnt vmcnt(4)
    buffer_load_dwordx4 v[8:11], v133, s[4:7], s39 offen offset:0 sc1
    buffer_load_dwordx4 v[12:15], v133, s[4:7], s39 offen offset:1024 sc1
    s_waitcnt vmcnt(5)
    buffer_load_dwordx4 v[16:19], v133, s[4:7], s40 offen offset:0 sc1
    buffer_load_dwordx4 v[20:23], v133, s[4:7], s40 offen offset:1024 sc1
    s_waitcnt vmcnt(6)
    buffer_load_dwordx4 v[24:27], v133, s[4:7], s41 offen offset:0 sc1
    buffer_load_dwordx4 v[28:31], v133, s[4:7], s41 offen offset:1024 sc1
    s_barrier
    s_mov_b64 exec, s[42:43]
    buffer_store_dword v134, v133, s[4:7], s47 offen offset:1024
    s_mov_b64 exec, -1
    s_waitcnt vmcnt(7) lgkmcnt(8)
    v_smfmac_f32_16x16x64_bf16 v[124:127], v[112:115], v[0:7], v116
    v_bitop3_b32 v130, 1, v0, v2 bitop3:0x80
    v_bitop3_b32 v130, v130, v4, v6 bitop3:0x80
    s_waitcnt vmcnt(5)
    v_smfmac_f32_16x16x64_bf16 v[124:127], v[112:115], v[8:15], v116
    v_bitop3_b32 v130, v130, v8, v10 bitop3:0x80
    v_bitop3_b32 v130, v130, v12, v14 bitop3:0x80
    s_waitcnt vmcnt(3)
    v_smfmac_f32_16x16x64_bf16 v[124:127], v[112:115], v[16:23], v116
    v_bitop3_b32 v130, v130, v16, v18 bitop3:0x80
    v_bitop3_b32 v130, v130, v20, v22 bitop3:0x80
    s_waitcnt vmcnt(2)
    v_bitop3_b32 v130, v130, v24, v26 bitop3:0x80
    s_waitcnt vmcnt(1)
    v_bitop3_b32 v130, v130, v28, v30 bitop3:0x80
    v_smfmac_f32_16x16x64_bf16 v[124:127], v[112:115], v[24:31], v116
    s_nop 1
    v_cmp_eq_u32 vcc, 0, v130
    s_nop 3
    s_cbranch_vccnz L_tfast01_retry
L_tfast01_good:
    v_cvt_pk_bf16_f32 v143, v124, v125
    buffer_store_dword v143, v140, s[4:7], s28 offen
    s_cmp_lt_u32 s25, 62
    s_cselect_b32 s57, 0x80000, 0
    s_add_u32 s34, s34, s57
    s_add_u32 s35, s35, s57
    s_add_u32 s36, s36, s57
    s_add_u32 s37, s37, s57
    s_mov_b32 s28, s29
    s_add_u32 s29, s29, 0x2000
    s_bitset0_b32 s29, 15
    s_mov_b64 s[16:17], -1
    s_barrier
    buffer_load_dwordx4 v[0:3], v133, s[4:7], s26 offen sc1
    s_barrier
    buffer_load_dwordx4 v133, s[4:7], s27 offen sc1 lds
    s_barrier
    buffer_store_dword v143, v140, s[4:7], s50 offen sc1
    buffer_load_dwordx4 v[104:107], v133, s[4:7], s34 offen sc1
    buffer_load_dwordx4 v[108:111], v133, s[4:7], s35 offen sc1
    buffer_load_dwordx4 v[112:115], v133, s[4:7], s36 offen sc1
    buffer_load_dwordx4 v[116:119], v133, s[4:7], s37 offen sc1
    s_branch L_tfast00_again
L_tfast00_late:
L_spin_9:
    v_cmp_gt_u32 vcc, s25, v136
    buffer_load_dword v136, v135, s[4:7], s53 offen offset:0 sc1
    s_cbranch_vccz L_spun_10
    v_cmp_gt_u32 vcc, s25, v136
    buffer_load_dword v136, v135, s[4:7], s53 offen offset:0 sc1
    s_cbranch_vccz L_spun_10
    v_cmp_gt_u32 vcc, s25, v136
    buffer_load_dword v136, v135, s[4:7], s53 offen offset:0 sc1
    s_cbranch_vccz L_spun_10
    v_cmp_gt_u32 vcc, s25, v136
    buffer_load_dword v136, v135, s[4:7], s53 offen offset:0 sc1
    s_cbranch_vccz L_spun_10
    s_movk_i32 s3, 19
    s_sub_u32 s24, s24, 1
    s_cbranch_scc1 L_timeout
    s_branch L_spin_9
L_spun_10:
    buffer_load_dword v136, v135, s[4:7], s53 offen offset:0 sc1
    s_waitcnt vmcnt(0)
    s_cmp_gt_u32 s25, 2
    s_cbranch_scc1 L_tfast00_fetch
    s_waitcnt lgkmcnt(0)
    s_barrier
L_tfast00_careful:
    buffer_load_dwordx4 v[0:3], v133, s[4:7], s38 offen offset:0 sc1
    buffer_load_dwordx4 v[4:7], v133, s[4:7], s38 offen offset:1024 sc1
    buffer_load_dwordx4 v[8:11], v133, s[4:7], s39 offen offset:0 sc1
    buffer_load_dwordx4 v[12:15], v133, s[4:7], s39 offen offset:1024 sc1
    buffer_load_dwordx4 v[16:19], v133, s[4:7], s40 offen offset:0 sc1
    buffer_load_dwordx4 v[20:23], v133, s[4:7], s40 offen offset:1024 sc1
    buffer_load_dwordx4 v[24:27], v133, s[4:7], s41 offen offset:0 sc1
    buffer_load_dwordx4 v[28:31], v133, s[4:7], s41 offen offset:1024 sc1
    s_movk_i32 s3, 21
    s_sub_u32 s24, s24, 1
    s_cbranch_scc1 L_timeout
    v_mov_b64 v[124:125], 0
    v_mov_b64 v[126:127], 0
    s_waitcnt vmcnt(6)
    s_nop 0
    v_smfmac_f32_16x16x64_bf16 v[124:127], v[96:99], v[0:7], v100
    v_bitop3_b32 v130, -2, v0, v2 bitop3:0xfe
    v_bitop3_b32 v130, v130, v4, v6 bitop3:0xfe
    s_waitcnt vmcnt(4)
    v_smfmac_f32_16x16x64_bf16 v[124:127], v[96:99], v[8:15], v100
    v_bitop3_b32 v130, v130, v8, v10 bitop3:0xfe
    v_bitop3_b32 v130, v130, v12, v14 bitop3:0xfe
    s_waitcnt vmcnt(2)
    v_smfmac_f32_16x16x64_bf16 v[124:127], v[96:99], v[16:23], v100
    v_bitop3_b32 v130, v130, v16, v18 bitop3:0xfe
    v_bitop3_b32 v130, v130, v20, v22 bitop3:0xfe
    s_waitcnt vmcnt(1)
    v_bitop3_b32 v130, v130, v24, v26 bitop3:0xfe
    s_waitcnt vmcnt(0)
    v_bitop3_b32 v130, v130, v28, v30 bitop3:0xfe
    v_smfmac_f32_16x16x64_bf16 v[124:127], v[96:99], v[24:31], v100
    s_nop 1
    v_cmp_eq_u32 vcc, -1, v130
    s_cbranch_vccnz L_tfast00_careful
    s_mov_b64 exec, s[42:43]
    buffer_store_dword v134, v133, s[4:7], s47 offen offset:1024
    s_mov_b64 exec, -1
    s_nop 0
    s_branch L_tfast00_good
L_tfast00_retry:
    s_mov_b64 exec, s[42:43]
    buffer_store_dword v129, v133, s[4:7], s47 offen offset:1024
    s_mov_b64 exec, -1
L_tfast00_retry1:
    buffer_load_dwordx4 v[0:3], v133, s[4:7], s38 offen offset:0 sc1
    buffer_load_dwordx4 v[4:7], v133, s[4:7], s38 offen offset:1024 sc1
    buffer_load_dwordx4 v[8:11], v133, s[4:7], s39 offen offset:0 sc1
    buffer_load_dwordx4 v[12:15], v133, s[4:7], s39 offen offset:1024 sc1
    buffer_load_dwordx4 v[16:19], v133, s[4:7], s40 offen offset:0 sc1
    buffer_load_dwordx4 v[20:23], v133, s[4:7], s40 offen offset:1024 sc1
    buffer_load_dwordx4 v[24:27], v133, s[4:7], s41 offen offset:0 sc1
    buffer_load_dwordx4 v[28:31], v133, s[4:7], s41 offen offset:1024 sc1
    s_movk_i32 s3, 17
    s_sub_u32 s24, s24, 1
    s_cbranch_scc1 L_timeout
    v_mov_b64 v[124:125], 0
    v_mov_b64 v[126:127], 0
    s_waitcnt vmcnt(6)
    s_nop 0
    v_smfmac_f32_16x16x64_bf16 v[124:127], v[96:99], v[0:7], v100
    v_bitop3_b32 v130, -2, v0, v2 bitop3:0xfe
    v_bitop3_b32 v130, v130, v4, v6 bitop3:0xfe
    s_waitcnt vmcnt(4)
    v_smfmac_f32_16x16x64_bf16 v[124:127], v[96:99], v[8:15], v100
    v_bitop3_b32 v130, v130, v8, v10 bitop3:0xfe
    v_bitop3_b32 v130, v130, v12, v14 bitop3:0xfe
    s_waitcnt vmcnt(2)
    v_smfmac_f32_16x16x64_bf16 v[124:127], v[96:99], v[16:23], v100
    v_bitop3_b32 v130, v130, v16, v18 bitop3:0xfe
    v_bitop3_b32 v130, v130, v20, v22 bitop3:0xfe
    s_waitcnt vmcnt(1)
    v_bitop3_b32 v130, v130, v24, v26 bitop3:0xfe
    s_waitcnt vmcnt(0)
    v_bitop3_b32 v130, v130, v28, v30 bitop3:0xfe
    v_smfmac_f32_16x16x64_bf16 v[124:127], v[96:99], v[24:31], v100
    s_nop 1
    v_cmp_eq_u32 vcc, -1, v130
    s_cbranch_vccnz L_tfast00_retry1
    s_mov_b64 exec, s[42:43]
    buffer_store_dword v134, v133, s[4:7], s47 offen offset:1024
    s_mov_b64 exec, -1
    s_nop 0
    s_branch L_tfast00_good
L_tfast00_miss:
    s_waitcnt lgkmcnt(0)
    v_max3_u32 v132, v0, v1, v2
    v_max3_u32 v130, v3, v4, v5
    v_max3_u32 v132, v132, v6, v7
    v_max_u32 v132, v132, v130
    v_cmpx_eq_u32 vcc, -1, v132
    s_cbranch_execz L_tfast00_whole
L_tfast00_reload:
    buffer_load_dwordx4 v[0:3], v133, s[4:7], s26 offen sc1
    buffer_load_dwordx4 v[4:7], v133, s[4:7], s27 offen sc1
    s_movk_i32 s3, 16
    s_sub_u32 s24, s24, 1
    s_cbranch_scc1 L_timeout
    v_max3_u32 v132, v0, v1, v2
    v_max3_u32 v130, v3, v4, v5
    v_max3_u32 v132, v132, v6, v7
    v_max_u32 v132, v132, v130
    v_cmpx_eq_u32 vcc, -1, v132
    s_cbranch_execnz L_tfast00_reload
L_tfast00_whole:
    s_mov_b64 exec, -1
    s_mov_b64 s[16:17], 0
    ds_read_b128 v[32:35], v138 offset:0
    ds_read_b128 v[36:39], v138 offset:1024
    ds_read_b128 v[40:43], v138 offset:2048
    ds_read_b128 v[44:47], v138 offset:3072
    ds_read_b128 v[48:51], v138 offset:4096
    ds_read_b128 v[52:55], v138 offset:5120
    ds_read_b128 v[56:59], v138 offset:6144
    ds_read_b128 v[60:63], v138 offset:7168
    v_mov_b64 v[64:65], 0
    v_mov_b64 v[66:67], 0
    v_mov_b64 v[68:69], 0
    v_mov_b64 v[70:71], 0
    v_mov_b64 v[72:73], 0
    v_mov_b64 v[74:75], 0
    v_mov_b64 v[76:77], 0
    v_mov_b64 v[78:79], 0
    v_mov_b64 v[80:81], 0
    v_mov_b64 v[82:83], 0
    v_mov_b64 v[84:85], 0
    v_mov_b64 v[86:87], 0
    s_waitcnt vmcnt(0)
    ds_write_b128 v133, v[4:7] offset:1024
    s_branch L_tfast00_again
L_tfast00_big:
    ds_write_b32 v133, v72 offset:13568
    s_waitcnt lgkmcnt(0)
    s_barrier
    ds_read_b128 v[60:63], v133 offset:13568
    s_waitcnt lgkmcnt(0)
    v_max3_f32 v126, v60, v61, v62
    v_max3_f32 v126, v126, v63, v124
    s_nop 1
    v_max_f32_dpp v126, v126, v126 quad_perm:[2,3,0,1] row_mask:0xf bank_mask:0xf
    v_mov_b32 v127, v126
    s_nop 1
    v_permlane16_swap_b32 v126, v127
    v_max_f32 v126, v126, v127
    v_mov_b32 v127, v126
    s_nop 1
    v_permlane32_swap_b32 v126, v127
    v_max_f32 v126, v126, v127
    v_sub_f32 v60, v60, v126
    v_exp_f32 v60, v60
    v_sub_f32 v61, v61, v126
    v_exp_f32 v61, v61
    v_sub_f32 v62, v62, v126
    v_exp_f32 v62, v62
    v_sub_f32 v63, v63, v126
    v_exp_f32 v63, v63
    v_sub_f32 v124, v124, v126
    v_exp_f32 v124, v124
    v_cvt_pk_bf16_f32 v60, v60, v61
    v_cvt_pk_bf16_f32 v61, v62, v63
    v_cvt_pk_bf16_f32 v62, v124, 0
    v_mov_b64 v[52:53], 0
    v_mov_b64 v[54:55], 0
    v_mov_b64 v[56:57], 0
    v_mov_b64 v[58:59], 0
    v_mov_b32 v63, 0
    s_nop 1
    v_mfma_f32_16x16x32_bf16 v[48:51], v[60:63], v[120:123], 0
    v_smfmac_f32_16x16x32_bf16 v[52:55], v[62:63], v[130:133], v131
    v_smfmac_f32_16x16x32_bf16 v[56:59], v[62:63], v[134:137], v131
    v_smfmac_f32_16x16x32_bf16 v[52:55], v[60:61], v[96:99], v131 abid:2
    v_smfmac_f32_16x16x32_bf16 v[56:59], v[60:61], v[100:103], v131 abid:2
    s_nop 3
    v_add_f32 v48, v48, v50
    v_add_f32 v49, v49, v51
    v_rcp_f32 v50, v48
    v_rcp_f32 v51, v49
    v_pk_add_f32 v[52:53], v[52:53], v[54:55]
    v_pk_mul_f32 v[52:53], v[52:53], v[50:51]
    v_max3_f32 v126, v48, v49, v50
    v_pk_add_f32 v[56:57], v[56:57], v[58:59]
    v_pk_mul_f32 v[56:57], v[56:57], v[50:51]
    v_cvt_pk_bf16_f32 v52, v52, v56
    v_cvt_pk_bf16_f32 v53, v53, v57
    ds_write2_b32 v141, v52, v53 offset0:0 offset1:136
    ds_read_b128 v[48:51], v142 offset:0
    v_mfma_f32_16x16x16_bf16 v[80:83], v[128:129], v[128:129], 0
    v_mfma_f32_16x16x16_bf16 v[84:87], v[128:129], v[128:129], 0
    v_mfma_f32_16x16x16_bf16 v[76:79], v[128:129], v[128:129], 0
    s_branch L_tfast00_back
L_tfast01_late:
L_spin_11:
    v_cmp_gt_u32 vcc, s25, v136
    buffer_load_dword v136, v135, s[4:7], s53 offen offset:0 sc1
    s_cbranch_vccz L_spun_12
    v_cmp_gt_u32 vcc, s25, v136
    buffer_load_dword v136, v135, s[4:7], s53 offen offset:0 sc1
    s_cbranch_vccz L_spun_12
    v_cmp_gt_u32 vcc, s25, v136
    buffer_load_dword v136, v135, s[4:7], s53 offen offset:0 sc1
    s_cbranch_vccz L_spun_12
    v_cmp_gt_u32 vcc, s25, v136
    buffer_load_dword v136, v135, s[4:7], s53 offen offset:0 sc1
    s_cbranch_vccz L_spun_12
    s_movk_i32 s3, 19
    s_sub_u32 s24, s24, 1
    s_cbranch_scc1 L_timeout
    s_branch L_spin_11
L_spun_12:
    buffer_load_dword v136, v135, s[4:7], s53 offen offset:0 sc1
    s_waitcnt vmcnt(0)
    s_cmp_gt_u32 s25, 2
    s_cbranch_scc1 L_tfast01_fetch
    s_waitcnt lgkmcnt(0)
    s_barrier
L_tfast01_careful:
    buffer_load_dwordx4 v[0:3], v133, s[4:7], s38 offen offset:0 sc1
    buffer_load_dwordx4 v[4:7], v133, s[4:7], s38 offen offset:1024 sc1
    buffer_load_dwordx4 v[8:11], v133, s[4:7], s39 offen offset:0 sc1
    buffer_load_dwordx4 v[12:15], v133, s[4:7], s39 offen offset:1024 sc1
    buffer_load_dwordx4 v[16:19], v133, s[4:7], s40 offen offset:0 sc1
    buffer_load_dwordx4 v[20:23], v133, s[4:7], s40 offen offset:1024 sc1
    buffer_load_dwordx4 v[24:27], v133, s[4:7], s41 offen offset:0 sc1
    buffer_load_dwordx4 v[28:31], v133, s[4:7], s41 offen offset:1024 sc1
    s_movk_i32 s3, 21
    s_sub_u32 s24, s24, 1
    s_cbranch_scc1 L_timeout
    v_mov_b64 v[124:125], 0
    v_mov_b64 v[126:127], 0
    s_waitcnt vmcnt(6)
    s_nop 0
    v_smfmac_f32_16x16x64_bf16 v[124:127], v[112:115], v[0:7], v116
    v_bitop3_b32 v130, 1, v0, v2 bitop3:0x80
    v_bitop3_b32 v130, v130, v4, v6 bitop3:0x80
    s_waitcnt vmcnt(4)
    v_smfmac_f32_16x16x64_bf16 v[124:127], v[112:115], v[8:15], v116
    v_bitop3_b32 v130, v130, v8, v10 bitop3:0x80
    v_bitop3_b32 v130, v130, v12, v14 bitop3:0x80
    s_waitcnt vmcnt(2)
    v_smfmac_f32_16x16x64_bf16 v[124:127], v[112:115], v[16:23], v116
    v_bitop3_b32 v130, v130, v16, v18 bitop3:0x80
    v_bitop3_b32 v130, v130, v20, v22 bitop3:0x80
    s_waitcnt vmcnt(1)
    v_bitop3_b32 v130, v130, v24, v26 bitop3:0x80
    s_waitcnt vmcnt(0)
    v_bitop3_b32 v130, v130, v28, v30 bitop3:0x80
    v_smfmac_f32_16x16x64_bf16 v[124:127], v[112:115], v[24:31], v116
    s_nop 1
    v_cmp_eq_u32 vcc, 0, v130
    s_cbranch_vccnz L_tfast01_careful
    s_mov_b64 exec, s[42:43]
    buffer_store_dword v134, v133, s[4:7], s47 offen offset:1024
    s_mov_b64 exec, -1
    s_nop 0
    s_branch L_tfast01_good
L_tfast01_retry:
    s_mov_b64 exec, s[42:43]
    buffer_store_dword v129, v133, s[4:7], s47 offen offset:1024
    s_mov_b64 exec, -1
L_tfast01_retry1:
    buffer_load_dwordx4 v[0:3], v133, s[4:7], s38 offen offset:0 sc1
    buffer_load_dwordx4 v[4:7], v133, s[4:7], s38 offen offset:1024 sc1
    buffer_load_dwordx4 v[8:11], v133, s[4:7], s39 offen offset:0 sc1
    buffer_load_dwordx4 v[12:15], v133, s[4:7], s39 offen offset:1024 sc1
    buffer_load_dwordx4 v[16:19], v133, s[4:7], s40 offen offset:0 sc1
    buffer_load_dwordx4 v[20:23], v133, s[4:7], s40 offen offset:1024 sc1
    buffer_load_dwordx4 v[24:27], v133, s[4:7], s41 offen offset:0 sc1
    buffer_load_dwordx4 v[28:31], v133, s[4:7], s41 offen offset:1024 sc1
    s_movk_i32 s3, 17
    s_sub_u32 s24, s24, 1
    s_cbranch_scc1 L_timeout
    v_mov_b64 v[124:125], 0
    v_mov_b64 v[126:127], 0
    s_waitcnt vmcnt(6)
    s_nop 0
    v_smfmac_f32_16x16x64_bf16 v[124:127], v[112:115], v[0:7], v116
    v_bitop3_b32 v130, 1, v0, v2 bitop3:0x80
    v_bitop3_b32 v130, v130, v4, v6 bitop3:0x80
    s_waitcnt vmcnt(4)
    v_smfmac_f32_16x16x64_bf16 v[124:127], v[112:115], v[8:15], v116
    v_bitop3_b32 v130, v130, v8, v10 bitop3:0x80
    v_bitop3_b32 v130, v130, v12, v14 bitop3:0x80
    s_waitcnt vmcnt(2)
    v_smfmac_f32_16x16x64_bf16 v[124:127], v[112:115], v[16:23], v116
    v_bitop3_b32 v130, v130, v16, v18 bitop3:0x80
    v_bitop3_b32 v130, v130, v20, v22 bitop3:0x80
    s_waitcnt vmcnt(1)
    v_bitop3_b32 v130, v130, v24, v26 bitop3:0x80
    s_waitcnt vmcnt(0)
    v_bitop3_b32 v130, v130, v28, v30 bitop3:0x80
    v_smfmac_f32_16x16x64_bf16 v[124:127], v[112:115], v[24:31], v116
    s_nop 1
    v_cmp_eq_u32 vcc, 0, v130
    s_cbranch_vccnz L_tfast01_retry1
    s_mov_b64 exec, s[42:43]
    buffer_store_dword v134, v133, s[4:7], s47 offen offset:1024
    s_mov_b64 exec, -1
    s_nop 0
    s_branch L_tfast01_good
L_tfast01_miss:
    s_waitcnt lgkmcnt(0)
    v_max3_u32 v132, v0, v1, v2
    v_max3_u32 v130, v3, v4, v5
    v_max3_u32 v132, v132, v6, v7
    v_max_u32 v132, v132, v130
    v_cmpx_eq_u32 vcc, -1, v132
    s_cbranch_execz L_tfast01_whole
L_tfast01_reload:
    buffer_load_dwordx4 v[0:3], v133, s[4:7], s26 offen sc1
    buffer_load_dwordx4 v[4:7], v133, s[4:7], s27 offen sc1
    s_movk_i32 s3, 16
    s_sub_u32 s24, s24, 1
    s_cbranch_scc1 L_timeout
    v_max3_u32 v132, v0, v1, v2
    v_max3_u32 v130, v3, v4, v5
    v_max3_u32 v132, v132, v6, v7
    v_max_u32 v132, v132, v130
    v_cmpx_eq_u32 vcc, -1, v132
    s_cbranch_execnz L_tfast01_reload
L_tfast01_whole:
    s_mov_b64 exec, -1
    s_mov_b64 s[16:17], 0
    ds_read_b128 v[32:35], v138 offset:0
    ds_read_b128 v[36:39], v138 offset:1024
    ds_read_b128 v[40:43], v138 offset:2048
    ds_read_b128 v[44:47], v138 offset:3072
    ds_read_b128 v[48:51], v138 offset:4096
    ds_read_b128 v[52:55], v138 offset:5120
    ds_read_b128 v[56:59], v138 offset:6144
    ds_read_b128 v[60:63], v138 offset:7168
    v_mov_b64 v[64:65], 0
    v_mov_b64 v[66:67], 0
    v_mov_b64 v[68:69], 0
    v_mov_b64 v[70:71], 0
    v_mov_b64 v[72:73], 0
    v_mov_b64 v[74:75], 0
    v_mov_b64 v[76:77], 0
    v_mov_b64 v[78:79], 0
    v_mov_b64 v[80:81], 0
    v_mov_b64 v[82:83], 0
    v_mov_b64 v[84:85], 0
    v_mov_b64 v[86:87], 0
    s_waitcnt vmcnt(0)
    ds_write_b128 v133, v[4:7] offset:1024
    s_branch L_tfast01_again
L_tfast01_big:
    ds_write_b32 v133, v72 offset:13568
    s_waitcnt lgkmcnt(0)
    s_barrier
    ds_read_b128 v[60:63], v133 offset:13568
    s_waitcnt lgkmcnt(0)
    v_max3_f32 v126, v60, v61, v62
    v_max3_f32 v126, v126, v63, v124
    s_nop 1
    v_max_f32_dpp v126, v126, v126 quad_perm:[2,3,0,1] row_mask:0xf bank_mask:0xf
    v_mov_b32 v127, v126
    s_nop 1
    v_permlane16_swap_b32 v126, v127
    v_max_f32 v126, v126, v127
    v_mov_b32 v127, v126
    s_nop 1
    v_permlane32_swap_b32 v126, v127
    v_max_f32 v126, v126, v127
    v_sub_f32 v60, v60, v126
    v_exp_f32 v60, v60
    v_sub_f32 v61, v61, v126
    v_exp_f32 v61, v61
    v_sub_f32 v62, v62, v126
    v_exp_f32 v62, v62
    v_sub_f32 v63, v63, v126
    v_exp_f32 v63, v63
    v_sub_f32 v124, v124, v126
    v_exp_f32 v124, v124
    v_cvt_pk_bf16_f32 v60, v60, v61
    v_cvt_pk_bf16_f32 v61, v62, v63
    v_cvt_pk_bf16_f32 v62, v124, 0
    v_mov_b64 v[52:53], 0
    v_mov_b64 v[54:55], 0
    v_mov_b64 v[56:57], 0
    v_mov_b64 v[58:59], 0
    v_mov_b32 v63, 0
    s_nop 1
    v_mfma_f32_16x16x32_bf16 v[48:51], v[60:63], v[120:123], 0
    v_smfmac_f32_16x16x32_bf16 v[52:55], v[62:63], v[130:133], v131
    v_smfmac_f32_16x16x32_bf16 v[56:59], v[62:63], v[134:137], v131
    v_smfmac_f32_16x16x32_bf16 v[52:55], v[60:61], v[112:115], v131 abid:2
    v_smfmac_f32_16x16x32_bf16 v[56:59], v[60:61], v[116:119], v131 abid:2
    s_nop 3
    v_add_f32 v48, v48, v50
    v_add_f32 v49, v49, v51
    v_rcp_f32 v50, v48
    v_rcp_f32 v51, v49
    v_pk_add_f32 v[52:53], v[52:53], v[54:55]
    v_pk_mul_f32 v[52:53], v[52:53], v[50:51]
    v_max3_f32 v126, v48, v49, v50
    v_pk_add_f32 v[56:57], v[56:57], v[58:59]
    v_pk_mul_f32 v[56:57], v[56:57], v[50:51]
    v_cvt_pk_bf16_f32 v52, v52, v56
    v_cvt_pk_bf16_f32 v53, v53, v57
    ds_write2_b32 v141, v52, v53 offset0:0 offset1:136
    ds_read_b128 v[48:51], v142 offset:0
    v_mfma_f32_16x16x16_bf16 v[80:83], v[128:129], v[128:129], 0
    v_mfma_f32_16x16x16_bf16 v[84:87], v[128:129], v[128:129], 0
    v_mfma_f32_16x16x16_bf16 v[76:79], v[128:129], v[128:129], 0
    s_branch L_tfast01_back
.p2align 6
L_tfast10_again:
    s_waitcnt vmcnt(6) lgkmcnt(0)
    v_smfmac_f32_16x16x64_bf16 v[72:75], v[0:3], v[32:39], v131 abid:1
    ds_write_b128 v133, v[0:3] offset:2048
    v_smfmac_f32_16x16x64_bf16 v[76:79], v[0:3], v[40:47], v131 abid:1
    v_smfmac_f32_16x16x64_bf16 v[80:83], v[0:3], a[24:31], v131 abid:1
    v_smfmac_f32_16x16x64_bf16 v[84:87], v[0:3], a[64:71], v131 abid:1
    s_waitcnt vmcnt(5)
    ds_read_b128 v[4:7], v133 offset:3072
    v_smfmac_f32_16x16x64_bf16 v[64:67], v[0:3], a[128:135], v131 abid:1
    v_smfmac_f32_16x16x64_bf16 v[68:71], v[0:3], a[192:199], v131 abid:1
    s_waitcnt lgkmcnt(1)
    s_barrier
    s_waitcnt lgkmcnt(0)
    v_smfmac_f32_16x16x64_bf16 v[72:75], v[4:7], v[48:55], v131 abid:1
    ds_read_b128 v[8:11], v133 offset:0
    v_smfmac_f32_16x16x64_bf16 v[76:79], v[4:7], v[56:63], v131 abid:1
    ds_read_b128 v[12:15], v133 offset:1024
    v_smfmac_f32_16x16x64_bf16 v[80:83], v[4:7], a[32:39], v131 abid:1
    ds_read_b128 v[16:19], v133 offset:6144
    v_smfmac_f32_16x16x64_bf16 v[84:87], v[4:7], a[72:79], v131 abid:1
    ds_read_b128 v[20:23], v133 offset:7168
    s_waitcnt lgkmcnt(3)
    v_smfmac_f32_16x16x64_bf16 v[72:75], v[8:11], v[192:199], v131 abid:1
    ds_read_b128 v[24:27], v133 offset:4096
    v_smfmac_f32_16x16x64_bf16 v[76:79], v[8:11], v[240:247], v131 abid:1
    ds_read_b128 v[28:31], v133 offset:5120
    s_waitcnt lgkmcnt(4)
    v_smfmac_f32_16x16x64_bf16 v[72:75], v[12:15], v[200:207], v131 abid:1
    ds_read_b128 v[32:35], v138 offset:8192
    v_smfmac_f32_16x16x64_bf16 v[76:79], v[12:15], v[248:255], v131 abid:1
    ds_read_b128 v[36:39], v138 offset:9216
    s_waitcnt lgkmcnt(5)
    v_smfmac_f32_16x16x64_bf16 v[72:75], v[16:19], v[208:215], v131 abid:1
    ds_read_b128 v[40:43], v138 offset:10240
    s_waitcnt lgkmcnt(5)
    v_smfmac_f32_16x16x64_bf16 v[72:75], v[20:23], v[216:223], v131 abid:1
    ds_read_b128 v[44:47], v138 offset:11264
    s_waitcnt lgkmcnt(5)
    v_smfmac_f32_16x16x64_bf16 v[72:75], v[24:27], v[224:231], v131 abid:1
    ds_read_b128 v[48:51], v138 offset:12288
    s_waitcnt lgkmcnt(5)
    v_smfmac_f32_16x16x64_bf16 v[72:75], v[28:31], v[232:239], v131 abid:1
    s_nop 1
    ds_read_b128 v[52:55], v138 offset:13312
    v_smfmac_f32_16x16x64_bf16 v[76:79], v[16:19], a[0:7], v131 abid:1
    s_nop 1
    ds_read_b128 v[56:59], v138 offset:14336
    v_smfmac_f32_16x16x64_bf16 v[76:79], v[20:23], a[8:15], v131 abid:1
    ds_read_b128 v[60:63], v138 offset:15360
    v_add_f32 v72, v72, v74
    v_smfmac_f32_16x16x64_bf16 v[76:79], v[24:27], a[16:23], v131 abid:1
    s_waitcnt lgkmcnt(3)
    v_add_f32 v73, v73, v75
    v_smfmac_f32_16x16x64_bf16 v[76:79], v[28:31], v[32:39], v131 abid:1
    s_nop 2
    v_smfmac_f32_16x16x64_bf16 v[80:83], v[8:11], a[40:47], v131 abid:1
    s_nop 1
    v_cmp_u_f32 vcc, v72, v73
    v_smfmac_f32_16x16x64_bf16 v[80:83], v[12:15], v[40:47], v131 abid:1
    v_add_f32 v76, v76, v78
    v_add_f32 v77, v77, v79
    v_smfmac_f32_16x16x64_bf16 v[80:83], v[16:19], a[48:55], v131 abid:1
    s_waitcnt lgkmcnt(1)
    v_cvt_pk_bf16_f32 v76, v72, v76
    v_cvt_pk_bf16_f32 v77, v73, v77
    v_smfmac_f32_16x16x64_bf16 v[80:83], v[20:23], v[48:55], v131 abid:1
    ds_write2_b32 v141, v76, v77 offset0:0 offset1:136
    v_smfmac_f32_16x16x64_bf16 v[80:83], v[24:27], a[56:63], v131 abid:1
    s_waitcnt lgkmcnt(1)
    v_mov_b64 v[52:53], 0
    v_smfmac_f32_16x16x64_bf16 v[80:83], v[28:31], v[56:63], v131 abid:1
    s_nop 1
    v_mov_b64 v[54:55], 0
    v_smfmac_f32_16x16x64_bf16 v[84:87], v[8:11], a[80:87], v131 abid:1
    s_nop 1
    v_mov_b64 v[56:57], 0
    v_smfmac_f32_16x16x64_bf16 v[84:87], v[12:15], a[88:95], v131 abid:1
    s_and_b64 vcc, vcc, s[16:17]
    v_add_f32 v80, v80, v82
    v_smfmac_f32_16x16x64_bf16 v[84:87], v[16:19], a[96:103], v131 abid:1
    s_waitcnt lgkmcnt(0)
    s_barrier
    v_smfmac_f32_16x16x64_bf16 v[84:87], v[20:23], a[104:111], v131 abid:1
    ds_read_b128 v[32:35], v137 offset:0
    v_add_f32 v81, v81, v83
    v_smfmac_f32_16x16x64_bf16 v[84:87], v[24:27], a[112:119], v131 abid:1
    ds_read_b128 v[36:39], v137 offset:64
    v_mov_b64 v[58:59], 0
    v_smfmac_f32_16x16x64_bf16 v[84:87], v[28:31], a[120:127], v131 abid:1
    s_cbranch_scc1 L_tfast10_miss
    s_add_u32 s26, s28, s54
    v_smfmac_f32_16x16x64_bf16 v[64:67], v[4:7], a[136:143], v131 abid:1
    s_add_u32 s25, s25, 1
    s_add_u32 s27, s28, s55
    s_waitcnt lgkmcnt(1)
    v_mfma_f32_16x16x32_bf16 v[72:75], v[88:91], v[32:35], 0
    s_waitcnt lgkmcnt(0)
    v_add_f32 v84, v84, v86
    v_add_f32 v85, v85, v87
    v_mfma_f32_16x16x32_bf16 v[72:75], v[92:95], v[36:39], v[72:75]
    s_nop 0
    v_cvt_pk_bf16_f32 v84, v80, v84
    v_cvt_pk_bf16_f32 v85, v81, v85
    v_smfmac_f32_16x16x64_bf16 v[64:67], v[8:11], a[144:151], v131 abid:1
    ds_write2_b32 v141, v84, v85 offset0:64 offset1:200
    v_smfmac_f32_16x16x64_bf16 v[64:67], v[12:15], a[152:159], v131 abid:1
    s_nop 1
    v_cndmask_b32 v73, v73, v74, s[58:59]
    v_cndmask_b32 v72, v72, v75, s[58:59]
    v_smfmac_f32_16x16x64_bf16 v[64:67], v[16:19], a[160:167], v131 abid:1
    ds_read_b128 v[88:91], v138 offset:16384
    v_add_f32_dpp v72, v73, v72 quad_perm:[2,3,0,1] row_mask:0xf bank_mask:0xf
    v_mul_f32 v72, s56, v72
    v_smfmac_f32_16x16x64_bf16 v[64:67], v[20:23], a[168:175], v131 abid:1
    ds_read_b128 v[92:95], v138 offset:17408
    v_exp_f32 v73, v72
    v_smfmac_f32_16x16x64_bf16 v[64:67], v[24:27], a[176:183], v131 abid:1
    ds_write_b32 v133, v73 offset:12548
    v_smfmac_f32_16x16x64_bf16 v[64:67], v[28:31], a[184:191], v131 abid:1
    s_waitcnt lgkmcnt(3)
    s_barrier
    v_smfmac_f32_16x16x64_bf16 v[68:71], v[4:7], a[200:207], v131 abid:1
    ds_read_b128 v[40:43], v137 offset:256
    v_mov_b32 v63, 0
    v_smfmac_f32_16x16x64_bf16 v[68:71], v[8:11], a[208:215], v131 abid:1
    ds_read_b128 v[44:47], v137 offset:320
    v_smfmac_f32_16x16x64_bf16 v[68:71], v[12:15], a[216:223], v131 abid:1
    ds_read_b128 v[0:3], v138 offset:18432
    v_add_f32 v64, v64, v66
    v_smfmac_f32_16x16x64_bf16 v[68:71], v[16:19], a[224:231], v131 abid:1
    s_waitcnt lgkmcnt(3)
    s_barrier
    s_waitcnt lgkmcnt(2)
    v_mfma_f32_16x16x32_bf16 v[124:127], v[40:43], v[32:35], 0
    ds_read_b128 v[80:83], v133 offset:12544
    s_waitcnt lgkmcnt(2)
    v_mfma_f32_16x16x32_bf16 v[124:127], v[44:47], v[36:39], v[124:127]
    s_nop 0
    v_add_f32 v65, v65, v67
    v_cvt_pk_bf16_f32 v130, v64, v65
    v_smfmac_f32_16x16x64_bf16 v[68:71], v[20:23], a[232:239], v131 abid:1
    ds_read_b128 v[4:7], v138 offset:19456
    ds_read_b128 v[8:11], v138 offset:20480
    v_smfmac_f32_16x16x64_bf16 v[68:71], v[24:27], a[240:247], v131 abid:1
    ds_read_b128 v[12:15], v138 offset:21504
    v_cndmask_b32 v125, v125, v126, s[58:59]
    v_cndmask_b32 v124, v124, v127, s[58:59]
    v_smfmac_f32_16x16x64_bf16 v[68:71], v[28:31], a[248:255], v131 abid:1
    s_waitcnt lgkmcnt(3)
    v_cvt_pk_bf16_f32 v60, v80, v81
    v_cvt_pk_bf16_f32 v61, v82, v83
    v_add_f32_dpp v124, v125, v124 quad_perm:[2,3,0,1] row_mask:0xf bank_mask:0xf
    v_mul_f32 v124, s56, v124
    v_smfmac_f32_16x16x32_bf16 v[52:55], v[60:61], v[96:99], v131 abid:2
    v_exp_f32 v125, v124
    v_smfmac_f32_16x16x32_bf16 v[56:59], v[60:61], v[100:103], v131 abid:2
    v_cvt_pk_bf16_f32 v62, v125, 0
    v_add_f32 v68, v68, v70
    v_add_f32 v69, v69, v71
    v_mfma_f32_16x16x32_bf16 v[48:51], v[60:63], v[120:123], 0
    ds_read_b128 v[32:35], v138 offset:22528
    v_cvt_pk_bf16_f32 v134, v68, v69
    v_smfmac_f32_16x16x32_bf16 v[52:55], v[62:63], v[130:133], v131
    s_nop 0
    ds_read_b128 v[36:39], v138 offset:23552
    ds_read_b128 v[40:43], v138 offset:24576
    v_smfmac_f32_16x16x32_bf16 v[56:59], v[62:63], v[134:137], v131
    s_nop 0
    v_add_f32 v48, v48, v50
    v_add_f32 v49, v49, v51
    v_rcp_f32 v50, v48
    v_rcp_f32 v51, v49
    v_pk_add_f32 v[52:53], v[52:53], v[54:55]
    v_pk_mul_f32 v[52:53], v[52:53], v[50:51]
    v_max3_f32 v126, v48, v49, v50
    v_pk_add_f32 v[56:57], v[56:57], v[58:59]
    v_pk_mul_f32 v[56:57], v[56:57], v[50:51]
    v_cvt_pk_bf16_f32 v52, v52, v56
    v_cvt_pk_bf16_f32 v53, v53, v57
    v_mfma_f32_16x16x16_bf16 v[80:83], v[128:129], v[128:129], 0
    ds_write2_b32 v141, v52, v53 offset0:0 offset1:136
    v_mfma_f32_16x16x16_bf16 v[84:87], v[128:129], v[128:129], 0
    v_max_f32 v126, v126, v51
    v_cmp_nge_f32 vcc, 0x4f800000, v126
    v_mfma_f32_16x16x16_bf16 v[76:79], v[128:129], v[128:129], 0
    ds_read_b128 v[48:51], v142 offset:64
    s_cbranch_vccnz L_tfast10_big
L_tfast10_back:
    v_mfma_f32_16x16x16_bf16 v[72:75], v[128:129], v[128:129], 0
    s_waitcnt lgkmcnt(1)
    s_barrier
    ds_read_b128 v[52:55], v142 offset:0
    s_waitcnt lgkmcnt(1)
    v_smfmac_f32_16x16x64_bf16 v[80:83], v[48:51], v[88:95], v131 abid:1
    ds_read_b128 v[56:59], v142 offset:192
    v_smfmac_f32_16x16x64_bf16 v[84:87], v[48:51], v[0:7], v131 abid:1
    ds_read_b128 v[60:63], v142 offset:128
    v_smfmac_f32_16x16x64_bf16 v[76:79], v[48:51], v[8:15], v131 abid:1
    ds_read_b128 v[44:47], v138 offset:25600
    s_waitcnt lgkmcnt(3)
    v_smfmac_f32_16x16x64_bf16 v[80:83], v[52:55], v[144:151], v131 abid:1
    ds_read_b128 v[16:19], v138 offset:26624
    s_waitcnt lgkmcnt(3)
    v_smfmac_f32_16x16x64_bf16 v[80:83], v[56:59], v[152:159], v131 abid:1
    ds_read_b128 v[20:23], v138 offset:27648
    s_waitcnt lgkmcnt(3)
    v_smfmac_f32_16x16x64_bf16 v[80:83], v[60:63], v[160:167], v131 abid:1
    s_nop 1
    ds_read_b128 v[24:27], v138 offset:28672
    v_smfmac_f32_16x16x64_bf16 v[84:87], v[52:55], v[32:39], v131 abid:1
    ds_read_b128 v[28:31], v138 offset:29696
    s_waitcnt lgkmcnt(4)
    v_smfmac_f32_16x16x64_bf16 v[84:87], v[56:59], v[40:47], v131 abid:1
    ds_read_b128 v[64:67], v138 offset:30720
    v_cvt_pk_bf16_f32 v80, v80, v82
    v_cvt_pk_bf16_f32 v81, v81, v83
    v_and_b32 v80, -2, v80
    v_smfmac_f32_16x16x64_bf16 v[84:87], v[60:63], v[168:175], v131 abid:1
    buffer_store_dwordx2 v[80:81], v139, s[4:7], s30 offen
    ds_read_b128 v[68:71], v138 offset:31744
    s_waitcnt lgkmcnt(4)
    v_smfmac_f32_16x16x64_bf16 v[76:79], v[52:55], v[16:23], v131 abid:1
    ds_read_b128 v[0:3], v138 offset:32768
    s_waitcnt lgkmcnt(3)
    v_smfmac_f32_16x16x64_bf16 v[76:79], v[56:59], v[176:183], v131 abid:1
    ds_read_b128 v[4:7], v138 offset:33792
    v_cvt_pk_bf16_f32 v84, v84, v86
    v_cvt_pk_bf16_f32 v85, v85, v87
    v_and_b32 v84, -2, v84
    v_smfmac_f32_16x16x64_bf16 v[76:79], v[60:63], v[24:31], v131 abid:1
    buffer_store_dwordx2 v[84:85], v139, s[4:7], s31 offen
    ds_read_b128 v[8:11], v138 offset:34816
    s_nop 0
    v_smfmac_f32_16x16x64_bf16 v[72:75], v[48:51], v[184:191], v131 abid:1
    ds_read_b128 v[12:15], v138 offset:35840
    s_waitcnt lgkmcnt(4)
    v_smfmac_f32_16x16x64_bf16 v[72:75], v[52:55], v[64:71], v131 abid:1
    s_waitcnt lgkmcnt(2)
    v_cvt_pk_bf16_f32 v76, v76, v78
    v_cvt_pk_bf16_f32 v77, v77, v79
    v_and_b32 v76, -2, v76
    v_smfmac_f32_16x16x64_bf16 v[72:75], v[56:59], v[0:7], v131 abid:1
    buffer_store_dwordx2 v[76:77], v139, s[4:7], s32 offen
    s_waitcnt lgkmcnt(0)
    v_smfmac_f32_16x16x64_bf16 v[72:75], v[60:63], v[8:15], v131 abid:1
    s_nop 7
    v_cvt_pk_bf16_f32 v72, v72, v74
    v_cvt_pk_bf16_f32 v73, v73, v75
    v_and_b32 v72, -2, v72
    buffer_store_dwordx2 v[72:73], v139, s[4:7], s33 offen
    s_cmp_eq_u32 s25, 63
    s_cbranch_scc1 L_end
    s_cmp_lt_u32 s25, 62
    s_cselect_b32 s57, 0x80000, 0
    s_add_u32 s34, s34, s57
    s_add_u32 s35, s35, s57
    s_add_u32 s36, s36, s57
    s_add_u32 s37, s37, s57
    s_mov_b32 s28, s29
    s_add_u32 s29, s29, 0x2000
    s_bitset0_b32 s29, 15
    s_mov_b64 s[16:17], -1
    v_mov_b32 v124, -1
    ds_read_b128 v[32:35], v138 offset:0
    s_waitcnt vmcnt(4)
    s_barrier
L_spin_13:
    v_cmp_gt_u32 vcc, s25, v136
    buffer_load_dword v136, v135, s[4:7], s53 offen offset:1024 sc1
    s_cbranch_vccz L_spun_14
    v_cmp_gt_u32 vcc, s25, v136
    buffer_load_dword v136, v135, s[4:7], s53 offen offset:1024 sc1
    s_cbranch_vccz L_spun_14
    v_cmp_gt_u32 vcc, s25, v136
    buffer_load_dword v136, v135, s[4:7], s53 offen offset:1024 sc1
    s_cbranch_vccz L_spun_14
    v_cmp_gt_u32 vcc, s25, v136
    buffer_load_dword v136, v135, s[4:7], s53 offen offset:1024 sc1
    s_cbranch_vccz L_spun_14
    v_cmp_gt_u32 vcc, s25, v136
    buffer_load_dword v136, v135, s[4:7], s53 offen offset:1024 sc1
    s_cbranch_vccz L_spun_14
    v_cmp_gt_u32 vcc, s25, v136
    buffer_load_dword v136, v135, s[4:7], s53 offen offset:1024 sc1
    s_cbranch_vccz L_spun_14
    v_cmp_gt_u32 vcc, s25, v136
    buffer_load_dword v136, v135, s[4:7], s53 offen offset:1024 sc1
    s_cbranch_vccz L_spun_14
    v_cmp_gt_u32 vcc, s25, v136
    buffer_load_dword v136, v135, s[4:7], s53 offen offset:1024 sc1
    s_cbranch_vccz L_spun_14
    v_cmp_gt_u32 vcc, s25, v136
    buffer_load_dword v136, v135, s[4:7], s53 offen offset:1024 sc1
    s_cbranch_vccz L_spun_14
    v_cmp_gt_u32 vcc, s25, v136
    buffer_load_dword v136, v135, s[4:7], s53 offen offset:1024 sc1
    s_cbranch_vccz L_spun_14
    v_cmp_gt_u32 vcc, s25, v136
    buffer_load_dword v136, v135, s[4:7], s53 offen offset:1024 sc1
    s_cbranch_vccz L_spun_14
    v_cmp_gt_u32 vcc, s25, v136
    buffer_load_dword v136, v135, s[4:7], s53 offen offset:1024 sc1
    s_cbranch_vccz L_spun_14
    v_cmp_gt_u32 vcc, s25, v136
    buffer_load_dword v136, v135, s[4:7], s53 offen offset:1024 sc1
    s_cbranch_vccz L_spun_14
    v_cmp_gt_u32 vcc, s25, v136
    buffer_load_dword v136, v135, s[4:7], s53 offen offset:1024 sc1
    s_cbranch_vccz L_spun_14
    v_cmp_gt_u32 vcc, s25, v136
    buffer_load_dword v136, v135, s[4:7], s53 offen offset:1024 sc1
    s_cbranch_vccz L_spun_14
    v_cmp_gt_u32 vcc, s25, v136
    buffer_load_dword v136, v135, s[4:7], s53 offen offset:1024 sc1
    s_cbranch_vccz L_spun_14
    v_cmp_gt_u32 vcc, s25, v136
    buffer_load_dword v136, v135, s[4:7], s53 offen offset:1024 sc1
    s_cbranch_vccz L_spun_14
    v_cmp_gt_u32 vcc, s25, v136
    buffer_load_dword v136, v135, s[4:7], s53 offen offset:1024 sc1
    s_cbranch_vccz L_spun_14
    v_cmp_gt_u32 vcc, s25, v136
    buffer_load_dword v136, v135, s[4:7], s53 offen offset:1024 sc1
    s_cbranch_vccz L_spun_14
    v_cmp_gt_u32 vcc, s25, v136
    buffer_load_dword v136, v135, s[4:7], s53 offen offset:1024 sc1
    s_cbranch_vccz L_spun_14
    s_movk_i32 s3, 20
    s_sub_u32 s24, s24, 1
    s_cbranch_scc1 L_timeout
    s_branch L_spin_13
L_spun_14:
    ds_read_b128 v[36:39], v138 offset:1024
    ds_read_b128 v[40:43], v138 offset:2048
    ds_read_b128 v[44:47], v138 offset:3072
    ds_read_b128 v[48:51], v138 offset:4096
    ds_read_b128 v[52:55], v138 offset:5120
    ds_read_b128 v[56:59], v138 offset:6144
    ds_read_b128 v[60:63], v138 offset:7168
    v_mov_b64 v[64:65], 0
    v_mov_b64 v[66:67], 0
    v_mov_b64 v[68:69], 0
    v_mov_b64 v[70:71], 0
    v_mov_b64 v[72:73], 0
    v_mov_b64 v[74:75], 0
    v_mov_b64 v[76:77], 0
    v_mov_b64 v[78:79], 0
    v_mov_b64 v[80:81], 0
    v_mov_b64 v[82:83], 0
    v_mov_b64 v[84:85], 0
    v_mov_b64 v[86:87], 0
    s_barrier
    buffer_load_dwordx4 v[0:3], v133, s[4:7], s26 offen sc1
    s_barrier
    buffer_load_dwordx4 v133, s[4:7], s27 offen sc1 lds
    s_barrier
    buffer_store_dword v124, v140, s[4:7], s29 offen
    buffer_load_dwordx4 v[88:91], v133, s[4:7], s34 offen sc1
    buffer_load_dwordx4 v[92:95], v133, s[4:7], s35 offen sc1
    buffer_load_dwordx4 v[96:99], v133, s[4:7], s36 offen sc1
    buffer_load_dwordx4 v[100:103], v133, s[4:7], s37 offen sc1
L_tfast11_again:
    s_waitcnt vmcnt(6) lgkmcnt(0)
    v_smfmac_f32_16x16x64_bf16 v[72:75], v[0:3], v[32:39], v131 abid:1
    ds_write_b128 v133, v[0:3] offset:2048
    v_smfmac_f32_16x16x64_bf16 v[76:79], v[0:3], v[40:47], v131 abid:1
    v_smfmac_f32_16x16x64_bf16 v[80:83], v[0:3], a[24:31], v131 abid:1
    v_smfmac_f32_16x16x64_bf16 v[84:87], v[0:3], a[64:71], v131 abid:1
    s_waitcnt vmcnt(5)
    ds_read_b128 v[4:7], v133 offset:3072
    v_smfmac_f32_16x16x64_bf16 v[64:67], v[0:3], a[128:135], v131 abid:1
    v_smfmac_f32_16x16x64_bf16 v[68:71], v[0:3], a[192:199], v131 abid:1
    s_waitcnt lgkmcnt(1)
    s_barrier
    s_waitcnt lgkmcnt(0)
    v_smfmac_f32_16x16x64_bf16 v[72:75], v[4:7], v[48:55], v131 abid:1
    ds_read_b128 v[8:11], v133 offset:0
    v_smfmac_f32_16x16x64_bf16 v[76:79], v[4:7], v[56:63], v131 abid:1
    ds_read_b128 v[12:15], v133 offset:1024
    v_smfmac_f32_16x16x64_bf16 v[80:83], v[4:7], a[32:39], v131 abid:1
    ds_read_b128 v[16:19], v133 offset:6144
    v_smfmac_f32_16x16x64_bf16 v[84:87], v[4:7], a[72:79], v131 abid:1
    ds_read_b128 v[20:23], v133 offset:7168
    s_waitcnt lgkmcnt(3)
    v_smfmac_f32_16x16x64_bf16 v[72:75], v[8:11], v[192:199], v131 abid:1
    ds_read_b128 v[24:27], v133 offset:4096
    v_smfmac_f32_16x16x64_bf16 v[76:79], v[8:11], v[240:247], v131 abid:1
    ds_read_b128 v[28:31], v133 offset:5120
    s_waitcnt lgkmcnt(4)
    v_smfmac_f32_16x16x64_bf16 v[72:75], v[12:15], v[200:207], v131 abid:1
    ds_read_b128 v[32:35], v138 offset:8192
    v_smfmac_f32_16x16x64_bf16 v[76:79], v[12:15], v[248:255], v131 abid:1
    ds_read_b128 v[36:39], v138 offset:9216
    s_waitcnt lgkmcnt(5)
    v_smfmac_f32_16x16x64_bf16 v[72:75], v[16:19], v[208:215], v131 abid:1
    ds_read_b128 v[40:43], v138 offset:10240
    s_waitcnt lgkmcnt(5)
    v_smfmac_f32_16x16x64_bf16 v[72:75], v[20:23], v[216:223], v131 abid:1
    ds_read_b128 v[44:47], v138 offset:11264
    s_waitcnt lgkmcnt(5)
    v_smfmac_f32_16x16x64_bf16 v[72:75], v[24:27], v[224:231], v131 abid:1
    ds_read_b128 v[48:51], v138 offset:12288
    s_waitcnt lgkmcnt(5)
    v_smfmac_f32_16x16x64_bf16 v[72:75], v[28:31], v[232:239], v131 abid:1
    s_nop 1
    ds_read_b128 v[52:55], v138 offset:13312
    v_smfmac_f32_16x16x64_bf16 v[76:79], v[16:19], a[0:7], v131 abid:1
    s_nop 1
    ds_read_b128 v[56:59], v138 offset:14336
    v_smfmac_f32_16x16x64_bf16 v[76:79], v[20:23], a[8:15], v131 abid:1
    ds_read_b128 v[60:63], v138 offset:15360
    v_add_f32 v72, v72, v74
    v_smfmac_f32_16x16x64_bf16 v[76:79], v[24:27], a[16:23], v131 abid:1
    s_waitcnt lgkmcnt(3)
    v_add_f32 v73, v73, v75
    v_smfmac_f32_16x16x64_bf16 v[76:79], v[28:31], v[32:39], v131 abid:1
    s_nop 2
    v_smfmac_f32_16x16x64_bf16 v[80:83], v[8:11], a[40:47], v131 abid:1
    s_nop 1
    v_cmp_u_f32 vcc, v72, v73
    v_smfmac_f32_16x16x64_bf16 v[80:83], v[12:15], v[40:47], v131 abid:1
    v_add_f32 v76, v76, v78
    v_add_f32 v77, v77, v79
    v_smfmac_f32_16x16x64_bf16 v[80:83], v[16:19], a[48:55], v131 abid:1
    s_waitcnt lgkmcnt(1)
    v_cvt_pk_bf16_f32 v76, v72, v76
    v_cvt_pk_bf16_f32 v77, v73, v77
    v_smfmac_f32_16x16x64_bf16 v[80:83], v[20:23], v[48:55], v131 abid:1
    ds_write2_b32 v141, v76, v77 offset0:0 offset1:136
    v_smfmac_f32_16x16x64_bf16 v[80:83], v[24:27], a[56:63], v131 abid:1
    s_waitcnt lgkmcnt(1)
    v_mov_b64 v[52:53], 0
    v_smfmac_f32_16x16x64_bf16 v[80:83], v[28:31], v[56:63], v131 abid:1
    s_nop 1
    v_mov_b64 v[54:55], 0
    v_smfmac_f32_16x16x64_bf16 v[84:87], v[8:11], a[80:87], v131 abid:1
    s_nop 1
    v_mov_b64 v[56:57], 0
    v_smfmac_f32_16x16x64_bf16 v[84:87], v[12:15], a[88:95], v131 abid:1
    s_and_b64 vcc, vcc, s[16:17]
    v_add_f32 v80, v80, v82
    v_smfmac_f32_16x16x64_bf16 v[84:87], v[16:19], a[96:103], v131 abid:1
    s_waitcnt lgkmcnt(0)
    s_barrier
    v_smfmac_f32_16x16x64_bf16 v[84:87], v[20:23], a[104:111], v131 abid:1
    ds_read_b128 v[32:35], v137 offset:0
    v_add_f32 v81, v81, v83
    v_smfmac_f32_16x16x64_bf16 v[84:87], v[24:27], a[112:119], v131 abid:1
    ds_read_b128 v[36:39], v137 offset:64
    v_mov_b64 v[58:59], 0
    v_smfmac_f32_16x16x64_bf16 v[84:87], v[28:31], a[120:127], v131 abid:1
    s_cbranch_scc1 L_tfast11_miss
    s_add_u32 s26, s28, s54
    v_smfmac_f32_16x16x64_bf16 v[64:67], v[4:7], a[136:143], v131 abid:1
    s_add_u32 s25, s25, 1
    s_add_u32 s27, s28, s55
    s_waitcnt lgkmcnt(1)
    v_mfma_f32_16x16x32_bf16 v[72:75], v[104:107], v[32:35], 0
    s_waitcnt lgkmcnt(0)
    v_add_f32 v84, v84, v86
    v_add_f32 v85, v85, v87
    v_mfma_f32_16x16x32_bf16 v[72:75], v[108:111], v[36:39], v[72:75]
    s_nop 0
    v_cvt_pk_bf16_f32 v84, v80, v84
    v_cvt_pk_bf16_f32 v85, v81, v85
    v_smfmac_f32_16x16x64_bf16 v[64:67], v[8:11], a[144:151], v131 abid:1
    ds_write2_b32 v141, v84, v85 offset0:64 offset1:200
    v_smfmac_f32_16x16x64_bf16 v[64:67], v[12:15], a[152:159], v131 abid:1
    s_nop 1
    v_cndmask_b32 v73, v73, v74, s[58:59]
    v_cndmask_b32 v72, v72, v75, s[58:59]
    v_smfmac_f32_16x16x64_bf16 v[64:67], v[16:19], a[160:167], v131 abid:1
    ds_read_b128 v[104:107], v138 offset:16384
    v_add_f32_dpp v72, v73, v72 quad_perm:[2,3,0,1] row_mask:0xf bank_mask:0xf
    v_mul_f32 v72, s56, v72
    v_smfmac_f32_16x16x64_bf16 v[64:67], v[20:23], a[168:175], v131 abid:1
    ds_read_b128 v[108:111], v138 offset:17408
    v_exp_f32 v73, v72
    v_smfmac_f32_16x16x64_bf16 v[64:67], v[24:27], a[176:183], v131 abid:1
    ds_write_b32 v133, v73 offset:12548
    v_smfmac_f32_16x16x64_bf16 v[64:67], v[28:31], a[184:191], v131 abid:1
    s_waitcnt lgkmcnt(3)
    s_barrier
    v_smfmac_f32_16x16x64_bf16 v[68:71], v[4:7], a[200:207], v131 abid:1
    ds_read_b128 v[40:43], v137 offset:256
    v_mov_b32 v63, 0
    v_smfmac_f32_16x16x64_bf16 v[68:71], v[8:11], a[208:215], v131 abid:1
    ds_read_b128 v[44:47], v137 offset:320
    v_smfmac_f32_16x16x64_bf16 v[68:71], v[12:15], a[216:223], v131 abid:1
    ds_read_b128 v[0:3], v138 offset:18432
    v_add_f32 v64, v64, v66
    v_smfmac_f32_16x16x64_bf16 v[68:71], v[16:19], a[224:231], v131 abid:1
    s_waitcnt lgkmcnt(3)
    s_barrier
    s_waitcnt lgkmcnt(2)
    v_mfma_f32_16x16x32_bf16 v[124:127], v[40:43], v[32:35], 0
    ds_read_b128 v[80:83], v133 offset:12544
    s_waitcnt lgkmcnt(2)
    v_mfma_f32_16x16x32_bf16 v[124:127], v[44:47], v[36:39], v[124:127]
    s_nop 0
    v_add_f32 v65, v65, v67
    v_cvt_pk_bf16_f32 v130, v64, v65
    v_smfmac_f32_16x16x64_bf16 v[68:71], v[20:23], a[232:239], v131 abid:1
    ds_read_b128 v[4:7], v138 offset:19456
    ds_read_b128 v[8:11], v138 offset:20480
    v_smfmac_f32_16x16x64_bf16 v[68:71], v[24:27], a[240:247], v131 abid:1
    ds_read_b128 v[12:15], v138 offset:21504
    v_cndmask_b32 v125, v125, v126, s[58:59]
    v_cndmask_b32 v124, v124, v127, s[58:59]
    v_smfmac_f32_16x16x64_bf16 v[68:71], v[28:31], a[248:255], v131 abid:1
    s_waitcnt lgkmcnt(3)
    v_cvt_pk_bf16_f32 v60, v80, v81
    v_cvt_pk_bf16_f32 v61, v82, v83
    v_add_f32_dpp v124, v125, v124 quad_perm:[2,3,0,1] row_mask:0xf bank_mask:0xf
    v_mul_f32 v124, s56, v124
    v_smfmac_f32_16x16x32_bf16 v[52:55], v[60:61], v[112:115], v131 abid:2
    v_exp_f32 v125, v124
    v_smfmac_f32_16x16x32_bf16 v[56:59], v[60:61], v[116:119], v131 abid:2
    v_cvt_pk_bf16_f32 v62, v125, 0
    v_add_f32 v68, v68, v70
    v_add_f32 v69, v69, v71
    v_mfma_f32_16x16x32_bf16 v[48:51], v[60:63], v[120:123], 0
    ds_read_b128 v[32:35], v138 offset:22528
    v_cvt_pk_bf16_f32 v134, v68, v69
    v_smfmac_f32_16x16x32_bf16 v[52:55], v[62:63], v[130:133], v131
    s_nop 0
    ds_read_b128 v[36:39], v138 offset:23552
    ds_read_b128 v[40:43], v138 offset:24576
    v_smfmac_f32_16x16x32_bf16 v[56:59], v[62:63], v[134:137], v131
    s_nop 0
    v_add_f32 v48, v48, v50
    v_add_f32 v49, v49, v51
    v_rcp_f32 v50, v48
    v_rcp_f32 v51, v49
    v_pk_add_f32 v[52:53], v[52:53], v[54:55]
    v_pk_mul_f32 v[52:53], v[52:53], v[50:51]
    v_max3_f32 v126, v48, v49, v50
    v_pk_add_f32 v[56:57], v[56:57], v[58:59]
    v_pk_mul_f32 v[56:57], v[56:57], v[50:51]
    v_cvt_pk_bf16_f32 v52, v52, v56
    v_cvt_pk_bf16_f32 v53, v53, v57
    v_mfma_f32_16x16x16_bf16 v[80:83], v[128:129], v[128:129], 0
    ds_write2_b32 v141, v52, v53 offset0:0 offset1:136
    v_mfma_f32_16x16x16_bf16 v[84:87], v[128:129], v[128:129], 0
    v_max_f32 v126, v126, v51
    v_cmp_nge_f32 vcc, 0x4f800000, v126
    v_mfma_f32_16x16x16_bf16 v[76:79], v[128:129], v[128:129], 0
    ds_read_b128 v[48:51], v142 offset:64
    s_cbranch_vccnz L_tfast11_big
L_tfast11_back:
    v_mfma_f32_16x16x16_bf16 v[72:75], v[128:129], v[128:129], 0
    s_waitcnt lgkmcnt(1)
    s_barrier
    ds_read_b128 v[52:55], v142 offset:0
    s_waitcnt lgkmcnt(1)
    v_smfmac_f32_16x16x64_bf16 v[80:83], v[48:51], v[104:111], v131 abid:1
    ds_read_b128 v[56:59], v142 offset:192
    v_smfmac_f32_16x16x64_bf16 v[84:87], v[48:51], v[0:7], v131 abid:1
    ds_read_b128 v[60:63], v142 offset:128
    v_smfmac_f32_16x16x64_bf16 v[76:79], v[48:51], v[8:15], v131 abid:1
    ds_read_b128 v[44:47], v138 offset:25600
    s_waitcnt lgkmcnt(3)
    v_smfmac_f32_16x16x64_bf16 v[80:83], v[52:55], v[144:151], v131 abid:1
    ds_read_b128 v[16:19], v138 offset:26624
    s_waitcnt lgkmcnt(3)
    v_smfmac_f32_16x16x64_bf16 v[80:83], v[56:59], v[152:159], v131 abid:1
    ds_read_b128 v[20:23], v138 offset:27648
    s_waitcnt lgkmcnt(3)
    v_smfmac_f32_16x16x64_bf16 v[80:83], v[60:63], v[160:167], v131 abid:1
    s_nop 1
    ds_read_b128 v[24:27], v138 offset:28672
    v_smfmac_f32_16x16x64_bf16 v[84:87], v[52:55], v[32:39], v131 abid:1
    ds_read_b128 v[28:31], v138 offset:29696
    s_waitcnt lgkmcnt(4)
    v_smfmac_f32_16x16x64_bf16 v[84:87], v[56:59], v[40:47], v131 abid:1
    ds_read_b128 v[64:67], v138 offset:30720
    v_cvt_pk_bf16_f32 v80, v80, v82
    v_cvt_pk_bf16_f32 v81, v81, v83
    v_or_b32 v80, 1, v80
    v_smfmac_f32_16x16x64_bf16 v[84:87], v[60:63], v[168:175], v131 abid:1
    buffer_store_dwordx2 v[80:81], v139, s[4:7], s30 offen
    ds_read_b128 v[68:71], v138 offset:31744
    s_waitcnt lgkmcnt(4)
    v_smfmac_f32_16x16x64_bf16 v[76:79], v[52:55], v[16:23], v131 abid:1
    ds_read_b128 v[0:3], v138 offset:32768
    s_waitcnt lgkmcnt(3)
    v_smfmac_f32_16x16x64_bf16 v[76:79], v[56:59], v[176:183], v131 abid:1
    ds_read_b128 v[4:7], v138 offset:33792
    v_cvt_pk_bf16_f32 v84, v84, v86
    v_cvt_pk_bf16_f32 v85, v85, v87
    v_or_b32 v84, 1, v84
    v_smfmac_f32_16x16x64_bf16 v[76:79], v[60:63], v[24:31], v131 abid:1
    buffer_store_dwordx2 v[84:85], v139, s[4:7], s31 offen
    ds_read_b128 v[8:11], v138 offset:34816
    s_nop 0
    v_smfmac_f32_16x16x64_bf16 v[72:75], v[48:51], v[184:191], v131 abid:1
    ds_read_b128 v[12:15], v138 offset:35840
    s_waitcnt lgkmcnt(4)
    v_smfmac_f32_16x16x64_bf16 v[72:75], v[52:55], v[64:71], v131 abid:1
    s_waitcnt lgkmcnt(2)
    v_cvt_pk_bf16_f32 v76, v76, v78
    v_cvt_pk_bf16_f32 v77, v77, v79
    v_or_b32 v76, 1, v76
    v_smfmac_f32_16x16x64_bf16 v[72:75], v[56:59], v[0:7], v131 abid:1
    buffer_store_dwordx2 v[76:77], v139, s[4:7], s32 offen
    s_waitcnt lgkmcnt(0)
    v_smfmac_f32_16x16x64_bf16 v[72:75], v[60:63], v[8:15], v131 abid:1
    s_nop 7
    v_cvt_pk_bf16_f32 v72, v72, v74
    v_cvt_pk_bf16_f32 v73, v73, v75
    v_or_b32 v72, 1, v72
    buffer_store_dwordx2 v[72:73], v139, s[4:7], s33 offen
    s_cmp_lt_u32 s25, 62
    s_cselect_b32 s57, 0x80000, 0
    s_add_u32 s34, s34, s57
    s_add_u32 s35, s35, s57
    s_add_u32 s36, s36, s57
    s_add_u32 s37, s37, s57
    s_mov_b32 s28, s29
    s_add_u32 s29, s29, 0x2000
    s_bitset0_b32 s29, 15
    s_mov_b64 s[16:17], -1
    v_mov_b32 v124, -1
    ds_read_b128 v[32:35], v138 offset:0
    s_waitcnt vmcnt(4)
    s_barrier
L_spin_15:
    v_cmp_gt_u32 vcc, s25, v136
    buffer_load_dword v136, v135, s[4:7], s53 offen offset:1024 sc1
    s_cbranch_vccz L_spun_16
    v_cmp_gt_u32 vcc, s25, v136
    buffer_load_dword v136, v135, s[4:7], s53 offen offset:1024 sc1
    s_cbranch_vccz L_spun_16
    v_cmp_gt_u32 vcc, s25, v136
    buffer_load_dword v136, v135, s[4:7], s53 offen offset:1024 sc1
    s_cbranch_vccz L_spun_16
    v_cmp_gt_u32 vcc, s25, v136
    buffer_load_dword v136, v135, s[4:7], s53 offen offset:1024 sc1
    s_cbranch_vccz L_spun_16
    v_cmp_gt_u32 vcc, s25, v136
    buffer_load_dword v136, v135, s[4:7], s53 offen offset:1024 sc1
    s_cbranch_vccz L_spun_16
    v_cmp_gt_u32 vcc, s25, v136
    buffer_load_dword v136, v135, s[4:7], s53 offen offset:1024 sc1
    s_cbranch_vccz L_spun_16
    v_cmp_gt_u32 vcc, s25, v136
    buffer_load_dword v136, v135, s[4:7], s53 offen offset:1024 sc1
    s_cbranch_vccz L_spun_16
    v_cmp_gt_u32 vcc, s25, v136
    buffer_load_dword v136, v135, s[4:7], s53 offen offset:1024 sc1
    s_cbranch_vccz L_spun_16
    v_cmp_gt_u32 vcc, s25, v136
    buffer_load_dword v136, v135, s[4:7], s53 offen offset:1024 sc1
    s_cbranch_vccz L_spun_16
    v_cmp_gt_u32 vcc, s25, v136
    buffer_load_dword v136, v135, s[4:7], s53 offen offset:1024 sc1
    s_cbranch_vccz L_spun_16
    v_cmp_gt_u32 vcc, s25, v136
    buffer_load_dword v136, v135, s[4:7], s53 offen offset:1024 sc1
    s_cbranch_vccz L_spun_16
    v_cmp_gt_u32 vcc, s25, v136
    buffer_load_dword v136, v135, s[4:7], s53 offen offset:1024 sc1
    s_cbranch_vccz L_spun_16
    v_cmp_gt_u32 vcc, s25, v136
    buffer_load_dword v136, v135, s[4:7], s53 offen offset:1024 sc1
    s_cbranch_vccz L_spun_16
    v_cmp_gt_u32 vcc, s25, v136
    buffer_load_dword v136, v135, s[4:7], s53 offen offset:1024 sc1
    s_cbranch_vccz L_spun_16
    v_cmp_gt_u32 vcc, s25, v136
    buffer_load_dword v136, v135, s[4:7], s53 offen offset:1024 sc1
    s_cbranch_vccz L_spun_16
    v_cmp_gt_u32 vcc, s25, v136
    buffer_load_dword v136, v135, s[4:7], s53 offen offset:1024 sc1
    s_cbranch_vccz L_spun_16
    v_cmp_gt_u32 vcc, s25, v136
    buffer_load_dword v136, v135, s[4:7], s53 offen offset:1024 sc1
    s_cbranch_vccz L_spun_16
    v_cmp_gt_u32 vcc, s25, v136
    buffer_load_dword v136, v135, s[4:7], s53 offen offset:1024 sc1
    s_cbranch_vccz L_spun_16
    v_cmp_gt_u32 vcc, s25, v136
    buffer_load_dword v136, v135, s[4:7], s53 offen offset:1024 sc1
    s_cbranch_vccz L_spun_16
    v_cmp_gt_u32 vcc, s25, v136
    buffer_load_dword v136, v135, s[4:7], s53 offen offset:1024 sc1
    s_cbranch_vccz L_spun_16
    s_movk_i32 s3, 20
    s_sub_u32 s24, s24, 1
    s_cbranch_scc1 L_timeout
    s_branch L_spin_15
L_spun_16:
    ds_read_b128 v[36:39], v138 offset:1024
    ds_read_b128 v[40:43], v138 offset:2048
    ds_read_b128 v[44:47], v138 offset:3072
    ds_read_b128 v[48:51], v138 offset:4096
    ds_read_b128 v[52:55], v138 offset:5120
    ds_read_b128 v[56:59], v138 offset:6144
    ds_read_b128 v[60:63], v138 offset:7168
    v_mov_b64 v[64:65], 0
    v_mov_b64 v[66:67], 0
    v_mov_b64 v[68:69], 0
    v_mov_b64 v[70:71], 0
    v_mov_b64 v[72:73], 0
    v_mov_b64 v[74:75], 0
    v_mov_b64 v[76:77], 0
    v_mov_b64 v[78:79], 0
    v_mov_b64 v[80:81], 0
    v_mov_b64 v[82:83], 0
    v_mov_b64 v[84:85], 0
    v_mov_b64 v[86:87], 0
    s_barrier
    buffer_load_dwordx4 v[0:3], v133, s[4:7], s26 offen sc1
    s_barrier
    buffer_load_dwordx4 v133, s[4:7], s27 offen sc1 lds
    s_barrier
    buffer_store_dword v124, v140, s[4:7], s29 offen
    buffer_load_dwordx4 v[104:107], v133, s[4:7], s34 offen sc1
    buffer_load_dwordx4 v[108:111], v133, s[4:7], s35 offen sc1
    buffer_load_dwordx4 v[112:115], v133, s[4:7], s36 offen sc1
    buffer_load_dwordx4 v[116:119], v133, s[4:7], s37 offen sc1
    s_branch L_tfast10_again
L_tfast10_miss:
    s_waitcnt lgkmcnt(0)
    v_max3_u32 v132, v0, v1, v2
    v_max3_u32 v130, v3, v4, v5
    v_max3_u32 v132, v132, v6, v7
    v_max_u32 v132, v132, v130
    v_cmpx_eq_u32 vcc, -1, v132
    s_cbranch_execz L_tfast10_whole
L_tfast10_reload:
    buffer_load_dwordx4 v[0:3], v133, s[4:7], s26 offen sc1
    buffer_load_dwordx4 v[4:7], v133, s[4:7], s27 offen sc1
    s_movk_i32 s3, 16
    s_sub_u32 s24, s24, 1
    s_cbranch_scc1 L_timeout
    v_max3_u32 v132, v0, v1, v2
    v_max3_u32 v130, v3, v4, v5
    v_max3_u32 v132, v132, v6, v7
    v_max_u32 v132, v132, v130
    v_cmpx_eq_u32 vcc, -1, v132
    s_cbranch_execnz L_tfast10_reload
L_tfast10_whole:
    s_mov_b64 exec, -1
    s_mov_b64 s[16:17], 0
    ds_read_b128 v[32:35], v138 offset:0
    ds_read_b128 v[36:39], v138 offset:1024
    ds_read_b128 v[40:43], v138 offset:2048
    ds_read_b128 v[44:47], v138 offset:3072
    ds_read_b128 v[48:51], v138 offset:4096
    ds_read_b128 v[52:55], v138 offset:5120
    ds_read_b128 v[56:59], v138 offset:6144
    ds_read_b128 v[60:63], v138 offset:7168
    v_mov_b64 v[64:65], 0
    v_mov_b64 v[66:67], 0
    v_mov_b64 v[68:69], 0
    v_mov_b64 v[70:71], 0
    v_mov_b64 v[72:73], 0
    v_mov_b64 v[74:75], 0
    v_mov_b64 v[76:77], 0
    v_mov_b64 v[78:79], 0
    v_mov_b64 v[80:81], 0
    v_mov_b64 v[82:83], 0
    v_mov_b64 v[84:85], 0
    v_mov_b64 v[86:87], 0
    s_waitcnt vmcnt(0)
    ds_write_b128 v133, v[4:7] offset:3072
    s_branch L_tfast10_again
L_tfast10_big:
    ds_write_b32 v133, v72 offset:13572
    s_waitcnt lgkmcnt(0)
    s_barrier
    ds_read_b128 v[60:63], v133 offset:13568
    s_waitcnt lgkmcnt(0)
    v_max3_f32 v126, v60, v61, v62
    v_max3_f32 v126, v126, v63, v124
    s_nop 1
    v_max_f32_dpp v126, v126, v126 quad_perm:[2,3,0,1] row_mask:0xf bank_mask:0xf
    v_mov_b32 v127, v126
    s_nop 1
    v_permlane16_swap_b32 v126, v127
    v_max_f32 v126, v126, v127
    v_mov_b32 v127, v126
    s_nop 1
    v_permlane32_swap_b32 v126, v127
    v_max_f32 v126, v126, v127
    v_sub_f32 v60, v60, v126
    v_exp_f32 v60, v60
    v_sub_f32 v61, v61, v126
    v_exp_f32 v61, v61
    v_sub_f32 v62, v62, v126
    v_exp_f32 v62, v62
    v_sub_f32 v63, v63, v126
    v_exp_f32 v63, v63
    v_sub_f32 v124, v124, v126
    v_exp_f32 v124, v124
    v_cvt_pk_bf16_f32 v60, v60, v61
    v_cvt_pk_bf16_f32 v61, v62, v63
    v_cvt_pk_bf16_f32 v62, v124, 0
    v_mov_b64 v[52:53], 0
    v_mov_b64 v[54:55], 0
    v_mov_b64 v[56:57], 0
    v_mov_b64 v[58:59], 0
    v_mov_b32 v63, 0
    s_nop 1
    v_mfma_f32_16x16x32_bf16 v[48:51], v[60:63], v[120:123], 0
    v_smfmac_f32_16x16x32_bf16 v[52:55], v[62:63], v[130:133], v131
    v_smfmac_f32_16x16x32_bf16 v[56:59], v[62:63], v[134:137], v131
    v_smfmac_f32_16x16x32_bf16 v[52:55], v[60:61], v[96:99], v131 abid:2
    v_smfmac_f32_16x16x32_bf16 v[56:59], v[60:61], v[100:103], v131 abid:2
    s_nop 3
    v_add_f32 v48, v48, v50
    v_add_f32 v49, v49, v51
    v_rcp_f32 v50, v48
    v_rcp_f32 v51, v49
    v_pk_add_f32 v[52:53], v[52:53], v[54:55]
    v_pk_mul_f32 v[52:53], v[52:53], v[50:51]
    v_max3_f32 v126, v48, v49, v50
    v_pk_add_f32 v[56:57], v[56:57], v[58:59]
    v_pk_mul_f32 v[56:57], v[56:57], v[50:51]
    v_cvt_pk_bf16_f32 v52, v52, v56
    v_cvt_pk_bf16_f32 v53, v53, v57
    ds_write2_b32 v141, v52, v53 offset0:0 offset1:136
    ds_read_b128 v[48:51], v142 offset:64
    v_mfma_f32_16x16x16_bf16 v[80:83], v[128:129], v[128:129], 0
    v_mfma_f32_16x16x16_bf16 v[84:87], v[128:129], v[128:129], 0
    v_mfma_f32_16x16x16_bf16 v[76:79], v[128:129], v[128:129], 0
    s_branch L_tfast10_back
L_tfast11_miss:
    s_waitcnt lgkmcnt(0)
    v_max3_u32 v132, v0, v1, v2
    v_max3_u32 v130, v3, v4, v5
    v_max3_u32 v132, v132, v6, v7
    v_max_u32 v132, v132, v130
    v_cmpx_eq_u32 vcc, -1, v132
    s_cbranch_execz L_tfast11_whole
L_tfast11_reload:
    buffer_load_dwordx4 v[0:3], v133, s[4:7], s26 offen sc1
    buffer_load_dwordx4 v[4:7], v133, s[4:7], s27 offen sc1
    s_movk_i32 s3, 16
    s_sub_u32 s24, s24, 1
    s_cbranch_scc1 L_timeout
    v_max3_u32 v132, v0, v1, v2
    v_max3_u32 v130, v3, v4, v5
    v_max3_u32 v132, v132, v6, v7
    v_max_u32 v132, v132, v130
    v_cmpx_eq_u32 vcc, -1, v132
    s_cbranch_execnz L_tfast11_reload
L_tfast11_whole:
    s_mov_b64 exec, -1
    s_mov_b64 s[16:17], 0
    ds_read_b128 v[32:35], v138 offset:0
    ds_read_b128 v[36:39], v138 offset:1024
    ds_read_b128 v[40:43], v138 offset:2048
    ds_read_b128 v[44:47], v138 offset:3072
    ds_read_b128 v[48:51], v138 offset:4096
    ds_read_b128 v[52:55], v138 offset:5120
    ds_read_b128 v[56:59], v138 offset:6144
    ds_read_b128 v[60:63], v138 offset:7168
    v_mov_b64 v[64:65], 0
    v_mov_b64 v[66:67], 0
    v_mov_b64 v[68:69], 0
    v_mov_b64 v[70:71], 0
    v_mov_b64 v[72:73], 0
    v_mov_b64 v[74:75], 0
    v_mov_b64 v[76:77], 0
    v_mov_b64 v[78:79], 0
    v_mov_b64 v[80:81], 0
    v_mov_b64 v[82:83], 0
    v_mov_b64 v[84:85], 0
    v_mov_b64 v[86:87], 0
    s_waitcnt vmcnt(0)
    ds_write_b128 v133, v[4:7] offset:3072
    s_branch L_tfast11_again
L_tfast11_big:
    ds_write_b32 v133, v72 offset:13572
    s_waitcnt lgkmcnt(0)
    s_barrier
    ds_read_b128 v[60:63], v133 offset:13568
    s_waitcnt lgkmcnt(0)
    v_max3_f32 v126, v60, v61, v62
    v_max3_f32 v126, v126, v63, v124
    s_nop 1
    v_max_f32_dpp v126, v126, v126 quad_perm:[2,3,0,1] row_mask:0xf bank_mask:0xf
    v_mov_b32 v127, v126
    s_nop 1
    v_permlane16_swap_b32 v126, v127
    v_max_f32 v126, v126, v127
    v_mov_b32 v127, v126
    s_nop 1
    v_permlane32_swap_b32 v126, v127
    v_max_f32 v126, v126, v127
    v_sub_f32 v60, v60, v126
    v_exp_f32 v60, v60
    v_sub_f32 v61, v61, v126
    v_exp_f32 v61, v61
    v_sub_f32 v62, v62, v126
    v_exp_f32 v62, v62
    v_sub_f32 v63, v63, v126
    v_exp_f32 v63, v63
    v_sub_f32 v124, v124, v126
    v_exp_f32 v124, v124
    v_cvt_pk_bf16_f32 v60, v60, v61
    v_cvt_pk_bf16_f32 v61, v62, v63
    v_cvt_pk_bf16_f32 v62, v124, 0
    v_mov_b64 v[52:53], 0
    v_mov_b64 v[54:55], 0
    v_mov_b64 v[56:57], 0
    v_mov_b64 v[58:59], 0
    v_mov_b32 v63, 0
    s_nop 1
    v_mfma_f32_16x16x32_bf16 v[48:51], v[60:63], v[120:123], 0
    v_smfmac_f32_16x16x32_bf16 v[52:55], v[62:63], v[130:133], v131
    v_smfmac_f32_16x16x32_bf16 v[56:59], v[62:63], v[134:137], v131
    v_smfmac_f32_16x16x32_bf16 v[52:55], v[60:61], v[112:115], v131 abid:2
    v_smfmac_f32_16x16x32_bf16 v[56:59], v[60:61], v[116:119], v131 abid:2
    s_nop 3
    v_add_f32 v48, v48, v50
    v_add_f32 v49, v49, v51
    v_rcp_f32 v50, v48
    v_rcp_f32 v51, v49
    v_pk_add_f32 v[52:53], v[52:53], v[54:55]
    v_pk_mul_f32 v[52:53], v[52:53], v[50:51]
    v_max3_f32 v126, v48, v49, v50
    v_pk_add_f32 v[56:57], v[56:57], v[58:59]
    v_pk_mul_f32 v[56:57], v[56:57], v[50:51]
    v_cvt_pk_bf16_f32 v52, v52, v56
    v_cvt_pk_bf16_f32 v53, v53, v57
    ds_write2_b32 v141, v52, v53 offset0:0 offset1:136
    ds_read_b128 v[48:51], v142 offset:64
    v_mfma_f32_16x16x16_bf16 v[80:83], v[128:129], v[128:129], 0
    v_mfma_f32_16x16x16_bf16 v[84:87], v[128:129], v[128:129], 0
    v_mfma_f32_16x16x16_bf16 v[76:79], v[128:129], v[128:129], 0
    s_branch L_tfast11_back
.p2align 6
L_tfast20_again:
    s_waitcnt vmcnt(6) lgkmcnt(0)
    v_smfmac_f32_16x16x64_bf16 v[72:75], v[0:3], v[32:39], v131 abid:1
    ds_write_b128 v133, v[0:3] offset:4096
    v_smfmac_f32_16x16x64_bf16 v[76:79], v[0:3], v[40:47], v131 abid:1
    v_smfmac_f32_16x16x64_bf16 v[80:83], v[0:3], a[24:31], v131 abid:1
    v_smfmac_f32_16x16x64_bf16 v[84:87], v[0:3], a[64:71], v131 abid:1
    s_waitcnt vmcnt(5)
    ds_read_b128 v[4:7], v133 offset:5120
    v_smfmac_f32_16x16x64_bf16 v[64:67], v[0:3], a[128:135], v131 abid:1
    v_smfmac_f32_16x16x64_bf16 v[68:71], v[0:3], a[192:199], v131 abid:1
    s_waitcnt lgkmcnt(1)
    s_barrier
    s_waitcnt lgkmcnt(0)
    v_smfmac_f32_16x16x64_bf16 v[72:75], v[4:7], v[48:55], v131 abid:1
    ds_read_b128 v[8:11], v133 offset:6144
    v_smfmac_f32_16x16x64_bf16 v[76:79], v[4:7], v[56:63], v131 abid:1
    ds_read_b128 v[12:15], v133 offset:7168
    v_smfmac_f32_16x16x64_bf16 v[80:83], v[4:7], a[32:39], v131 abid:1
    ds_read_b128 v[16:19], v133 offset:0
    v_smfmac_f32_16x16x64_bf16 v[84:87], v[4:7], a[72:79], v131 abid:1
    ds_read_b128 v[20:23], v133 offset:1024
    s_waitcnt lgkmcnt(3)
    v_smfmac_f32_16x16x64_bf16 v[72:75], v[8:11], v[192:199], v131 abid:1
    ds_read_b128 v[24:27], v133 offset:2048
    v_smfmac_f32_16x16x64_bf16 v[76:79], v[8:11], v[240:247], v131 abid:1
    ds_read_b128 v[28:31], v133 offset:3072
    s_waitcnt lgkmcnt(4)
    v_smfmac_f32_16x16x64_bf16 v[72:75], v[12:15], v[200:207], v131 abid:1
    ds_read_b128 v[32:35], v138 offset:8192
    v_smfmac_f32_16x16x64_bf16 v[76:79], v[12:15], v[248:255], v131 abid:1
    ds_read_b128 v[36:39], v138 offset:9216
    s_waitcnt lgkmcnt(5)
    v_smfmac_f32_16x16x64_bf16 v[72:75], v[16:19], v[208:215], v131 abid:1
    ds_read_b128 v[40:43], v138 offset:10240
    s_waitcnt lgkmcnt(5)
    v_smfmac_f32_16x16x64_bf16 v[72:75], v[20:23], v[216:223], v131 abid:1
    ds_read_b128 v[44:47], v138 offset:11264
    s_waitcnt lgkmcnt(5)
    v_smfmac_f32_16x16x64_bf16 v[72:75], v[24:27], v[224:231], v131 abid:1
    ds_read_b128 v[48:51], v138 offset:12288
    s_waitcnt lgkmcnt(5)
    v_smfmac_f32_16x16x64_bf16 v[72:75], v[28:31], v[232:239], v131 abid:1
    s_nop 1
    ds_read_b128 v[52:55], v138 offset:13312
    v_smfmac_f32_16x16x64_bf16 v[76:79], v[16:19], a[0:7], v131 abid:1
    s_nop 1
    ds_read_b128 v[56:59], v138 offset:14336
    v_smfmac_f32_16x16x64_bf16 v[76:79], v[20:23], a[8:15], v131 abid:1
    ds_read_b128 v[60:63], v138 offset:15360
    v_add_f32 v72, v72, v74
    v_smfmac_f32_16x16x64_bf16 v[76:79], v[24:27], a[16:23], v131 abid:1
    s_waitcnt lgkmcnt(3)
    v_add_f32 v73, v73, v75
    v_smfmac_f32_16x16x64_bf16 v[76:79], v[28:31], v[32:39], v131 abid:1
    s_nop 2
    v_smfmac_f32_16x16x64_bf16 v[80:83], v[8:11], a[40:47], v131 abid:1
    s_nop 1
    v_cmp_u_f32 vcc, v72, v73
    v_smfmac_f32_16x16x64_bf16 v[80:83], v[12:15], v[40:47], v131 abid:1
    v_add_f32 v76, v76, v78
    v_add_f32 v77, v77, v79
    v_smfmac_f32_16x16x64_bf16 v[80:83], v[16:19], a[48:55], v131 abid:1
    s_waitcnt lgkmcnt(1)
    v_cvt_pk_bf16_f32 v76, v72, v76
    v_cvt_pk_bf16_f32 v77, v73, v77
    v_smfmac_f32_16x16x64_bf16 v[80:83], v[20:23], v[48:55], v131 abid:1
    ds_write2_b32 v141, v76, v77 offset0:0 offset1:136
    v_smfmac_f32_16x16x64_bf16 v[80:83], v[24:27], a[56:63], v131 abid:1
    s_waitcnt lgkmcnt(1)
    v_mov_b64 v[52:53], 0
    v_smfmac_f32_16x16x64_bf16 v[80:83], v[28:31], v[56:63], v131 abid:1
    s_nop 1
    v_mov_b64 v[54:55], 0
    v_smfmac_f32_16x16x64_bf16 v[84:87], v[8:11], a[80:87], v131 abid:1
    s_nop 1
    v_mov_b64 v[56:57], 0
    v_smfmac_f32_16x16x64_bf16 v[84:87], v[12:15], a[88:95], v131 abid:1
    s_and_b64 vcc, vcc, s[16:17]
    v_add_f32 v80, v80, v82
    v_smfmac_f32_16x16x64_bf16 v[84:87], v[16:19], a[96:103], v131 abid:1
    s_waitcnt lgkmcnt(0)
    s_barrier
    v_smfmac_f32_16x16x64_bf16 v[84:87], v[20:23], a[104:111], v131 abid:1
    ds_read_b128 v[32:35], v137 offset:0
    v_add_f32 v81, v81, v83
    v_smfmac_f32_16x16x64_bf16 v[84:87], v[24:27], a[112:119], v131 abid:1
    ds_read_b128 v[36:39], v137 offset:64
    v_mov_b64 v[58:59], 0
    v_smfmac_f32_16x16x64_bf16 v[84:87], v[28:31], a[120:127], v131 abid:1
    s_cbranch_scc1 L_tfast20_miss
    s_add_u32 s26, s28, s54
    v_smfmac_f32_16x16x64_bf16 v[64:67], v[4:7], a[136:143], v131 abid:1
    s_add_u32 s25, s25, 1
    s_add_u32 s27, s28, s55
    s_waitcnt lgkmcnt(1)
    v_mfma_f32_16x16x32_bf16 v[72:75], v[88:91], v[32:35], 0
    s_waitcnt lgkmcnt(0)
    v_add_f32 v84, v84, v86
    v_add_f32 v85, v85, v87
    v_mfma_f32_16x16x32_bf16 v[72:75], v[92:95], v[36:39], v[72:75]
    s_nop 0
    v_cvt_pk_bf16_f32 v84, v80, v84
    v_cvt_pk_bf16_f32 v85, v81, v85
    v_smfmac_f32_16x16x64_bf16 v[64:67], v[8:11], a[144:151], v131 abid:1
    ds_write2_b32 v141, v84, v85 offset0:64 offset1:200
    v_smfmac_f32_16x16x64_bf16 v[64:67], v[12:15], a[152:159], v131 abid:1
    s_nop 1
    v_cndmask_b32 v73, v73, v74, s[58:59]
    v_cndmask_b32 v72, v72, v75, s[58:59]
    v_smfmac_f32_16x16x64_bf16 v[64:67], v[16:19], a[160:167], v131 abid:1
    ds_read_b128 v[88:91], v138 offset:16384
    v_add_f32_dpp v72, v73, v72 quad_perm:[2,3,0,1] row_mask:0xf bank_mask:0xf
    v_mul_f32 v72, s56, v72
    v_smfmac_f32_16x16x64_bf16 v[64:67], v[20:23], a[168:175], v131 abid:1
    ds_read_b128 v[92:95], v138 offset:17408
    v_exp_f32 v73, v72
    v_smfmac_f32_16x16x64_bf16 v[64:67], v[24:27], a[176:183], v131 abid:1
    ds_write_b32 v133, v73 offset:12552
    v_smfmac_f32_16x16x64_bf16 v[64:67], v[28:31], a[184:191], v131 abid:1
    s_waitcnt lgkmcnt(3)
    s_barrier
    v_smfmac_f32_16x16x64_bf16 v[68:71], v[4:7], a[200:207], v131 abid:1
    ds_read_b128 v[40:43], v137 offset:256
    v_mov_b32 v63, 0
    v_smfmac_f32_16x16x64_bf16 v[68:71], v[8:11], a[208:215], v131 abid:1
    ds_read_b128 v[44:47], v137 offset:320
    v_smfmac_f32_16x16x64_bf16 v[68:71], v[12:15], a[216:223], v131 abid:1
    ds_read_b128 v[0:3], v138 offset:18432
    v_add_f32 v64, v64, v66
    v_smfmac_f32_16x16x64_bf16 v[68:71], v[16:19], a[224:231], v131 abid:1
    s_waitcnt lgkmcnt(3)
    s_barrier
    s_waitcnt lgkmcnt(2)
    v_mfma_f32_16x16x32_bf16 v[124:127], v[40:43], v[32:35], 0
    ds_read_b128 v[80:83], v133 offset:12544
    s_waitcnt lgkmcnt(2)
    v_mfma_f32_16x16x32_bf16 v[124:127], v[44:47], v[36:39], v[124:127]
    s_nop 0
    v_add_f32 v65, v65, v67
    v_cvt_pk_bf16_f32 v130, v64, v65
    v_smfmac_f32_16x16x64_bf16 v[68:71], v[20:23], a[232:239], v131 abid:1
    ds_read_b128 v[4:7], v138 offset:19456
    ds_read_b128 v[8:11], v138 offset:20480
    v_smfmac_f32_16x16x64_bf16 v[68:71], v[24:27], a[240:247], v131 abid:1
    ds_read_b128 v[12:15], v138 offset:21504
    v_cndmask_b32 v125, v125, v126, s[58:59]
    v_cndmask_b32 v124, v124, v127, s[58:59]
    v_smfmac_f32_16x16x64_bf16 v[68:71], v[28:31], a[248:255], v131 abid:1
    s_waitcnt lgkmcnt(3)
    v_cvt_pk_bf16_f32 v60, v80, v81
    v_cvt_pk_bf16_f32 v61, v82, v83
    v_add_f32_dpp v124, v125, v124 quad_perm:[2,3,0,1] row_mask:0xf bank_mask:0xf
    v_mul_f32 v124, s56, v124
    v_smfmac_f32_16x16x32_bf16 v[52:55], v[60:61], v[96:99], v131 abid:2
    v_exp_f32 v125, v124
    v_smfmac_f32_16x16x32_bf16 v[56:59], v[60:61], v[100:103], v131 abid:2
    v_cvt_pk_bf16_f32 v62, v125, 0
    v_add_f32 v68, v68, v70
    v_add_f32 v69, v69, v71
    v_mfma_f32_16x16x32_bf16 v[48:51], v[60:63], v[120:123], 0
    ds_read_b128 v[32:35], v138 offset:22528
    v_cvt_pk_bf16_f32 v134, v68, v69
    v_smfmac_f32_16x16x32_bf16 v[52:55], v[62:63], v[130:133], v131
    s_nop 0
    ds_read_b128 v[36:39], v138 offset:23552
    ds_read_b128 v[40:43], v138 offset:24576
    v_smfmac_f32_16x16x32_bf16 v[56:59], v[62:63], v[134:137], v131
    s_nop 0
    v_add_f32 v48, v48, v50
    v_add_f32 v49, v49, v51
    v_rcp_f32 v50, v48
    v_rcp_f32 v51, v49
    v_pk_add_f32 v[52:53], v[52:53], v[54:55]
    v_pk_mul_f32 v[52:53], v[52:53], v[50:51]
    v_max3_f32 v126, v48, v49, v50
    v_pk_add_f32 v[56:57], v[56:57], v[58:59]
    v_pk_mul_f32 v[56:57], v[56:57], v[50:51]
    v_cvt_pk_bf16_f32 v52, v52, v56
    v_cvt_pk_bf16_f32 v53, v53, v57
    v_mfma_f32_16x16x16_bf16 v[80:83], v[128:129], v[128:129], 0
    ds_write2_b32 v141, v52, v53 offset0:0 offset1:136
    v_mfma_f32_16x16x16_bf16 v[84:87], v[128:129], v[128:129], 0
    v_max_f32 v126, v126, v51
    v_cmp_nge_f32 vcc, 0x4f800000, v126
    v_mfma_f32_16x16x16_bf16 v[76:79], v[128:129], v[128:129], 0
    ds_read_b128 v[48:51], v142 offset:128
    s_cbranch_vccnz L_tfast20_big
L_tfast20_back:
    v_mfma_f32_16x16x16_bf16 v[72:75], v[128:129], v[128:129], 0
    s_waitcnt lgkmcnt(1)
    s_barrier
    ds_read_b128 v[52:55], v142 offset:192
    s_waitcnt lgkmcnt(1)
    v_smfmac_f32_16x16x64_bf16 v[80:83], v[48:51], v[88:95], v131 abid:1
    ds_read_b128 v[56:59], v142 offset:0
    v_smfmac_f32_16x16x64_bf16 v[84:87], v[48:51], v[0:7], v131 abid:1
    ds_read_b128 v[60:63], v142 offset:64
    v_smfmac_f32_16x16x64_bf16 v[76:79], v[48:51], v[8:15], v131 abid:1
    ds_read_b128 v[44:47], v138 offset:25600
    s_waitcnt lgkmcnt(3)
    v_smfmac_f32_16x16x64_bf16 v[80:83], v[52:55], v[144:151], v131 abid:1
    ds_read_b128 v[16:19], v138 offset:26624
    s_waitcnt lgkmcnt(3)
    v_smfmac_f32_16x16x64_bf16 v[80:83], v[56:59], v[152:159], v131 abid:1
    ds_read_b128 v[20:23], v138 offset:27648
    s_waitcnt lgkmcnt(3)
    v_smfmac_f32_16x16x64_bf16 v[80:83], v[60:63], v[160:167], v131 abid:1
    s_nop 1
    ds_read_b128 v[24:27], v138 offset:28672
    v_smfmac_f32_16x16x64_bf16 v[84:87], v[52:55], v[32:39], v131 abid:1
    ds_read_b128 v[28:31], v138 offset:29696
    s_waitcnt lgkmcnt(4)
    v_smfmac_f32_16x16x64_bf16 v[84:87], v[56:59], v[40:47], v131 abid:1
    ds_read_b128 v[64:67], v138 offset:30720
    v_cvt_pk_bf16_f32 v80, v80, v82
    v_cvt_pk_bf16_f32 v81, v81, v83
    v_and_b32 v80, -2, v80
    v_smfmac_f32_16x16x64_bf16 v[84:87], v[60:63], v[168:175], v131 abid:1
    buffer_store_dwordx2 v[80:81], v139, s[4:7], s30 offen
    ds_read_b128 v[68:71], v138 offset:31744
    s_waitcnt lgkmcnt(4)
    v_smfmac_f32_16x16x64_bf16 v[76:79], v[52:55], v[16:23], v131 abid:1
    ds_read_b128 v[0:3], v138 offset:32768
    s_waitcnt lgkmcnt(3)
    v_smfmac_f32_16x16x64_bf16 v[76:79], v[56:59], v[176:183], v131 abid:1
    ds_read_b128 v[4:7], v138 offset:33792
    v_cvt_pk_bf16_f32 v84, v84, v86
    v_cvt_pk_bf16_f32 v85, v85, v87
    v_and_b32 v84, -2, v84
    v_smfmac_f32_16x16x64_bf16 v[76:79], v[60:63], v[24:31], v131 abid:1
    buffer_store_dwordx2 v[84:85], v139, s[4:7], s31 offen
    ds_read_b128 v[8:11], v138 offset:34816
    s_nop 0
    v_smfmac_f32_16x16x64_bf16 v[72:75], v[48:51], v[184:191], v131 abid:1
    ds_read_b128 v[12:15], v138 offset:35840
    s_waitcnt lgkmcnt(4)
    v_smfmac_f32_16x16x64_bf16 v[72:75], v[52:55], v[64:71], v131 abid:1
    s_waitcnt lgkmcnt(2)
    v_cvt_pk_bf16_f32 v76, v76, v78
    v_cvt_pk_bf16_f32 v77, v77, v79
    v_and_b32 v76, -2, v76
    v_smfmac_f32_16x16x64_bf16 v[72:75], v[56:59], v[0:7], v131 abid:1
    buffer_store_dwordx2 v[76:77], v139, s[4:7], s32 offen
    s_waitcnt lgkmcnt(0)
    v_smfmac_f32_16x16x64_bf16 v[72:75], v[60:63], v[8:15], v131 abid:1
    s_nop 7
    v_cvt_pk_bf16_f32 v72, v72, v74
    v_cvt_pk_bf16_f32 v73, v73, v75
    v_and_b32 v72, -2, v72
    buffer_store_dwordx2 v[72:73], v139, s[4:7], s33 offen
    s_cmp_eq_u32 s25, 63
    s_cbranch_scc1 L_end
    s_barrier
    v_mov_b64 v[64:65], 0
    v_mov_b64 v[66:67], 0
    v_mov_b64 v[68:69], 0
    v_mov_b64 v[70:71], 0
    v_mov_b64 v[72:73], 0
    v_mov_b64 v[74:75], 0
    v_mov_b64 v[76:77], 0
    v_mov_b64 v[78:79], 0
    v_mov_b64 v[80:81], 0
    v_mov_b64 v[82:83], 0
    v_mov_b64 v[84:85], 0
    v_mov_b64 v[86:87], 0
    ds_read_b128 v[32:35], v138 offset:0
    ds_read_b128 v[36:39], v138 offset:1024
    ds_read_b128 v[40:43], v138 offset:2048
    ds_read_b128 v[44:47], v138 offset:3072
    ds_read_b128 v[48:51], v138 offset:4096
    ds_read_b128 v[52:55], v138 offset:5120
    ds_read_b128 v[56:59], v138 offset:6144
    ds_read_b128 v[60:63], v138 offset:7168
    s_cmp_lt_u32 s25, 62
    s_cselect_b32 s57, 0x80000, 0
    s_add_u32 s34, s34, s57
    s_add_u32 s35, s35, s57
    s_add_u32 s36, s36, s57
    s_add_u32 s37, s37, s57
    s_mov_b32 s28, s29
    s_add_u32 s29, s29, 0x2000
    s_bitset0_b32 s29, 15
    s_mov_b64 s[16:17], -1
    s_waitcnt vmcnt(4)
    v_cmp_ne_u32 vcc, 0x1010101, v143
    s_cbranch_vccnz L_tfast20_noflag
L_tfast20_flag:
    s_cmp_lt_u32 s25, 61
    s_cselect_b32 s57, 4, 0
    s_add_u32 s51, s51, s57
    s_barrier
    buffer_load_dwordx4 v[0:3], v133, s[4:7], s26 offen sc1
    s_barrier
    buffer_load_dwordx4 v133, s[4:7], s27 offen sc1 lds
    s_barrier
    buffer_load_dword v143, v129, s[4:7], s51 offen sc1
    buffer_load_dwordx4 v[88:91], v133, s[4:7], s34 offen sc1
    buffer_load_dwordx4 v[92:95], v133, s[4:7], s35 offen sc1
    buffer_load_dwordx4 v[96:99], v133, s[4:7], s36 offen sc1
    buffer_load_dwordx4 v[100:103], v133, s[4:7], s37 offen sc1
L_tfast21_again:
    s_waitcnt vmcnt(6) lgkmcnt(0)
    v_smfmac_f32_16x16x64_bf16 v[72:75], v[0:3], v[32:39], v131 abid:1
    ds_write_b128 v133, v[0:3] offset:4096
    v_smfmac_f32_16x16x64_bf16 v[76:79], v[0:3], v[40:47], v131 abid:1
    v_smfmac_f32_16x16x64_bf16 v[80:83], v[0:3], a[24:31], v131 abid:1
    v_smfmac_f32_16x16x64_bf16 v[84:87], v[0:3], a[64:71], v131 abid:1
    s_waitcnt vmcnt(5)
    ds_read_b128 v[4:7], v133 offset:5120
    v_smfmac_f32_16x16x64_bf16 v[64:67], v[0:3], a[128:135], v131 abid:1
    v_smfmac_f32_16x16x64_bf16 v[68:71], v[0:3], a[192:199], v131 abid:1
    s_waitcnt lgkmcnt(1)
    s_barrier
    s_waitcnt lgkmcnt(0)
    v_smfmac_f32_16x16x64_bf16 v[72:75], v[4:7], v[48:55], v131 abid:1
    ds_read_b128 v[8:11], v133 offset:6144
    v_smfmac_f32_16x16x64_bf16 v[76:79], v[4:7], v[56:63], v131 abid:1
    ds_read_b128 v[12:15], v133 offset:7168
    v_smfmac_f32_16x16x64_bf16 v[80:83], v[4:7], a[32:39], v131 abid:1
    ds_read_b128 v[16:19], v133 offset:0
    v_smfmac_f32_16x16x64_bf16 v[84:87], v[4:7], a[72:79], v131 abid:1
    ds_read_b128 v[20:23], v133 offset:1024
    s_waitcnt lgkmcnt(3)
    v_smfmac_f32_16x16x64_bf16 v[72:75], v[8:11], v[192:199], v131 abid:1
    ds_read_b128 v[24:27], v133 offset:2048
    v_smfmac_f32_16x16x64_bf16 v[76:79], v[8:11], v[240:247], v131 abid:1
    ds_read_b128 v[28:31], v133 offset:3072
    s_waitcnt lgkmcnt(4)
    v_smfmac_f32_16x16x64_bf16 v[72:75], v[12:15], v[200:207], v131 abid:1
    ds_read_b128 v[32:35], v138 offset:8192
    v_smfmac_f32_16x16x64_bf16 v[76:79], v[12:15], v[248:255], v131 abid:1
    ds_read_b128 v[36:39], v138 offset:9216
    s_waitcnt lgkmcnt(5)
    v_smfmac_f32_16x16x64_bf16 v[72:75], v[16:19], v[208:215], v131 abid:1
    ds_read_b128 v[40:43], v138 offset:10240
    s_waitcnt lgkmcnt(5)
    v_smfmac_f32_16x16x64_bf16 v[72:75], v[20:23], v[216:223], v131 abid:1
    ds_read_b128 v[44:47], v138 offset:11264
    s_waitcnt lgkmcnt(5)
    v_smfmac_f32_16x16x64_bf16 v[72:75], v[24:27], v[224:231], v131 abid:1
    ds_read_b128 v[48:51], v138 offset:12288
    s_waitcnt lgkmcnt(5)
    v_smfmac_f32_16x16x64_bf16 v[72:75], v[28:31], v[232:239], v131 abid:1
    s_nop 1
    ds_read_b128 v[52:55], v138 offset:13312
    v_smfmac_f32_16x16x64_bf16 v[76:79], v[16:19], a[0:7], v131 abid:1
    s_nop 1
    ds_read_b128 v[56:59], v138 offset:14336
    v_smfmac_f32_16x16x64_bf16 v[76:79], v[20:23], a[8:15], v131 abid:1
    ds_read_b128 v[60:63], v138 offset:15360
    v_add_f32 v72, v72, v74
    v_smfmac_f32_16x16x64_bf16 v[76:79], v[24:27], a[16:23], v131 abid:1
    s_waitcnt lgkmcnt(3)
    v_add_f32 v73, v73, v75
    v_smfmac_f32_16x16x64_bf16 v[76:79], v[28:31], v[32:39], v131 abid:1
    s_nop 2
    v_smfmac_f32_16x16x64_bf16 v[80:83], v[8:11], a[40:47], v131 abid:1
    s_nop 1
    v_cmp_u_f32 vcc, v72, v73
    v_smfmac_f32_16x16x64_bf16 v[80:83], v[12:15], v[40:47], v131 abid:1
    v_add_f32 v76, v76, v78
    v_add_f32 v77, v77, v79
    v_smfmac_f32_16x16x64_bf16 v[80:83], v[16:19], a[48:55], v131 abid:1
    s_waitcnt lgkmcnt(1)
    v_cvt_pk_bf16_f32 v76, v72, v76
    v_cvt_pk_bf16_f32 v77, v73, v77
    v_smfmac_f32_16x16x64_bf16 v[80:83], v[20:23], v[48:55], v131 abid:1
    ds_write2_b32 v141, v76, v77 offset0:0 offset1:136
    v_smfmac_f32_16x16x64_bf16 v[80:83], v[24:27], a[56:63], v131 abid:1
    s_waitcnt lgkmcnt(1)
    v_mov_b64 v[52:53], 0
    v_smfmac_f32_16x16x64_bf16 v[80:83], v[28:31], v[56:63], v131 abid:1
    s_nop 1
    v_mov_b64 v[54:55], 0
    v_smfmac_f32_16x16x64_bf16 v[84:87], v[8:11], a[80:87], v131 abid:1
    s_nop 1
    v_mov_b64 v[56:57], 0
    v_smfmac_f32_16x16x64_bf16 v[84:87], v[12:15], a[88:95], v131 abid:1
    s_and_b64 vcc, vcc, s[16:17]
    v_add_f32 v80, v80, v82
    v_smfmac_f32_16x16x64_bf16 v[84:87], v[16:19], a[96:103], v131 abid:1
    s_waitcnt lgkmcnt(0)
    s_barrier
    v_smfmac_f32_16x16x64_bf16 v[84:87], v[20:23], a[104:111], v131 abid:1
    ds_read_b128 v[32:35], v137 offset:0
    v_add_f32 v81, v81, v83
    v_smfmac_f32_16x16x64_bf16 v[84:87], v[24:27], a[112:119], v131 abid:1
    ds_read_b128 v[36:39], v137 offset:64
    v_mov_b64 v[58:59], 0
    v_smfmac_f32_16x16x64_bf16 v[84:87], v[28:31], a[120:127], v131 abid:1
    s_cbranch_scc1 L_tfast21_miss
    s_add_u32 s26, s28, s54
    v_smfmac_f32_16x16x64_bf16 v[64:67], v[4:7], a[136:143], v131 abid:1
    s_add_u32 s25, s25, 1
    s_add_u32 s27, s28, s55
    s_waitcnt lgkmcnt(1)
    v_mfma_f32_16x16x32_bf16 v[72:75], v[104:107], v[32:35], 0
    s_waitcnt lgkmcnt(0)
    v_add_f32 v84, v84, v86
    v_add_f32 v85, v85, v87
    v_mfma_f32_16x16x32_bf16 v[72:75], v[108:111], v[36:39], v[72:75]
    s_nop 0
    v_cvt_pk_bf16_f32 v84, v80, v84
    v_cvt_pk_bf16_f32 v85, v81, v85
    v_smfmac_f32_16x16x64_bf16 v[64:67], v[8:11], a[144:151], v131 abid:1
    ds_write2_b32 v141, v84, v85 offset0:64 offset1:200
    v_smfmac_f32_16x16x64_bf16 v[64:67], v[12:15], a[152:159], v131 abid:1
    s_nop 1
    v_cndmask_b32 v73, v73, v74, s[58:59]
    v_cndmask_b32 v72, v72, v75, s[58:59]
    v_smfmac_f32_16x16x64_bf16 v[64:67], v[16:19], a[160:167], v131 abid:1
    ds_read_b128 v[104:107], v138 offset:16384
    v_add_f32_dpp v72, v73, v72 quad_perm:[2,3,0,1] row_mask:0xf bank_mask:0xf
    v_mul_f32 v72, s56, v72
    v_smfmac_f32_16x16x64_bf16 v[64:67], v[20:23], a[168:175], v131 abid:1
    ds_read_b128 v[108:111], v138 offset:17408
    v_exp_f32 v73, v72
    v_smfmac_f32_16x16x64_bf16 v[64:67], v[24:27], a[176:183], v131 abid:1
    ds_write_b32 v133, v73 offset:12552
    v_smfmac_f32_16x16x64_bf16 v[64:67], v[28:31], a[184:191], v131 abid:1
    s_waitcnt lgkmcnt(3)
    s_barrier
    v_smfmac_f32_16x16x64_bf16 v[68:71], v[4:7], a[200:207], v131 abid:1
    ds_read_b128 v[40:43], v137 offset:256
    v_mov_b32 v63, 0
    v_smfmac_f32_16x16x64_bf16 v[68:71], v[8:11], a[208:215], v131 abid:1
    ds_read_b128 v[44:47], v137 offset:320
    v_smfmac_f32_16x16x64_bf16 v[68:71], v[12:15], a[216:223], v131 abid:1
    ds_read_b128 v[0:3], v138 offset:18432
    v_add_f32 v64, v64, v66
    v_smfmac_f32_16x16x64_bf16 v[68:71], v[16:19], a[224:231], v131 abid:1
    s_waitcnt lgkmcnt(3)
    s_barrier
    s_waitcnt lgkmcnt(2)
    v_mfma_f32_16x16x32_bf16 v[124:127], v[40:43], v[32:35], 0
    ds_read_b128 v[80:83], v133 offset:12544
    s_waitcnt lgkmcnt(2)
    v_mfma_f32_16x16x32_bf16 v[124:127], v[44:47], v[36:39], v[124:127]
    s_nop 0
    v_add_f32 v65, v65, v67
    v_cvt_pk_bf16_f32 v130, v64, v65
    v_smfmac_f32_16x16x64_bf16 v[68:71], v[20:23], a[232:239], v131 abid:1
    ds_read_b128 v[4:7], v138 offset:19456
    ds_read_b128 v[8:11], v138 offset:20480
    v_smfmac_f32_16x16x64_bf16 v[68:71], v[24:27], a[240:247], v131 abid:1
    ds_read_b128 v[12:15], v138 offset:21504
    v_cndmask_b32 v125, v125, v126, s[58:59]
    v_cndmask_b32 v124, v124, v127, s[58:59]
    v_smfmac_f32_16x16x64_bf16 v[68:71], v[28:31], a[248:255], v131 abid:1
    s_waitcnt lgkmcnt(3)
    v_cvt_pk_bf16_f32 v60, v80, v81
    v_cvt_pk_bf16_f32 v61, v82, v83
    v_add_f32_dpp v124, v125, v124 quad_perm:[2,3,0,1] row_mask:0xf bank_mask:0xf
    v_mul_f32 v124, s56, v124
    v_smfmac_f32_16x16x32_bf16 v[52:55], v[60:61], v[112:115], v131 abid:2
    v_exp_f32 v125, v124
    v_smfmac_f32_16x16x32_bf16 v[56:59], v[60:61], v[116:119], v131 abid:2
    v_cvt_pk_bf16_f32 v62, v125, 0
    v_add_f32 v68, v68, v70
    v_add_f32 v69, v69, v71
    v_mfma_f32_16x16x32_bf16 v[48:51], v[60:63], v[120:123], 0
    ds_read_b128 v[32:35], v138 offset:22528
    v_cvt_pk_bf16_f32 v134, v68, v69
    v_smfmac_f32_16x16x32_bf16 v[52:55], v[62:63], v[130:133], v131
    s_nop 0
    ds_read_b128 v[36:39], v138 offset:23552
    ds_read_b128 v[40:43], v138 offset:24576
    v_smfmac_f32_16x16x32_bf16 v[56:59], v[62:63], v[134:137], v131
    s_nop 0
    v_add_f32 v48, v48, v50
    v_add_f32 v49, v49, v51
    v_rcp_f32 v50, v48
    v_rcp_f32 v51, v49
    v_pk_add_f32 v[52:53], v[52:53], v[54:55]
    v_pk_mul_f32 v[52:53], v[52:53], v[50:51]
    v_max3_f32 v126, v48, v49, v50
    v_pk_add_f32 v[56:57], v[56:57], v[58:59]
    v_pk_mul_f32 v[56:57], v[56:57], v[50:51]
    v_cvt_pk_bf16_f32 v52, v52, v56
    v_cvt_pk_bf16_f32 v53, v53, v57
    v_mfma_f32_16x16x16_bf16 v[80:83], v[128:129], v[128:129], 0
    ds_write2_b32 v141, v52, v53 offset0:0 offset1:136
    v_mfma_f32_16x16x16_bf16 v[84:87], v[128:129], v[128:129], 0
    v_max_f32 v126, v126, v51
    v_cmp_nge_f32 vcc, 0x4f800000, v126
    v_mfma_f32_16x16x16_bf16 v[76:79], v[128:129], v[128:129], 0
    ds_read_b128 v[48:51], v142 offset:128
    s_cbranch_vccnz L_tfast21_big
L_tfast21_back:
    v_mfma_f32_16x16x16_bf16 v[72:75], v[128:129], v[128:129], 0
    s_waitcnt lgkmcnt(1)
    s_barrier
    ds_read_b128 v[52:55], v142 offset:192
    s_waitcnt lgkmcnt(1)
    v_smfmac_f32_16x16x64_bf16 v[80:83], v[48:51], v[104:111], v131 abid:1
    ds_read_b128 v[56:59], v142 offset:0
    v_smfmac_f32_16x16x64_bf16 v[84:87], v[48:51], v[0:7], v131 abid:1
    ds_read_b128 v[60:63], v142 offset:64
    v_smfmac_f32_16x16x64_bf16 v[76:79], v[48:51], v[8:15], v131 abid:1
    ds_read_b128 v[44:47], v138 offset:25600
    s_waitcnt lgkmcnt(3)
    v_smfmac_f32_16x16x64_bf16 v[80:83], v[52:55], v[144:151], v131 abid:1
    ds_read_b128 v[16:19], v138 offset:26624
    s_waitcnt lgkmcnt(3)
    v_smfmac_f32_16x16x64_bf16 v[80:83], v[56:59], v[152:159], v131 abid:1
    ds_read_b128 v[20:23], v138 offset:27648
    s_waitcnt lgkmcnt(3)
    v_smfmac_f32_16x16x64_bf16 v[80:83], v[60:63], v[160:167], v131 abid:1
    s_nop 1
    ds_read_b128 v[24:27], v138 offset:28672
    v_smfmac_f32_16x16x64_bf16 v[84:87], v[52:55], v[32:39], v131 abid:1
    ds_read_b128 v[28:31], v138 offset:29696
    s_waitcnt lgkmcnt(4)
    v_smfmac_f32_16x16x64_bf16 v[84:87], v[56:59], v[40:47], v131 abid:1
    ds_read_b128 v[64:67], v138 offset:30720
    v_cvt_pk_bf16_f32 v80, v80, v82
    v_cvt_pk_bf16_f32 v81, v81, v83
    v_or_b32 v80, 1, v80
    v_smfmac_f32_16x16x64_bf16 v[84:87], v[60:63], v[168:175], v131 abid:1
    buffer_store_dwordx2 v[80:81], v139, s[4:7], s30 offen
    ds_read_b128 v[68:71], v138 offset:31744
    s_waitcnt lgkmcnt(4)
    v_smfmac_f32_16x16x64_bf16 v[76:79], v[52:55], v[16:23], v131 abid:1
    ds_read_b128 v[0:3], v138 offset:32768
    s_waitcnt lgkmcnt(3)
    v_smfmac_f32_16x16x64_bf16 v[76:79], v[56:59], v[176:183], v131 abid:1
    ds_read_b128 v[4:7], v138 offset:33792
    v_cvt_pk_bf16_f32 v84, v84, v86
    v_cvt_pk_bf16_f32 v85, v85, v87
    v_or_b32 v84, 1, v84
    v_smfmac_f32_16x16x64_bf16 v[76:79], v[60:63], v[24:31], v131 abid:1
    buffer_store_dwordx2 v[84:85], v139, s[4:7], s31 offen
    ds_read_b128 v[8:11], v138 offset:34816
    s_nop 0
    v_smfmac_f32_16x16x64_bf16 v[72:75], v[48:51], v[184:191], v131 abid:1
    ds_read_b128 v[12:15], v138 offset:35840
    s_waitcnt lgkmcnt(4)
    v_smfmac_f32_16x16x64_bf16 v[72:75], v[52:55], v[64:71], v131 abid:1
    s_waitcnt lgkmcnt(2)
    v_cvt_pk_bf16_f32 v76, v76, v78
    v_cvt_pk_bf16_f32 v77, v77, v79
    v_or_b32 v76, 1, v76
    v_smfmac_f32_16x16x64_bf16 v[72:75], v[56:59], v[0:7], v131 abid:1
    buffer_store_dwordx2 v[76:77], v139, s[4:7], s32 offen
    s_waitcnt lgkmcnt(0)
    v_smfmac_f32_16x16x64_bf16 v[72:75], v[60:63], v[8:15], v131 abid:1
    s_nop 7
    v_cvt_pk_bf16_f32 v72, v72, v74
    v_cvt_pk_bf16_f32 v73, v73, v75
    v_or_b32 v72, 1, v72
    buffer_store_dwordx2 v[72:73], v139, s[4:7], s33 offen
    s_barrier
    v_mov_b64 v[64:65], 0
    v_mov_b64 v[66:67], 0
    v_mov_b64 v[68:69], 0
    v_mov_b64 v[70:71], 0
    v_mov_b64 v[72:73], 0
    v_mov_b64 v[74:75], 0
    v_mov_b64 v[76:77], 0
    v_mov_b64 v[78:79], 0
    v_mov_b64 v[80:81], 0
    v_mov_b64 v[82:83], 0
    v_mov_b64 v[84:85], 0
    v_mov_b64 v[86:87], 0
    ds_read_b128 v[32:35], v138 offset:0
    ds_read_b128 v[36:39], v138 offset:1024
    ds_read_b128 v[40:43], v138 offset:2048
    ds_read_b128 v[44:47], v138 offset:3072
    ds_read_b128 v[48:51], v138 offset:4096
    ds_read_b128 v[52:55], v138 offset:5120
    ds_read_b128 v[56:59], v138 offset:6144
    ds_read_b128 v[60:63], v138 offset:7168
    s_cmp_lt_u32 s25, 62
    s_cselect_b32 s57, 0x80000, 0
    s_add_u32 s34, s34, s57
    s_add_u32 s35, s35, s57
    s_add_u32 s36, s36, s57
    s_add_u32 s37, s37, s57
    s_mov_b32 s28, s29
    s_add_u32 s29, s29, 0x2000
    s_bitset0_b32 s29, 15
    s_mov_b64 s[16:17], -1
    s_waitcnt vmcnt(4)
    v_cmp_ne_u32 vcc, 0x1010101, v143
    s_cbranch_vccnz L_tfast21_noflag
L_tfast21_flag:
    s_cmp_lt_u32 s25, 61
    s_cselect_b32 s57, 4, 0
    s_add_u32 s51, s51, s57
    s_barrier
    buffer_load_dwordx4 v[0:3], v133, s[4:7], s26 offen sc1
    s_barrier
    buffer_load_dwordx4 v133, s[4:7], s27 offen sc1 lds
    s_barrier
    buffer_load_dword v143, v129, s[4:7], s51 offen sc1
    buffer_load_dwordx4 v[104:107], v133, s[4:7], s34 offen sc1
    buffer_load_dwordx4 v[108:111], v133, s[4:7], s35 offen sc1
    buffer_load_dwordx4 v[112:115], v133, s[4:7], s36 offen sc1
    buffer_load_dwordx4 v[116:119], v133, s[4:7], s37 offen sc1
    s_branch L_tfast20_again
L_tfast20_noflag:
    s_waitcnt vmcnt(0)
L_poll_17:
    buffer_load_dword v143, v129, s[4:7], s51 offen offset:0 sc1
    s_movk_i32 s3, 18
    s_sub_u32 s24, s24, 1
    s_cbranch_scc1 L_timeout
    s_waitcnt vmcnt(0)
    v_cmp_gt_u32 vcc, 16843009, v143
    s_cbranch_vccnz L_poll_17
    s_branch L_tfast20_flag
L_tfast20_miss:
    s_waitcnt lgkmcnt(0)
    v_max3_u32 v132, v0, v1, v2
    v_max3_u32 v130, v3, v4, v5
    v_max3_u32 v132, v132, v6, v7
    v_max_u32 v132, v132, v130
    v_cmpx_eq_u32 vcc, -1, v132
    s_cbranch_execz L_tfast20_whole
L_tfast20_reload:
    buffer_load_dwordx4 v[0:3], v133, s[4:7], s26 offen sc1
    buffer_load_dwordx4 v[4:7], v133, s[4:7], s27 offen sc1
    s_movk_i32 s3, 16
    s_sub_u32 s24, s24, 1
    s_cbranch_scc1 L_timeout
    v_max3_u32 v132, v0, v1, v2
    v_max3_u32 v130, v3, v4, v5
    v_max3_u32 v132, v132, v6, v7
    v_max_u32 v132, v132, v130
    v_cmpx_eq_u32 vcc, -1, v132
    s_cbranch_execnz L_tfast20_reload
L_tfast20_whole:
    s_mov_b64 exec, -1
    s_mov_b64 s[16:17], 0
    ds_read_b128 v[32:35], v138 offset:0
    ds_read_b128 v[36:39], v138 offset:1024
    ds_read_b128 v[40:43], v138 offset:2048
    ds_read_b128 v[44:47], v138 offset:3072
    ds_read_b128 v[48:51], v138 offset:4096
    ds_read_b128 v[52:55], v138 offset:5120
    ds_read_b128 v[56:59], v138 offset:6144
    ds_read_b128 v[60:63], v138 offset:7168
    v_mov_b64 v[64:65], 0
    v_mov_b64 v[66:67], 0
    v_mov_b64 v[68:69], 0
    v_mov_b64 v[70:71], 0
    v_mov_b64 v[72:73], 0
    v_mov_b64 v[74:75], 0
    v_mov_b64 v[76:77], 0
    v_mov_b64 v[78:79], 0
    v_mov_b64 v[80:81], 0
    v_mov_b64 v[82:83], 0
    v_mov_b64 v[84:85], 0
    v_mov_b64 v[86:87], 0
    s_waitcnt vmcnt(0)
    ds_write_b128 v133, v[4:7] offset:5120
    s_branch L_tfast20_again
L_tfast20_big:
    ds_write_b32 v133, v72 offset:13576
    s_waitcnt lgkmcnt(0)
    s_barrier
    ds_read_b128 v[60:63], v133 offset:13568
    s_waitcnt lgkmcnt(0)
    v_max3_f32 v126, v60, v61, v62
    v_max3_f32 v126, v126, v63, v124
    s_nop 1
    v_max_f32_dpp v126, v126, v126 quad_perm:[2,3,0,1] row_mask:0xf bank_mask:0xf
    v_mov_b32 v127, v126
    s_nop 1
    v_permlane16_swap_b32 v126, v127
    v_max_f32 v126, v126, v127
    v_mov_b32 v127, v126
    s_nop 1
    v_permlane32_swap_b32 v126, v127
    v_max_f32 v126, v126, v127
    v_sub_f32 v60, v60, v126
    v_exp_f32 v60, v60
    v_sub_f32 v61, v61, v126
    v_exp_f32 v61, v61
    v_sub_f32 v62, v62, v126
    v_exp_f32 v62, v62
    v_sub_f32 v63, v63, v126
    v_exp_f32 v63, v63
    v_sub_f32 v124, v124, v126
    v_exp_f32 v124, v124
    v_cvt_pk_bf16_f32 v60, v60, v61
    v_cvt_pk_bf16_f32 v61, v62, v63
    v_cvt_pk_bf16_f32 v62, v124, 0
    v_mov_b64 v[52:53], 0
    v_mov_b64 v[54:55], 0
    v_mov_b64 v[56:57], 0
    v_mov_b64 v[58:59], 0
    v_mov_b32 v63, 0
    s_nop 1
    v_mfma_f32_16x16x32_bf16 v[48:51], v[60:63], v[120:123], 0
    v_smfmac_f32_16x16x32_bf16 v[52:55], v[62:63], v[130:133], v131
    v_smfmac_f32_16x16x32_bf16 v[56:59], v[62:63], v[134:137], v131
    v_smfmac_f32_16x16x32_bf16 v[52:55], v[60:61], v[96:99], v131 abid:2
    v_smfmac_f32_16x16x32_bf16 v[56:59], v[60:61], v[100:103], v131 abid:2
    s_nop 3
    v_add_f32 v48, v48, v50
    v_add_f32 v49, v49, v51
    v_rcp_f32 v50, v48
    v_rcp_f32 v51, v49
    v_pk_add_f32 v[52:53], v[52:53], v[54:55]
    v_pk_mul_f32 v[52:53], v[52:53], v[50:51]
    v_max3_f32 v126, v48, v49, v50
    v_pk_add_f32 v[56:57], v[56:57], v[58:59]
    v_pk_mul_f32 v[56:57], v[56:57], v[50:51]
    v_cvt_pk_bf16_f32 v52, v52, v56
    v_cvt_pk_bf16_f32 v53, v53, v57
    ds_write2_b32 v141, v52, v53 offset0:0 offset1:136
    ds_read_b128 v[48:51], v142 offset:128
    v_mfma_f32_16x16x16_bf16 v[80:83], v[128:129], v[128:129], 0
    v_mfma_f32_16x16x16_bf16 v[84:87], v[128:129], v[128:129], 0
    v_mfma_f32_16x16x16_bf16 v[76:79], v[128:129], v[128:129], 0
    s_branch L_tfast20_back
L_tfast21_noflag:
    s_waitcnt vmcnt(0)
L_poll_18:
    buffer_load_dword v143, v129, s[4:7], s51 offen offset:0 sc1
    s_movk_i32 s3, 18
    s_sub_u32 s24, s24, 1
    s_cbranch_scc1 L_timeout
    s_waitcnt vmcnt(0)
    v_cmp_gt_u32 vcc, 16843009, v143
    s_cbranch_vccnz L_poll_18
    s_branch L_tfast21_flag
L_tfast21_miss:
    s_waitcnt lgkmcnt(0)
    v_max3_u32 v132, v0, v1, v2
    v_max3_u32 v130, v3, v4, v5
    v_max3_u32 v132, v132, v6, v7
    v_max_u32 v132, v132, v130
    v_cmpx_eq_u32 vcc, -1, v132
    s_cbranch_execz L_tfast21_whole
L_tfast21_reload:
    buffer_load_dwordx4 v[0:3], v133, s[4:7], s26 offen sc1
    buffer_load_dwordx4 v[4:7], v133, s[4:7], s27 offen sc1
    s_movk_i32 s3, 16
    s_sub_u32 s24, s24, 1
    s_cbranch_scc1 L_timeout
    v_max3_u32 v132, v0, v1, v2
    v_max3_u32 v130, v3, v4, v5
    v_max3_u32 v132, v132, v6, v7
    v_max_u32 v132, v132, v130
    v_cmpx_eq_u32 vcc, -1, v132
    s_cbranch_execnz L_tfast21_reload
L_tfast21_whole:
    s_mov_b64 exec, -1
    s_mov_b64 s[16:17], 0
    ds_read_b128 v[32:35], v138 offset:0
    ds_read_b128 v[36:39], v138 offset:1024
    ds_read_b128 v[40:43], v138 offset:2048
    ds_read_b128 v[44:47], v138 offset:3072
    ds_read_b128 v[48:51], v138 offset:4096
    ds_read_b128 v[52:55], v138 offset:5120
    ds_read_b128 v[56:59], v138 offset:6144
    ds_read_b128 v[60:63], v138 offset:7168
    v_mov_b64 v[64:65], 0
    v_mov_b64 v[66:67], 0
    v_mov_b64 v[68:69], 0
    v_mov_b64 v[70:71], 0
    v_mov_b64 v[72:73], 0
    v_mov_b64 v[74:75], 0
    v_mov_b64 v[76:77], 0
    v_mov_b64 v[78:79], 0
    v_mov_b64 v[80:81], 0
    v_mov_b64 v[82:83], 0
    v_mov_b64 v[84:85], 0
    v_mov_b64 v[86:87], 0
    s_waitcnt vmcnt(0)
    ds_write_b128 v133, v[4:7] offset:5120
    s_branch L_tfast21_again
L_tfast21_big:
    ds_write_b32 v133, v72 offset:13576
    s_waitcnt lgkmcnt(0)
    s_barrier
    ds_read_b128 v[60:63], v133 offset:13568
    s_waitcnt lgkmcnt(0)
    v_max3_f32 v126, v60, v61, v62
    v_max3_f32 v126, v126, v63, v124
    s_nop 1
    v_max_f32_dpp v126, v126, v126 quad_perm:[2,3,0,1] row_mask:0xf bank_mask:0xf
    v_mov_b32 v127, v126
    s_nop 1
    v_permlane16_swap_b32 v126, v127
    v_max_f32 v126, v126, v127
    v_mov_b32 v127, v126
    s_nop 1
    v_permlane32_swap_b32 v126, v127
    v_max_f32 v126, v126, v127
    v_sub_f32 v60, v60, v126
    v_exp_f32 v60, v60
    v_sub_f32 v61, v61, v126
    v_exp_f32 v61, v61
    v_sub_f32 v62, v62, v126
    v_exp_f32 v62, v62
    v_sub_f32 v63, v63, v126
    v_exp_f32 v63, v63
    v_sub_f32 v124, v124, v126
    v_exp_f32 v124, v124
    v_cvt_pk_bf16_f32 v60, v60, v61
    v_cvt_pk_bf16_f32 v61, v62, v63
    v_cvt_pk_bf16_f32 v62, v124, 0
    v_mov_b64 v[52:53], 0
    v_mov_b64 v[54:55], 0
    v_mov_b64 v[56:57], 0
    v_mov_b64 v[58:59], 0
    v_mov_b32 v63, 0
    s_nop 1
    v_mfma_f32_16x16x32_bf16 v[48:51], v[60:63], v[120:123], 0
    v_smfmac_f32_16x16x32_bf16 v[52:55], v[62:63], v[130:133], v131
    v_smfmac_f32_16x16x32_bf16 v[56:59], v[62:63], v[134:137], v131
    v_smfmac_f32_16x16x32_bf16 v[52:55], v[60:61], v[112:115], v131 abid:2
    v_smfmac_f32_16x16x32_bf16 v[56:59], v[60:61], v[116:119], v131 abid:2
    s_nop 3
    v_add_f32 v48, v48, v50
    v_add_f32 v49, v49, v51
    v_rcp_f32 v50, v48
    v_rcp_f32 v51, v49
    v_pk_add_f32 v[52:53], v[52:53], v[54:55]
    v_pk_mul_f32 v[52:53], v[52:53], v[50:51]
    v_max3_f32 v126, v48, v49, v50
    v_pk_add_f32 v[56:57], v[56:57], v[58:59]
    v_pk_mul_f32 v[56:57], v[56:57], v[50:51]
    v_cvt_pk_bf16_f32 v52, v52, v56
    v_cvt_pk_bf16_f32 v53, v53, v57
    ds_write2_b32 v141, v52, v53 offset0:0 offset1:136
    ds_read_b128 v[48:51], v142 offset:128
    v_mfma_f32_16x16x16_bf16 v[80:83], v[128:129], v[128:129], 0
    v_mfma_f32_16x16x16_bf16 v[84:87], v[128:129], v[128:129], 0
    v_mfma_f32_16x16x16_bf16 v[76:79], v[128:129], v[128:129], 0
    s_branch L_tfast21_back
.p2align 6
L_tfast30_again:
    s_waitcnt vmcnt(5) lgkmcnt(0)
    v_smfmac_f32_16x16x64_bf16 v[72:75], v[0:3], v[32:39], v131 abid:1
    ds_write_b128 v133, v[0:3] offset:6144
    v_smfmac_f32_16x16x64_bf16 v[76:79], v[0:3], v[40:47], v131 abid:1
    v_smfmac_f32_16x16x64_bf16 v[80:83], v[0:3], a[24:31], v131 abid:1
    v_smfmac_f32_16x16x64_bf16 v[84:87], v[0:3], a[64:71], v131 abid:1
    s_waitcnt vmcnt(4)
    ds_read_b128 v[4:7], v133 offset:7168
    v_smfmac_f32_16x16x64_bf16 v[64:67], v[0:3], a[128:135], v131 abid:1
    v_smfmac_f32_16x16x64_bf16 v[68:71], v[0:3], a[192:199], v131 abid:1
    s_waitcnt lgkmcnt(1)
    s_barrier
    s_waitcnt lgkmcnt(0)
    v_smfmac_f32_16x16x64_bf16 v[72:75], v[4:7], v[48:55], v131 abid:1
    ds_read_b128 v[8:11], v133 offset:4096
    v_smfmac_f32_16x16x64_bf16 v[76:79], v[4:7], v[56:63], v131 abid:1
    ds_read_b128 v[12:15], v133 offset:5120
    v_smfmac_f32_16x16x64_bf16 v[80:83], v[4:7], a[32:39], v131 abid:1
    ds_read_b128 v[16:19], v133 offset:2048
    v_smfmac_f32_16x16x64_bf16 v[84:87], v[4:7], a[72:79], v131 abid:1
    ds_read_b128 v[20:23], v133 offset:3072
    s_waitcnt lgkmcnt(3)
    v_smfmac_f32_16x16x64_bf16 v[72:75], v[8:11], v[192:199], v131 abid:1
    ds_read_b128 v[24:27], v133 offset:0
    v_smfmac_f32_16x16x64_bf16 v[76:79], v[8:11], v[240:247], v131 abid:1
    ds_read_b128 v[28:31], v133 offset:1024
    s_waitcnt lgkmcnt(4)
    v_smfmac_f32_16x16x64_bf16 v[72:75], v[12:15], v[200:207], v131 abid:1
    ds_read_b128 v[32:35], v138 offset:8192
    v_smfmac_f32_16x16x64_bf16 v[76:79], v[12:15], v[248:255], v131 abid:1
    ds_read_b128 v[36:39], v138 offset:9216
    s_waitcnt lgkmcnt(5)
    v_smfmac_f32_16x16x64_bf16 v[72:75], v[16:19], v[208:215], v131 abid:1
    ds_read_b128 v[40:43], v138 offset:10240
    s_waitcnt lgkmcnt(5)
    v_smfmac_f32_16x16x64_bf16 v[72:75], v[20:23], v[216:223], v131 abid:1
    ds_read_b128 v[44:47], v138 offset:11264
    s_waitcnt lgkmcnt(5)
    v_smfmac_f32_16x16x64_bf16 v[72:75], v[24:27], v[224:231], v131 abid:1
    ds_read_b128 v[48:51], v138 offset:12288
    s_waitcnt lgkmcnt(5)
    v_smfmac_f32_16x16x64_bf16 v[72:75], v[28:31], v[232:239], v131 abid:1
    s_nop 1
    ds_read_b128 v[52:55], v138 offset:13312
    v_smfmac_f32_16x16x64_bf16 v[76:79], v[16:19], a[0:7], v131 abid:1
    s_nop 1
    ds_read_b128 v[56:59], v138 offset:14336
    v_smfmac_f32_16x16x64_bf16 v[76:79], v[20:23], a[8:15], v131 abid:1
    ds_read_b128 v[60:63], v138 offset:15360
    v_add_f32 v72, v72, v74
    v_smfmac_f32_16x16x64_bf16 v[76:79], v[24:27], a[16:23], v131 abid:1
    s_waitcnt lgkmcnt(3)
    v_add_f32 v73, v73, v75
    v_smfmac_f32_16x16x64_bf16 v[76:79], v[28:31], v[32:39], v131 abid:1
    s_nop 2
    v_smfmac_f32_16x16x64_bf16 v[80:83], v[8:11], a[40:47], v131 abid:1
    s_nop 1
    v_cmp_u_f32 vcc, v72, v73
    v_smfmac_f32_16x16x64_bf16 v[80:83], v[12:15], v[40:47], v131 abid:1
    v_add_f32 v76, v76, v78
    v_add_f32 v77, v77, v79
    v_smfmac_f32_16x16x64_bf16 v[80:83], v[16:19], a[48:55], v131 abid:1
    s_waitcnt lgkmcnt(1)
    v_cvt_pk_bf16_f32 v76, v72, v76
    v_cvt_pk_bf16_f32 v77, v73, v77
    v_smfmac_f32_16x16x64_bf16 v[80:83], v[20:23], v[48:55], v131 abid:1
    ds_write2_b32 v141, v76, v77 offset0:0 offset1:136
    v_smfmac_f32_16x16x64_bf16 v[80:83], v[24:27], a[56:63], v131 abid:1
    s_waitcnt lgkmcnt(1)
    v_mov_b64 v[52:53], 0
    v_smfmac_f32_16x16x64_bf16 v[80:83], v[28:31], v[56:63], v131 abid:1
    s_nop 1
    v_mov_b64 v[54:55], 0
    v_smfmac_f32_16x16x64_bf16 v[84:87], v[8:11], a[80:87], v131 abid:1
    s_nop 1
    v_mov_b64 v[56:57], 0
    v_smfmac_f32_16x16x64_bf16 v[84:87], v[12:15], a[88:95], v131 abid:1
    s_and_b64 vcc, vcc, s[16:17]
    v_add_f32 v80, v80, v82
    v_smfmac_f32_16x16x64_bf16 v[84:87], v[16:19], a[96:103], v131 abid:1
    s_waitcnt lgkmcnt(0)
    s_barrier
    v_smfmac_f32_16x16x64_bf16 v[84:87], v[20:23], a[104:111], v131 abid:1
    ds_read_b128 v[32:35], v137 offset:0
    v_add_f32 v81, v81, v83
    v_smfmac_f32_16x16x64_bf16 v[84:87], v[24:27], a[112:119], v131 abid:1
    ds_read_b128 v[36:39], v137 offset:64
    v_mov_b64 v[58:59], 0
    v_smfmac_f32_16x16x64_bf16 v[84:87], v[28:31], a[120:127], v131 abid:1
    s_cbranch_scc1 L_tfast30_miss
    s_add_u32 s26, s28, s54
    v_smfmac_f32_16x16x64_bf16 v[64:67], v[4:7], a[136:143], v131 abid:1
    s_add_u32 s25, s25, 1
    s_add_u32 s27, s28, s55
    s_waitcnt lgkmcnt(1)
    v_mfma_f32_16x16x32_bf16 v[72:75], v[88:91], v[32:35], 0
    s_waitcnt lgkmcnt(0)
    v_add_f32 v84, v84, v86
    v_add_f32 v85, v85, v87
    v_mfma_f32_16x16x32_bf16 v[72:75], v[92:95], v[36:39], v[72:75]
    s_nop 0
    v_cvt_pk_bf16_f32 v84, v80, v84
    v_cvt_pk_bf16_f32 v85, v81, v85
    v_smfmac_f32_16x16x64_bf16 v[64:67], v[8:11], a[144:151], v131 abid:1
    ds_write2_b32 v141, v84, v85 offset0:64 offset1:200
    v_smfmac_f32_16x16x64_bf16 v[64:67], v[12:15], a[152:159], v131 abid:1
    s_nop 1
    v_cndmask_b32 v73, v73, v74, s[58:59]
    v_cndmask_b32 v72, v72, v75, s[58:59]
    v_smfmac_f32_16x16x64_bf16 v[64:67], v[16:19], a[160:167], v131 abid:1
    ds_read_b128 v[88:91], v138 offset:16384
    v_add_f32_dpp v72, v73, v72 quad_perm:[2,3,0,1] row_mask:0xf bank_mask:0xf
    v_mul_f32 v72, s56, v72
    v_smfmac_f32_16x16x64_bf16 v[64:67], v[20:23], a[168:175], v131 abid:1
    ds_read_b128 v[92:95], v138 offset:17408
    v_exp_f32 v73, v72
    v_smfmac_f32_16x16x64_bf16 v[64:67], v[24:27], a[176:183], v131 abid:1
    ds_write_b32 v133, v73 offset:12556
    v_smfmac_f32_16x16x64_bf16 v[64:67], v[28:31], a[184:191], v131 abid:1
    s_waitcnt lgkmcnt(3)
    s_barrier
    v_smfmac_f32_16x16x64_bf16 v[68:71], v[4:7], a[200:207], v131 abid:1
    ds_read_b128 v[40:43], v137 offset:256
    v_mov_b32 v63, 0
    v_smfmac_f32_16x16x64_bf16 v[68:71], v[8:11], a[208:215], v131 abid:1
    ds_read_b128 v[44:47], v137 offset:320
    v_mov_b32 v143, s25
    v_smfmac_f32_16x16x64_bf16 v[68:71], v[12:15], a[216:223], v131 abid:1
    ds_read_b128 v[0:3], v138 offset:18432
    v_add_f32 v64, v64, v66
    v_smfmac_f32_16x16x64_bf16 v[68:71], v[16:19], a[224:231], v131 abid:1
    s_waitcnt lgkmcnt(3)
    s_barrier
    s_waitcnt lgkmcnt(2)
    v_mfma_f32_16x16x32_bf16 v[124:127], v[40:43], v[32:35], 0
    ds_read_b128 v[80:83], v133 offset:12544
    s_waitcnt lgkmcnt(2)
    v_mfma_f32_16x16x32_bf16 v[124:127], v[44:47], v[36:39], v[124:127]
    s_nop 0
    v_add_f32 v65, v65, v67
    v_cvt_pk_bf16_f32 v130, v64, v65
    v_smfmac_f32_16x16x64_bf16 v[68:71], v[20:23], a[232:239], v131 abid:1
    ds_read_b128 v[4:7], v138 offset:19456
    ds_read_b128 v[8:11], v138 offset:20480
    v_smfmac_f32_16x16x64_bf16 v[68:71], v[24:27], a[240:247], v131 abid:1
    ds_read_b128 v[12:15], v138 offset:21504
    v_cndmask_b32 v125, v125, v126, s[58:59]
    v_cndmask_b32 v124, v124, v127, s[58:59]
    v_smfmac_f32_16x16x64_bf16 v[68:71], v[28:31], a[248:255], v131 abid:1
    s_waitcnt lgkmcnt(3)
    v_cvt_pk_bf16_f32 v60, v80, v81
    v_cvt_pk_bf16_f32 v61, v82, v83
    v_add_f32_dpp v124, v125, v124 quad_perm:[2,3,0,1] row_mask:0xf bank_mask:0xf
    v_mul_f32 v124, s56, v124
    v_smfmac_f32_16x16x32_bf16 v[52:55], v[60:61], v[96:99], v131 abid:2
    v_exp_f32 v125, v124
    v_smfmac_f32_16x16x32_bf16 v[56:59], v[60:61], v[100:103], v131 abid:2
    v_cvt_pk_bf16_f32 v62, v125, 0
    v_add_f32 v68, v68, v70
    v_add_f32 v69, v69, v71
    v_mfma_f32_16x16x32_bf16 v[48:51], v[60:63], v[120:123], 0
    ds_read_b128 v[32:35], v138 offset:22528
    v_cvt_pk_bf16_f32 v134, v68, v69
    v_smfmac_f32_16x16x32_bf16 v[52:55], v[62:63], v[130:133], v131
    s_nop 0
    ds_read_b128 v[36:39], v138 offset:23552
    ds_read_b128 v[40:43], v138 offset:24576
    v_smfmac_f32_16x16x32_bf16 v[56:59], v[62:63], v[134:137], v131
    s_nop 0
    v_add_f32 v48, v48, v50
    v_add_f32 v49, v49, v51
    v_rcp_f32 v50, v48
    v_rcp_f32 v51, v49
    v_pk_add_f32 v[52:53], v[52:53], v[54:55]
    v_pk_mul_f32 v[52:53], v[52:53], v[50:51]
    v_max3_f32 v126, v48, v49, v50
    v_pk_add_f32 v[56:57], v[56:57], v[58:59]
    v_pk_mul_f32 v[56:57], v[56:57], v[50:51]
    v_cvt_pk_bf16_f32 v52, v52, v56
    v_cvt_pk_bf16_f32 v53, v53, v57
    v_mfma_f32_16x16x16_bf16 v[80:83], v[128:129], v[128:129], 0
    ds_write2_b32 v141, v52, v53 offset0:0 offset1:136
    v_mfma_f32_16x16x16_bf16 v[84:87], v[128:129], v[128:129], 0
    v_max_f32 v126, v126, v51
    v_cmp_nge_f32 vcc, 0x4f800000, v126
    v_mfma_f32_16x16x16_bf16 v[76:79], v[128:129], v[128:129], 0
    ds_read_b128 v[48:51], v142 offset:192
    s_cbranch_vccnz L_tfast30_big
L_tfast30_back:
    v_mfma_f32_16x16x16_bf16 v[72:75], v[128:129], v[128:129], 0
    buffer_store_dword v143, v140, s[4:7], s47 offen
    s_waitcnt lgkmcnt(1)
    s_barrier
    ds_read_b128 v[52:55], v142 offset:128
    s_waitcnt lgkmcnt(1)
    v_smfmac_f32_16x16x64_bf16 v[80:83], v[48:51], v[88:95], v131 abid:1
    ds_read_b128 v[56:59], v142 offset:64
    v_smfmac_f32_16x16x64_bf16 v[84:87], v[48:51], v[0:7], v131 abid:1
    ds_read_b128 v[60:63], v142 offset:0
    v_smfmac_f32_16x16x64_bf16 v[76:79], v[48:51], v[8:15], v131 abid:1
    ds_read_b128 v[44:47], v138 offset:25600
    s_waitcnt lgkmcnt(3)
    v_smfmac_f32_16x16x64_bf16 v[80:83], v[52:55], v[144:151], v131 abid:1
    ds_read_b128 v[16:19], v138 offset:26624
    s_waitcnt lgkmcnt(3)
    v_smfmac_f32_16x16x64_bf16 v[80:83], v[56:59], v[152:159], v131 abid:1
    ds_read_b128 v[20:23], v138 offset:27648
    s_waitcnt lgkmcnt(3)
    v_smfmac_f32_16x16x64_bf16 v[80:83], v[60:63], v[160:167], v131 abid:1
    s_nop 1
    ds_read_b128 v[24:27], v138 offset:28672
    v_smfmac_f32_16x16x64_bf16 v[84:87], v[52:55], v[32:39], v131 abid:1
    ds_read_b128 v[28:31], v138 offset:29696
    s_waitcnt lgkmcnt(4)
    v_smfmac_f32_16x16x64_bf16 v[84:87], v[56:59], v[40:47], v131 abid:1
    ds_read_b128 v[64:67], v138 offset:30720
    v_cvt_pk_bf16_f32 v80, v80, v82
    v_cvt_pk_bf16_f32 v81, v81, v83
    v_and_b32 v80, -2, v80
    v_smfmac_f32_16x16x64_bf16 v[84:87], v[60:63], v[168:175], v131 abid:1
    buffer_store_dwordx2 v[80:81], v139, s[4:7], s30 offen
    ds_read_b128 v[68:71], v138 offset:31744
    s_waitcnt lgkmcnt(4)
    v_smfmac_f32_16x16x64_bf16 v[76:79], v[52:55], v[16:23], v131 abid:1
    ds_read_b128 v[0:3], v138 offset:32768
    s_waitcnt lgkmcnt(3)
    v_smfmac_f32_16x16x64_bf16 v[76:79], v[56:59], v[176:183], v131 abid:1
    ds_read_b128 v[4:7], v138 offset:33792
    v_cvt_pk_bf16_f32 v84, v84, v86
    v_cvt_pk_bf16_f32 v85, v85, v87
    v_and_b32 v84, -2, v84
    v_smfmac_f32_16x16x64_bf16 v[76:79], v[60:63], v[24:31], v131 abid:1
    buffer_store_dwordx2 v[84:85], v139, s[4:7], s31 offen
    ds_read_b128 v[8:11], v138 offset:34816
    s_nop 0
    v_smfmac_f32_16x16x64_bf16 v[72:75], v[48:51], v[184:191], v131 abid:1
    ds_read_b128 v[12:15], v138 offset:35840
    s_waitcnt lgkmcnt(4)
    v_smfmac_f32_16x16x64_bf16 v[72:75], v[52:55], v[64:71], v131 abid:1
    s_waitcnt lgkmcnt(2)
    v_cvt_pk_bf16_f32 v76, v76, v78
    v_cvt_pk_bf16_f32 v77, v77, v79
    v_and_b32 v76, -2, v76
    v_smfmac_f32_16x16x64_bf16 v[72:75], v[56:59], v[0:7], v131 abid:1
    buffer_store_dwordx2 v[76:77], v139, s[4:7], s32 offen
    s_waitcnt lgkmcnt(0)
    v_smfmac_f32_16x16x64_bf16 v[72:75], v[60:63], v[8:15], v131 abid:1
    s_nop 7
    v_cvt_pk_bf16_f32 v72, v72, v74
    v_cvt_pk_bf16_f32 v73, v73, v75
    v_and_b32 v72, -2, v72
    buffer_store_dwordx2 v[72:73], v139, s[4:7], s33 offen
    s_cmp_eq_u32 s25, 63
    s_cbranch_scc1 L_end
    s_barrier
    v_mov_b64 v[64:65], 0
    v_mov_b64 v[66:67], 0
    v_mov_b64 v[68:69], 0
    v_mov_b64 v[70:71], 0
    v_mov_b64 v[72:73], 0
    v_mov_b64 v[74:75], 0
    v_mov_b64 v[76:77], 0
    v_mov_b64 v[78:79], 0
    v_mov_b64 v[80:81], 0
    v_mov_b64 v[82:83], 0
    v_mov_b64 v[84:85], 0
    v_mov_b64 v[86:87], 0
    ds_read_b128 v[32:35], v138 offset:0
    ds_read_b128 v[36:39], v138 offset:1024
    ds_read_b128 v[40:43], v138 offset:2048
    ds_read_b128 v[44:47], v138 offset:3072
    ds_read_b128 v[48:51], v138 offset:4096
    ds_read_b128 v[52:55], v138 offset:5120
    ds_read_b128 v[56:59], v138 offset:6144
    ds_read_b128 v[60:63], v138 offset:7168
    s_cmp_lt_u32 s25, 62
    s_cselect_b32 s57, 0x80000, 0
    s_add_u32 s34, s34, s57
    s_add_u32 s35, s35, s57
    s_add_u32 s36, s36, s57
    s_add_u32 s37, s37, s57
    s_mov_b32 s28, s29
    s_add_u32 s29, s29, 0x2000
    s_bitset0_b32 s29, 15
    s_mov_b64 s[16:17], -1
    s_barrier
    buffer_load_dwordx4 v[0:3], v133, s[4:7], s26 offen sc1
    s_barrier
    buffer_load_dwordx4 v133, s[4:7], s27 offen sc1 lds
    s_barrier
    buffer_load_dwordx4 v[88:91], v133, s[4:7], s34 offen sc1
    buffer_load_dwordx4 v[92:95], v133, s[4:7], s35 offen sc1
    buffer_load_dwordx4 v[96:99], v133, s[4:7], s36 offen sc1
    buffer_load_dwordx4 v[100:103], v133, s[4:7], s37 offen sc1
L_tfast31_again:
    s_waitcnt vmcnt(5) lgkmcnt(0)
    v_smfmac_f32_16x16x64_bf16 v[72:75], v[0:3], v[32:39], v131 abid:1
    ds_write_b128 v133, v[0:3] offset:6144
    v_smfmac_f32_16x16x64_bf16 v[76:79], v[0:3], v[40:47], v131 abid:1
    v_smfmac_f32_16x16x64_bf16 v[80:83], v[0:3], a[24:31], v131 abid:1
    v_smfmac_f32_16x16x64_bf16 v[84:87], v[0:3], a[64:71], v131 abid:1
    s_waitcnt vmcnt(4)
    ds_read_b128 v[4:7], v133 offset:7168
    v_smfmac_f32_16x16x64_bf16 v[64:67], v[0:3], a[128:135], v131 abid:1
    v_smfmac_f32_16x16x64_bf16 v[68:71], v[0:3], a[192:199], v131 abid:1
    s_waitcnt lgkmcnt(1)
    s_barrier
    s_waitcnt lgkmcnt(0)
    v_smfmac_f32_16x16x64_bf16 v[72:75], v[4:7], v[48:55], v131 abid:1
    ds_read_b128 v[8:11], v133 offset:4096
    v_smfmac_f32_16x16x64_bf16 v[76:79], v[4:7], v[56:63], v131 abid:1
    ds_read_b128 v[12:15], v133 offset:5120
    v_smfmac_f32_16x16x64_bf16 v[80:83], v[4:7], a[32:39], v131 abid:1
    ds_read_b128 v[16:19], v133 offset:2048
    v_smfmac_f32_16x16x64_bf16 v[84:87], v[4:7], a[72:79], v131 abid:1
    ds_read_b128 v[20:23], v133 offset:3072
    s_waitcnt lgkmcnt(3)
    v_smfmac_f32_16x16x64_bf16 v[72:75], v[8:11], v[192:199], v131 abid:1
    ds_read_b128 v[24:27], v133 offset:0
    v_smfmac_f32_16x16x64_bf16 v[76:79], v[8:11], v[240:247], v131 abid:1
    ds_read_b128 v[28:31], v133 offset:1024
    s_waitcnt lgkmcnt(4)
    v_smfmac_f32_16x16x64_bf16 v[72:75], v[12:15], v[200:207], v131 abid:1
    ds_read_b128 v[32:35], v138 offset:8192
    v_smfmac_f32_16x16x64_bf16 v[76:79], v[12:15], v[248:255], v131 abid:1
    ds_read_b128 v[36:39], v138 offset:9216
    s_waitcnt lgkmcnt(5)
    v_smfmac_f32_16x16x64_bf16 v[72:75], v[16:19], v[208:215], v131 abid:1
    ds_read_b128 v[40:43], v138 offset:10240
    s_waitcnt lgkmcnt(5)
    v_smfmac_f32_16x16x64_bf16 v[72:75], v[20:23], v[216:223], v131 abid:1
    ds_read_b128 v[44:47], v138 offset:11264
    s_waitcnt lgkmcnt(5)
    v_smfmac_f32_16x16x64_bf16 v[72:75], v[24:27], v[224:231], v131 abid:1
    ds_read_b128 v[48:51], v138 offset:12288
    s_waitcnt lgkmcnt(5)
    v_smfmac_f32_16x16x64_bf16 v[72:75], v[28:31], v[232:239], v131 abid:1
    s_nop 1
    ds_read_b128 v[52:55], v138 offset:13312
    v_smfmac_f32_16x16x64_bf16 v[76:79], v[16:19], a[0:7], v131 abid:1
    s_nop 1
    ds_read_b128 v[56:59], v138 offset:14336
    v_smfmac_f32_16x16x64_bf16 v[76:79], v[20:23], a[8:15], v131 abid:1
    ds_read_b128 v[60:63], v138 offset:15360
    v_add_f32 v72, v72, v74
    v_smfmac_f32_16x16x64_bf16 v[76:79], v[24:27], a[16:23], v131 abid:1
    s_waitcnt lgkmcnt(3)
    v_add_f32 v73, v73, v75
    v_smfmac_f32_16x16x64_bf16 v[76:79], v[28:31], v[32:39], v131 abid:1
    s_nop 2
    v_smfmac_f32_16x16x64_bf16 v[80:83], v[8:11], a[40:47], v131 abid:1
    s_nop 1
    v_cmp_u_f32 vcc, v72, v73
    v_smfmac_f32_16x16x64_bf16 v[80:83], v[12:15], v[40:47], v131 abid:1
    v_add_f32 v76, v76, v78
    v_add_f32 v77, v77, v79
    v_smfmac_f32_16x16x64_bf16 v[80:83], v[16:19], a[48:55], v131 abid:1
    s_waitcnt lgkmcnt(1)
    v_cvt_pk_bf16_f32 v76, v72, v76
    v_cvt_pk_bf16_f32 v77, v73, v77
    v_smfmac_f32_16x16x64_bf16 v[80:83], v[20:23], v[48:55], v131 abid:1
    ds_write2_b32 v141, v76, v77 offset0:0 offset1:136
    v_smfmac_f32_16x16x64_bf16 v[80:83], v[24:27], a[56:63], v131 abid:1
    s_waitcnt lgkmcnt(1)
    v_mov_b64 v[52:53], 0
    v_smfmac_f32_16x16x64_bf16 v[80:83], v[28:31], v[56:63], v131 abid:1
    s_nop 1
    v_mov_b64 v[54:55], 0
    v_smfmac_f32_16x16x64_bf16 v[84:87], v[8:11], a[80:87], v131 abid:1
    s_nop 1
    v_mov_b64 v[56:57], 0
    v_smfmac_f32_16x16x64_bf16 v[84:87], v[12:15], a[88:95], v131 abid:1
    s_and_b64 vcc, vcc, s[16:17]
    v_add_f32 v80, v80, v82
    v_smfmac_f32_16x16x64_bf16 v[84:87], v[16:19], a[96:103], v131 abid:1
    s_waitcnt lgkmcnt(0)
    s_barrier
    v_smfmac_f32_16x16x64_bf16 v[84:87], v[20:23], a[104:111], v131 abid:1
    ds_read_b128 v[32:35], v137 offset:0
    v_add_f32 v81, v81, v83
    v_smfmac_f32_16x16x64_bf16 v[84:87], v[24:27], a[112:119], v131 abid:1
    ds_read_b128 v[36:39], v137 offset:64
    v_mov_b64 v[58:59], 0
    v_smfmac_f32_16x16x64_bf16 v[84:87], v[28:31], a[120:127], v131 abid:1
    s_cbranch_scc1 L_tfast31_miss
    s_add_u32 s26, s28, s54
    v_smfmac_f32_16x16x64_bf16 v[64:67], v[4:7], a[136:143], v131 abid:1
    s_add_u32 s25, s25, 1
    s_add_u32 s27, s28, s55
    s_waitcnt lgkmcnt(1)
    v_mfma_f32_16x16x32_bf16 v[72:75], v[104:107], v[32:35], 0
    s_waitcnt lgkmcnt(0)
    v_add_f32 v84, v84, v86
    v_add_f32 v85, v85, v87
    v_mfma_f32_16x16x32_bf16 v[72:75], v[108:111], v[36:39], v[72:75]
    s_nop 0
    v_cvt_pk_bf16_f32 v84, v80, v84
    v_cvt_pk_bf16_f32 v85, v81, v85
    v_smfmac_f32_16x16x64_bf16 v[64:67], v[8:11], a[144:151], v131 abid:1
    ds_write2_b32 v141, v84, v85 offset0:64 offset1:200
    v_smfmac_f32_16x16x64_bf16 v[64:67], v[12:15], a[152:159], v131 abid:1
    s_nop 1
    v_cndmask_b32 v73, v73, v74, s[58:59]
    v_cndmask_b32 v72, v72, v75, s[58:59]
    v_smfmac_f32_16x16x64_bf16 v[64:67], v[16:19], a[160:167], v131 abid:1
    ds_read_b128 v[104:107], v138 offset:16384
    v_add_f32_dpp v72, v73, v72 quad_perm:[2,3,0,1] row_mask:0xf bank_mask:0xf
    v_mul_f32 v72, s56, v72
    v_smfmac_f32_16x16x64_bf16 v[64:67], v[20:23], a[168:175], v131 abid:1
    ds_read_b128 v[108:111], v138 offset:17408
    v_exp_f32 v73, v72
    v_smfmac_f32_16x16x64_bf16 v[64:67], v[24:27], a[176:183], v131 abid:1
    ds_write_b32 v133, v73 offset:12556
    v_smfmac_f32_16x16x64_bf16 v[64:67], v[28:31], a[184:191], v131 abid:1
    s_waitcnt lgkmcnt(3)
    s_barrier
    v_smfmac_f32_16x16x64_bf16 v[68:71], v[4:7], a[200:207], v131 abid:1
    ds_read_b128 v[40:43], v137 offset:256
    v_mov_b32 v63, 0
    v_smfmac_f32_16x16x64_bf16 v[68:71], v[8:11], a[208:215], v131 abid:1
    ds_read_b128 v[44:47], v137 offset:320
    v_mov_b32 v143, s25
    v_smfmac_f32_16x16x64_bf16 v[68:71], v[12:15], a[216:223], v131 abid:1
    ds_read_b128 v[0:3], v138 offset:18432
    v_add_f32 v64, v64, v66
    v_smfmac_f32_16x16x64_bf16 v[68:71], v[16:19], a[224:231], v131 abid:1
    s_waitcnt lgkmcnt(3)
    s_barrier
    s_waitcnt lgkmcnt(2)
    v_mfma_f32_16x16x32_bf16 v[124:127], v[40:43], v[32:35], 0
    ds_read_b128 v[80:83], v133 offset:12544
    s_waitcnt lgkmcnt(2)
    v_mfma_f32_16x16x32_bf16 v[124:127], v[44:47], v[36:39], v[124:127]
    s_nop 0
    v_add_f32 v65, v65, v67
    v_cvt_pk_bf16_f32 v130, v64, v65
    v_smfmac_f32_16x16x64_bf16 v[68:71], v[20:23], a[232:239], v131 abid:1
    ds_read_b128 v[4:7], v138 offset:19456
    ds_read_b128 v[8:11], v138 offset:20480
    v_smfmac_f32_16x16x64_bf16 v[68:71], v[24:27], a[240:247], v131 abid:1
    ds_read_b128 v[12:15], v138 offset:21504
    v_cndmask_b32 v125, v125, v126, s[58:59]
    v_cndmask_b32 v124, v124, v127, s[58:59]
    v_smfmac_f32_16x16x64_bf16 v[68:71], v[28:31], a[248:255], v131 abid:1
    s_waitcnt lgkmcnt(3)
    v_cvt_pk_bf16_f32 v60, v80, v81
    v_cvt_pk_bf16_f32 v61, v82, v83
    v_add_f32_dpp v124, v125, v124 quad_perm:[2,3,0,1] row_mask:0xf bank_mask:0xf
    v_mul_f32 v124, s56, v124
    v_smfmac_f32_16x16x32_bf16 v[52:55], v[60:61], v[112:115], v131 abid:2
    v_exp_f32 v125, v124
    v_smfmac_f32_16x16x32_bf16 v[56:59], v[60:61], v[116:119], v131 abid:2
    v_cvt_pk_bf16_f32 v62, v125, 0
    v_add_f32 v68, v68, v70
    v_add_f32 v69, v69, v71
    v_mfma_f32_16x16x32_bf16 v[48:51], v[60:63], v[120:123], 0
    ds_read_b128 v[32:35], v138 offset:22528
    v_cvt_pk_bf16_f32 v134, v68, v69
    v_smfmac_f32_16x16x32_bf16 v[52:55], v[62:63], v[130:133], v131
    s_nop 0
    ds_read_b128 v[36:39], v138 offset:23552
    ds_read_b128 v[40:43], v138 offset:24576
    v_smfmac_f32_16x16x32_bf16 v[56:59], v[62:63], v[134:137], v131
    s_nop 0
    v_add_f32 v48, v48, v50
    v_add_f32 v49, v49, v51
    v_rcp_f32 v50, v48
    v_rcp_f32 v51, v49
    v_pk_add_f32 v[52:53], v[52:53], v[54:55]
    v_pk_mul_f32 v[52:53], v[52:53], v[50:51]
    v_max3_f32 v126, v48, v49, v50
    v_pk_add_f32 v[56:57], v[56:57], v[58:59]
    v_pk_mul_f32 v[56:57], v[56:57], v[50:51]
    v_cvt_pk_bf16_f32 v52, v52, v56
    v_cvt_pk_bf16_f32 v53, v53, v57
    v_mfma_f32_16x16x16_bf16 v[80:83], v[128:129], v[128:129], 0
    ds_write2_b32 v141, v52, v53 offset0:0 offset1:136
    v_mfma_f32_16x16x16_bf16 v[84:87], v[128:129], v[128:129], 0
    v_max_f32 v126, v126, v51
    v_cmp_nge_f32 vcc, 0x4f800000, v126
    v_mfma_f32_16x16x16_bf16 v[76:79], v[128:129], v[128:129], 0
    ds_read_b128 v[48:51], v142 offset:192
    s_cbranch_vccnz L_tfast31_big
L_tfast31_back:
    v_mfma_f32_16x16x16_bf16 v[72:75], v[128:129], v[128:129], 0
    buffer_store_dword v143, v140, s[4:7], s47 offen
    s_waitcnt lgkmcnt(1)
    s_barrier
    ds_read_b128 v[52:55], v142 offset:128
    s_waitcnt lgkmcnt(1)
    v_smfmac_f32_16x16x64_bf16 v[80:83], v[48:51], v[104:111], v131 abid:1
    ds_read_b128 v[56:59], v142 offset:64
    v_smfmac_f32_16x16x64_bf16 v[84:87], v[48:51], v[0:7], v131 abid:1
    ds_read_b128 v[60:63], v142 offset:0
    v_smfmac_f32_16x16x64_bf16 v[76:79], v[48:51], v[8:15], v131 abid:1
    ds_read_b128 v[44:47], v138 offset:25600
    s_waitcnt lgkmcnt(3)
    v_smfmac_f32_16x16x64_bf16 v[80:83], v[52:55], v[144:151], v131 abid:1
    ds_read_b128 v[16:19], v138 offset:26624
    s_waitcnt lgkmcnt(3)
    v_smfmac_f32_16x16x64_bf16 v[80:83], v[56:59], v[152:159], v131 abid:1
    ds_read_b128 v[20:23], v138 offset:27648
    s_waitcnt lgkmcnt(3)
    v_smfmac_f32_16x16x64_bf16 v[80:83], v[60:63], v[160:167], v131 abid:1
    s_nop 1
    ds_read_b128 v[24:27], v138 offset:28672
    v_smfmac_f32_16x16x64_bf16 v[84:87], v[52:55], v[32:39], v131 abid:1
    ds_read_b128 v[28:31], v138 offset:29696
    s_waitcnt lgkmcnt(4)
    v_smfmac_f32_16x16x64_bf16 v[84:87], v[56:59], v[40:47], v131 abid:1
    ds_read_b128 v[64:67], v138 offset:30720
    v_cvt_pk_bf16_f32 v80, v80, v82
    v_cvt_pk_bf16_f32 v81, v81, v83
    v_or_b32 v80, 1, v80
    v_smfmac_f32_16x16x64_bf16 v[84:87], v[60:63], v[168:175], v131 abid:1
    buffer_store_dwordx2 v[80:81], v139, s[4:7], s30 offen
    ds_read_b128 v[68:71], v138 offset:31744
    s_waitcnt lgkmcnt(4)
    v_smfmac_f32_16x16x64_bf16 v[76:79], v[52:55], v[16:23], v131 abid:1
    ds_read_b128 v[0:3], v138 offset:32768
    s_waitcnt lgkmcnt(3)
    v_smfmac_f32_16x16x64_bf16 v[76:79], v[56:59], v[176:183], v131 abid:1
    ds_read_b128 v[4:7], v138 offset:33792
    v_cvt_pk_bf16_f32 v84, v84, v86
    v_cvt_pk_bf16_f32 v85, v85, v87
    v_or_b32 v84, 1, v84
    v_smfmac_f32_16x16x64_bf16 v[76:79], v[60:63], v[24:31], v131 abid:1
    buffer_store_dwordx2 v[84:85], v139, s[4:7], s31 offen
    ds_read_b128 v[8:11], v138 offset:34816
    s_nop 0
    v_smfmac_f32_16x16x64_bf16 v[72:75], v[48:51], v[184:191], v131 abid:1
    ds_read_b128 v[12:15], v138 offset:35840
    s_waitcnt lgkmcnt(4)
    v_smfmac_f32_16x16x64_bf16 v[72:75], v[52:55], v[64:71], v131 abid:1
    s_waitcnt lgkmcnt(2)
    v_cvt_pk_bf16_f32 v76, v76, v78
    v_cvt_pk_bf16_f32 v77, v77, v79
    v_or_b32 v76, 1, v76
    v_smfmac_f32_16x16x64_bf16 v[72:75], v[56:59], v[0:7], v131 abid:1
    buffer_store_dwordx2 v[76:77], v139, s[4:7], s32 offen
    s_waitcnt lgkmcnt(0)
    v_smfmac_f32_16x16x64_bf16 v[72:75], v[60:63], v[8:15], v131 abid:1
    s_nop 7
    v_cvt_pk_bf16_f32 v72, v72, v74
    v_cvt_pk_bf16_f32 v73, v73, v75
    v_or_b32 v72, 1, v72
    buffer_store_dwordx2 v[72:73], v139, s[4:7], s33 offen
    s_barrier
    v_mov_b64 v[64:65], 0
    v_mov_b64 v[66:67], 0
    v_mov_b64 v[68:69], 0
    v_mov_b64 v[70:71], 0
    v_mov_b64 v[72:73], 0
    v_mov_b64 v[74:75], 0
    v_mov_b64 v[76:77], 0
    v_mov_b64 v[78:79], 0
    v_mov_b64 v[80:81], 0
    v_mov_b64 v[82:83], 0
    v_mov_b64 v[84:85], 0
    v_mov_b64 v[86:87], 0
    ds_read_b128 v[32:35], v138 offset:0
    ds_read_b128 v[36:39], v138 offset:1024
    ds_read_b128 v[40:43], v138 offset:2048
    ds_read_b128 v[44:47], v138 offset:3072
    ds_read_b128 v[48:51], v138 offset:4096
    ds_read_b128 v[52:55], v138 offset:5120
    ds_read_b128 v[56:59], v138 offset:6144
    ds_read_b128 v[60:63], v138 offset:7168
    s_cmp_lt_u32 s25, 62
    s_cselect_b32 s57, 0x80000, 0
    s_add_u32 s34, s34, s57
    s_add_u32 s35, s35, s57
    s_add_u32 s36, s36, s57
    s_add_u32 s37, s37, s57
    s_mov_b32 s28, s29
    s_add_u32 s29, s29, 0x2000
    s_bitset0_b32 s29, 15
    s_mov_b64 s[16:17], -1
    s_barrier
    buffer_load_dwordx4 v[0:3], v133, s[4:7], s26 offen sc1
    s_barrier
    buffer_load_dwordx4 v133, s[4:7], s27 offen sc1 lds
    s_barrier
    buffer_load_dwordx4 v[104:107], v133, s[4:7], s34 offen sc1
    buffer_load_dwordx4 v[108:111], v133, s[4:7], s35 offen sc1
    buffer_load_dwordx4 v[112:115], v133, s[4:7], s36 offen sc1
    buffer_load_dwordx4 v[116:119], v133, s[4:7], s37 offen sc1
    s_branch L_tfast30_again
L_tfast30_miss:
    s_waitcnt lgkmcnt(0)
    v_max3_u32 v132, v0, v1, v2
    v_max3_u32 v130, v3, v4, v5
    v_max3_u32 v132, v132, v6, v7
    v_max_u32 v132, v132, v130
    v_cmpx_eq_u32 vcc, -1, v132
    s_cbranch_execz L_tfast30_whole
L_tfast30_reload:
    buffer_load_dwordx4 v[0:3], v133, s[4:7], s26 offen sc1
    buffer_load_dwordx4 v[4:7], v133, s[4:7], s27 offen sc1
    s_movk_i32 s3, 16
    s_sub_u32 s24, s24, 1
    s_cbranch_scc1 L_timeout
    v_max3_u32 v132, v0, v1, v2
    v_max3_u32 v130, v3, v4, v5
    v_max3_u32 v132, v132, v6, v7
    v_max_u32 v132, v132, v130
    v_cmpx_eq_u32 vcc, -1, v132
    s_cbranch_execnz L_tfast30_reload
L_tfast30_whole:
    s_mov_b64 exec, -1
    s_mov_b64 s[16:17], 0
    ds_read_b128 v[32:35], v138 offset:0
    ds_read_b128 v[36:39], v138 offset:1024
    ds_read_b128 v[40:43], v138 offset:2048
    ds_read_b128 v[44:47], v138 offset:3072
    ds_read_b128 v[48:51], v138 offset:4096
    ds_read_b128 v[52:55], v138 offset:5120
    ds_read_b128 v[56:59], v138 offset:6144
    ds_read_b128 v[60:63], v138 offset:7168
    v_mov_b64 v[64:65], 0
    v_mov_b64 v[66:67], 0
    v_mov_b64 v[68:69], 0
    v_mov_b64 v[70:71], 0
    v_mov_b64 v[72:73], 0
    v_mov_b64 v[74:75], 0
    v_mov_b64 v[76:77], 0
    v_mov_b64 v[78:79], 0
    v_mov_b64 v[80:81], 0
    v_mov_b64 v[82:83], 0
    v_mov_b64 v[84:85], 0
    v_mov_b64 v[86:87], 0
    s_waitcnt vmcnt(0)
    ds_write_b128 v133, v[4:7] offset:7168
    s_branch L_tfast30_again
L_tfast30_big:
    ds_write_b32 v133, v72 offset:13580
    s_waitcnt lgkmcnt(0)
    s_barrier
    ds_read_b128 v[60:63], v133 offset:13568
    s_waitcnt lgkmcnt(0)
    v_max3_f32 v126, v60, v61, v62
    v_max3_f32 v126, v126, v63, v124
    s_nop 1
    v_max_f32_dpp v126, v126, v126 quad_perm:[2,3,0,1] row_mask:0xf bank_mask:0xf
    v_mov_b32 v127, v126
    s_nop 1
    v_permlane16_swap_b32 v126, v127
    v_max_f32 v126, v126, v127
    v_mov_b32 v127, v126
    s_nop 1
    v_permlane32_swap_b32 v126, v127
    v_max_f32 v126, v126, v127
    v_sub_f32 v60, v60, v126
    v_exp_f32 v60, v60
    v_sub_f32 v61, v61, v126
    v_exp_f32 v61, v61
    v_sub_f32 v62, v62, v126
    v_exp_f32 v62, v62
    v_sub_f32 v63, v63, v126
    v_exp_f32 v63, v63
    v_sub_f32 v124, v124, v126
    v_exp_f32 v124, v124
    v_cvt_pk_bf16_f32 v60, v60, v61
    v_cvt_pk_bf16_f32 v61, v62, v63
    v_cvt_pk_bf16_f32 v62, v124, 0
    v_mov_b64 v[52:53], 0
    v_mov_b64 v[54:55], 0
    v_mov_b64 v[56:57], 0
    v_mov_b64 v[58:59], 0
    v_mov_b32 v63, 0
    s_nop 1
    v_mfma_f32_16x16x32_bf16 v[48:51], v[60:63], v[120:123], 0
    v_smfmac_f32_16x16x32_bf16 v[52:55], v[62:63], v[130:133], v131
    v_smfmac_f32_16x16x32_bf16 v[56:59], v[62:63], v[134:137], v131
    v_smfmac_f32_16x16x32_bf16 v[52:55], v[60:61], v[96:99], v131 abid:2
    v_smfmac_f32_16x16x32_bf16 v[56:59], v[60:61], v[100:103], v131 abid:2
    s_nop 3
    v_add_f32 v48, v48, v50
    v_add_f32 v49, v49, v51
    v_rcp_f32 v50, v48
    v_rcp_f32 v51, v49
    v_pk_add_f32 v[52:53], v[52:53], v[54:55]
    v_pk_mul_f32 v[52:53], v[52:53], v[50:51]
    v_max3_f32 v126, v48, v49, v50
    v_pk_add_f32 v[56:57], v[56:57], v[58:59]
    v_pk_mul_f32 v[56:57], v[56:57], v[50:51]
    v_cvt_pk_bf16_f32 v52, v52, v56
    v_cvt_pk_bf16_f32 v53, v53, v57
    ds_write2_b32 v141, v52, v53 offset0:0 offset1:136
    ds_read_b128 v[48:51], v142 offset:192
    v_mfma_f32_16x16x16_bf16 v[80:83], v[128:129], v[128:129], 0
    v_mfma_f32_16x16x16_bf16 v[84:87], v[128:129], v[128:129], 0
    v_mfma_f32_16x16x16_bf16 v[76:79], v[128:129], v[128:129], 0
    s_branch L_tfast30_back
L_tfast31_miss:
    s_waitcnt lgkmcnt(0)
    v_max3_u32 v132, v0, v1, v2
    v_max3_u32 v130, v3, v4, v5
    v_max3_u32 v132, v132, v6, v7
    v_max_u32 v132, v132, v130
    v_cmpx_eq_u32 vcc, -1, v132
    s_cbranch_execz L_tfast31_whole
L_tfast31_reload:
    buffer_load_dwordx4 v[0:3], v133, s[4:7], s26 offen sc1
    buffer_load_dwordx4 v[4:7], v133, s[4:7], s27 offen sc1
    s_movk_i32 s3, 16
    s_sub_u32 s24, s24, 1
    s_cbranch_scc1 L_timeout
    v_max3_u32 v132, v0, v1, v2
    v_max3_u32 v130, v3, v4, v5
    v_max3_u32 v132, v132, v6, v7
    v_max_u32 v132, v132, v130
    v_cmpx_eq_u32 vcc, -1, v132
    s_cbranch_execnz L_tfast31_reload
L_tfast31_whole:
    s_mov_b64 exec, -1
    s_mov_b64 s[16:17], 0
    ds_read_b128 v[32:35], v138 offset:0
    ds_read_b128 v[36:39], v138 offset:1024
    ds_read_b128 v[40:43], v138 offset:2048
    ds_read_b128 v[44:47], v138 offset:3072
    ds_read_b128 v[48:51], v138 offset:4096
    ds_read_b128 v[52:55], v138 offset:5120
    ds_read_b128 v[56:59], v138 offset:6144
    ds_read_b128 v[60:63], v138 offset:7168
    v_mov_b64 v[64:65], 0
    v_mov_b64 v[66:67], 0
    v_mov_b64 v[68:69], 0
    v_mov_b64 v[70:71], 0
    v_mov_b64 v[72:73], 0
    v_mov_b64 v[74:75], 0
    v_mov_b64 v[76:77], 0
    v_mov_b64 v[78:79], 0
    v_mov_b64 v[80:81], 0
    v_mov_b64 v[82:83], 0
    v_mov_b64 v[84:85], 0
    v_mov_b64 v[86:87], 0
    s_waitcnt vmcnt(0)
    ds_write_b128 v133, v[4:7] offset:7168
    s_branch L_tfast31_again
L_tfast31_big:
    ds_write_b32 v133, v72 offset:13580
    s_waitcnt lgkmcnt(0)
    s_barrier
    ds_read_b128 v[60:63], v133 offset:13568
    s_waitcnt lgkmcnt(0)
    v_max3_f32 v126, v60, v61, v62
    v_max3_f32 v126, v126, v63, v124
    s_nop 1
    v_max_f32_dpp v126, v126, v126 quad_perm:[2,3,0,1] row_mask:0xf bank_mask:0xf
    v_mov_b32 v127, v126
    s_nop 1
    v_permlane16_swap_b32 v126, v127
    v_max_f32 v126, v126, v127
    v_mov_b32 v127, v126
    s_nop 1
    v_permlane32_swap_b32 v126, v127
    v_max_f32 v126, v126, v127
    v_sub_f32 v60, v60, v126
    v_exp_f32 v60, v60
    v_sub_f32 v61, v61, v126
    v_exp_f32 v61, v61
    v_sub_f32 v62, v62, v126
    v_exp_f32 v62, v62
    v_sub_f32 v63, v63, v126
    v_exp_f32 v63, v63
    v_sub_f32 v124, v124, v126
    v_exp_f32 v124, v124
    v_cvt_pk_bf16_f32 v60, v60, v61
    v_cvt_pk_bf16_f32 v61, v62, v63
    v_cvt_pk_bf16_f32 v62, v124, 0
    v_mov_b64 v[52:53], 0
    v_mov_b64 v[54:55], 0
    v_mov_b64 v[56:57], 0
    v_mov_b64 v[58:59], 0
    v_mov_b32 v63, 0
    s_nop 1
    v_mfma_f32_16x16x32_bf16 v[48:51], v[60:63], v[120:123], 0
    v_smfmac_f32_16x16x32_bf16 v[52:55], v[62:63], v[130:133], v131
    v_smfmac_f32_16x16x32_bf16 v[56:59], v[62:63], v[134:137], v131
    v_smfmac_f32_16x16x32_bf16 v[52:55], v[60:61], v[112:115], v131 abid:2
    v_smfmac_f32_16x16x32_bf16 v[56:59], v[60:61], v[116:119], v131 abid:2
    s_nop 3
    v_add_f32 v48, v48, v50
    v_add_f32 v49, v49, v51
    v_rcp_f32 v50, v48
    v_rcp_f32 v51, v49
    v_pk_add_f32 v[52:53], v[52:53], v[54:55]
    v_pk_mul_f32 v[52:53], v[52:53], v[50:51]
    v_max3_f32 v126, v48, v49, v50
    v_pk_add_f32 v[56:57], v[56:57], v[58:59]
    v_pk_mul_f32 v[56:57], v[56:57], v[50:51]
    v_cvt_pk_bf16_f32 v52, v52, v56
    v_cvt_pk_bf16_f32 v53, v53, v57
    ds_write2_b32 v141, v52, v53 offset0:0 offset1:136
    ds_read_b128 v[48:51], v142 offset:192
    v_mfma_f32_16x16x16_bf16 v[80:83], v[128:129], v[128:129], 0
    v_mfma_f32_16x16x16_bf16 v[84:87], v[128:129], v[128:129], 0
    v_mfma_f32_16x16x16_bf16 v[76:79], v[128:129], v[128:129], 0
    s_branch L_tfast31_back
L_team_fast_end:
L_team_slow:
    s_cmp_eq_u32 s22, 1
    s_cbranch_scc1 L_tslow10_again
    s_cmp_eq_u32 s22, 2
    s_cbranch_scc1 L_tslow20_again
    s_cmp_eq_u32 s22, 3
    s_cbranch_scc1 L_tslow30_again
.p2align 6
L_tslow00_again:
    s_waitcnt vmcnt(6) lgkmcnt(0)
    v_smfmac_f32_16x16x64_bf16 v[72:75], v[0:3], v[32:39], v131 abid:1
    ds_write_b128 v133, v[0:3] offset:0
    v_smfmac_f32_16x16x64_bf16 v[76:79], v[0:3], v[40:47], v131 abid:1
    v_smfmac_f32_16x16x64_bf16 v[80:83], v[0:3], a[24:31], v131 abid:1
    v_smfmac_f32_16x16x64_bf16 v[84:87], v[0:3], a[64:71], v131 abid:1
    s_waitcnt vmcnt(5)
    ds_read_b128 v[4:7], v133 offset:1024
    v_smfmac_f32_16x16x64_bf16 v[64:67], v[0:3], a[128:135], v131 abid:1
    v_smfmac_f32_16x16x64_bf16 v[68:71], v[0:3], a[192:199], v131 abid:1
    s_waitcnt lgkmcnt(1)
    s_barrier
    s_waitcnt lgkmcnt(0)
    v_smfmac_f32_16x16x64_bf16 v[72:75], v[4:7], v[48:55], v131 abid:1
    ds_read_b128 v[8:11], v133 offset:2048
    v_smfmac_f32_16x16x64_bf16 v[76:79], v[4:7], v[56:63], v131 abid:1
    ds_read_b128 v[12:15], v133 offset:3072
    v_smfmac_f32_16x16x64_bf16 v[80:83], v[4:7], a[32:39], v131 abid:1
    ds_read_b128 v[16:19], v133 offset:4096
    v_smfmac_f32_16x16x64_bf16 v[84:87], v[4:7], a[72:79], v131 abid:1
    ds_read_b128 v[20:23], v133 offset:5120
    s_waitcnt lgkmcnt(3)
    v_smfmac_f32_16x16x64_bf16 v[72:75], v[8:11], v[192:199], v131 abid:1
    ds_read_b128 v[24:27], v133 offset:6144
    v_smfmac_f32_16x16x64_bf16 v[76:79], v[8:11], v[240:247], v131 abid:1
    ds_read_b128 v[28:31], v133 offset:7168
    s_waitcnt lgkmcnt(4)
    v_smfmac_f32_16x16x64_bf16 v[72:75], v[12:15], v[200:207], v131 abid:1
    ds_read_b128 v[32:35], v138 offset:8192
    v_smfmac_f32_16x16x64_bf16 v[76:79], v[12:15], v[248:255], v131 abid:1
    ds_read_b128 v[36:39], v138 offset:9216
    s_waitcnt lgkmcnt(5)
    v_smfmac_f32_16x16x64_bf16 v[72:75], v[16:19], v[208:215], v131 abid:1
    ds_read_b128 v[40:43], v138 offset:10240
    s_waitcnt lgkmcnt(5)
    v_smfmac_f32_16x16x64_bf16 v[72:75], v[20:23], v[216:223], v131 abid:1
    ds_read_b128 v[44:47], v138 offset:11264
    s_waitcnt lgkmcnt(5)
    v_smfmac_f32_16x16x64_bf16 v[72:75], v[24:27], v[224:231], v131 abid:1
    ds_read_b128 v[48:51], v138 offset:12288
    s_waitcnt lgkmcnt(5)
    v_smfmac_f32_16x16x64_bf16 v[72:75], v[28:31], v[232:239], v131 abid:1
    s_nop 1
    ds_read_b128 v[52:55], v138 offset:13312
    v_smfmac_f32_16x16x64_bf16 v[76:79], v[16:19], a[0:7], v131 abid:1
    s_nop 1
    ds_read_b128 v[56:59], v138 offset:14336
    v_smfmac_f32_16x16x64_bf16 v[76:79], v[20:23], a[8:15], v131 abid:1
    ds_read_b128 v[60:63], v138 offset:15360
    v_add_f32 v72, v72, v74
    v_smfmac_f32_16x16x64_bf16 v[76:79], v[24:27], a[16:23], v131 abid:1
    s_waitcnt lgkmcnt(3)
    v_add_f32 v73, v73, v75
    v_smfmac_f32_16x16x64_bf16 v[76:79], v[28:31], v[32:39], v131 abid:1
    s_nop 2
    v_smfmac_f32_16x16x64_bf16 v[80:83], v[8:11], a[40:47], v131 abid:1
    s_nop 1
    v_cmp_u_f32 vcc, v72, v73
    v_smfmac_f32_16x16x64_bf16 v[80:83], v[12:15], v[40:47], v131 abid:1
    v_add_f32 v76, v76, v78
    v_add_f32 v77, v77, v79
    v_smfmac_f32_16x16x64_bf16 v[80:83], v[16:19], a[48:55], v131 abid:1
    s_waitcnt lgkmcnt(1)
    v_cvt_pk_bf16_f32 v76, v72, v76
    v_cvt_pk_bf16_f32 v77, v73, v77
    v_smfmac_f32_16x16x64_bf16 v[80:83], v[20:23], v[48:55], v131 abid:1
    ds_write2_b32 v141, v76, v77 offset0:0 offset1:136
    v_smfmac_f32_16x16x64_bf16 v[80:83], v[24:27], a[56:63], v131 abid:1
    s_waitcnt lgkmcnt(1)
    v_mov_b64 v[52:53], 0
    v_smfmac_f32_16x16x64_bf16 v[80:83], v[28:31], v[56:63], v131 abid:1
    s_nop 1
    v_mov_b64 v[54:55], 0
    v_smfmac_f32_16x16x64_bf16 v[84:87], v[8:11], a[80:87], v131 abid:1
    s_nop 1
    v_mov_b64 v[56:57], 0
    v_smfmac_f32_16x16x64_bf16 v[84:87], v[12:15], a[88:95], v131 abid:1
    s_and_b64 vcc, vcc, s[16:17]
    v_add_f32 v80, v80, v82
    v_smfmac_f32_16x16x64_bf16 v[84:87], v[16:19], a[96:103], v131 abid:1
    s_waitcnt lgkmcnt(0)
    s_barrier
    v_smfmac_f32_16x16x64_bf16 v[84:87], v[20:23], a[104:111], v131 abid:1
    ds_read_b128 v[32:35], v137 offset:0
    v_add_f32 v81, v81, v83
    v_smfmac_f32_16x16x64_bf16 v[84:87], v[24:27], a[112:119], v131 abid:1
    ds_read_b128 v[36:39], v137 offset:64
    v_mov_b64 v[58:59], 0
    v_smfmac_f32_16x16x64_bf16 v[84:87], v[28:31], a[120:127], v131 abid:1
    s_cbranch_scc1 L_tslow00_miss
    s_add_u32 s26, s28, s54
    v_smfmac_f32_16x16x64_bf16 v[64:67], v[4:7], a[136:143], v131 abid:1
    s_add_u32 s25, s25, 1
    s_add_u32 s27, s28, s55
    s_waitcnt lgkmcnt(1)
    v_mfma_f32_16x16x32_bf16 v[72:75], v[88:91], v[32:35], 0
    s_waitcnt lgkmcnt(0)
    v_add_f32 v84, v84, v86
    v_add_f32 v85, v85, v87
    v_mfma_f32_16x16x32_bf16 v[72:75], v[92:95], v[36:39], v[72:75]
    s_nop 0
    v_cvt_pk_bf16_f32 v84, v80, v84
    v_cvt_pk_bf16_f32 v85, v81, v85
    v_smfmac_f32_16x16x64_bf16 v[64:67], v[8:11], a[144:151], v131 abid:1
    ds_write2_b32 v141, v84, v85 offset0:64 offset1:200
    v_smfmac_f32_16x16x64_bf16 v[64:67], v[12:15], a[152:159], v131 abid:1
    s_nop 1
    v_cndmask_b32 v73, v73, v74, s[58:59]
    v_cndmask_b32 v72, v72, v75, s[58:59]
    v_smfmac_f32_16x16x64_bf16 v[64:67], v[16:19], a[160:167], v131 abid:1
    ds_read_b128 v[88:91], v138 offset:16384
    v_add_f32_dpp v72, v73, v72 quad_perm:[2,3,0,1] row_mask:0xf bank_mask:0xf
    v_mul_f32 v72, s56, v72
    v_smfmac_f32_16x16x64_bf16 v[64:67], v[20:23], a[168:175], v131 abid:1
    ds_read_b128 v[92:95], v138 offset:17408
    v_exp_f32 v73, v72
    v_smfmac_f32_16x16x64_bf16 v[64:67], v[24:27], a[176:183], v131 abid:1
    ds_write_b32 v133, v73 offset:12544
    v_smfmac_f32_16x16x64_bf16 v[64:67], v[28:31], a[184:191], v131 abid:1
    s_waitcnt lgkmcnt(3)
    s_barrier
    v_smfmac_f32_16x16x64_bf16 v[68:71], v[4:7], a[200:207], v131 abid:1
    ds_read_b128 v[40:43], v137 offset:256
    v_mov_b32 v63, 0
    v_smfmac_f32_16x16x64_bf16 v[68:71], v[8:11], a[208:215], v131 abid:1
    ds_read_b128 v[44:47], v137 offset:320
    v_smfmac_f32_16x16x64_bf16 v[68:71], v[12:15], a[216:223], v131 abid:1
    ds_read_b128 v[0:3], v138 offset:18432
    v_add_f32 v64, v64, v66
    v_smfmac_f32_16x16x64_bf16 v[68:71], v[16:19], a[224:231], v131 abid:1
    s_waitcnt lgkmcnt(3)
    s_barrier
    s_waitcnt lgkmcnt(2)
    v_mfma_f32_16x16x32_bf16 v[124:127], v[40:43], v[32:35], 0
    ds_read_b128 v[80:83], v133 offset:12544
    s_waitcnt lgkmcnt(2)
    v_mfma_f32_16x16x32_bf16 v[124:127], v[44:47], v[36:39], v[124:127]
    s_nop 0
    v_add_f32 v65, v65, v67
    v_cvt_pk_bf16_f32 v130, v64, v65
    v_smfmac_f32_16x16x64_bf16 v[68:71], v[20:23], a[232:239], v131 abid:1
    ds_read_b128 v[4:7], v138 offset:19456
    ds_read_b128 v[8:11], v138 offset:20480
    v_smfmac_f32_16x16x64_bf16 v[68:71], v[24:27], a[240:247], v131 abid:1
    ds_read_b128 v[12:15], v138 offset:21504
    v_cndmask_b32 v125, v125, v126, s[58:59]
    v_cndmask_b32 v124, v124, v127, s[58:59]
    v_smfmac_f32_16x16x64_bf16 v[68:71], v[28:31], a[248:255], v131 abid:1
    s_waitcnt lgkmcnt(3)
    v_cvt_pk_bf16_f32 v60, v80, v81
    v_cvt_pk_bf16_f32 v61, v82, v83
    v_add_f32_dpp v124, v125, v124 quad_perm:[2,3,0,1] row_mask:0xf bank_mask:0xf
    v_mul_f32 v124, s56, v124
    v_smfmac_f32_16x16x32_bf16 v[52:55], v[60:61], v[96:99], v131 abid:2
    v_exp_f32 v125, v124
    v_smfmac_f32_16x16x32_bf16 v[56:59], v[60:61], v[100:103], v131 abid:2
    v_cvt_pk_bf16_f32 v62, v125, 0
    v_add_f32 v68, v68, v70
    v_add_f32 v69, v69, v71
    v_mfma_f32_16x16x32_bf16 v[48:51], v[60:63], v[120:123], 0
    ds_read_b128 v[32:35], v138 offset:22528
    v_cvt_pk_bf16_f32 v134, v68, v69
    v_smfmac_f32_16x16x32_bf16 v[52:55], v[62:63], v[130:133], v131
    s_nop 0
    ds_read_b128 v[36:39], v138 offset:23552
    ds_read_b128 v[40:43], v138 offset:24576
    v_smfmac_f32_16x16x32_bf16 v[56:59], v[62:63], v[134:137], v131
    s_nop 0
    v_add_f32 v48, v48, v50
    v_add_f32 v49, v49, v51
    v_rcp_f32 v50, v48
    v_rcp_f32 v51, v49
    v_pk_add_f32 v[52:53], v[52:53], v[54:55]
    v_pk_mul_f32 v[52:53], v[52:53], v[50:51]
    v_max3_f32 v126, v48, v49, v50
    v_pk_add_f32 v[56:57], v[56:57], v[58:59]
    v_pk_mul_f32 v[56:57], v[56:57], v[50:51]
    v_cvt_pk_bf16_f32 v52, v52, v56
    v_cvt_pk_bf16_f32 v53, v53, v57
    v_mfma_f32_16x16x16_bf16 v[80:83], v[128:129], v[128:129], 0
    ds_write2_b32 v141, v52, v53 offset0:0 offset1:136
    v_mfma_f32_16x16x16_bf16 v[84:87], v[128:129], v[128:129], 0
    v_max_f32 v126, v126, v51
    v_cmp_nge_f32 vcc, 0x4f800000, v126
    v_mfma_f32_16x16x16_bf16 v[76:79], v[128:129], v[128:129], 0
    ds_read_b128 v[48:51], v142 offset:0
    s_cbranch_vccnz L_tslow00_big
L_tslow00_back:
    v_mfma_f32_16x16x16_bf16 v[72:75], v[128:129], v[128:129], 0
    s_waitcnt lgkmcnt(1)
    s_barrier
    ds_read_b128 v[52:55], v142 offset:64
    s_waitcnt lgkmcnt(1)
    v_smfmac_f32_16x16x64_bf16 v[80:83], v[48:51], v[88:95], v131 abid:1
    ds_read_b128 v[56:59], v142 offset:128
    v_smfmac_f32_16x16x64_bf16 v[84:87], v[48:51], v[0:7], v131 abid:1
    ds_read_b128 v[60:63], v142 offset:192
    v_smfmac_f32_16x16x64_bf16 v[76:79], v[48:51], v[8:15], v131 abid:1
    ds_read_b128 v[44:47], v138 offset:25600
    s_waitcnt lgkmcnt(3)
    v_smfmac_f32_16x16x64_bf16 v[80:83], v[52:55], v[144:151], v131 abid:1
    ds_read_b128 v[16:19], v138 offset:26624
    s_waitcnt lgkmcnt(3)
    v_smfmac_f32_16x16x64_bf16 v[80:83], v[56:59], v[152:159], v131 abid:1
    ds_read_b128 v[20:23], v138 offset:27648
    s_waitcnt lgkmcnt(3)
    v_smfmac_f32_16x16x64_bf16 v[80:83], v[60:63], v[160:167], v131 abid:1
    s_nop 1
    ds_read_b128 v[24:27], v138 offset:28672
    v_smfmac_f32_16x16x64_bf16 v[84:87], v[52:55], v[32:39], v131 abid:1
    ds_read_b128 v[28:31], v138 offset:29696
    s_waitcnt lgkmcnt(4)
    v_smfmac_f32_16x16x64_bf16 v[84:87], v[56:59], v[40:47], v131 abid:1
    ds_read_b128 v[64:67], v138 offset:30720
    v_cvt_pk_bf16_f32 v80, v80, v82
    v_cvt_pk_bf16_f32 v81, v81, v83
    v_and_b32 v80, -2, v80
    v_smfmac_f32_16x16x64_bf16 v[84:87], v[60:63], v[168:175], v131 abid:1
    buffer_store_dwordx2 v[80:81], v139, s[4:7], s30 offen sc1
    ds_read_b128 v[68:71], v138 offset:31744
    s_waitcnt lgkmcnt(4)
    v_smfmac_f32_16x16x64_bf16 v[76:79], v[52:55], v[16:23], v131 abid:1
    buffer_load_dword v136, v135, s[4:7], s53 offen offset:0 sc1
    ds_read_b128 v[0:3], v138 offset:32768
    s_waitcnt lgkmcnt(3)
    v_smfmac_f32_16x16x64_bf16 v[76:79], v[56:59], v[176:183], v131 abid:1
    ds_read_b128 v[4:7], v138 offset:33792
    v_cvt_pk_bf16_f32 v84, v84, v86
    v_cvt_pk_bf16_f32 v85, v85, v87
    v_and_b32 v84, -2, v84
    v_smfmac_f32_16x16x64_bf16 v[76:79], v[60:63], v[24:31], v131 abid:1
    buffer_store_dwordx2 v[84:85], v139, s[4:7], s31 offen sc1
    ds_read_b128 v[8:11], v138 offset:34816
    s_nop 0
    v_smfmac_f32_16x16x64_bf16 v[72:75], v[48:51], v[184:191], v131 abid:1
    ds_read_b128 v[12:15], v138 offset:35840
    s_waitcnt lgkmcnt(4)
    v_smfmac_f32_16x16x64_bf16 v[72:75], v[52:55], v[64:71], v131 abid:1
    s_waitcnt lgkmcnt(2)
    v_cvt_pk_bf16_f32 v76, v76, v78
    v_cvt_pk_bf16_f32 v77, v77, v79
    v_and_b32 v76, -2, v76
    v_smfmac_f32_16x16x64_bf16 v[72:75], v[56:59], v[0:7], v131 abid:1
    buffer_store_dwordx2 v[76:77], v139, s[4:7], s32 offen sc1
    s_waitcnt lgkmcnt(0)
    v_smfmac_f32_16x16x64_bf16 v[72:75], v[60:63], v[8:15], v131 abid:1
    s_nop 7
    v_cvt_pk_bf16_f32 v72, v72, v74
    v_cvt_pk_bf16_f32 v73, v73, v75
    v_and_b32 v72, -2, v72
    buffer_store_dwordx2 v[72:73], v139, s[4:7], s33 offen sc1
    ds_read_b128 v[96:99], v133 offset:14592
    ds_read_b32 v100, v135 offset:15616
    ds_read_b128 v[32:35], v138 offset:0
    ds_read_b128 v[36:39], v138 offset:1024
    ds_read_b128 v[40:43], v138 offset:2048
    ds_read_b128 v[44:47], v138 offset:3072
    ds_read_b128 v[48:51], v138 offset:4096
    ds_read_b128 v[52:55], v138 offset:5120
    ds_read_b128 v[56:59], v138 offset:6144
    ds_read_b128 v[60:63], v138 offset:7168
    v_mov_b64 v[64:65], 0
    v_mov_b64 v[66:67], 0
    v_mov_b64 v[68:69], 0
    v_mov_b64 v[70:71], 0
    v_mov_b64 v[72:73], 0
    v_mov_b64 v[74:75], 0
    v_mov_b64 v[76:77], 0
    v_mov_b64 v[78:79], 0
    v_mov_b64 v[80:81], 0
    v_mov_b64 v[82:83], 0
    v_mov_b64 v[84:85], 0
    v_mov_b64 v[86:87], 0
    v_mov_b64 v[124:125], 0
    v_mov_b64 v[126:127], 0
    v_mov_b32 v134, s25
    s_lshl_b32 s50, s25, 13
    s_add_u32 s50, s50, 0x100000
    s_cmp_eq_u32 s25, 63
    s_cselect_b32 s61, s50, 0x4000000
    s_cmp_le_u32 s25, 2
    s_cbranch_scc1 L_tslow00_late
    s_waitcnt vmcnt(3)
    v_cmp_gt_u32 vcc, s25, v136
    s_cbranch_vccnz L_tslow00_late
L_tslow00_fetch:
    s_waitcnt vmcnt(3)
    buffer_load_dwordx4 v[0:3], v133, s[4:7], s38 offen offset:0 sc1
    buffer_load_dwordx4 v[4:7], v133, s[4:7], s38 offen offset:1024 sc1
    s_waitcnt vmcnt(4)
    buffer_load_dwordx4 v[8:11], v133, s[4:7], s39 offen offset:0 sc1
    buffer_load_dwordx4 v[12:15], v133, s[4:7], s39 offen offset:1024 sc1
    s_waitcnt vmcnt(5)
    buffer_load_dwordx4 v[16:19], v133, s[4:7], s40 offen offset:0 sc1
    buffer_load_dwordx4 v[20:23], v133, s[4:7], s40 offen offset:1024 sc1
    s_waitcnt vmcnt(6)
    buffer_load_dwordx4 v[24:27], v133, s[4:7], s41 offen offset:0 sc1
    buffer_load_dwordx4 v[28:31], v133, s[4:7], s41 offen offset:1024 sc1
    s_barrier
    s_mov_b64 exec, s[42:43]
    buffer_store_dword v134, v133, s[4:7], s47 offen offset:1024 sc1
    s_mov_b64 exec, -1
    s_waitcnt vmcnt(7) lgkmcnt(8)
    v_smfmac_f32_16x16x64_bf16 v[124:127], v[96:99], v[0:7], v100
    v_bitop3_b32 v130, -2, v0, v2 bitop3:0xfe
    v_bitop3_b32 v130, v130, v4, v6 bitop3:0xfe
    s_waitcnt vmcnt(5)
    v_smfmac_f32_16x16x64_bf16 v[124:127], v[96:99], v[8:15], v100
    v_bitop3_b32 v130, v130, v8, v10 bitop3:0xfe
    v_bitop3_b32 v130, v130, v12, v14 bitop3:0xfe
    s_waitcnt vmcnt(3)
    v_smfmac_f32_16x16x64_bf16 v[124:127], v[96:99], v[16:23], v100
    v_bitop3_b32 v130, v130, v16, v18 bitop3:0xfe
    v_bitop3_b32 v130, v130, v20, v22 bitop3:0xfe
    s_waitcnt vmcnt(2)
    v_bitop3_b32 v130, v130, v24, v26 bitop3:0xfe
    s_waitcnt vmcnt(1)
    v_bitop3_b32 v130, v130, v28, v30 bitop3:0xfe
    v_smfmac_f32_16x16x64_bf16 v[124:127], v[96:99], v[24:31], v100
    s_nop 1
    v_cmp_eq_u32 vcc, -1, v130
    s_nop 3
    s_cbranch_vccnz L_tslow00_retry
L_tslow00_good:
    v_cvt_pk_bf16_f32 v143, v124, v125
    buffer_store_dword v143, v140, s[4:7], s28 offen sc1
    buffer_store_dword v143, v140, s[4:7], s61 offen sc1
    s_cmp_eq_u32 s25, 63
    s_cbranch_scc1 L_exit
    s_cmp_lt_u32 s25, 62
    s_cselect_b32 s57, 0x80000, 0
    s_add_u32 s34, s34, s57
    s_add_u32 s35, s35, s57
    s_add_u32 s36, s36, s57
    s_add_u32 s37, s37, s57
    s_mov_b32 s28, s29
    s_add_u32 s29, s29, 0x2000
    s_bitset0_b32 s29, 15
    s_mov_b64 s[16:17], -1
    s_barrier
    buffer_load_dwordx4 v[0:3], v133, s[4:7], s26 offen sc1
    s_barrier
    buffer_load_dwordx4 v133, s[4:7], s27 offen sc1 lds
    s_barrier
    buffer_store_dword v143, v140, s[4:7], s50 offen sc1
    buffer_load_dwordx4 v[88:91], v133, s[4:7], s34 offen sc1
    buffer_load_dwordx4 v[92:95], v133, s[4:7], s35 offen sc1
    buffer_load_dwordx4 v[96:99], v133, s[4:7], s36 offen sc1
    buffer_load_dwordx4 v[100:103], v133, s[4:7], s37 offen sc1
L_tslow01_again:
    s_waitcnt vmcnt(6) lgkmcnt(0)
    v_smfmac_f32_16x16x64_bf16 v[72:75], v[0:3], v[32:39], v131 abid:1
    ds_write_b128 v133, v[0:3] offset:0
    v_smfmac_f32_16x16x64_bf16 v[76:79], v[0:3], v[40:47], v131 abid:1
    v_smfmac_f32_16x16x64_bf16 v[80:83], v[0:3], a[24:31], v131 abid:1
    v_smfmac_f32_16x16x64_bf16 v[84:87], v[0:3], a[64:71], v131 abid:1
    s_waitcnt vmcnt(5)
    ds_read_b128 v[4:7], v133 offset:1024
    v_smfmac_f32_16x16x64_bf16 v[64:67], v[0:3], a[128:135], v131 abid:1
    v_smfmac_f32_16x16x64_bf16 v[68:71], v[0:3], a[192:199], v131 abid:1
    s_waitcnt lgkmcnt(1)
    s_barrier
    s_waitcnt lgkmcnt(0)
    v_smfmac_f32_16x16x64_bf16 v[72:75], v[4:7], v[48:55], v131 abid:1
    ds_read_b128 v[8:11], v133 offset:2048
    v_smfmac_f32_16x16x64_bf16 v[76:79], v[4:7], v[56:63], v131 abid:1
    ds_read_b128 v[12:15], v133 offset:3072
    v_smfmac_f32_16x16x64_bf16 v[80:83], v[4:7], a[32:39], v131 abid:1
    ds_read_b128 v[16:19], v133 offset:4096
    v_smfmac_f32_16x16x64_bf16 v[84:87], v[4:7], a[72:79], v131 abid:1
    ds_read_b128 v[20:23], v133 offset:5120
    s_waitcnt lgkmcnt(3)
    v_smfmac_f32_16x16x64_bf16 v[72:75], v[8:11], v[192:199], v131 abid:1
    ds_read_b128 v[24:27], v133 offset:6144
    v_smfmac_f32_16x16x64_bf16 v[76:79], v[8:11], v[240:247], v131 abid:1
    ds_read_b128 v[28:31], v133 offset:7168
    s_waitcnt lgkmcnt(4)
    v_smfmac_f32_16x16x64_bf16 v[72:75], v[12:15], v[200:207], v131 abid:1
    ds_read_b128 v[32:35], v138 offset:8192
    v_smfmac_f32_16x16x64_bf16 v[76:79], v[12:15], v[248:255], v131 abid:1
    ds_read_b128 v[36:39], v138 offset:9216
    s_waitcnt lgkmcnt(5)
    v_smfmac_f32_16x16x64_bf16 v[72:75], v[16:19], v[208:215], v131 abid:1
    ds_read_b128 v[40:43], v138 offset:10240
    s_waitcnt lgkmcnt(5)
    v_smfmac_f32_16x16x64_bf16 v[72:75], v[20:23], v[216:223], v131 abid:1
    ds_read_b128 v[44:47], v138 offset:11264
    s_waitcnt lgkmcnt(5)
    v_smfmac_f32_16x16x64_bf16 v[72:75], v[24:27], v[224:231], v131 abid:1
    ds_read_b128 v[48:51], v138 offset:12288
    s_waitcnt lgkmcnt(5)
    v_smfmac_f32_16x16x64_bf16 v[72:75], v[28:31], v[232:239], v131 abid:1
    s_nop 1
    ds_read_b128 v[52:55], v138 offset:13312
    v_smfmac_f32_16x16x64_bf16 v[76:79], v[16:19], a[0:7], v131 abid:1
    s_nop 1
    ds_read_b128 v[56:59], v138 offset:14336
    v_smfmac_f32_16x16x64_bf16 v[76:79], v[20:23], a[8:15], v131 abid:1
    ds_read_b128 v[60:63], v138 offset:15360
    v_add_f32 v72, v72, v74
    v_smfmac_f32_16x16x64_bf16 v[76:79], v[24:27], a[16:23], v131 abid:1
    s_waitcnt lgkmcnt(3)
    v_add_f32 v73, v73, v75
    v_smfmac_f32_16x16x64_bf16 v[76:79], v[28:31], v[32:39], v131 abid:1
    s_nop 2
    v_smfmac_f32_16x16x64_bf16 v[80:83], v[8:11], a[40:47], v131 abid:1
    s_nop 1
    v_cmp_u_f32 vcc, v72, v73
    v_smfmac_f32_16x16x64_bf16 v[80:83], v[12:15], v[40:47], v131 abid:1
    v_add_f32 v76, v76, v78
    v_add_f32 v77, v77, v79
    v_smfmac_f32_16x16x64_bf16 v[80:83], v[16:19], a[48:55], v131 abid:1
    s_waitcnt lgkmcnt(1)
    v_cvt_pk_bf16_f32 v76, v72, v76
    v_cvt_pk_bf16_f32 v77, v73, v77
    v_smfmac_f32_16x16x64_bf16 v[80:83], v[20:23], v[48:55], v131 abid:1
    ds_write2_b32 v141, v76, v77 offset0:0 offset1:136
    v_smfmac_f32_16x16x64_bf16 v[80:83], v[24:27], a[56:63], v131 abid:1
    s_waitcnt lgkmcnt(1)
    v_mov_b64 v[52:53], 0
    v_smfmac_f32_16x16x64_bf16 v[80:83], v[28:31], v[56:63], v131 abid:1
    s_nop 1
    v_mov_b64 v[54:55], 0
    v_smfmac_f32_16x16x64_bf16 v[84:87], v[8:11], a[80:87], v131 abid:1
    s_nop 1
    v_mov_b64 v[56:57], 0
    v_smfmac_f32_16x16x64_bf16 v[84:87], v[12:15], a[88:95], v131 abid:1
    s_and_b64 vcc, vcc, s[16:17]
    v_add_f32 v80, v80, v82
    v_smfmac_f32_16x16x64_bf16 v[84:87], v[16:19], a[96:103], v131 abid:1
    s_waitcnt lgkmcnt(0)
    s_barrier
    v_smfmac_f32_16x16x64_bf16 v[84:87], v[20:23], a[104:111], v131 abid:1
    ds_read_b128 v[32:35], v137 offset:0
    v_add_f32 v81, v81, v83
    v_smfmac_f32_16x16x64_bf16 v[84:87], v[24:27], a[112:119], v131 abid:1
    ds_read_b128 v[36:39], v137 offset:64
    v_mov_b64 v[58:59], 0
    v_smfmac_f32_16x16x64_bf16 v[84:87], v[28:31], a[120:127], v131 abid:1
    s_cbranch_scc1 L_tslow01_miss
    s_add_u32 s26, s28, s54
    v_smfmac_f32_16x16x64_bf16 v[64:67], v[4:7], a[136:143], v131 abid:1
    s_add_u32 s25, s25, 1
    s_add_u32 s27, s28, s55
    s_waitcnt lgkmcnt(1)
    v_mfma_f32_16x16x32_bf16 v[72:75], v[104:107], v[32:35], 0
    s_waitcnt lgkmcnt(0)
    v_add_f32 v84, v84, v86
    v_add_f32 v85, v85, v87
    v_mfma_f32_16x16x32_bf16 v[72:75], v[108:111], v[36:39], v[72:75]
    s_nop 0
    v_cvt_pk_bf16_f32 v84, v80, v84
    v_cvt_pk_bf16_f32 v85, v81, v85
    v_smfmac_f32_16x16x64_bf16 v[64:67], v[8:11], a[144:151], v131 abid:1
    ds_write2_b32 v141, v84, v85 offset0:64 offset1:200
    v_smfmac_f32_16x16x64_bf16 v[64:67], v[12:15], a[152:159], v131 abid:1
    s_nop 1
    v_cndmask_b32 v73, v73, v74, s[58:59]
    v_cndmask_b32 v72, v72, v75, s[58:59]
    v_smfmac_f32_16x16x64_bf16 v[64:67], v[16:19], a[160:167], v131 abid:1
    ds_read_b128 v[104:107], v138 offset:16384
    v_add_f32_dpp v72, v73, v72 quad_perm:[2,3,0,1] row_mask:0xf bank_mask:0xf
    v_mul_f32 v72, s56, v72
    v_smfmac_f32_16x16x64_bf16 v[64:67], v[20:23], a[168:175], v131 abid:1
    ds_read_b128 v[108:111], v138 offset:17408
    v_exp_f32 v73, v72
    v_smfmac_f32_16x16x64_bf16 v[64:67], v[24:27], a[176:183], v131 abid:1
    ds_write_b32 v133, v73 offset:12544
    v_smfmac_f32_16x16x64_bf16 v[64:67], v[28:31], a[184:191], v131 abid:1
    s_waitcnt lgkmcnt(3)
    s_barrier
    v_smfmac_f32_16x16x64_bf16 v[68:71], v[4:7], a[200:207], v131 abid:1
    ds_read_b128 v[40:43], v137 offset:256
    v_mov_b32 v63, 0
    v_smfmac_f32_16x16x64_bf16 v[68:71], v[8:11], a[208:215], v131 abid:1
    ds_read_b128 v[44:47], v137 offset:320
    v_smfmac_f32_16x16x64_bf16 v[68:71], v[12:15], a[216:223], v131 abid:1
    ds_read_b128 v[0:3], v138 offset:18432
    v_add_f32 v64, v64, v66
    v_smfmac_f32_16x16x64_bf16 v[68:71], v[16:19], a[224:231], v131 abid:1
    s_waitcnt lgkmcnt(3)
    s_barrier
    s_waitcnt lgkmcnt(2)
    v_mfma_f32_16x16x32_bf16 v[124:127], v[40:43], v[32:35], 0
    ds_read_b128 v[80:83], v133 offset:12544
    s_waitcnt lgkmcnt(2)
    v_mfma_f32_16x16x32_bf16 v[124:127], v[44:47], v[36:39], v[124:127]
    s_nop 0
    v_add_f32 v65, v65, v67
    v_cvt_pk_bf16_f32 v130, v64, v65
    v_smfmac_f32_16x16x64_bf16 v[68:71], v[20:23], a[232:239], v131 abid:1
    ds_read_b128 v[4:7], v138 offset:19456
    ds_read_b128 v[8:11], v138 offset:20480
    v_smfmac_f32_16x16x64_bf16 v[68:71], v[24:27], a[240:247], v131 abid:1
    ds_read_b128 v[12:15], v138 offset:21504
    v_cndmask_b32 v125, v125, v126, s[58:59]
    v_cndmask_b32 v124, v124, v127, s[58:59]
    v_smfmac_f32_16x16x64_bf16 v[68:71], v[28:31], a[248:255], v131 abid:1
    s_waitcnt lgkmcnt(3)
    v_cvt_pk_bf16_f32 v60, v80, v81
    v_cvt_pk_bf16_f32 v61, v82, v83
    v_add_f32_dpp v124, v125, v124 quad_perm:[2,3,0,1] row_mask:0xf bank_mask:0xf
    v_mul_f32 v124, s56, v124
    v_smfmac_f32_16x16x32_bf16 v[52:55], v[60:61], v[112:115], v131 abid:2
    v_exp_f32 v125, v124
    v_smfmac_f32_16x16x32_bf16 v[56:59], v[60:61], v[116:119], v131 abid:2
    v_cvt_pk_bf16_f32 v62, v125, 0
    v_add_f32 v68, v68, v70
    v_add_f32 v69, v69, v71
    v_mfma_f32_16x16x32_bf16 v[48:51], v[60:63], v[120:123], 0
    ds_read_b128 v[32:35], v138 offset:22528
    v_cvt_pk_bf16_f32 v134, v68, v69
    v_smfmac_f32_16x16x32_bf16 v[52:55], v[62:63], v[130:133], v131
    s_nop 0
    ds_read_b128 v[36:39], v138 offset:23552
    ds_read_b128 v[40:43], v138 offset:24576
    v_smfmac_f32_16x16x32_bf16 v[56:59], v[62:63], v[134:137], v131
    s_nop 0
    v_add_f32 v48, v48, v50
    v_add_f32 v49, v49, v51
    v_rcp_f32 v50, v48
    v_rcp_f32 v51, v49
    v_pk_add_f32 v[52:53], v[52:53], v[54:55]
    v_pk_mul_f32 v[52:53], v[52:53], v[50:51]
    v_max3_f32 v126, v48, v49, v50
    v_pk_add_f32 v[56:57], v[56:57], v[58:59]
    v_pk_mul_f32 v[56:57], v[56:57], v[50:51]
    v_cvt_pk_bf16_f32 v52, v52, v56
    v_cvt_pk_bf16_f32 v53, v53, v57
    v_mfma_f32_16x16x16_bf16 v[80:83], v[128:129], v[128:129], 0
    ds_write2_b32 v141, v52, v53 offset0:0 offset1:136
    v_mfma_f32_16x16x16_bf16 v[84:87], v[128:129], v[128:129], 0
    v_max_f32 v126, v126, v51
    v_cmp_nge_f32 vcc, 0x4f800000, v126
    v_mfma_f32_16x16x16_bf16 v[76:79], v[128:129], v[128:129], 0
    ds_read_b128 v[48:51], v142 offset:0
    s_cbranch_vccnz L_tslow01_big
L_tslow01_back:
    v_mfma_f32_16x16x16_bf16 v[72:75], v[128:129], v[128:129], 0
    s_waitcnt lgkmcnt(1)
    s_barrier
    ds_read_b128 v[52:55], v142 offset:64
    s_waitcnt lgkmcnt(1)
    v_smfmac_f32_16x16x64_bf16 v[80:83], v[48:51], v[104:111], v131 abid:1
    ds_read_b128 v[56:59], v142 offset:128
    v_smfmac_f32_16x16x64_bf16 v[84:87], v[48:51], v[0:7], v131 abid:1
    ds_read_b128 v[60:63], v142 offset:192
    v_smfmac_f32_16x16x64_bf16 v[76:79], v[48:51], v[8:15], v131 abid:1
    ds_read_b128 v[44:47], v138 offset:25600
    s_waitcnt lgkmcnt(3)
    v_smfmac_f32_16x16x64_bf16 v[80:83], v[52:55], v[144:151], v131 abid:1
    ds_read_b128 v[16:19], v138 offset:26624
    s_waitcnt lgkmcnt(3)
    v_smfmac_f32_16x16x64_bf16 v[80:83], v[56:59], v[152:159], v131 abid:1
    ds_read_b128 v[20:23], v138 offset:27648
    s_waitcnt lgkmcnt(3)
    v_smfmac_f32_16x16x64_bf16 v[80:83], v[60:63], v[160:167], v131 abid:1
    s_nop 1
    ds_read_b128 v[24:27], v138 offset:28672
    v_smfmac_f32_16x16x64_bf16 v[84:87], v[52:55], v[32:39], v131 abid:1
    ds_read_b128 v[28:31], v138 offset:29696
    s_waitcnt lgkmcnt(4)
    v_smfmac_f32_16x16x64_bf16 v[84:87], v[56:59], v[40:47], v131 abid:1
    ds_read_b128 v[64:67], v138 offset:30720
    v_cvt_pk_bf16_f32 v80, v80, v82
    v_cvt_pk_bf16_f32 v81, v81, v83
    v_or_b32 v80, 1, v80
    v_smfmac_f32_16x16x64_bf16 v[84:87], v[60:63], v[168:175], v131 abid:1
    buffer_store_dwordx2 v[80:81], v139, s[4:7], s30 offen sc1
    ds_read_b128 v[68:71], v138 offset:31744
    s_waitcnt lgkmcnt(4)
    v_smfmac_f32_16x16x64_bf16 v[76:79], v[52:55], v[16:23], v131 abid:1
    buffer_load_dword v136, v135, s[4:7], s53 offen offset:0 sc1
    ds_read_b128 v[0:3], v138 offset:32768
    s_waitcnt lgkmcnt(3)
    v_smfmac_f32_16x16x64_bf16 v[76:79], v[56:59], v[176:183], v131 abid:1
    ds_read_b128 v[4:7], v138 offset:33792
    v_cvt_pk_bf16_f32 v84, v84, v86
    v_cvt_pk_bf16_f32 v85, v85, v87
    v_or_b32 v84, 1, v84
    v_smfmac_f32_16x16x64_bf16 v[76:79], v[60:63], v[24:31], v131 abid:1
    buffer_store_dwordx2 v[84:85], v139, s[4:7], s31 offen sc1
    ds_read_b128 v[8:11], v138 offset:34816
    s_nop 0
    v_smfmac_f32_16x16x64_bf16 v[72:75], v[48:51], v[184:191], v131 abid:1
    ds_read_b128 v[12:15], v138 offset:35840
    s_waitcnt lgkmcnt(4)
    v_smfmac_f32_16x16x64_bf16 v[72:75], v[52:55], v[64:71], v131 abid:1
    s_waitcnt lgkmcnt(2)
    v_cvt_pk_bf16_f32 v76, v76, v78
    v_cvt_pk_bf16_f32 v77, v77, v79
    v_or_b32 v76, 1, v76
    v_smfmac_f32_16x16x64_bf16 v[72:75], v[56:59], v[0:7], v131 abid:1
    buffer_store_dwordx2 v[76:77], v139, s[4:7], s32 offen sc1
    s_waitcnt lgkmcnt(0)
    v_smfmac_f32_16x16x64_bf16 v[72:75], v[60:63], v[8:15], v131 abid:1
    s_nop 7
    v_cvt_pk_bf16_f32 v72, v72, v74
    v_cvt_pk_bf16_f32 v73, v73, v75
    v_or_b32 v72, 1, v72
    buffer_store_dwordx2 v[72:73], v139, s[4:7], s33 offen sc1
    ds_read_b128 v[112:115], v133 offset:14592
    ds_read_b32 v116, v135 offset:15616
    ds_read_b128 v[32:35], v138 offset:0
    ds_read_b128 v[36:39], v138 offset:1024
    ds_read_b128 v[40:43], v138 offset:2048
    ds_read_b128 v[44:47], v138 offset:3072
    ds_read_b128 v[48:51], v138 offset:4096
    ds_read_b128 v[52:55], v138 offset:5120
    ds_read_b128 v[56:59], v138 offset:6144
    ds_read_b128 v[60:63], v138 offset:7168
    v_mov_b64 v[64:65], 0
    v_mov_b64 v[66:67], 0
    v_mov_b64 v[68:69], 0
    v_mov_b64 v[70:71], 0
    v_mov_b64 v[72:73], 0
    v_mov_b64 v[74:75], 0
    v_mov_b64 v[76:77], 0
    v_mov_b64 v[78:79], 0
    v_mov_b64 v[80:81], 0
    v_mov_b64 v[82:83], 0
    v_mov_b64 v[84:85], 0
    v_mov_b64 v[86:87], 0
    v_mov_b64 v[124:125], 0
    v_mov_b64 v[126:127], 0
    v_mov_b32 v134, s25
    s_lshl_b32 s50, s25, 13
    s_add_u32 s50, s50, 0x100000
    s_cmp_le_u32 s25, 2
    s_cbranch_scc1 L_tslow01_late
    s_waitcnt vmcnt(3)
    v_cmp_gt_u32 vcc, s25, v136
    s_cbranch_vccnz L_tslow01_late
L_tslow01_fetch:
    s_waitcnt vmcnt(3)
    buffer_load_dwordx4 v[0:3], v133, s[4:7], s38 offen offset:0 sc1
    buffer_load_dwordx4 v[4:7], v133, s[4:7], s38 offen offset:1024 sc1
    s_waitcnt vmcnt(4)
    buffer_load_dwordx4 v[8:11], v133, s[4:7], s39 offen offset:0 sc1
    buffer_load_dwordx4 v[12:15], v133, s[4:7], s39 offen offset:1024 sc1
    s_waitcnt vmcnt(5)
    buffer_load_dwordx4 v[16:19], v133, s[4:7], s40 offen offset:0 sc1
    buffer_load_dwordx4 v[20:23], v133, s[4:7], s40 offen offset:1024 sc1
    s_waitcnt vmcnt(6)
    buffer_load_dwordx4 v[24:27], v133, s[4:7], s41 offen offset:0 sc1
    buffer_load_dwordx4 v[28:31], v133, s[4:7], s41 offen offset:1024 sc1
    s_barrier
    s_mov_b64 exec, s[42:43]
    buffer_store_dword v134, v133, s[4:7], s47 offen offset:1024 sc1
    s_mov_b64 exec, -1
    s_waitcnt vmcnt(7) lgkmcnt(8)
    v_smfmac_f32_16x16x64_bf16 v[124:127], v[112:115], v[0:7], v116
    v_bitop3_b32 v130, 1, v0, v2 bitop3:0x80
    v_bitop3_b32 v130, v130, v4, v6 bitop3:0x80
    s_waitcnt vmcnt(5)
    v_smfmac_f32_16x16x64_bf16 v[124:127], v[112:115], v[8:15], v116
    v_bitop3_b32 v130, v130, v8, v10 bitop3:0x80
    v_bitop3_b32 v130, v130, v12, v14 bitop3:0x80
    s_waitcnt vmcnt(3)
    v_smfmac_f32_16x16x64_bf16 v[124:127], v[112:115], v[16:23], v116
    v_bitop3_b32 v130, v130, v16, v18 bitop3:0x80
    v_bitop3_b32 v130, v130, v20, v22 bitop3:0x80
    s_waitcnt vmcnt(2)
    v_bitop3_b32 v130, v130, v24, v26 bitop3:0x80
    s_waitcnt vmcnt(1)
    v_bitop3_b32 v130, v130, v28, v30 bitop3:0x80
    v_smfmac_f32_16x16x64_bf16 v[124:127], v[112:115], v[24:31], v116
    s_nop 1
    v_cmp_eq_u32 vcc, 0, v130
    s_nop 3
    s_cbranch_vccnz L_tslow01_retry
L_tslow01_good:
    v_cvt_pk_bf16_f32 v143, v124, v125
    buffer_store_dword v143, v140, s[4:7], s28 offen sc1
    s_cmp_lt_u32 s25, 62
    s_cselect_b32 s57, 0x80000, 0
    s_add_u32 s34, s34, s57
    s_add_u32 s35, s35, s57
    s_add_u32 s36, s36, s57
    s_add_u32 s37, s37, s57
    s_mov_b32 s28, s29
    s_add_u32 s29, s29, 0x2000
    s_bitset0_b32 s29, 15
    s_mov_b64 s[16:17], -1
    s_barrier
    buffer_load_dwordx4 v[0:3], v133, s[4:7], s26 offen sc1
    s_barrier
    buffer_load_dwordx4 v133, s[4:7], s27 offen sc1 lds
    s_barrier
    buffer_store_dword v143, v140, s[4:7], s50 offen sc1
    buffer_load_dwordx4 v[104:107], v133, s[4:7], s34 offen sc1
    buffer_load_dwordx4 v[108:111], v133, s[4:7], s35 offen sc1
    buffer_load_dwordx4 v[112:115], v133, s[4:7], s36 offen sc1
    buffer_load_dwordx4 v[116:119], v133, s[4:7], s37 offen sc1
    s_branch L_tslow00_again
L_tslow00_late:
L_spin_19:
    v_cmp_gt_u32 vcc, s25, v136
    buffer_load_dword v136, v135, s[4:7], s53 offen offset:0 sc1
    s_cbranch_vccz L_spun_20
    v_cmp_gt_u32 vcc, s25, v136
    buffer_load_dword v136, v135, s[4:7], s53 offen offset:0 sc1
    s_cbranch_vccz L_spun_20
    v_cmp_gt_u32 vcc, s25, v136
    buffer_load_dword v136, v135, s[4:7], s53 offen offset:0 sc1
    s_cbranch_vccz L_spun_20
    v_cmp_gt_u32 vcc, s25, v136
    buffer_load_dword v136, v135, s[4:7], s53 offen offset:0 sc1
    s_cbranch_vccz L_spun_20
    s_movk_i32 s3, 19
    s_sub_u32 s24, s24, 1
    s_cbranch_scc1 L_timeout
    s_branch L_spin_19
L_spun_20:
    buffer_load_dword v136, v135, s[4:7], s53 offen offset:0 sc1
    s_waitcnt vmcnt(0)
    s_cmp_gt_u32 s25, 2
    s_cbranch_scc1 L_tslow00_fetch
    s_waitcnt lgkmcnt(0)
    s_barrier
L_tslow00_careful:
    buffer_load_dwordx4 v[0:3], v133, s[4:7], s38 offen offset:0 sc1
    buffer_load_dwordx4 v[4:7], v133, s[4:7], s38 offen offset:1024 sc1
    buffer_load_dwordx4 v[8:11], v133, s[4:7], s39 offen offset:0 sc1
    buffer_load_dwordx4 v[12:15], v133, s[4:7], s39 offen offset:1024 sc1
    buffer_load_dwordx4 v[16:19], v133, s[4:7], s40 offen offset:0 sc1
    buffer_load_dwordx4 v[20:23], v133, s[4:7], s40 offen offset:1024 sc1
    buffer_load_dwordx4 v[24:27], v133, s[4:7], s41 offen offset:0 sc1
    buffer_load_dwordx4 v[28:31], v133, s[4:7], s41 offen offset:1024 sc1
    s_movk_i32 s3, 21
    s_sub_u32 s24, s24, 1
    s_cbranch_scc1 L_timeout
    v_mov_b64 v[124:125], 0
    v_mov_b64 v[126:127], 0
    s_waitcnt vmcnt(6)
    s_nop 0
    v_smfmac_f32_16x16x64_bf16 v[124:127], v[96:99], v[0:7], v100
    v_bitop3_b32 v130, -2, v0, v2 bitop3:0xfe
    v_bitop3_b32 v130, v130, v4, v6 bitop3:0xfe
    s_waitcnt vmcnt(4)
    v_smfmac_f32_16x16x64_bf16 v[124:127], v[96:99], v[8:15], v100
    v_bitop3_b32 v130, v130, v8, v10 bitop3:0xfe
    v_bitop3_b32 v130, v130, v12, v14 bitop3:0xfe
    s_waitcnt vmcnt(2)
    v_smfmac_f32_16x16x64_bf16 v[124:127], v[96:99], v[16:23], v100
    v_bitop3_b32 v130, v130, v16, v18 bitop3:0xfe
    v_bitop3_b32 v130, v130, v20, v22 bitop3:0xfe
    s_waitcnt vmcnt(1)
    v_bitop3_b32 v130, v130, v24, v26 bitop3:0xfe
    s_waitcnt vmcnt(0)
    v_bitop3_b32 v130, v130, v28, v30 bitop3:0xfe
    v_smfmac_f32_16x16x64_bf16 v[124:127], v[96:99], v[24:31], v100
    s_nop 1
    v_cmp_eq_u32 vcc, -1, v130
    s_cbranch_vccnz L_tslow00_careful
    s_mov_b64 exec, s[42:43]
    buffer_store_dword v134, v133, s[4:7], s47 offen offset:1024 sc1
    s_mov_b64 exec, -1
    s_nop 0
    s_branch L_tslow00_good
L_tslow00_retry:
    s_mov_b64 exec, s[42:43]
    buffer_store_dword v129, v133, s[4:7], s47 offen offset:1024 sc1
    s_mov_b64 exec, -1
L_tslow00_retry1:
    buffer_load_dwordx4 v[0:3], v133, s[4:7], s38 offen offset:0 sc1
    buffer_load_dwordx4 v[4:7], v133, s[4:7], s38 offen offset:1024 sc1
    buffer_load_dwordx4 v[8:11], v133, s[4:7], s39 offen offset:0 sc1
    buffer_load_dwordx4 v[12:15], v133, s[4:7], s39 offen offset:1024 sc1
    buffer_load_dwordx4 v[16:19], v133, s[4:7], s40 offen offset:0 sc1
    buffer_load_dwordx4 v[20:23], v133, s[4:7], s40 offen offset:1024 sc1
    buffer_load_dwordx4 v[24:27], v133, s[4:7], s41 offen offset:0 sc1
    buffer_load_dwordx4 v[28:31], v133, s[4:7], s41 offen offset:1024 sc1
    s_movk_i32 s3, 17
    s_sub_u32 s24, s24, 1
    s_cbranch_scc1 L_timeout
    v_mov_b64 v[124:125], 0
    v_mov_b64 v[126:127], 0
    s_waitcnt vmcnt(6)
    s_nop 0
    v_smfmac_f32_16x16x64_bf16 v[124:127], v[96:99], v[0:7], v100
    v_bitop3_b32 v130, -2, v0, v2 bitop3:0xfe
    v_bitop3_b32 v130, v130, v4, v6 bitop3:0xfe
    s_waitcnt vmcnt(4)
    v_smfmac_f32_16x16x64_bf16 v[124:127], v[96:99], v[8:15], v100
    v_bitop3_b32 v130, v130, v8, v10 bitop3:0xfe
    v_bitop3_b32 v130, v130, v12, v14 bitop3:0xfe
    s_waitcnt vmcnt(2)
    v_smfmac_f32_16x16x64_bf16 v[124:127], v[96:99], v[16:23], v100
    v_bitop3_b32 v130, v130, v16, v18 bitop3:0xfe
    v_bitop3_b32 v130, v130, v20, v22 bitop3:0xfe
    s_waitcnt vmcnt(1)
    v_bitop3_b32 v130, v130, v24, v26 bitop3:0xfe
    s_waitcnt vmcnt(0)
    v_bitop3_b32 v130, v130, v28, v30 bitop3:0xfe
    v_smfmac_f32_16x16x64_bf16 v[124:127], v[96:99], v[24:31], v100
    s_nop 1
    v_cmp_eq_u32 vcc, -1, v130
    s_cbranch_vccnz L_tslow00_retry1
    s_mov_b64 exec, s[42:43]
    buffer_store_dword v134, v133, s[4:7], s47 offen offset:1024 sc1
    s_mov_b64 exec, -1
    s_nop 0
    s_branch L_tslow00_good
L_tslow00_miss:
    s_waitcnt lgkmcnt(0)
    v_max3_u32 v132, v0, v1, v2
    v_max3_u32 v130, v3, v4, v5
    v_max3_u32 v132, v132, v6, v7
    v_max_u32 v132, v132, v130
    v_cmpx_eq_u32 vcc, -1, v132
    s_cbranch_execz L_tslow00_whole
L_tslow00_reload:
    buffer_load_dwordx4 v[0:3], v133, s[4:7], s26 offen sc1
    buffer_load_dwordx4 v[4:7], v133, s[4:7], s27 offen sc1
    s_movk_i32 s3, 16
    s_sub_u32 s24, s24, 1
    s_cbranch_scc1 L_timeout
    v_max3_u32 v132, v0, v1, v2
    v_max3_u32 v130, v3, v4, v5
    v_max3_u32 v132, v132, v6, v7
    v_max_u32 v132, v132, v130
    v_cmpx_eq_u32 vcc, -1, v132
    s_cbranch_execnz L_tslow00_reload
L_tslow00_whole:
    s_mov_b64 exec, -1
    s_mov_b64 s[16:17], 0
    ds_read_b128 v[32:35], v138 offset:0
    ds_read_b128 v[36:39], v138 offset:1024
    ds_read_b128 v[40:43], v138 offset:2048
    ds_read_b128 v[44:47], v138 offset:3072
    ds_read_b128 v[48:51], v138 offset:4096
    ds_read_b128 v[52:55], v138 offset:5120
    ds_read_b128 v[56:59], v138 offset:6144
    ds_read_b128 v[60:63], v138 offset:7168
    v_mov_b64 v[64:65], 0
    v_mov_b64 v[66:67], 0
    v_mov_b64 v[68:69], 0
    v_mov_b64 v[70:71], 0
    v_mov_b64 v[72:73], 0
    v_mov_b64 v[74:75], 0
    v_mov_b64 v[76:77], 0
    v_mov_b64 v[78:79], 0
    v_mov_b64 v[80:81], 0
    v_mov_b64 v[82:83], 0
    v_mov_b64 v[84:85], 0
    v_mov_b64 v[86:87], 0
    s_waitcnt vmcnt(0)
    ds_write_b128 v133, v[4:7] offset:1024
    s_branch L_tslow00_again
L_tslow00_big:
    ds_write_b32 v133, v72 offset:13568
    s_waitcnt lgkmcnt(0)
    s_barrier
    ds_read_b128 v[60:63], v133 offset:13568
    s_waitcnt lgkmcnt(0)
    v_max3_f32 v126, v60, v61, v62
    v_max3_f32 v126, v126, v63, v124
    s_nop 1
    v_max_f32_dpp v126, v126, v126 quad_perm:[2,3,0,1] row_mask:0xf bank_mask:0xf
    v_mov_b32 v127, v126
    s_nop 1
    v_permlane16_swap_b32 v126, v127
    v_max_f32 v126, v126, v127
    v_mov_b32 v127, v126
    s_nop 1
    v_permlane32_swap_b32 v126, v127
    v_max_f32 v126, v126, v127
    v_sub_f32 v60, v60, v126
    v_exp_f32 v60, v60
    v_sub_f32 v61, v61, v126
    v_exp_f32 v61, v61
    v_sub_f32 v62, v62, v126
    v_exp_f32 v62, v62
    v_sub_f32 v63, v63, v126
    v_exp_f32 v63, v63
    v_sub_f32 v124, v124, v126
    v_exp_f32 v124, v124
    v_cvt_pk_bf16_f32 v60, v60, v61
    v_cvt_pk_bf16_f32 v61, v62, v63
    v_cvt_pk_bf16_f32 v62, v124, 0
    v_mov_b64 v[52:53], 0
    v_mov_b64 v[54:55], 0
    v_mov_b64 v[56:57], 0
    v_mov_b64 v[58:59], 0
    v_mov_b32 v63, 0
    s_nop 1
    v_mfma_f32_16x16x32_bf16 v[48:51], v[60:63], v[120:123], 0
    v_smfmac_f32_16x16x32_bf16 v[52:55], v[62:63], v[130:133], v131
    v_smfmac_f32_16x16x32_bf16 v[56:59], v[62:63], v[134:137], v131
    v_smfmac_f32_16x16x32_bf16 v[52:55], v[60:61], v[96:99], v131 abid:2
    v_smfmac_f32_16x16x32_bf16 v[56:59], v[60:61], v[100:103], v131 abid:2
    s_nop 3
    v_add_f32 v48, v48, v50
    v_add_f32 v49, v49, v51
    v_rcp_f32 v50, v48
    v_rcp_f32 v51, v49
    v_pk_add_f32 v[52:53], v[52:53], v[54:55]
    v_pk_mul_f32 v[52:53], v[52:53], v[50:51]
    v_max3_f32 v126, v48, v49, v50
    v_pk_add_f32 v[56:57], v[56:57], v[58:59]
    v_pk_mul_f32 v[56:57], v[56:57], v[50:51]
    v_cvt_pk_bf16_f32 v52, v52, v56
    v_cvt_pk_bf16_f32 v53, v53, v57
    ds_write2_b32 v141, v52, v53 offset0:0 offset1:136
    ds_read_b128 v[48:51], v142 offset:0
    v_mfma_f32_16x16x16_bf16 v[80:83], v[128:129], v[128:129], 0
    v_mfma_f32_16x16x16_bf16 v[84:87], v[128:129], v[128:129], 0
    v_mfma_f32_16x16x16_bf16 v[76:79], v[128:129], v[128:129], 0
    s_branch L_tslow00_back
L_tslow01_late:
L_spin_21:
    v_cmp_gt_u32 vcc, s25, v136
    buffer_load_dword v136, v135, s[4:7], s53 offen offset:0 sc1
    s_cbranch_vccz L_spun_22
    v_cmp_gt_u32 vcc, s25, v136
    buffer_load_dword v136, v135, s[4:7], s53 offen offset:0 sc1
    s_cbranch_vccz L_spun_22
    v_cmp_gt_u32 vcc, s25, v136
    buffer_load_dword v136, v135, s[4:7], s53 offen offset:0 sc1
    s_cbranch_vccz L_spun_22
    v_cmp_gt_u32 vcc, s25, v136
    buffer_load_dword v136, v135, s[4:7], s53 offen offset:0 sc1
    s_cbranch_vccz L_spun_22
    s_movk_i32 s3, 19
    s_sub_u32 s24, s24, 1
    s_cbranch_scc1 L_timeout
    s_branch L_spin_21
L_spun_22:
    buffer_load_dword v136, v135, s[4:7], s53 offen offset:0 sc1
    s_waitcnt vmcnt(0)
    s_cmp_gt_u32 s25, 2
    s_cbranch_scc1 L_tslow01_fetch
    s_waitcnt lgkmcnt(0)
    s_barrier
L_tslow01_careful:
    buffer_load_dwordx4 v[0:3], v133, s[4:7], s38 offen offset:0 sc1
    buffer_load_dwordx4 v[4:7], v133, s[4:7], s38 offen offset:1024 sc1
    buffer_load_dwordx4 v[8:11], v133, s[4:7], s39 offen offset:0 sc1
    buffer_load_dwordx4 v[12:15], v133, s[4:7], s39 offen offset:1024 sc1
    buffer_load_dwordx4 v[16:19], v133, s[4:7], s40 offen offset:0 sc1
    buffer_load_dwordx4 v[20:23], v133, s[4:7], s40 offen offset:1024 sc1
    buffer_load_dwordx4 v[24:27], v133, s[4:7], s41 offen offset:0 sc1
    buffer_load_dwordx4 v[28:31], v133, s[4:7], s41 offen offset:1024 sc1
    s_movk_i32 s3, 21
    s_sub_u32 s24, s24, 1
    s_cbranch_scc1 L_timeout
    v_mov_b64 v[124:125], 0
    v_mov_b64 v[126:127], 0
    s_waitcnt vmcnt(6)
    s_nop 0
    v_smfmac_f32_16x16x64_bf16 v[124:127], v[112:115], v[0:7], v116
    v_bitop3_b32 v130, 1, v0, v2 bitop3:0x80
    v_bitop3_b32 v130, v130, v4, v6 bitop3:0x80
    s_waitcnt vmcnt(4)
    v_smfmac_f32_16x16x64_bf16 v[124:127], v[112:115], v[8:15], v116
    v_bitop3_b32 v130, v130, v8, v10 bitop3:0x80
    v_bitop3_b32 v130, v130, v12, v14 bitop3:0x80
    s_waitcnt vmcnt(2)
    v_smfmac_f32_16x16x64_bf16 v[124:127], v[112:115], v[16:23], v116
    v_bitop3_b32 v130, v130, v16, v18 bitop3:0x80
    v_bitop3_b32 v130, v130, v20, v22 bitop3:0x80
    s_waitcnt vmcnt(1)
    v_bitop3_b32 v130, v130, v24, v26 bitop3:0x80
    s_waitcnt vmcnt(0)
    v_bitop3_b32 v130, v130, v28, v30 bitop3:0x80
    v_smfmac_f32_16x16x64_bf16 v[124:127], v[112:115], v[24:31], v116
    s_nop 1
    v_cmp_eq_u32 vcc, 0, v130
    s_cbranch_vccnz L_tslow01_careful
    s_mov_b64 exec, s[42:43]
    buffer_store_dword v134, v133, s[4:7], s47 offen offset:1024 sc1
    s_mov_b64 exec, -1
    s_nop 0
    s_branch L_tslow01_good
L_tslow01_retry:
    s_mov_b64 exec, s[42:43]
    buffer_store_dword v129, v133, s[4:7], s47 offen offset:1024 sc1
    s_mov_b64 exec, -1
L_tslow01_retry1:
    buffer_load_dwordx4 v[0:3], v133, s[4:7], s38 offen offset:0 sc1
    buffer_load_dwordx4 v[4:7], v133, s[4:7], s38 offen offset:1024 sc1
    buffer_load_dwordx4 v[8:11], v133, s[4:7], s39 offen offset:0 sc1
    buffer_load_dwordx4 v[12:15], v133, s[4:7], s39 offen offset:1024 sc1
    buffer_load_dwordx4 v[16:19], v133, s[4:7], s40 offen offset:0 sc1
    buffer_load_dwordx4 v[20:23], v133, s[4:7], s40 offen offset:1024 sc1
    buffer_load_dwordx4 v[24:27], v133, s[4:7], s41 offen offset:0 sc1
    buffer_load_dwordx4 v[28:31], v133, s[4:7], s41 offen offset:1024 sc1
    s_movk_i32 s3, 17
    s_sub_u32 s24, s24, 1
    s_cbranch_scc1 L_timeout
    v_mov_b64 v[124:125], 0
    v_mov_b64 v[126:127], 0
    s_waitcnt vmcnt(6)
    s_nop 0
    v_smfmac_f32_16x16x64_bf16 v[124:127], v[112:115], v[0:7], v116
    v_bitop3_b32 v130, 1, v0, v2 bitop3:0x80
    v_bitop3_b32 v130, v130, v4, v6 bitop3:0x80
    s_waitcnt vmcnt(4)
    v_smfmac_f32_16x16x64_bf16 v[124:127], v[112:115], v[8:15], v116
    v_bitop3_b32 v130, v130, v8, v10 bitop3:0x80
    v_bitop3_b32 v130, v130, v12, v14 bitop3:0x80
    s_waitcnt vmcnt(2)
    v_smfmac_f32_16x16x64_bf16 v[124:127], v[112:115], v[16:23], v116
    v_bitop3_b32 v130, v130, v16, v18 bitop3:0x80
    v_bitop3_b32 v130, v130, v20, v22 bitop3:0x80
    s_waitcnt vmcnt(1)
    v_bitop3_b32 v130, v130, v24, v26 bitop3:0x80
    s_waitcnt vmcnt(0)
    v_bitop3_b32 v130, v130, v28, v30 bitop3:0x80
    v_smfmac_f32_16x16x64_bf16 v[124:127], v[112:115], v[24:31], v116
    s_nop 1
    v_cmp_eq_u32 vcc, 0, v130
    s_cbranch_vccnz L_tslow01_retry1
    s_mov_b64 exec, s[42:43]
    buffer_store_dword v134, v133, s[4:7], s47 offen offset:1024 sc1
    s_mov_b64 exec, -1
    s_nop 0
    s_branch L_tslow01_good
L_tslow01_miss:
    s_waitcnt lgkmcnt(0)
    v_max3_u32 v132, v0, v1, v2
    v_max3_u32 v130, v3, v4, v5
    v_max3_u32 v132, v132, v6, v7
    v_max_u32 v132, v132, v130
    v_cmpx_eq_u32 vcc, -1, v132
    s_cbranch_execz L_tslow01_whole
L_tslow01_reload:
    buffer_load_dwordx4 v[0:3], v133, s[4:7], s26 offen sc1
    buffer_load_dwordx4 v[4:7], v133, s[4:7], s27 offen sc1
    s_movk_i32 s3, 16
    s_sub_u32 s24, s24, 1
    s_cbranch_scc1 L_timeout
    v_max3_u32 v132, v0, v1, v2
    v_max3_u32 v130, v3, v4, v5
    v_max3_u32 v132, v132, v6, v7
    v_max_u32 v132, v132, v130
    v_cmpx_eq_u32 vcc, -1, v132
    s_cbranch_execnz L_tslow01_reload
L_tslow01_whole:
    s_mov_b64 exec, -1
    s_mov_b64 s[16:17], 0
    ds_read_b128 v[32:35], v138 offset:0
    ds_read_b128 v[36:39], v138 offset:1024
    ds_read_b128 v[40:43], v138 offset:2048
    ds_read_b128 v[44:47], v138 offset:3072
    ds_read_b128 v[48:51], v138 offset:4096
    ds_read_b128 v[52:55], v138 offset:5120
    ds_read_b128 v[56:59], v138 offset:6144
    ds_read_b128 v[60:63], v138 offset:7168
    v_mov_b64 v[64:65], 0
    v_mov_b64 v[66:67], 0
    v_mov_b64 v[68:69], 0
    v_mov_b64 v[70:71], 0
    v_mov_b64 v[72:73], 0
    v_mov_b64 v[74:75], 0
    v_mov_b64 v[76:77], 0
    v_mov_b64 v[78:79], 0
    v_mov_b64 v[80:81], 0
    v_mov_b64 v[82:83], 0
    v_mov_b64 v[84:85], 0
    v_mov_b64 v[86:87], 0
    s_waitcnt vmcnt(0)
    ds_write_b128 v133, v[4:7] offset:1024
    s_branch L_tslow01_again
L_tslow01_big:
    ds_write_b32 v133, v72 offset:13568
    s_waitcnt lgkmcnt(0)
    s_barrier
    ds_read_b128 v[60:63], v133 offset:13568
    s_waitcnt lgkmcnt(0)
    v_max3_f32 v126, v60, v61, v62
    v_max3_f32 v126, v126, v63, v124
    s_nop 1
    v_max_f32_dpp v126, v126, v126 quad_perm:[2,3,0,1] row_mask:0xf bank_mask:0xf
    v_mov_b32 v127, v126
    s_nop 1
    v_permlane16_swap_b32 v126, v127
    v_max_f32 v126, v126, v127
    v_mov_b32 v127, v126
    s_nop 1
    v_permlane32_swap_b32 v126, v127
    v_max_f32 v126, v126, v127
    v_sub_f32 v60, v60, v126
    v_exp_f32 v60, v60
    v_sub_f32 v61, v61, v126
    v_exp_f32 v61, v61
    v_sub_f32 v62, v62, v126
    v_exp_f32 v62, v62
    v_sub_f32 v63, v63, v126
    v_exp_f32 v63, v63
    v_sub_f32 v124, v124, v126
    v_exp_f32 v124, v124
    v_cvt_pk_bf16_f32 v60, v60, v61
    v_cvt_pk_bf16_f32 v61, v62, v63
    v_cvt_pk_bf16_f32 v62, v124, 0
    v_mov_b64 v[52:53], 0
    v_mov_b64 v[54:55], 0
    v_mov_b64 v[56:57], 0
    v_mov_b64 v[58:59], 0
    v_mov_b32 v63, 0
    s_nop 1
    v_mfma_f32_16x16x32_bf16 v[48:51], v[60:63], v[120:123], 0
    v_smfmac_f32_16x16x32_bf16 v[52:55], v[62:63], v[130:133], v131
    v_smfmac_f32_16x16x32_bf16 v[56:59], v[62:63], v[134:137], v131
    v_smfmac_f32_16x16x32_bf16 v[52:55], v[60:61], v[112:115], v131 abid:2
    v_smfmac_f32_16x16x32_bf16 v[56:59], v[60:61], v[116:119], v131 abid:2
    s_nop 3
    v_add_f32 v48, v48, v50
    v_add_f32 v49, v49, v51
    v_rcp_f32 v50, v48
    v_rcp_f32 v51, v49
    v_pk_add_f32 v[52:53], v[52:53], v[54:55]
    v_pk_mul_f32 v[52:53], v[52:53], v[50:51]
    v_max3_f32 v126, v48, v49, v50
    v_pk_add_f32 v[56:57], v[56:57], v[58:59]
    v_pk_mul_f32 v[56:57], v[56:57], v[50:51]
    v_cvt_pk_bf16_f32 v52, v52, v56
    v_cvt_pk_bf16_f32 v53, v53, v57
    ds_write2_b32 v141, v52, v53 offset0:0 offset1:136
    ds_read_b128 v[48:51], v142 offset:0
    v_mfma_f32_16x16x16_bf16 v[80:83], v[128:129], v[128:129], 0
    v_mfma_f32_16x16x16_bf16 v[84:87], v[128:129], v[128:129], 0
    v_mfma_f32_16x16x16_bf16 v[76:79], v[128:129], v[128:129], 0
    s_branch L_tslow01_back
.p2align 6
L_tslow10_again:
    s_waitcnt vmcnt(6) lgkmcnt(0)
    v_smfmac_f32_16x16x64_bf16 v[72:75], v[0:3], v[32:39], v131 abid:1
    ds_write_b128 v133, v[0:3] offset:2048
    v_smfmac_f32_16x16x64_bf16 v[76:79], v[0:3], v[40:47], v131 abid:1
    v_smfmac_f32_16x16x64_bf16 v[80:83], v[0:3], a[24:31], v131 abid:1
    v_smfmac_f32_16x16x64_bf16 v[84:87], v[0:3], a[64:71], v131 abid:1
    s_waitcnt vmcnt(5)
    ds_read_b128 v[4:7], v133 offset:3072
    v_smfmac_f32_16x16x64_bf16 v[64:67], v[0:3], a[128:135], v131 abid:1
    v_smfmac_f32_16x16x64_bf16 v[68:71], v[0:3], a[192:199], v131 abid:1
    s_waitcnt lgkmcnt(1)
    s_barrier
    s_waitcnt lgkmcnt(0)
    v_smfmac_f32_16x16x64_bf16 v[72:75], v[4:7], v[48:55], v131 abid:1
    ds_read_b128 v[8:11], v133 offset:0
    v_smfmac_f32_16x16x64_bf16 v[76:79], v[4:7], v[56:63], v131 abid:1
    ds_read_b128 v[12:15], v133 offset:1024
    v_smfmac_f32_16x16x64_bf16 v[80:83], v[4:7], a[32:39], v131 abid:1
    ds_read_b128 v[16:19], v133 offset:6144
    v_smfmac_f32_16x16x64_bf16 v[84:87], v[4:7], a[72:79], v131 abid:1
    ds_read_b128 v[20:23], v133 offset:7168
    s_waitcnt lgkmcnt(3)
    v_smfmac_f32_16x16x64_bf16 v[72:75], v[8:11], v[192:199], v131 abid:1
    ds_read_b128 v[24:27], v133 offset:4096
    v_smfmac_f32_16x16x64_bf16 v[76:79], v[8:11], v[240:247], v131 abid:1
    ds_read_b128 v[28:31], v133 offset:5120
    s_waitcnt lgkmcnt(4)
    v_smfmac_f32_16x16x64_bf16 v[72:75], v[12:15], v[200:207], v131 abid:1
    ds_read_b128 v[32:35], v138 offset:8192
    v_smfmac_f32_16x16x64_bf16 v[76:79], v[12:15], v[248:255], v131 abid:1
    ds_read_b128 v[36:39], v138 offset:9216
    s_waitcnt lgkmcnt(5)
    v_smfmac_f32_16x16x64_bf16 v[72:75], v[16:19], v[208:215], v131 abid:1
    ds_read_b128 v[40:43], v138 offset:10240
    s_waitcnt lgkmcnt(5)
    v_smfmac_f32_16x16x64_bf16 v[72:75], v[20:23], v[216:223], v131 abid:1
    ds_read_b128 v[44:47], v138 offset:11264
    s_waitcnt lgkmcnt(5)
    v_smfmac_f32_16x16x64_bf16 v[72:75], v[24:27], v[224:231], v131 abid:1
    ds_read_b128 v[48:51], v138 offset:12288
    s_waitcnt lgkmcnt(5)
    v_smfmac_f32_16x16x64_bf16 v[72:75], v[28:31], v[232:239], v131 abid:1
    s_nop 1
    ds_read_b128 v[52:55], v138 offset:13312
    v_smfmac_f32_16x16x64_bf16 v[76:79], v[16:19], a[0:7], v131 abid:1
    s_nop 1
    ds_read_b128 v[56:59], v138 offset:14336
    v_smfmac_f32_16x16x64_bf16 v[76:79], v[20:23], a[8:15], v131 abid:1
    ds_read_b128 v[60:63], v138 offset:15360
    v_add_f32 v72, v72, v74
    v_smfmac_f32_16x16x64_bf16 v[76:79], v[24:27], a[16:23], v131 abid:1
    s_waitcnt lgkmcnt(3)
    v_add_f32 v73, v73, v75
    v_smfmac_f32_16x16x64_bf16 v[76:79], v[28:31], v[32:39], v131 abid:1
    s_nop 2
    v_smfmac_f32_16x16x64_bf16 v[80:83], v[8:11], a[40:47], v131 abid:1
    s_nop 1
    v_cmp_u_f32 vcc, v72, v73
    v_smfmac_f32_16x16x64_bf16 v[80:83], v[12:15], v[40:47], v131 abid:1
    v_add_f32 v76, v76, v78
    v_add_f32 v77, v77, v79
    v_smfmac_f32_16x16x64_bf16 v[80:83], v[16:19], a[48:55], v131 abid:1
    s_waitcnt lgkmcnt(1)
    v_cvt_pk_bf16_f32 v76, v72, v76
    v_cvt_pk_bf16_f32 v77, v73, v77
    v_smfmac_f32_16x16x64_bf16 v[80:83], v[20:23], v[48:55], v131 abid:1
    ds_write2_b32 v141, v76, v77 offset0:0 offset1:136
    v_smfmac_f32_16x16x64_bf16 v[80:83], v[24:27], a[56:63], v131 abid:1
    s_waitcnt lgkmcnt(1)
    v_mov_b64 v[52:53], 0
    v_smfmac_f32_16x16x64_bf16 v[80:83], v[28:31], v[56:63], v131 abid:1
    s_nop 1
    v_mov_b64 v[54:55], 0
    v_smfmac_f32_16x16x64_bf16 v[84:87], v[8:11], a[80:87], v131 abid:1
    s_nop 1
    v_mov_b64 v[56:57], 0
    v_smfmac_f32_16x16x64_bf16 v[84:87], v[12:15], a[88:95], v131 abid:1
    s_and_b64 vcc, vcc, s[16:17]
    v_add_f32 v80, v80, v82
    v_smfmac_f32_16x16x64_bf16 v[84:87], v[16:19], a[96:103], v131 abid:1
    s_waitcnt lgkmcnt(0)
    s_barrier
    v_smfmac_f32_16x16x64_bf16 v[84:87], v[20:23], a[104:111], v131 abid:1
    ds_read_b128 v[32:35], v137 offset:0
    v_add_f32 v81, v81, v83
    v_smfmac_f32_16x16x64_bf16 v[84:87], v[24:27], a[112:119], v131 abid:1
    ds_read_b128 v[36:39], v137 offset:64
    v_mov_b64 v[58:59], 0
    v_smfmac_f32_16x16x64_bf16 v[84:87], v[28:31], a[120:127], v131 abid:1
    s_cbranch_scc1 L_tslow10_miss
    s_add_u32 s26, s28, s54
    v_smfmac_f32_16x16x64_bf16 v[64:67], v[4:7], a[136:143], v131 abid:1
    s_add_u32 s25, s25, 1
    s_add_u32 s27, s28, s55
    s_waitcnt lgkmcnt(1)
    v_mfma_f32_16x16x32_bf16 v[72:75], v[88:91], v[32:35], 0
    s_waitcnt lgkmcnt(0)
    v_add_f32 v84, v84, v86
    v_add_f32 v85, v85, v87
    v_mfma_f32_16x16x32_bf16 v[72:75], v[92:95], v[36:39], v[72:75]
    s_nop 0
    v_cvt_pk_bf16_f32 v84, v80, v84
    v_cvt_pk_bf16_f32 v85, v81, v85
    v_smfmac_f32_16x16x64_bf16 v[64:67], v[8:11], a[144:151], v131 abid:1
    ds_write2_b32 v141, v84, v85 offset0:64 offset1:200
    v_smfmac_f32_16x16x64_bf16 v[64:67], v[12:15], a[152:159], v131 abid:1
    s_nop 1
    v_cndmask_b32 v73, v73, v74, s[58:59]
    v_cndmask_b32 v72, v72, v75, s[58:59]
    v_smfmac_f32_16x16x64_bf16 v[64:67], v[16:19], a[160:167], v131 abid:1
    ds_read_b128 v[88:91], v138 offset:16384
    v_add_f32_dpp v72, v73, v72 quad_perm:[2,3,0,1] row_mask:0xf bank_mask:0xf
    v_mul_f32 v72, s56, v72
    v_smfmac_f32_16x16x64_bf16 v[64:67], v[20:23], a[168:175], v131 abid:1
    ds_read_b128 v[92:95], v138 offset:17408
    v_exp_f32 v73, v72
    v_smfmac_f32_16x16x64_bf16 v[64:67], v[24:27], a[176:183], v131 abid:1
    ds_write_b32 v133, v73 offset:12548
    v_smfmac_f32_16x16x64_bf16 v[64:67], v[28:31], a[184:191], v131 abid:1
    s_waitcnt lgkmcnt(3)
    s_barrier
    v_smfmac_f32_16x16x64_bf16 v[68:71], v[4:7], a[200:207], v131 abid:1
    ds_read_b128 v[40:43], v137 offset:256
    v_mov_b32 v63, 0
    v_smfmac_f32_16x16x64_bf16 v[68:71], v[8:11], a[208:215], v131 abid:1
    ds_read_b128 v[44:47], v137 offset:320
    v_smfmac_f32_16x16x64_bf16 v[68:71], v[12:15], a[216:223], v131 abid:1
    ds_read_b128 v[0:3], v138 offset:18432
    v_add_f32 v64, v64, v66
    v_smfmac_f32_16x16x64_bf16 v[68:71], v[16:19], a[224:231], v131 abid:1
    s_waitcnt lgkmcnt(3)
    s_barrier
    s_waitcnt lgkmcnt(2)
    v_mfma_f32_16x16x32_bf16 v[124:127], v[40:43], v[32:35], 0
    ds_read_b128 v[80:83], v133 offset:12544
    s_waitcnt lgkmcnt(2)
    v_mfma_f32_16x16x32_bf16 v[124:127], v[44:47], v[36:39], v[124:127]
    s_nop 0
    v_add_f32 v65, v65, v67
    v_cvt_pk_bf16_f32 v130, v64, v65
    v_smfmac_f32_16x16x64_bf16 v[68:71], v[20:23], a[232:239], v131 abid:1
    ds_read_b128 v[4:7], v138 offset:19456
    ds_read_b128 v[8:11], v138 offset:20480
    v_smfmac_f32_16x16x64_bf16 v[68:71], v[24:27], a[240:247], v131 abid:1
    ds_read_b128 v[12:15], v138 offset:21504
    v_cndmask_b32 v125, v125, v126, s[58:59]
    v_cndmask_b32 v124, v124, v127, s[58:59]
    v_smfmac_f32_16x16x64_bf16 v[68:71], v[28:31], a[248:255], v131 abid:1
    s_waitcnt lgkmcnt(3)
    v_cvt_pk_bf16_f32 v60, v80, v81
    v_cvt_pk_bf16_f32 v61, v82, v83
    v_add_f32_dpp v124, v125, v124 quad_perm:[2,3,0,1] row_mask:0xf bank_mask:0xf
    v_mul_f32 v124, s56, v124
    v_smfmac_f32_16x16x32_bf16 v[52:55], v[60:61], v[96:99], v131 abid:2
    v_exp_f32 v125, v124
    v_smfmac_f32_16x16x32_bf16 v[56:59], v[60:61], v[100:103], v131 abid:2
    v_cvt_pk_bf16_f32 v62, v125, 0
    v_add_f32 v68, v68, v70
    v_add_f32 v69, v69, v71
    v_mfma_f32_16x16x32_bf16 v[48:51], v[60:63], v[120:123], 0
    ds_read_b128 v[32:35], v138 offset:22528
    v_cvt_pk_bf16_f32 v134, v68, v69
    v_smfmac_f32_16x16x32_bf16 v[52:55], v[62:63], v[130:133], v131
    s_nop 0
    ds_read_b128 v[36:39], v138 offset:23552
    ds_read_b128 v[40:43], v138 offset:24576
    v_smfmac_f32_16x16x32_bf16 v[56:59], v[62:63], v[134:137], v131
    s_nop 0
    v_add_f32 v48, v48, v50
    v_add_f32 v49, v49, v51
    v_rcp_f32 v50, v48
    v_rcp_f32 v51, v49
    v_pk_add_f32 v[52:53], v[52:53], v[54:55]
    v_pk_mul_f32 v[52:53], v[52:53], v[50:51]
    v_max3_f32 v126, v48, v49, v50
    v_pk_add_f32 v[56:57], v[56:57], v[58:59]
    v_pk_mul_f32 v[56:57], v[56:57], v[50:51]
    v_cvt_pk_bf16_f32 v52, v52, v56
    v_cvt_pk_bf16_f32 v53, v53, v57
    v_mfma_f32_16x16x16_bf16 v[80:83], v[128:129], v[128:129], 0
    ds_write2_b32 v141, v52, v53 offset0:0 offset1:136
    v_mfma_f32_16x16x16_bf16 v[84:87], v[128:129], v[128:129], 0
    v_max_f32 v126, v126, v51
    v_cmp_nge_f32 vcc, 0x4f800000, v126
    v_mfma_f32_16x16x16_bf16 v[76:79], v[128:129], v[128:129], 0
    ds_read_b128 v[48:51], v142 offset:64
    s_cbranch_vccnz L_tslow10_big
L_tslow10_back:
    v_mfma_f32_16x16x16_bf16 v[72:75], v[128:129], v[128:129], 0
    s_waitcnt lgkmcnt(1)
    s_barrier
    ds_read_b128 v[52:55], v142 offset:0
    s_waitcnt lgkmcnt(1)
    v_smfmac_f32_16x16x64_bf16 v[80:83], v[48:51], v[88:95], v131 abid:1
    ds_read_b128 v[56:59], v142 offset:192
    v_smfmac_f32_16x16x64_bf16 v[84:87], v[48:51], v[0:7], v131 abid:1
    ds_read_b128 v[60:63], v142 offset:128
    v_smfmac_f32_16x16x64_bf16 v[76:79], v[48:51], v[8:15], v131 abid:1
    ds_read_b128 v[44:47], v138 offset:25600
    s_waitcnt lgkmcnt(3)
    v_smfmac_f32_16x16x64_bf16 v[80:83], v[52:55], v[144:151], v131 abid:1
    ds_read_b128 v[16:19], v138 offset:26624
    s_waitcnt lgkmcnt(3)
    v_smfmac_f32_16x16x64_bf16 v[80:83], v[56:59], v[152:159], v131 abid:1
    ds_read_b128 v[20:23], v138 offset:27648
    s_waitcnt lgkmcnt(3)
    v_smfmac_f32_16x16x64_bf16 v[80:83], v[60:63], v[160:167], v131 abid:1
    s_nop 1
    ds_read_b128 v[24:27], v138 offset:28672
    v_smfmac_f32_16x16x64_bf16 v[84:87], v[52:55], v[32:39], v131 abid:1
    ds_read_b128 v[28:31], v138 offset:29696
    s_waitcnt lgkmcnt(4)
    v_smfmac_f32_16x16x64_bf16 v[84:87], v[56:59], v[40:47], v131 abid:1
    ds_read_b128 v[64:67], v138 offset:30720
    v_cvt_pk_bf16_f32 v80, v80, v82
    v_cvt_pk_bf16_f32 v81, v81, v83
    v_and_b32 v80, -2, v80
    v_smfmac_f32_16x16x64_bf16 v[84:87], v[60:63], v[168:175], v131 abid:1
    buffer_store_dwordx2 v[80:81], v139, s[4:7], s30 offen sc1
    ds_read_b128 v[68:71], v138 offset:31744
    s_waitcnt lgkmcnt(4)
    v_smfmac_f32_16x16x64_bf16 v[76:79], v[52:55], v[16:23], v131 abid:1
    ds_read_b128 v[0:3], v138 offset:32768
    s_waitcnt lgkmcnt(3)
    v_smfmac_f32_16x16x64_bf16 v[76:79], v[56:59], v[176:183], v131 abid:1
    ds_read_b128 v[4:7], v138 offset:33792
    v_cvt_pk_bf16_f32 v84, v84, v86
    v_cvt_pk_bf16_f32 v85, v85, v87
    v_and_b32 v84, -2, v84
    v_smfmac_f32_16x16x64_bf16 v[76:79], v[60:63], v[24:31], v131 abid:1
    buffer_store_dwordx2 v[84:85], v139, s[4:7], s31 offen sc1
    ds_read_b128 v[8:11], v138 offset:34816
    s_nop 0
    v_smfmac_f32_16x16x64_bf16 v[72:75], v[48:51], v[184:191], v131 abid:1
    ds_read_b128 v[12:15], v138 offset:35840
    s_waitcnt lgkmcnt(4)
    v_smfmac_f32_16x16x64_bf16 v[72:75], v[52:55], v[64:71], v131 abid:1
    s_waitcnt lgkmcnt(2)
    v_cvt_pk_bf16_f32 v76, v76, v78
    v_cvt_pk_bf16_f32 v77, v77, v79
    v_and_b32 v76, -2, v76
    v_smfmac_f32_16x16x64_bf16 v[72:75], v[56:59], v[0:7], v131 abid:1
    buffer_store_dwordx2 v[76:77], v139, s[4:7], s32 offen sc1
    s_waitcnt lgkmcnt(0)
    v_smfmac_f32_16x16x64_bf16 v[72:75], v[60:63], v[8:15], v131 abid:1
    s_nop 7
    v_cvt_pk_bf16_f32 v72, v72, v74
    v_cvt_pk_bf16_f32 v73, v73, v75
    v_and_b32 v72, -2, v72
    buffer_store_dwordx2 v[72:73], v139, s[4:7], s33 offen sc1
    s_cmp_eq_u32 s25, 63
    s_cbranch_scc1 L_end
    s_cmp_lt_u32 s25, 62
    s_cselect_b32 s57, 0x80000, 0
    s_add_u32 s34, s34, s57
    s_add_u32 s35, s35, s57
    s_add_u32 s36, s36, s57
    s_add_u32 s37, s37, s57
    s_mov_b32 s28, s29
    s_add_u32 s29, s29, 0x2000
    s_bitset0_b32 s29, 15
    s_mov_b64 s[16:17], -1
    v_mov_b32 v124, -1
    ds_read_b128 v[32:35], v138 offset:0
    s_waitcnt vmcnt(4)
    s_barrier
L_spin_23:
    v_cmp_gt_u32 vcc, s25, v136
    buffer_load_dword v136, v135, s[4:7], s53 offen offset:1024 sc1
    s_cbranch_vccz L_spun_24
    v_cmp_gt_u32 vcc, s25, v136
    buffer_load_dword v136, v135, s[4:7], s53 offen offset:1024 sc1
    s_cbranch_vccz L_spun_24
    v_cmp_gt_u32 vcc, s25, v136
    buffer_load_dword v136, v135, s[4:7], s53 offen offset:1024 sc1
    s_cbranch_vccz L_spun_24
    v_cmp_gt_u32 vcc, s25, v136
    buffer_load_dword v136, v135, s[4:7], s53 offen offset:1024 sc1
    s_cbranch_vccz L_spun_24
    v_cmp_gt_u32 vcc, s25, v136
    buffer_load_dword v136, v135, s[4:7], s53 offen offset:1024 sc1
    s_cbranch_vccz L_spun_24
    v_cmp_gt_u32 vcc, s25, v136
    buffer_load_dword v136, v135, s[4:7], s53 offen offset:1024 sc1
    s_cbranch_vccz L_spun_24
    v_cmp_gt_u32 vcc, s25, v136
    buffer_load_dword v136, v135, s[4:7], s53 offen offset:1024 sc1
    s_cbranch_vccz L_spun_24
    v_cmp_gt_u32 vcc, s25, v136
    buffer_load_dword v136, v135, s[4:7], s53 offen offset:1024 sc1
    s_cbranch_vccz L_spun_24
    v_cmp_gt_u32 vcc, s25, v136
    buffer_load_dword v136, v135, s[4:7], s53 offen offset:1024 sc1
    s_cbranch_vccz L_spun_24
    v_cmp_gt_u32 vcc, s25, v136
    buffer_load_dword v136, v135, s[4:7], s53 offen offset:1024 sc1
    s_cbranch_vccz L_spun_24
    v_cmp_gt_u32 vcc, s25, v136
    buffer_load_dword v136, v135, s[4:7], s53 offen offset:1024 sc1
    s_cbranch_vccz L_spun_24
    v_cmp_gt_u32 vcc, s25, v136
    buffer_load_dword v136, v135, s[4:7], s53 offen offset:1024 sc1
    s_cbranch_vccz L_spun_24
    v_cmp_gt_u32 vcc, s25, v136
    buffer_load_dword v136, v135, s[4:7], s53 offen offset:1024 sc1
    s_cbranch_vccz L_spun_24
    v_cmp_gt_u32 vcc, s25, v136
    buffer_load_dword v136, v135, s[4:7], s53 offen offset:1024 sc1
    s_cbranch_vccz L_spun_24
    v_cmp_gt_u32 vcc, s25, v136
    buffer_load_dword v136, v135, s[4:7], s53 offen offset:1024 sc1
    s_cbranch_vccz L_spun_24
    v_cmp_gt_u32 vcc, s25, v136
    buffer_load_dword v136, v135, s[4:7], s53 offen offset:1024 sc1
    s_cbranch_vccz L_spun_24
    v_cmp_gt_u32 vcc, s25, v136
    buffer_load_dword v136, v135, s[4:7], s53 offen offset:1024 sc1
    s_cbranch_vccz L_spun_24
    v_cmp_gt_u32 vcc, s25, v136
    buffer_load_dword v136, v135, s[4:7], s53 offen offset:1024 sc1
    s_cbranch_vccz L_spun_24
    v_cmp_gt_u32 vcc, s25, v136
    buffer_load_dword v136, v135, s[4:7], s53 offen offset:1024 sc1
    s_cbranch_vccz L_spun_24
    v_cmp_gt_u32 vcc, s25, v136
    buffer_load_dword v136, v135, s[4:7], s53 offen offset:1024 sc1
    s_cbranch_vccz L_spun_24
    s_movk_i32 s3, 20
    s_sub_u32 s24, s24, 1
    s_cbranch_scc1 L_timeout
    s_branch L_spin_23
L_spun_24:
    ds_read_b128 v[36:39], v138 offset:1024
    ds_read_b128 v[40:43], v138 offset:2048
    ds_read_b128 v[44:47], v138 offset:3072
    ds_read_b128 v[48:51], v138 offset:4096
    ds_read_b128 v[52:55], v138 offset:5120
    ds_read_b128 v[56:59], v138 offset:6144
    ds_read_b128 v[60:63], v138 offset:7168
    v_mov_b64 v[64:65], 0
    v_mov_b64 v[66:67], 0
    v_mov_b64 v[68:69], 0
    v_mov_b64 v[70:71], 0
    v_mov_b64 v[72:73], 0
    v_mov_b64 v[74:75], 0
    v_mov_b64 v[76:77], 0
    v_mov_b64 v[78:79], 0
    v_mov_b64 v[80:81], 0
    v_mov_b64 v[82:83], 0
    v_mov_b64 v[84:85], 0
    v_mov_b64 v[86:87], 0
    s_barrier
    buffer_load_dwordx4 v[0:3], v133, s[4:7], s26 offen sc1
    s_barrier
    buffer_load_dwordx4 v133, s[4:7], s27 offen sc1 lds
    s_barrier
    buffer_store_dword v124, v140, s[4:7], s29 offen sc1
    buffer_load_dwordx4 v[88:91], v133, s[4:7], s34 offen sc1
    buffer_load_dwordx4 v[92:95], v133, s[4:7], s35 offen sc1
    buffer_load_dwordx4 v[96:99], v133, s[4:7], s36 offen sc1
    buffer_load_dwordx4 v[100:103], v133, s[4:7], s37 offen sc1
L_tslow11_again:
    s_waitcnt vmcnt(6) lgkmcnt(0)
    v_smfmac_f32_16x16x64_bf16 v[72:75], v[0:3], v[32:39], v131 abid:1
    ds_write_b128 v133, v[0:3] offset:2048
    v_smfmac_f32_16x16x64_bf16 v[76:79], v[0:3], v[40:47], v131 abid:1
    v_smfmac_f32_16x16x64_bf16 v[80:83], v[0:3], a[24:31], v131 abid:1
    v_smfmac_f32_16x16x64_bf16 v[84:87], v[0:3], a[64:71], v131 abid:1
    s_waitcnt vmcnt(5)
    ds_read_b128 v[4:7], v133 offset:3072
    v_smfmac_f32_16x16x64_bf16 v[64:67], v[0:3], a[128:135], v131 abid:1
    v_smfmac_f32_16x16x64_bf16 v[68:71], v[0:3], a[192:199], v131 abid:1
    s_waitcnt lgkmcnt(1)
    s_barrier
    s_waitcnt lgkmcnt(0)
    v_smfmac_f32_16x16x64_bf16 v[72:75], v[4:7], v[48:55], v131 abid:1
    ds_read_b128 v[8:11], v133 offset:0
    v_smfmac_f32_16x16x64_bf16 v[76:79], v[4:7], v[56:63], v131 abid:1
    ds_read_b128 v[12:15], v133 offset:1024
    v_smfmac_f32_16x16x64_bf16 v[80:83], v[4:7], a[32:39], v131 abid:1
    ds_read_b128 v[16:19], v133 offset:6144
    v_smfmac_f32_16x16x64_bf16 v[84:87], v[4:7], a[72:79], v131 abid:1
    ds_read_b128 v[20:23], v133 offset:7168
    s_waitcnt lgkmcnt(3)
    v_smfmac_f32_16x16x64_bf16 v[72:75], v[8:11], v[192:199], v131 abid:1
    ds_read_b128 v[24:27], v133 offset:4096
    v_smfmac_f32_16x16x64_bf16 v[76:79], v[8:11], v[240:247], v131 abid:1
    ds_read_b128 v[28:31], v133 offset:5120
    s_waitcnt lgkmcnt(4)
    v_smfmac_f32_16x16x64_bf16 v[72:75], v[12:15], v[200:207], v131 abid:1
    ds_read_b128 v[32:35], v138 offset:8192
    v_smfmac_f32_16x16x64_bf16 v[76:79], v[12:15], v[248:255], v131 abid:1
    ds_read_b128 v[36:39], v138 offset:9216
    s_waitcnt lgkmcnt(5)
    v_smfmac_f32_16x16x64_bf16 v[72:75], v[16:19], v[208:215], v131 abid:1
    ds_read_b128 v[40:43], v138 offset:10240
    s_waitcnt lgkmcnt(5)
    v_smfmac_f32_16x16x64_bf16 v[72:75], v[20:23], v[216:223], v131 abid:1
    ds_read_b128 v[44:47], v138 offset:11264
    s_waitcnt lgkmcnt(5)
    v_smfmac_f32_16x16x64_bf16 v[72:75], v[24:27], v[224:231], v131 abid:1
    ds_read_b128 v[48:51], v138 offset:12288
    s_waitcnt lgkmcnt(5)
    v_smfmac_f32_16x16x64_bf16 v[72:75], v[28:31], v[232:239], v131 abid:1
    s_nop 1
    ds_read_b128 v[52:55], v138 offset:13312
    v_smfmac_f32_16x16x64_bf16 v[76:79], v[16:19], a[0:7], v131 abid:1
    s_nop 1
    ds_read_b128 v[56:59], v138 offset:14336
    v_smfmac_f32_16x16x64_bf16 v[76:79], v[20:23], a[8:15], v131 abid:1
    ds_read_b128 v[60:63], v138 offset:15360
    v_add_f32 v72, v72, v74
    v_smfmac_f32_16x16x64_bf16 v[76:79], v[24:27], a[16:23], v131 abid:1
    s_waitcnt lgkmcnt(3)
    v_add_f32 v73, v73, v75
    v_smfmac_f32_16x16x64_bf16 v[76:79], v[28:31], v[32:39], v131 abid:1
    s_nop 2
    v_smfmac_f32_16x16x64_bf16 v[80:83], v[8:11], a[40:47], v131 abid:1
    s_nop 1
    v_cmp_u_f32 vcc, v72, v73
    v_smfmac_f32_16x16x64_bf16 v[80:83], v[12:15], v[40:47], v131 abid:1
    v_add_f32 v76, v76, v78
    v_add_f32 v77, v77, v79
    v_smfmac_f32_16x16x64_bf16 v[80:83], v[16:19], a[48:55], v131 abid:1
    s_waitcnt lgkmcnt(1)
    v_cvt_pk_bf16_f32 v76, v72, v76
    v_cvt_pk_bf16_f32 v77, v73, v77
    v_smfmac_f32_16x16x64_bf16 v[80:83], v[20:23], v[48:55], v131 abid:1
    ds_write2_b32 v141, v76, v77 offset0:0 offset1:136
    v_smfmac_f32_16x16x64_bf16 v[80:83], v[24:27], a[56:63], v131 abid:1
    s_waitcnt lgkmcnt(1)
    v_mov_b64 v[52:53], 0
    v_smfmac_f32_16x16x64_bf16 v[80:83], v[28:31], v[56:63], v131 abid:1
    s_nop 1
    v_mov_b64 v[54:55], 0
    v_smfmac_f32_16x16x64_bf16 v[84:87], v[8:11], a[80:87], v131 abid:1
    s_nop 1
    v_mov_b64 v[56:57], 0
    v_smfmac_f32_16x16x64_bf16 v[84:87], v[12:15], a[88:95], v131 abid:1
    s_and_b64 vcc, vcc, s[16:17]
    v_add_f32 v80, v80, v82
    v_smfmac_f32_16x16x64_bf16 v[84:87], v[16:19], a[96:103], v131 abid:1
    s_waitcnt lgkmcnt(0)
    s_barrier
    v_smfmac_f32_16x16x64_bf16 v[84:87], v[20:23], a[104:111], v131 abid:1
    ds_read_b128 v[32:35], v137 offset:0
    v_add_f32 v81, v81, v83
    v_smfmac_f32_16x16x64_bf16 v[84:87], v[24:27], a[112:119], v131 abid:1
    ds_read_b128 v[36:39], v137 offset:64
    v_mov_b64 v[58:59], 0
    v_smfmac_f32_16x16x64_bf16 v[84:87], v[28:31], a[120:127], v131 abid:1
    s_cbranch_scc1 L_tslow11_miss
    s_add_u32 s26, s28, s54
    v_smfmac_f32_16x16x64_bf16 v[64:67], v[4:7], a[136:143], v131 abid:1
    s_add_u32 s25, s25, 1
    s_add_u32 s27, s28, s55
    s_waitcnt lgkmcnt(1)
    v_mfma_f32_16x16x32_bf16 v[72:75], v[104:107], v[32:35], 0
    s_waitcnt lgkmcnt(0)
    v_add_f32 v84, v84, v86
    v_add_f32 v85, v85, v87
    v_mfma_f32_16x16x32_bf16 v[72:75], v[108:111], v[36:39], v[72:75]
    s_nop 0
    v_cvt_pk_bf16_f32 v84, v80, v84
    v_cvt_pk_bf16_f32 v85, v81, v85
    v_smfmac_f32_16x16x64_bf16 v[64:67], v[8:11], a[144:151], v131 abid:1
    ds_write2_b32 v141, v84, v85 offset0:64 offset1:200
    v_smfmac_f32_16x16x64_bf16 v[64:67], v[12:15], a[152:159], v131 abid:1
    s_nop 1
    v_cndmask_b32 v73, v73, v74, s[58:59]
    v_cndmask_b32 v72, v72, v75, s[58:59]
    v_smfmac_f32_16x16x64_bf16 v[64:67], v[16:19], a[160:167], v131 abid:1
    ds_read_b128 v[104:107], v138 offset:16384
    v_add_f32_dpp v72, v73, v72 quad_perm:[2,3,0,1] row_mask:0xf bank_mask:0xf
    v_mul_f32 v72, s56, v72
    v_smfmac_f32_16x16x64_bf16 v[64:67], v[20:23], a[168:175], v131 abid:1
    ds_read_b128 v[108:111], v138 offset:17408
    v_exp_f32 v73, v72
    v_smfmac_f32_16x16x64_bf16 v[64:67], v[24:27], a[176:183], v131 abid:1
    ds_write_b32 v133, v73 offset:12548
    v_smfmac_f32_16x16x64_bf16 v[64:67], v[28:31], a[184:191], v131 abid:1
    s_waitcnt lgkmcnt(3)
    s_barrier
    v_smfmac_f32_16x16x64_bf16 v[68:71], v[4:7], a[200:207], v131 abid:1
    ds_read_b128 v[40:43], v137 offset:256
    v_mov_b32 v63, 0
    v_smfmac_f32_16x16x64_bf16 v[68:71], v[8:11], a[208:215], v131 abid:1
    ds_read_b128 v[44:47], v137 offset:320
    v_smfmac_f32_16x16x64_bf16 v[68:71], v[12:15], a[216:223], v131 abid:1
    ds_read_b128 v[0:3], v138 offset:18432
    v_add_f32 v64, v64, v66
    v_smfmac_f32_16x16x64_bf16 v[68:71], v[16:19], a[224:231], v131 abid:1
    s_waitcnt lgkmcnt(3)
    s_barrier
    s_waitcnt lgkmcnt(2)
    v_mfma_f32_16x16x32_bf16 v[124:127], v[40:43], v[32:35], 0
    ds_read_b128 v[80:83], v133 offset:12544
    s_waitcnt lgkmcnt(2)
    v_mfma_f32_16x16x32_bf16 v[124:127], v[44:47], v[36:39], v[124:127]
    s_nop 0
    v_add_f32 v65, v65, v67
    v_cvt_pk_bf16_f32 v130, v64, v65
    v_smfmac_f32_16x16x64_bf16 v[68:71], v[20:23], a[232:239], v131 abid:1
    ds_read_b128 v[4:7], v138 offset:19456
    ds_read_b128 v[8:11], v138 offset:20480
    v_smfmac_f32_16x16x64_bf16 v[68:71], v[24:27], a[240:247], v131 abid:1
    ds_read_b128 v[12:15], v138 offset:21504
    v_cndmask_b32 v125, v125, v126, s[58:59]
    v_cndmask_b32 v124, v124, v127, s[58:59]
    v_smfmac_f32_16x16x64_bf16 v[68:71], v[28:31], a[248:255], v131 abid:1
    s_waitcnt lgkmcnt(3)
    v_cvt_pk_bf16_f32 v60, v80, v81
    v_cvt_pk_bf16_f32 v61, v82, v83
    v_add_f32_dpp v124, v125, v124 quad_perm:[2,3,0,1] row_mask:0xf bank_mask:0xf
    v_mul_f32 v124, s56, v124
    v_smfmac_f32_16x16x32_bf16 v[52:55], v[60:61], v[112:115], v131 abid:2
    v_exp_f32 v125, v124
    v_smfmac_f32_16x16x32_bf16 v[56:59], v[60:61], v[116:119], v131 abid:2
    v_cvt_pk_bf16_f32 v62, v125, 0
    v_add_f32 v68, v68, v70
    v_add_f32 v69, v69, v71
    v_mfma_f32_16x16x32_bf16 v[48:51], v[60:63], v[120:123], 0
    ds_read_b128 v[32:35], v138 offset:22528
    v_cvt_pk_bf16_f32 v134, v68, v69
    v_smfmac_f32_16x16x32_bf16 v[52:55], v[62:63], v[130:133], v131
    s_nop 0
    ds_read_b128 v[36:39], v138 offset:23552
    ds_read_b128 v[40:43], v138 offset:24576
    v_smfmac_f32_16x16x32_bf16 v[56:59], v[62:63], v[134:137], v131
    s_nop 0
    v_add_f32 v48, v48, v50
    v_add_f32 v49, v49, v51
    v_rcp_f32 v50, v48
    v_rcp_f32 v51, v49
    v_pk_add_f32 v[52:53], v[52:53], v[54:55]
    v_pk_mul_f32 v[52:53], v[52:53], v[50:51]
    v_max3_f32 v126, v48, v49, v50
    v_pk_add_f32 v[56:57], v[56:57], v[58:59]
    v_pk_mul_f32 v[56:57], v[56:57], v[50:51]
    v_cvt_pk_bf16_f32 v52, v52, v56
    v_cvt_pk_bf16_f32 v53, v53, v57
    v_mfma_f32_16x16x16_bf16 v[80:83], v[128:129], v[128:129], 0
    ds_write2_b32 v141, v52, v53 offset0:0 offset1:136
    v_mfma_f32_16x16x16_bf16 v[84:87], v[128:129], v[128:129], 0
    v_max_f32 v126, v126, v51
    v_cmp_nge_f32 vcc, 0x4f800000, v126
    v_mfma_f32_16x16x16_bf16 v[76:79], v[128:129], v[128:129], 0
    ds_read_b128 v[48:51], v142 offset:64
    s_cbranch_vccnz L_tslow11_big
L_tslow11_back:
    v_mfma_f32_16x16x16_bf16 v[72:75], v[128:129], v[128:129], 0
    s_waitcnt lgkmcnt(1)
    s_barrier
    ds_read_b128 v[52:55], v142 offset:0
    s_waitcnt lgkmcnt(1)
    v_smfmac_f32_16x16x64_bf16 v[80:83], v[48:51], v[104:111], v131 abid:1
    ds_read_b128 v[56:59], v142 offset:192
    v_smfmac_f32_16x16x64_bf16 v[84:87], v[48:51], v[0:7], v131 abid:1
    ds_read_b128 v[60:63], v142 offset:128
    v_smfmac_f32_16x16x64_bf16 v[76:79], v[48:51], v[8:15], v131 abid:1
    ds_read_b128 v[44:47], v138 offset:25600
    s_waitcnt lgkmcnt(3)
    v_smfmac_f32_16x16x64_bf16 v[80:83], v[52:55], v[144:151], v131 abid:1
    ds_read_b128 v[16:19], v138 offset:26624
    s_waitcnt lgkmcnt(3)
    v_smfmac_f32_16x16x64_bf16 v[80:83], v[56:59], v[152:159], v131 abid:1
    ds_read_b128 v[20:23], v138 offset:27648
    s_waitcnt lgkmcnt(3)
    v_smfmac_f32_16x16x64_bf16 v[80:83], v[60:63], v[160:167], v131 abid:1
    s_nop 1
    ds_read_b128 v[24:27], v138 offset:28672
    v_smfmac_f32_16x16x64_bf16 v[84:87], v[52:55], v[32:39], v131 abid:1
    ds_read_b128 v[28:31], v138 offset:29696
    s_waitcnt lgkmcnt(4)
    v_smfmac_f32_16x16x64_bf16 v[84:87], v[56:59], v[40:47], v131 abid:1
    ds_read_b128 v[64:67], v138 offset:30720
    v_cvt_pk_bf16_f32 v80, v80, v82
    v_cvt_pk_bf16_f32 v81, v81, v83
    v_or_b32 v80, 1, v80
    v_smfmac_f32_16x16x64_bf16 v[84:87], v[60:63], v[168:175], v131 abid:1
    buffer_store_dwordx2 v[80:81], v139, s[4:7], s30 offen sc1
    ds_read_b128 v[68:71], v138 offset:31744
    s_waitcnt lgkmcnt(4)
    v_smfmac_f32_16x16x64_bf16 v[76:79], v[52:55], v[16:23], v131 abid:1
    ds_read_b128 v[0:3], v138 offset:32768
    s_waitcnt lgkmcnt(3)
    v_smfmac_f32_16x16x64_bf16 v[76:79], v[56:59], v[176:183], v131 abid:1
    ds_read_b128 v[4:7], v138 offset:33792
    v_cvt_pk_bf16_f32 v84, v84, v86
    v_cvt_pk_bf16_f32 v85, v85, v87
    v_or_b32 v84, 1, v84
    v_smfmac_f32_16x16x64_bf16 v[76:79], v[60:63], v[24:31], v131 abid:1
    buffer_store_dwordx2 v[84:85], v139, s[4:7], s31 offen sc1
    ds_read_b128 v[8:11], v138 offset:34816
    s_nop 0
    v_smfmac_f32_16x16x64_bf16 v[72:75], v[48:51], v[184:191], v131 abid:1
    ds_read_b128 v[12:15], v138 offset:35840
    s_waitcnt lgkmcnt(4)
    v_smfmac_f32_16x16x64_bf16 v[72:75], v[52:55], v[64:71], v131 abid:1
    s_waitcnt lgkmcnt(2)
    v_cvt_pk_bf16_f32 v76, v76, v78
    v_cvt_pk_bf16_f32 v77, v77, v79
    v_or_b32 v76, 1, v76
    v_smfmac_f32_16x16x64_bf16 v[72:75], v[56:59], v[0:7], v131 abid:1
    buffer_store_dwordx2 v[76:77], v139, s[4:7], s32 offen sc1
    s_waitcnt lgkmcnt(0)
    v_smfmac_f32_16x16x64_bf16 v[72:75], v[60:63], v[8:15], v131 abid:1
    s_nop 7
    v_cvt_pk_bf16_f32 v72, v72, v74
    v_cvt_pk_bf16_f32 v73, v73, v75
    v_or_b32 v72, 1, v72
    buffer_store_dwordx2 v[72:73], v139, s[4:7], s33 offen sc1
    s_cmp_lt_u32 s25, 62
    s_cselect_b32 s57, 0x80000, 0
    s_add_u32 s34, s34, s57
    s_add_u32 s35, s35, s57
    s_add_u32 s36, s36, s57
    s_add_u32 s37, s37, s57
    s_mov_b32 s28, s29
    s_add_u32 s29, s29, 0x2000
    s_bitset0_b32 s29, 15
    s_mov_b64 s[16:17], -1
    v_mov_b32 v124, -1
    ds_read_b128 v[32:35], v138 offset:0
    s_waitcnt vmcnt(4)
    s_barrier
L_spin_25:
    v_cmp_gt_u32 vcc, s25, v136
    buffer_load_dword v136, v135, s[4:7], s53 offen offset:1024 sc1
    s_cbranch_vccz L_spun_26
    v_cmp_gt_u32 vcc, s25, v136
    buffer_load_dword v136, v135, s[4:7], s53 offen offset:1024 sc1
    s_cbranch_vccz L_spun_26
    v_cmp_gt_u32 vcc, s25, v136
    buffer_load_dword v136, v135, s[4:7], s53 offen offset:1024 sc1
    s_cbranch_vccz L_spun_26
    v_cmp_gt_u32 vcc, s25, v136
    buffer_load_dword v136, v135, s[4:7], s53 offen offset:1024 sc1
    s_cbranch_vccz L_spun_26
    v_cmp_gt_u32 vcc, s25, v136
    buffer_load_dword v136, v135, s[4:7], s53 offen offset:1024 sc1
    s_cbranch_vccz L_spun_26
    v_cmp_gt_u32 vcc, s25, v136
    buffer_load_dword v136, v135, s[4:7], s53 offen offset:1024 sc1
    s_cbranch_vccz L_spun_26
    v_cmp_gt_u32 vcc, s25, v136
    buffer_load_dword v136, v135, s[4:7], s53 offen offset:1024 sc1
    s_cbranch_vccz L_spun_26
    v_cmp_gt_u32 vcc, s25, v136
    buffer_load_dword v136, v135, s[4:7], s53 offen offset:1024 sc1
    s_cbranch_vccz L_spun_26
    v_cmp_gt_u32 vcc, s25, v136
    buffer_load_dword v136, v135, s[4:7], s53 offen offset:1024 sc1
    s_cbranch_vccz L_spun_26
    v_cmp_gt_u32 vcc, s25, v136
    buffer_load_dword v136, v135, s[4:7], s53 offen offset:1024 sc1
    s_cbranch_vccz L_spun_26
    v_cmp_gt_u32 vcc, s25, v136
    buffer_load_dword v136, v135, s[4:7], s53 offen offset:1024 sc1
    s_cbranch_vccz L_spun_26
    v_cmp_gt_u32 vcc, s25, v136
    buffer_load_dword v136, v135, s[4:7], s53 offen offset:1024 sc1
    s_cbranch_vccz L_spun_26
    v_cmp_gt_u32 vcc, s25, v136
    buffer_load_dword v136, v135, s[4:7], s53 offen offset:1024 sc1
    s_cbranch_vccz L_spun_26
    v_cmp_gt_u32 vcc, s25, v136
    buffer_load_dword v136, v135, s[4:7], s53 offen offset:1024 sc1
    s_cbranch_vccz L_spun_26
    v_cmp_gt_u32 vcc, s25, v136
    buffer_load_dword v136, v135, s[4:7], s53 offen offset:1024 sc1
    s_cbranch_vccz L_spun_26
    v_cmp_gt_u32 vcc, s25, v136
    buffer_load_dword v136, v135, s[4:7], s53 offen offset:1024 sc1
    s_cbranch_vccz L_spun_26
    v_cmp_gt_u32 vcc, s25, v136
    buffer_load_dword v136, v135, s[4:7], s53 offen offset:1024 sc1
    s_cbranch_vccz L_spun_26
    v_cmp_gt_u32 vcc, s25, v136
    buffer_load_dword v136, v135, s[4:7], s53 offen offset:1024 sc1
    s_cbranch_vccz L_spun_26
    v_cmp_gt_u32 vcc, s25, v136
    buffer_load_dword v136, v135, s[4:7], s53 offen offset:1024 sc1
    s_cbranch_vccz L_spun_26
    v_cmp_gt_u32 vcc, s25, v136
    buffer_load_dword v136, v135, s[4:7], s53 offen offset:1024 sc1
    s_cbranch_vccz L_spun_26
    s_movk_i32 s3, 20
    s_sub_u32 s24, s24, 1
    s_cbranch_scc1 L_timeout
    s_branch L_spin_25
L_spun_26:
    ds_read_b128 v[36:39], v138 offset:1024
    ds_read_b128 v[40:43], v138 offset:2048
    ds_read_b128 v[44:47], v138 offset:3072
    ds_read_b128 v[48:51], v138 offset:4096
    ds_read_b128 v[52:55], v138 offset:5120
    ds_read_b128 v[56:59], v138 offset:6144
    ds_read_b128 v[60:63], v138 offset:7168
    v_mov_b64 v[64:65], 0
    v_mov_b64 v[66:67], 0
    v_mov_b64 v[68:69], 0
    v_mov_b64 v[70:71], 0
    v_mov_b64 v[72:73], 0
    v_mov_b64 v[74:75], 0
    v_mov_b64 v[76:77], 0
    v_mov_b64 v[78:79], 0
    v_mov_b64 v[80:81], 0
    v_mov_b64 v[82:83], 0
    v_mov_b64 v[84:85], 0
    v_mov_b64 v[86:87], 0
    s_barrier
    buffer_load_dwordx4 v[0:3], v133, s[4:7], s26 offen sc1
    s_barrier
    buffer_load_dwordx4 v133, s[4:7], s27 offen sc1 lds
    s_barrier
    buffer_store_dword v124, v140, s[4:7], s29 offen sc1
    buffer_load_dwordx4 v[104:107], v133, s[4:7], s34 offen sc1
    buffer_load_dwordx4 v[108:111], v133, s[4:7], s35 offen sc1
    buffer_load_dwordx4 v[112:115], v133, s[4:7], s36 offen sc1
    buffer_load_dwordx4 v[116:119], v133, s[4:7], s37 offen sc1
    s_branch L_tslow10_again
L_tslow10_miss:
    s_waitcnt lgkmcnt(0)
    v_max3_u32 v132, v0, v1, v2
    v_max3_u32 v130, v3, v4, v5
    v_max3_u32 v132, v132, v6, v7
    v_max_u32 v132, v132, v130
    v_cmpx_eq_u32 vcc, -1, v132
    s_cbranch_execz L_tslow10_whole
L_tslow10_reload:
    buffer_load_dwordx4 v[0:3], v133, s[4:7], s26 offen sc1
    buffer_load_dwordx4 v[4:7], v133, s[4:7], s27 offen sc1
    s_movk_i32 s3, 16
    s_sub_u32 s24, s24, 1
    s_cbranch_scc1 L_timeout
    v_max3_u32 v132, v0, v1, v2
    v_max3_u32 v130, v3, v4, v5
    v_max3_u32 v132, v132, v6, v7
    v_max_u32 v132, v132, v130
    v_cmpx_eq_u32 vcc, -1, v132
    s_cbranch_execnz L_tslow10_reload
L_tslow10_whole:
    s_mov_b64 exec, -1
    s_mov_b64 s[16:17], 0
    ds_read_b128 v[32:35], v138 offset:0
    ds_read_b128 v[36:39], v138 offset:1024
    ds_read_b128 v[40:43], v138 offset:2048
    ds_read_b128 v[44:47], v138 offset:3072
    ds_read_b128 v[48:51], v138 offset:4096
    ds_read_b128 v[52:55], v138 offset:5120
    ds_read_b128 v[56:59], v138 offset:6144
    ds_read_b128 v[60:63], v138 offset:7168
    v_mov_b64 v[64:65], 0
    v_mov_b64 v[66:67], 0
    v_mov_b64 v[68:69], 0
    v_mov_b64 v[70:71], 0
    v_mov_b64 v[72:73], 0
    v_mov_b64 v[74:75], 0
    v_mov_b64 v[76:77], 0
    v_mov_b64 v[78:79], 0
    v_mov_b64 v[80:81], 0
    v_mov_b64 v[82:83], 0
    v_mov_b64 v[84:85], 0
    v_mov_b64 v[86:87], 0
    s_waitcnt vmcnt(0)
    ds_write_b128 v133, v[4:7] offset:3072
    s_branch L_tslow10_again
L_tslow10_big:
    ds_write_b32 v133, v72 offset:13572
    s_waitcnt lgkmcnt(0)
    s_barrier
    ds_read_b128 v[60:63], v133 offset:13568
    s_waitcnt lgkmcnt(0)
    v_max3_f32 v126, v60, v61, v62
    v_max3_f32 v126, v126, v63, v124
    s_nop 1
    v_max_f32_dpp v126, v126, v126 quad_perm:[2,3,0,1] row_mask:0xf bank_mask:0xf
    v_mov_b32 v127, v126
    s_nop 1
    v_permlane16_swap_b32 v126, v127
    v_max_f32 v126, v126, v127
    v_mov_b32 v127, v126
    s_nop 1
    v_permlane32_swap_b32 v126, v127
    v_max_f32 v126, v126, v127
    v_sub_f32 v60, v60, v126
    v_exp_f32 v60, v60
    v_sub_f32 v61, v61, v126
    v_exp_f32 v61, v61
    v_sub_f32 v62, v62, v126
    v_exp_f32 v62, v62
    v_sub_f32 v63, v63, v126
    v_exp_f32 v63, v63
    v_sub_f32 v124, v124, v126
    v_exp_f32 v124, v124
    v_cvt_pk_bf16_f32 v60, v60, v61
    v_cvt_pk_bf16_f32 v61, v62, v63
    v_cvt_pk_bf16_f32 v62, v124, 0
    v_mov_b64 v[52:53], 0
    v_mov_b64 v[54:55], 0
    v_mov_b64 v[56:57], 0
    v_mov_b64 v[58:59], 0
    v_mov_b32 v63, 0
    s_nop 1
    v_mfma_f32_16x16x32_bf16 v[48:51], v[60:63], v[120:123], 0
    v_smfmac_f32_16x16x32_bf16 v[52:55], v[62:63], v[130:133], v131
    v_smfmac_f32_16x16x32_bf16 v[56:59], v[62:63], v[134:137], v131
    v_smfmac_f32_16x16x32_bf16 v[52:55], v[60:61], v[96:99], v131 abid:2
    v_smfmac_f32_16x16x32_bf16 v[56:59], v[60:61], v[100:103], v131 abid:2
    s_nop 3
    v_add_f32 v48, v48, v50
    v_add_f32 v49, v49, v51
    v_rcp_f32 v50, v48
    v_rcp_f32 v51, v49
    v_pk_add_f32 v[52:53], v[52:53], v[54:55]
    v_pk_mul_f32 v[52:53], v[52:53], v[50:51]
    v_max3_f32 v126, v48, v49, v50
    v_pk_add_f32 v[56:57], v[56:57], v[58:59]
    v_pk_mul_f32 v[56:57], v[56:57], v[50:51]
    v_cvt_pk_bf16_f32 v52, v52, v56
    v_cvt_pk_bf16_f32 v53, v53, v57
    ds_write2_b32 v141, v52, v53 offset0:0 offset1:136
    ds_read_b128 v[48:51], v142 offset:64
    v_mfma_f32_16x16x16_bf16 v[80:83], v[128:129], v[128:129], 0
    v_mfma_f32_16x16x16_bf16 v[84:87], v[128:129], v[128:129], 0
    v_mfma_f32_16x16x16_bf16 v[76:79], v[128:129], v[128:129], 0
    s_branch L_tslow10_back
L_tslow11_miss:
    s_waitcnt lgkmcnt(0)
    v_max3_u32 v132, v0, v1, v2
    v_max3_u32 v130, v3, v4, v5
    v_max3_u32 v132, v132, v6, v7
    v_max_u32 v132, v132, v130
    v_cmpx_eq_u32 vcc, -1, v132
    s_cbranch_execz L_tslow11_whole
L_tslow11_reload:
    buffer_load_dwordx4 v[0:3], v133, s[4:7], s26 offen sc1
    buffer_load_dwordx4 v[4:7], v133, s[4:7], s27 offen sc1
    s_movk_i32 s3, 16
    s_sub_u32 s24, s24, 1
    s_cbranch_scc1 L_timeout
    v_max3_u32 v132, v0, v1, v2
    v_max3_u32 v130, v3, v4, v5
    v_max3_u32 v132, v132, v6, v7
    v_max_u32 v132, v132, v130
    v_cmpx_eq_u32 vcc, -1, v132
    s_cbranch_execnz L_tslow11_reload
L_tslow11_whole:
    s_mov_b64 exec, -1
    s_mov_b64 s[16:17], 0
    ds_read_b128 v[32:35], v138 offset:0
    ds_read_b128 v[36:39], v138 offset:1024
    ds_read_b128 v[40:43], v138 offset:2048
    ds_read_b128 v[44:47], v138 offset:3072
    ds_read_b128 v[48:51], v138 offset:4096
    ds_read_b128 v[52:55], v138 offset:5120
    ds_read_b128 v[56:59], v138 offset:6144
    ds_read_b128 v[60:63], v138 offset:7168
    v_mov_b64 v[64:65], 0
    v_mov_b64 v[66:67], 0
    v_mov_b64 v[68:69], 0
    v_mov_b64 v[70:71], 0
    v_mov_b64 v[72:73], 0
    v_mov_b64 v[74:75], 0
    v_mov_b64 v[76:77], 0
    v_mov_b64 v[78:79], 0
    v_mov_b64 v[80:81], 0
    v_mov_b64 v[82:83], 0
    v_mov_b64 v[84:85], 0
    v_mov_b64 v[86:87], 0
    s_waitcnt vmcnt(0)
    ds_write_b128 v133, v[4:7] offset:3072
    s_branch L_tslow11_again
L_tslow11_big:
    ds_write_b32 v133, v72 offset:13572
    s_waitcnt lgkmcnt(0)
    s_barrier
    ds_read_b128 v[60:63], v133 offset:13568
    s_waitcnt lgkmcnt(0)
    v_max3_f32 v126, v60, v61, v62
    v_max3_f32 v126, v126, v63, v124
    s_nop 1
    v_max_f32_dpp v126, v126, v126 quad_perm:[2,3,0,1] row_mask:0xf bank_mask:0xf
    v_mov_b32 v127, v126
    s_nop 1
    v_permlane16_swap_b32 v126, v127
    v_max_f32 v126, v126, v127
    v_mov_b32 v127, v126
    s_nop 1
    v_permlane32_swap_b32 v126, v127
    v_max_f32 v126, v126, v127
    v_sub_f32 v60, v60, v126
    v_exp_f32 v60, v60
    v_sub_f32 v61, v61, v126
    v_exp_f32 v61, v61
    v_sub_f32 v62, v62, v126
    v_exp_f32 v62, v62
    v_sub_f32 v63, v63, v126
    v_exp_f32 v63, v63
    v_sub_f32 v124, v124, v126
    v_exp_f32 v124, v124
    v_cvt_pk_bf16_f32 v60, v60, v61
    v_cvt_pk_bf16_f32 v61, v62, v63
    v_cvt_pk_bf16_f32 v62, v124, 0
    v_mov_b64 v[52:53], 0
    v_mov_b64 v[54:55], 0
    v_mov_b64 v[56:57], 0
    v_mov_b64 v[58:59], 0
    v_mov_b32 v63, 0
    s_nop 1
    v_mfma_f32_16x16x32_bf16 v[48:51], v[60:63], v[120:123], 0
    v_smfmac_f32_16x16x32_bf16 v[52:55], v[62:63], v[130:133], v131
    v_smfmac_f32_16x16x32_bf16 v[56:59], v[62:63], v[134:137], v131
    v_smfmac_f32_16x16x32_bf16 v[52:55], v[60:61], v[112:115], v131 abid:2
    v_smfmac_f32_16x16x32_bf16 v[56:59], v[60:61], v[116:119], v131 abid:2
    s_nop 3
    v_add_f32 v48, v48, v50
    v_add_f32 v49, v49, v51
    v_rcp_f32 v50, v48
    v_rcp_f32 v51, v49
    v_pk_add_f32 v[52:53], v[52:53], v[54:55]
    v_pk_mul_f32 v[52:53], v[52:53], v[50:51]
    v_max3_f32 v126, v48, v49, v50
    v_pk_add_f32 v[56:57], v[56:57], v[58:59]
    v_pk_mul_f32 v[56:57], v[56:57], v[50:51]
    v_cvt_pk_bf16_f32 v52, v52, v56
    v_cvt_pk_bf16_f32 v53, v53, v57
    ds_write2_b32 v141, v52, v53 offset0:0 offset1:136
    ds_read_b128 v[48:51], v142 offset:64
    v_mfma_f32_16x16x16_bf16 v[80:83], v[128:129], v[128:129], 0
    v_mfma_f32_16x16x16_bf16 v[84:87], v[128:129], v[128:129], 0
    v_mfma_f32_16x16x16_bf16 v[76:79], v[128:129], v[128:129], 0
    s_branch L_tslow11_back
.p2align 6
L_tslow20_again:
    s_waitcnt vmcnt(6) lgkmcnt(0)
    v_smfmac_f32_16x16x64_bf16 v[72:75], v[0:3], v[32:39], v131 abid:1
    ds_write_b128 v133, v[0:3] offset:4096
    v_smfmac_f32_16x16x64_bf16 v[76:79], v[0:3], v[40:47], v131 abid:1
    v_smfmac_f32_16x16x64_bf16 v[80:83], v[0:3], a[24:31], v131 abid:1
    v_smfmac_f32_16x16x64_bf16 v[84:87], v[0:3], a[64:71], v131 abid:1
    s_waitcnt vmcnt(5)
    ds_read_b128 v[4:7], v133 offset:5120
    v_smfmac_f32_16x16x64_bf16 v[64:67], v[0:3], a[128:135], v131 abid:1
    v_smfmac_f32_16x16x64_bf16 v[68:71], v[0:3], a[192:199], v131 abid:1
    s_waitcnt lgkmcnt(1)
    s_barrier
    s_waitcnt lgkmcnt(0)
    v_smfmac_f32_16x16x64_bf16 v[72:75], v[4:7], v[48:55], v131 abid:1
    ds_read_b128 v[8:11], v133 offset:6144
    v_smfmac_f32_16x16x64_bf16 v[76:79], v[4:7], v[56:63], v131 abid:1
    ds_read_b128 v[12:15], v133 offset:7168
    v_smfmac_f32_16x16x64_bf16 v[80:83], v[4:7], a[32:39], v131 abid:1
    ds_read_b128 v[16:19], v133 offset:0
    v_smfmac_f32_16x16x64_bf16 v[84:87], v[4:7], a[72:79], v131 abid:1
    ds_read_b128 v[20:23], v133 offset:1024
    s_waitcnt lgkmcnt(3)
    v_smfmac_f32_16x16x64_bf16 v[72:75], v[8:11], v[192:199], v131 abid:1
    ds_read_b128 v[24:27], v133 offset:2048
    v_smfmac_f32_16x16x64_bf16 v[76:79], v[8:11], v[240:247], v131 abid:1
    ds_read_b128 v[28:31], v133 offset:3072
    s_waitcnt lgkmcnt(4)
    v_smfmac_f32_16x16x64_bf16 v[72:75], v[12:15], v[200:207], v131 abid:1
    ds_read_b128 v[32:35], v138 offset:8192
    v_smfmac_f32_16x16x64_bf16 v[76:79], v[12:15], v[248:255], v131 abid:1
    ds_read_b128 v[36:39], v138 offset:9216
    s_waitcnt lgkmcnt(5)
    v_smfmac_f32_16x16x64_bf16 v[72:75], v[16:19], v[208:215], v131 abid:1
    ds_read_b128 v[40:43], v138 offset:10240
    s_waitcnt lgkmcnt(5)
    v_smfmac_f32_16x16x64_bf16 v[72:75], v[20:23], v[216:223], v131 abid:1
    ds_read_b128 v[44:47], v138 offset:11264
    s_waitcnt lgkmcnt(5)
    v_smfmac_f32_16x16x64_bf16 v[72:75], v[24:27], v[224:231], v131 abid:1
    ds_read_b128 v[48:51], v138 offset:12288
    s_waitcnt lgkmcnt(5)
    v_smfmac_f32_16x16x64_bf16 v[72:75], v[28:31], v[232:239], v131 abid:1
    s_nop 1
    ds_read_b128 v[52:55], v138 offset:13312
    v_smfmac_f32_16x16x64_bf16 v[76:79], v[16:19], a[0:7], v131 abid:1
    s_nop 1
    ds_read_b128 v[56:59], v138 offset:14336
    v_smfmac_f32_16x16x64_bf16 v[76:79], v[20:23], a[8:15], v131 abid:1
    ds_read_b128 v[60:63], v138 offset:15360
    v_add_f32 v72, v72, v74
    v_smfmac_f32_16x16x64_bf16 v[76:79], v[24:27], a[16:23], v131 abid:1
    s_waitcnt lgkmcnt(3)
    v_add_f32 v73, v73, v75
    v_smfmac_f32_16x16x64_bf16 v[76:79], v[28:31], v[32:39], v131 abid:1
    s_nop 2
    v_smfmac_f32_16x16x64_bf16 v[80:83], v[8:11], a[40:47], v131 abid:1
    s_nop 1
    v_cmp_u_f32 vcc, v72, v73
    v_smfmac_f32_16x16x64_bf16 v[80:83], v[12:15], v[40:47], v131 abid:1
    v_add_f32 v76, v76, v78
    v_add_f32 v77, v77, v79
    v_smfmac_f32_16x16x64_bf16 v[80:83], v[16:19], a[48:55], v131 abid:1
    s_waitcnt lgkmcnt(1)
    v_cvt_pk_bf16_f32 v76, v72, v76
    v_cvt_pk_bf16_f32 v77, v73, v77
    v_smfmac_f32_16x16x64_bf16 v[80:83], v[20:23], v[48:55], v131 abid:1
    ds_write2_b32 v141, v76, v77 offset0:0 offset1:136
    v_smfmac_f32_16x16x64_bf16 v[80:83], v[24:27], a[56:63], v131 abid:1
    s_waitcnt lgkmcnt(1)
    v_mov_b64 v[52:53], 0
    v_smfmac_f32_16x16x64_bf16 v[80:83], v[28:31], v[56:63], v131 abid:1
    s_nop 1
    v_mov_b64 v[54:55], 0
    v_smfmac_f32_16x16x64_bf16 v[84:87], v[8:11], a[80:87], v131 abid:1
    s_nop 1
    v_mov_b64 v[56:57], 0
    v_smfmac_f32_16x16x64_bf16 v[84:87], v[12:15], a[88:95], v131 abid:1
    s_and_b64 vcc, vcc, s[16:17]
    v_add_f32 v80, v80, v82
    v_smfmac_f32_16x16x64_bf16 v[84:87], v[16:19], a[96:103], v131 abid:1
    s_waitcnt lgkmcnt(0)
    s_barrier
    v_smfmac_f32_16x16x64_bf16 v[84:87], v[20:23], a[104:111], v131 abid:1
    ds_read_b128 v[32:35], v137 offset:0
    v_add_f32 v81, v81, v83
    v_smfmac_f32_16x16x64_bf16 v[84:87], v[24:27], a[112:119], v131 abid:1
    ds_read_b128 v[36:39], v137 offset:64
    v_mov_b64 v[58:59], 0
    v_smfmac_f32_16x16x64_bf16 v[84:87], v[28:31], a[120:127], v131 abid:1
    s_cbranch_scc1 L_tslow20_miss
    s_add_u32 s26, s28, s54
    v_smfmac_f32_16x16x64_bf16 v[64:67], v[4:7], a[136:143], v131 abid:1
    s_add_u32 s25, s25, 1
    s_add_u32 s27, s28, s55
    s_waitcnt lgkmcnt(1)
    v_mfma_f32_16x16x32_bf16 v[72:75], v[88:91], v[32:35], 0
    s_waitcnt lgkmcnt(0)
    v_add_f32 v84, v84, v86
    v_add_f32 v85, v85, v87
    v_mfma_f32_16x16x32_bf16 v[72:75], v[92:95], v[36:39], v[72:75]
    s_nop 0
    v_cvt_pk_bf16_f32 v84, v80, v84
    v_cvt_pk_bf16_f32 v85, v81, v85
    v_smfmac_f32_16x16x64_bf16 v[64:67], v[8:11], a[144:151], v131 abid:1
    ds_write2_b32 v141, v84, v85 offset0:64 offset1:200
    v_smfmac_f32_16x16x64_bf16 v[64:67], v[12:15], a[152:159], v131 abid:1
    s_nop 1
    v_cndmask_b32 v73, v73, v74, s[58:59]
    v_cndmask_b32 v72, v72, v75, s[58:59]
    v_smfmac_f32_16x16x64_bf16 v[64:67], v[16:19], a[160:167], v131 abid:1
    ds_read_b128 v[88:91], v138 offset:16384
    v_add_f32_dpp v72, v73, v72 quad_perm:[2,3,0,1] row_mask:0xf bank_mask:0xf
    v_mul_f32 v72, s56, v72
    v_smfmac_f32_16x16x64_bf16 v[64:67], v[20:23], a[168:175], v131 abid:1
    ds_read_b128 v[92:95], v138 offset:17408
    v_exp_f32 v73, v72
    v_smfmac_f32_16x16x64_bf16 v[64:67], v[24:27], a[176:183], v131 abid:1
    ds_write_b32 v133, v73 offset:12552
    v_smfmac_f32_16x16x64_bf16 v[64:67], v[28:31], a[184:191], v131 abid:1
    s_waitcnt lgkmcnt(3)
    s_barrier
    v_smfmac_f32_16x16x64_bf16 v[68:71], v[4:7], a[200:207], v131 abid:1
    ds_read_b128 v[40:43], v137 offset:256
    v_mov_b32 v63, 0
    v_smfmac_f32_16x16x64_bf16 v[68:71], v[8:11], a[208:215], v131 abid:1
    ds_read_b128 v[44:47], v137 offset:320
    v_smfmac_f32_16x16x64_bf16 v[68:71], v[12:15], a[216:223], v131 abid:1
    ds_read_b128 v[0:3], v138 offset:18432
    v_add_f32 v64, v64, v66
    v_smfmac_f32_16x16x64_bf16 v[68:71], v[16:19], a[224:231], v131 abid:1
    s_waitcnt lgkmcnt(3)
    s_barrier
    s_waitcnt lgkmcnt(2)
    v_mfma_f32_16x16x32_bf16 v[124:127], v[40:43], v[32:35], 0
    ds_read_b128 v[80:83], v133 offset:12544
    s_waitcnt lgkmcnt(2)
    v_mfma_f32_16x16x32_bf16 v[124:127], v[44:47], v[36:39], v[124:127]
    s_nop 0
    v_add_f32 v65, v65, v67
    v_cvt_pk_bf16_f32 v130, v64, v65
    v_smfmac_f32_16x16x64_bf16 v[68:71], v[20:23], a[232:239], v131 abid:1
    ds_read_b128 v[4:7], v138 offset:19456
    ds_read_b128 v[8:11], v138 offset:20480
    v_smfmac_f32_16x16x64_bf16 v[68:71], v[24:27], a[240:247], v131 abid:1
    ds_read_b128 v[12:15], v138 offset:21504
    v_cndmask_b32 v125, v125, v126, s[58:59]
    v_cndmask_b32 v124, v124, v127, s[58:59]
    v_smfmac_f32_16x16x64_bf16 v[68:71], v[28:31], a[248:255], v131 abid:1
    s_waitcnt lgkmcnt(3)
    v_cvt_pk_bf16_f32 v60, v80, v81
    v_cvt_pk_bf16_f32 v61, v82, v83
    v_add_f32_dpp v124, v125, v124 quad_perm:[2,3,0,1] row_mask:0xf bank_mask:0xf
    v_mul_f32 v124, s56, v124
    v_smfmac_f32_16x16x32_bf16 v[52:55], v[60:61], v[96:99], v131 abid:2
    v_exp_f32 v125, v124
    v_smfmac_f32_16x16x32_bf16 v[56:59], v[60:61], v[100:103], v131 abid:2
    v_cvt_pk_bf16_f32 v62, v125, 0
    v_add_f32 v68, v68, v70
    v_add_f32 v69, v69, v71
    v_mfma_f32_16x16x32_bf16 v[48:51], v[60:63], v[120:123], 0
    ds_read_b128 v[32:35], v138 offset:22528
    v_cvt_pk_bf16_f32 v134, v68, v69
    v_smfmac_f32_16x16x32_bf16 v[52:55], v[62:63], v[130:133], v131
    s_nop 0
    ds_read_b128 v[36:39], v138 offset:23552
    ds_read_b128 v[40:43], v138 offset:24576
    v_smfmac_f32_16x16x32_bf16 v[56:59], v[62:63], v[134:137], v131
    s_nop 0
    v_add_f32 v48, v48, v50
    v_add_f32 v49, v49, v51
    v_rcp_f32 v50, v48
    v_rcp_f32 v51, v49
    v_pk_add_f32 v[52:53], v[52:53], v[54:55]
    v_pk_mul_f32 v[52:53], v[52:53], v[50:51]
    v_max3_f32 v126, v48, v49, v50
    v_pk_add_f32 v[56:57], v[56:57], v[58:59]
    v_pk_mul_f32 v[56:57], v[56:57], v[50:51]
    v_cvt_pk_bf16_f32 v52, v52, v56
    v_cvt_pk_bf16_f32 v53, v53, v57
    v_mfma_f32_16x16x16_bf16 v[80:83], v[128:129], v[128:129], 0
    ds_write2_b32 v141, v52, v53 offset0:0 offset1:136
    v_mfma_f32_16x16x16_bf16 v[84:87], v[128:129], v[128:129], 0
    v_max_f32 v126, v126, v51
    v_cmp_nge_f32 vcc, 0x4f800000, v126
    v_mfma_f32_16x16x16_bf16 v[76:79], v[128:129], v[128:129], 0
    ds_read_b128 v[48:51], v142 offset:128
    s_cbranch_vccnz L_tslow20_big
L_tslow20_back:
    v_mfma_f32_16x16x16_bf16 v[72:75], v[128:129], v[128:129], 0
    s_waitcnt lgkmcnt(1)
    s_barrier
    ds_read_b128 v[52:55], v142 offset:192
    s_waitcnt lgkmcnt(1)
    v_smfmac_f32_16x16x64_bf16 v[80:83], v[48:51], v[88:95], v131 abid:1
    ds_read_b128 v[56:59], v142 offset:0
    v_smfmac_f32_16x16x64_bf16 v[84:87], v[48:51], v[0:7], v131 abid:1
    ds_read_b128 v[60:63], v142 offset:64
    v_smfmac_f32_16x16x64_bf16 v[76:79], v[48:51], v[8:15], v131 abid:1
    ds_read_b128 v[44:47], v138 offset:25600
    s_waitcnt lgkmcnt(3)
    v_smfmac_f32_16x16x64_bf16 v[80:83], v[52:55], v[144:151], v131 abid:1
    ds_read_b128 v[16:19], v138 offset:26624
    s_waitcnt lgkmcnt(3)
    v_smfmac_f32_16x16x64_bf16 v[80:83], v[56:59], v[152:159], v131 abid:1
    ds_read_b128 v[20:23], v138 offset:27648
    s_waitcnt lgkmcnt(3)
    v_smfmac_f32_16x16x64_bf16 v[80:83], v[60:63], v[160:167], v131 abid:1
    s_nop 1
    ds_read_b128 v[24:27], v138 offset:28672
    v_smfmac_f32_16x16x64_bf16 v[84:87], v[52:55], v[32:39], v131 abid:1
    ds_read_b128 v[28:31], v138 offset:29696
    s_waitcnt lgkmcnt(4)
    v_smfmac_f32_16x16x64_bf16 v[84:87], v[56:59], v[40:47], v131 abid:1
    ds_read_b128 v[64:67], v138 offset:30720
    v_cvt_pk_bf16_f32 v80, v80, v82
    v_cvt_pk_bf16_f32 v81, v81, v83
    v_and_b32 v80, -2, v80
    v_smfmac_f32_16x16x64_bf16 v[84:87], v[60:63], v[168:175], v131 abid:1
    buffer_store_dwordx2 v[80:81], v139, s[4:7], s30 offen sc1
    ds_read_b128 v[68:71], v138 offset:31744
    s_waitcnt lgkmcnt(4)
    v_smfmac_f32_16x16x64_bf16 v[76:79], v[52:55], v[16:23], v131 abid:1
    ds_read_b128 v[0:3], v138 offset:32768
    s_waitcnt lgkmcnt(3)
    v_smfmac_f32_16x16x64_bf16 v[76:79], v[56:59], v[176:183], v131 abid:1
    ds_read_b128 v[4:7], v138 offset:33792
    v_cvt_pk_bf16_f32 v84, v84, v86
    v_cvt_pk_bf16_f32 v85, v85, v87
    v_and_b32 v84, -2, v84
    v_smfmac_f32_16x16x64_bf16 v[76:79], v[60:63], v[24:31], v131 abid:1
    buffer_store_dwordx2 v[84:85], v139, s[4:7], s31 offen sc1
    ds_read_b128 v[8:11], v138 offset:34816
    s_nop 0
    v_smfmac_f32_16x16x64_bf16 v[72:75], v[48:51], v[184:191], v131 abid:1
    ds_read_b128 v[12:15], v138 offset:35840
    s_waitcnt lgkmcnt(4)
    v_smfmac_f32_16x16x64_bf16 v[72:75], v[52:55], v[64:71], v131 abid:1
    s_waitcnt lgkmcnt(2)
    v_cvt_pk_bf16_f32 v76, v76, v78
    v_cvt_pk_bf16_f32 v77, v77, v79
    v_and_b32 v76, -2, v76
    v_smfmac_f32_16x16x64_bf16 v[72:75], v[56:59], v[0:7], v131 abid:1
    buffer_store_dwordx2 v[76:77], v139, s[4:7], s32 offen sc1
    s_waitcnt lgkmcnt(0)
    v_smfmac_f32_16x16x64_bf16 v[72:75], v[60:63], v[8:15], v131 abid:1
    s_nop 7
    v_cvt_pk_bf16_f32 v72, v72, v74
    v_cvt_pk_bf16_f32 v73, v73, v75
    v_and_b32 v72, -2, v72
    buffer_store_dwordx2 v[72:73], v139, s[4:7], s33 offen sc1
    s_cmp_eq_u32 s25, 63
    s_cbranch_scc1 L_end
    s_barrier
    v_mov_b64 v[64:65], 0
    v_mov_b64 v[66:67], 0
    v_mov_b64 v[68:69], 0
    v_mov_b64 v[70:71], 0
    v_mov_b64 v[72:73], 0
    v_mov_b64 v[74:75], 0
    v_mov_b64 v[76:77], 0
    v_mov_b64 v[78:79], 0
    v_mov_b64 v[80:81], 0
    v_mov_b64 v[82:83], 0
    v_mov_b64 v[84:85], 0
    v_mov_b64 v[86:87], 0
    ds_read_b128 v[32:35], v138 offset:0
    ds_read_b128 v[36:39], v138 offset:1024
    ds_read_b128 v[40:43], v138 offset:2048
    ds_read_b128 v[44:47], v138 offset:3072
    ds_read_b128 v[48:51], v138 offset:4096
    ds_read_b128 v[52:55], v138 offset:5120
    ds_read_b128 v[56:59], v138 offset:6144
    ds_read_b128 v[60:63], v138 offset:7168
    s_cmp_lt_u32 s25, 62
    s_cselect_b32 s57, 0x80000, 0
    s_add_u32 s34, s34, s57
    s_add_u32 s35, s35, s57
    s_add_u32 s36, s36, s57
    s_add_u32 s37, s37, s57
    s_mov_b32 s28, s29
    s_add_u32 s29, s29, 0x2000
    s_bitset0_b32 s29, 15
    s_mov_b64 s[16:17], -1
    s_waitcnt vmcnt(4)
    v_cmp_ne_u32 vcc, 0x1010101, v143
    s_cbranch_vccnz L_tslow20_noflag
L_tslow20_flag:
    s_cmp_lt_u32 s25, 61
    s_cselect_b32 s57, 4, 0
    s_add_u32 s51, s51, s57
    s_barrier
    buffer_load_dwordx4 v[0:3], v133, s[4:7], s26 offen sc1
    s_barrier
    buffer_load_dwordx4 v133, s[4:7], s27 offen sc1 lds
    s_barrier
    buffer_load_dword v143, v129, s[4:7], s51 offen sc1
    buffer_load_dwordx4 v[88:91], v133, s[4:7], s34 offen sc1
    buffer_load_dwordx4 v[92:95], v133, s[4:7], s35 offen sc1
    buffer_load_dwordx4 v[96:99], v133, s[4:7], s36 offen sc1
    buffer_load_dwordx4 v[100:103], v133, s[4:7], s37 offen sc1
L_tslow21_again:
    s_waitcnt vmcnt(6) lgkmcnt(0)
    v_smfmac_f32_16x16x64_bf16 v[72:75], v[0:3], v[32:39], v131 abid:1
    ds_write_b128 v133, v[0:3] offset:4096
    v_smfmac_f32_16x16x64_bf16 v[76:79], v[0:3], v[40:47], v131 abid:1
    v_smfmac_f32_16x16x64_bf16 v[80:83], v[0:3], a[24:31], v131 abid:1
    v_smfmac_f32_16x16x64_bf16 v[84:87], v[0:3], a[64:71], v131 abid:1
    s_waitcnt vmcnt(5)
    ds_read_b128 v[4:7], v133 offset:5120
    v_smfmac_f32_16x16x64_bf16 v[64:67], v[0:3], a[128:135], v131 abid:1
    v_smfmac_f32_16x16x64_bf16 v[68:71], v[0:3], a[192:199], v131 abid:1
    s_waitcnt lgkmcnt(1)
    s_barrier
    s_waitcnt lgkmcnt(0)
    v_smfmac_f32_16x16x64_bf16 v[72:75], v[4:7], v[48:55], v131 abid:1
    ds_read_b128 v[8:11], v133 offset:6144
    v_smfmac_f32_16x16x64_bf16 v[76:79], v[4:7], v[56:63], v131 abid:1
    ds_read_b128 v[12:15], v133 offset:7168
    v_smfmac_f32_16x16x64_bf16 v[80:83], v[4:7], a[32:39], v131 abid:1
    ds_read_b128 v[16:19], v133 offset:0
    v_smfmac_f32_16x16x64_bf16 v[84:87], v[4:7], a[72:79], v131 abid:1
    ds_read_b128 v[20:23], v133 offset:1024
    s_waitcnt lgkmcnt(3)
    v_smfmac_f32_16x16x64_bf16 v[72:75], v[8:11], v[192:199], v131 abid:1
    ds_read_b128 v[24:27], v133 offset:2048
    v_smfmac_f32_16x16x64_bf16 v[76:79], v[8:11], v[240:247], v131 abid:1
    ds_read_b128 v[28:31], v133 offset:3072
    s_waitcnt lgkmcnt(4)
    v_smfmac_f32_16x16x64_bf16 v[72:75], v[12:15], v[200:207], v131 abid:1
    ds_read_b128 v[32:35], v138 offset:8192
    v_smfmac_f32_16x16x64_bf16 v[76:79], v[12:15], v[248:255], v131 abid:1
    ds_read_b128 v[36:39], v138 offset:9216
    s_waitcnt lgkmcnt(5)
    v_smfmac_f32_16x16x64_bf16 v[72:75], v[16:19], v[208:215], v131 abid:1
    ds_read_b128 v[40:43], v138 offset:10240
    s_waitcnt lgkmcnt(5)
    v_smfmac_f32_16x16x64_bf16 v[72:75], v[20:23], v[216:223], v131 abid:1
    ds_read_b128 v[44:47], v138 offset:11264
    s_waitcnt lgkmcnt(5)
    v_smfmac_f32_16x16x64_bf16 v[72:75], v[24:27], v[224:231], v131 abid:1
    ds_read_b128 v[48:51], v138 offset:12288
    s_waitcnt lgkmcnt(5)
    v_smfmac_f32_16x16x64_bf16 v[72:75], v[28:31], v[232:239], v131 abid:1
    s_nop 1
    ds_read_b128 v[52:55], v138 offset:13312
    v_smfmac_f32_16x16x64_bf16 v[76:79], v[16:19], a[0:7], v131 abid:1
    s_nop 1
    ds_read_b128 v[56:59], v138 offset:14336
    v_smfmac_f32_16x16x64_bf16 v[76:79], v[20:23], a[8:15], v131 abid:1
    ds_read_b128 v[60:63], v138 offset:15360
    v_add_f32 v72, v72, v74
    v_smfmac_f32_16x16x64_bf16 v[76:79], v[24:27], a[16:23], v131 abid:1
    s_waitcnt lgkmcnt(3)
    v_add_f32 v73, v73, v75
    v_smfmac_f32_16x16x64_bf16 v[76:79], v[28:31], v[32:39], v131 abid:1
    s_nop 2
    v_smfmac_f32_16x16x64_bf16 v[80:83], v[8:11], a[40:47], v131 abid:1
    s_nop 1
    v_cmp_u_f32 vcc, v72, v73
    v_smfmac_f32_16x16x64_bf16 v[80:83], v[12:15], v[40:47], v131 abid:1
    v_add_f32 v76, v76, v78
    v_add_f32 v77, v77, v79
    v_smfmac_f32_16x16x64_bf16 v[80:83], v[16:19], a[48:55], v131 abid:1
    s_waitcnt lgkmcnt(1)
    v_cvt_pk_bf16_f32 v76, v72, v76
    v_cvt_pk_bf16_f32 v77, v73, v77
    v_smfmac_f32_16x16x64_bf16 v[80:83], v[20:23], v[48:55], v131 abid:1
    ds_write2_b32 v141, v76, v77 offset0:0 offset1:136
    v_smfmac_f32_16x16x64_bf16 v[80:83], v[24:27], a[56:63], v131 abid:1
    s_waitcnt lgkmcnt(1)
    v_mov_b64 v[52:53], 0
    v_smfmac_f32_16x16x64_bf16 v[80:83], v[28:31], v[56:63], v131 abid:1
    s_nop 1
    v_mov_b64 v[54:55], 0
    v_smfmac_f32_16x16x64_bf16 v[84:87], v[8:11], a[80:87], v131 abid:1
    s_nop 1
    v_mov_b64 v[56:57], 0
    v_smfmac_f32_16x16x64_bf16 v[84:87], v[12:15], a[88:95], v131 abid:1
    s_and_b64 vcc, vcc, s[16:17]
    v_add_f32 v80, v80, v82
    v_smfmac_f32_16x16x64_bf16 v[84:87], v[16:19], a[96:103], v131 abid:1
    s_waitcnt lgkmcnt(0)
    s_barrier
    v_smfmac_f32_16x16x64_bf16 v[84:87], v[20:23], a[104:111], v131 abid:1
    ds_read_b128 v[32:35], v137 offset:0
    v_add_f32 v81, v81, v83
    v_smfmac_f32_16x16x64_bf16 v[84:87], v[24:27], a[112:119], v131 abid:1
    ds_read_b128 v[36:39], v137 offset:64
    v_mov_b64 v[58:59], 0
    v_smfmac_f32_16x16x64_bf16 v[84:87], v[28:31], a[120:127], v131 abid:1
    s_cbranch_scc1 L_tslow21_miss
    s_add_u32 s26, s28, s54
    v_smfmac_f32_16x16x64_bf16 v[64:67], v[4:7], a[136:143], v131 abid:1
    s_add_u32 s25, s25, 1
    s_add_u32 s27, s28, s55
    s_waitcnt lgkmcnt(1)
    v_mfma_f32_16x16x32_bf16 v[72:75], v[104:107], v[32:35], 0
    s_waitcnt lgkmcnt(0)
    v_add_f32 v84, v84, v86
    v_add_f32 v85, v85, v87
    v_mfma_f32_16x16x32_bf16 v[72:75], v[108:111], v[36:39], v[72:75]
    s_nop 0
    v_cvt_pk_bf16_f32 v84, v80, v84
    v_cvt_pk_bf16_f32 v85, v81, v85
    v_smfmac_f32_16x16x64_bf16 v[64:67], v[8:11], a[144:151], v131 abid:1
    ds_write2_b32 v141, v84, v85 offset0:64 offset1:200
    v_smfmac_f32_16x16x64_bf16 v[64:67], v[12:15], a[152:159], v131 abid:1
    s_nop 1
    v_cndmask_b32 v73, v73, v74, s[58:59]
    v_cndmask_b32 v72, v72, v75, s[58:59]
    v_smfmac_f32_16x16x64_bf16 v[64:67], v[16:19], a[160:167], v131 abid:1
    ds_read_b128 v[104:107], v138 offset:16384
    v_add_f32_dpp v72, v73, v72 quad_perm:[2,3,0,1] row_mask:0xf bank_mask:0xf
    v_mul_f32 v72, s56, v72
    v_smfmac_f32_16x16x64_bf16 v[64:67], v[20:23], a[168:175], v131 abid:1
    ds_read_b128 v[108:111], v138 offset:17408
    v_exp_f32 v73, v72
    v_smfmac_f32_16x16x64_bf16 v[64:67], v[24:27], a[176:183], v131 abid:1
    ds_write_b32 v133, v73 offset:12552
    v_smfmac_f32_16x16x64_bf16 v[64:67], v[28:31], a[184:191], v131 abid:1
    s_waitcnt lgkmcnt(3)
    s_barrier
    v_smfmac_f32_16x16x64_bf16 v[68:71], v[4:7], a[200:207], v131 abid:1
    ds_read_b128 v[40:43], v137 offset:256
    v_mov_b32 v63, 0
    v_smfmac_f32_16x16x64_bf16 v[68:71], v[8:11], a[208:215], v131 abid:1
    ds_read_b128 v[44:47], v137 offset:320
    v_smfmac_f32_16x16x64_bf16 v[68:71], v[12:15], a[216:223], v131 abid:1
    ds_read_b128 v[0:3], v138 offset:18432
    v_add_f32 v64, v64, v66
    v_smfmac_f32_16x16x64_bf16 v[68:71], v[16:19], a[224:231], v131 abid:1
    s_waitcnt lgkmcnt(3)
    s_barrier
    s_waitcnt lgkmcnt(2)
    v_mfma_f32_16x16x32_bf16 v[124:127], v[40:43], v[32:35], 0
    ds_read_b128 v[80:83], v133 offset:12544
    s_waitcnt lgkmcnt(2)
    v_mfma_f32_16x16x32_bf16 v[124:127], v[44:47], v[36:39], v[124:127]
    s_nop 0
    v_add_f32 v65, v65, v67
    v_cvt_pk_bf16_f32 v130, v64, v65
    v_smfmac_f32_16x16x64_bf16 v[68:71], v[20:23], a[232:239], v131 abid:1
    ds_read_b128 v[4:7], v138 offset:19456
    ds_read_b128 v[8:11], v138 offset:20480
    v_smfmac_f32_16x16x64_bf16 v[68:71], v[24:27], a[240:247], v131 abid:1
    ds_read_b128 v[12:15], v138 offset:21504
    v_cndmask_b32 v125, v125, v126, s[58:59]
    v_cndmask_b32 v124, v124, v127, s[58:59]
    v_smfmac_f32_16x16x64_bf16 v[68:71], v[28:31], a[248:255], v131 abid:1
    s_waitcnt lgkmcnt(3)
    v_cvt_pk_bf16_f32 v60, v80, v81
    v_cvt_pk_bf16_f32 v61, v82, v83
    v_add_f32_dpp v124, v125, v124 quad_perm:[2,3,0,1] row_mask:0xf bank_mask:0xf
    v_mul_f32 v124, s56, v124
    v_smfmac_f32_16x16x32_bf16 v[52:55], v[60:61], v[112:115], v131 abid:2
    v_exp_f32 v125, v124
    v_smfmac_f32_16x16x32_bf16 v[56:59], v[60:61], v[116:119], v131 abid:2
    v_cvt_pk_bf16_f32 v62, v125, 0
    v_add_f32 v68, v68, v70
    v_add_f32 v69, v69, v71
    v_mfma_f32_16x16x32_bf16 v[48:51], v[60:63], v[120:123], 0
    ds_read_b128 v[32:35], v138 offset:22528
    v_cvt_pk_bf16_f32 v134, v68, v69
    v_smfmac_f32_16x16x32_bf16 v[52:55], v[62:63], v[130:133], v131
    s_nop 0
    ds_read_b128 v[36:39], v138 offset:23552
    ds_read_b128 v[40:43], v138 offset:24576
    v_smfmac_f32_16x16x32_bf16 v[56:59], v[62:63], v[134:137], v131
    s_nop 0
    v_add_f32 v48, v48, v50
    v_add_f32 v49, v49, v51
    v_rcp_f32 v50, v48
    v_rcp_f32 v51, v49
    v_pk_add_f32 v[52:53], v[52:53], v[54:55]
    v_pk_mul_f32 v[52:53], v[52:53], v[50:51]
    v_max3_f32 v126, v48, v49, v50
    v_pk_add_f32 v[56:57], v[56:57], v[58:59]
    v_pk_mul_f32 v[56:57], v[56:57], v[50:51]
    v_cvt_pk_bf16_f32 v52, v52, v56
    v_cvt_pk_bf16_f32 v53, v53, v57
    v_mfma_f32_16x16x16_bf16 v[80:83], v[128:129], v[128:129], 0
    ds_write2_b32 v141, v52, v53 offset0:0 offset1:136
    v_mfma_f32_16x16x16_bf16 v[84:87], v[128:129], v[128:129], 0
    v_max_f32 v126, v126, v51
    v_cmp_nge_f32 vcc, 0x4f800000, v126
    v_mfma_f32_16x16x16_bf16 v[76:79], v[128:129], v[128:129], 0
    ds_read_b128 v[48:51], v142 offset:128
    s_cbranch_vccnz L_tslow21_big
L_tslow21_back:
    v_mfma_f32_16x16x16_bf16 v[72:75], v[128:129], v[128:129], 0
    s_waitcnt lgkmcnt(1)
    s_barrier
    ds_read_b128 v[52:55], v142 offset:192
    s_waitcnt lgkmcnt(1)
    v_smfmac_f32_16x16x64_bf16 v[80:83], v[48:51], v[104:111], v131 abid:1
    ds_read_b128 v[56:59], v142 offset:0
    v_smfmac_f32_16x16x64_bf16 v[84:87], v[48:51], v[0:7], v131 abid:1
    ds_read_b128 v[60:63], v142 offset:64
    v_smfmac_f32_16x16x64_bf16 v[76:79], v[48:51], v[8:15], v131 abid:1
    ds_read_b128 v[44:47], v138 offset:25600
    s_waitcnt lgkmcnt(3)
    v_smfmac_f32_16x16x64_bf16 v[80:83], v[52:55], v[144:151], v131 abid:1
    ds_read_b128 v[16:19], v138 offset:26624
    s_waitcnt lgkmcnt(3)
    v_smfmac_f32_16x16x64_bf16 v[80:83], v[56:59], v[152:159], v131 abid:1
    ds_read_b128 v[20:23], v138 offset:27648
    s_waitcnt lgkmcnt(3)
    v_smfmac_f32_16x16x64_bf16 v[80:83], v[60:63], v[160:167], v131 abid:1
    s_nop 1
    ds_read_b128 v[24:27], v138 offset:28672
    v_smfmac_f32_16x16x64_bf16 v[84:87], v[52:55], v[32:39], v131 abid:1
    ds_read_b128 v[28:31], v138 offset:29696
    s_waitcnt lgkmcnt(4)
    v_smfmac_f32_16x16x64_bf16 v[84:87], v[56:59], v[40:47], v131 abid:1
    ds_read_b128 v[64:67], v138 offset:30720
    v_cvt_pk_bf16_f32 v80, v80, v82
    v_cvt_pk_bf16_f32 v81, v81, v83
    v_or_b32 v80, 1, v80
    v_smfmac_f32_16x16x64_bf16 v[84:87], v[60:63], v[168:175], v131 abid:1
    buffer_store_dwordx2 v[80:81], v139, s[4:7], s30 offen sc1
    ds_read_b128 v[68:71], v138 offset:31744
    s_waitcnt lgkmcnt(4)
    v_smfmac_f32_16x16x64_bf16 v[76:79], v[52:55], v[16:23], v131 abid:1
    ds_read_b128 v[0:3], v138 offset:32768
    s_waitcnt lgkmcnt(3)
    v_smfmac_f32_16x16x64_bf16 v[76:79], v[56:59], v[176:183], v131 abid:1
    ds_read_b128 v[4:7], v138 offset:33792
    v_cvt_pk_bf16_f32 v84, v84, v86
    v_cvt_pk_bf16_f32 v85, v85, v87
    v_or_b32 v84, 1, v84
    v_smfmac_f32_16x16x64_bf16 v[76:79], v[60:63], v[24:31], v131 abid:1
    buffer_store_dwordx2 v[84:85], v139, s[4:7], s31 offen sc1
    ds_read_b128 v[8:11], v138 offset:34816
    s_nop 0
    v_smfmac_f32_16x16x64_bf16 v[72:75], v[48:51], v[184:191], v131 abid:1
    ds_read_b128 v[12:15], v138 offset:35840
    s_waitcnt lgkmcnt(4)
    v_smfmac_f32_16x16x64_bf16 v[72:75], v[52:55], v[64:71], v131 abid:1
    s_waitcnt lgkmcnt(2)
    v_cvt_pk_bf16_f32 v76, v76, v78
    v_cvt_pk_bf16_f32 v77, v77, v79
    v_or_b32 v76, 1, v76
    v_smfmac_f32_16x16x64_bf16 v[72:75], v[56:59], v[0:7], v131 abid:1
    buffer_store_dwordx2 v[76:77], v139, s[4:7], s32 offen sc1
    s_waitcnt lgkmcnt(0)
    v_smfmac_f32_16x16x64_bf16 v[72:75], v[60:63], v[8:15], v131 abid:1
    s_nop 7
    v_cvt_pk_bf16_f32 v72, v72, v74
    v_cvt_pk_bf16_f32 v73, v73, v75
    v_or_b32 v72, 1, v72
    buffer_store_dwordx2 v[72:73], v139, s[4:7], s33 offen sc1
    s_barrier
    v_mov_b64 v[64:65], 0
    v_mov_b64 v[66:67], 0
    v_mov_b64 v[68:69], 0
    v_mov_b64 v[70:71], 0
    v_mov_b64 v[72:73], 0
    v_mov_b64 v[74:75], 0
    v_mov_b64 v[76:77], 0
    v_mov_b64 v[78:79], 0
    v_mov_b64 v[80:81], 0
    v_mov_b64 v[82:83], 0
    v_mov_b64 v[84:85], 0
    v_mov_b64 v[86:87], 0
    ds_read_b128 v[32:35], v138 offset:0
    ds_read_b128 v[36:39], v138 offset:1024
    ds_read_b128 v[40:43], v138 offset:2048
    ds_read_b128 v[44:47], v138 offset:3072
    ds_read_b128 v[48:51], v138 offset:4096
    ds_read_b128 v[52:55], v138 offset:5120
    ds_read_b128 v[56:59], v138 offset:6144
    ds_read_b128 v[60:63], v138 offset:7168
    s_cmp_lt_u32 s25, 62
    s_cselect_b32 s57, 0x80000, 0
    s_add_u32 s34, s34, s57
    s_add_u32 s35, s35, s57
    s_add_u32 s36, s36, s57
    s_add_u32 s37, s37, s57
    s_mov_b32 s28, s29
    s_add_u32 s29, s29, 0x2000
    s_bitset0_b32 s29, 15
    s_mov_b64 s[16:17], -1
    s_waitcnt vmcnt(4)
    v_cmp_ne_u32 vcc, 0x1010101, v143
    s_cbranch_vccnz L_tslow21_noflag
L_tslow21_flag:
    s_cmp_lt_u32 s25, 61
    s_cselect_b32 s57, 4, 0
    s_add_u32 s51, s51, s57
    s_barrier
    buffer_load_dwordx4 v[0:3], v133, s[4:7], s26 offen sc1
    s_barrier
    buffer_load_dwordx4 v133, s[4:7], s27 offen sc1 lds
    s_barrier
    buffer_load_dword v143, v129, s[4:7], s51 offen sc1
    buffer_load_dwordx4 v[104:107], v133, s[4:7], s34 offen sc1
    buffer_load_dwordx4 v[108:111], v133, s[4:7], s35 offen sc1
    buffer_load_dwordx4 v[112:115], v133, s[4:7], s36 offen sc1
    buffer_load_dwordx4 v[116:119], v133, s[4:7], s37 offen sc1
    s_branch L_tslow20_again
L_tslow20_noflag:
    s_waitcnt vmcnt(0)
L_poll_27:
    buffer_load_dword v143, v129, s[4:7], s51 offen offset:0 sc1
    s_movk_i32 s3, 18
    s_sub_u32 s24, s24, 1
    s_cbranch_scc1 L_timeout
    s_waitcnt vmcnt(0)
    v_cmp_gt_u32 vcc, 16843009, v143
    s_cbranch_vccnz L_poll_27
    s_branch L_tslow20_flag
L_tslow20_miss:
    s_waitcnt lgkmcnt(0)
    v_max3_u32 v132, v0, v1, v2
    v_max3_u32 v130, v3, v4, v5
    v_max3_u32 v132, v132, v6, v7
    v_max_u32 v132, v132, v130
    v_cmpx_eq_u32 vcc, -1, v132
    s_cbranch_execz L_tslow20_whole
L_tslow20_reload:
    buffer_load_dwordx4 v[0:3], v133, s[4:7], s26 offen sc1
    buffer_load_dwordx4 v[4:7], v133, s[4:7], s27 offen sc1
    s_movk_i32 s3, 16
    s_sub_u32 s24, s24, 1
    s_cbranch_scc1 L_timeout
    v_max3_u32 v132, v0, v1, v2
    v_max3_u32 v130, v3, v4, v5
    v_max3_u32 v132, v132, v6, v7
    v_max_u32 v132, v132, v130
    v_cmpx_eq_u32 vcc, -1, v132
    s_cbranch_execnz L_tslow20_reload
L_tslow20_whole:
    s_mov_b64 exec, -1
    s_mov_b64 s[16:17], 0
    ds_read_b128 v[32:35], v138 offset:0
    ds_read_b128 v[36:39], v138 offset:1024
    ds_read_b128 v[40:43], v138 offset:2048
    ds_read_b128 v[44:47], v138 offset:3072
    ds_read_b128 v[48:51], v138 offset:4096
    ds_read_b128 v[52:55], v138 offset:5120
    ds_read_b128 v[56:59], v138 offset:6144
    ds_read_b128 v[60:63], v138 offset:7168
    v_mov_b64 v[64:65], 0
    v_mov_b64 v[66:67], 0
    v_mov_b64 v[68:69], 0
    v_mov_b64 v[70:71], 0
    v_mov_b64 v[72:73], 0
    v_mov_b64 v[74:75], 0
    v_mov_b64 v[76:77], 0
    v_mov_b64 v[78:79], 0
    v_mov_b64 v[80:81], 0
    v_mov_b64 v[82:83], 0
    v_mov_b64 v[84:85], 0
    v_mov_b64 v[86:87], 0
    s_waitcnt vmcnt(0)
    ds_write_b128 v133, v[4:7] offset:5120
    s_branch L_tslow20_again
L_tslow20_big:
    ds_write_b32 v133, v72 offset:13576
    s_waitcnt lgkmcnt(0)
    s_barrier
    ds_read_b128 v[60:63], v133 offset:13568
    s_waitcnt lgkmcnt(0)
    v_max3_f32 v126, v60, v61, v62
    v_max3_f32 v126, v126, v63, v124
    s_nop 1
    v_max_f32_dpp v126, v126, v126 quad_perm:[2,3,0,1] row_mask:0xf bank_mask:0xf
    v_mov_b32 v127, v126
    s_nop 1
    v_permlane16_swap_b32 v126, v127
    v_max_f32 v126, v126, v127
    v_mov_b32 v127, v126
    s_nop 1
    v_permlane32_swap_b32 v126, v127
    v_max_f32 v126, v126, v127
    v_sub_f32 v60, v60, v126
    v_exp_f32 v60, v60
    v_sub_f32 v61, v61, v126
    v_exp_f32 v61, v61
    v_sub_f32 v62, v62, v126
    v_exp_f32 v62, v62
    v_sub_f32 v63, v63, v126
    v_exp_f32 v63, v63
    v_sub_f32 v124, v124, v126
    v_exp_f32 v124, v124
    v_cvt_pk_bf16_f32 v60, v60, v61
    v_cvt_pk_bf16_f32 v61, v62, v63
    v_cvt_pk_bf16_f32 v62, v124, 0
    v_mov_b64 v[52:53], 0
    v_mov_b64 v[54:55], 0
    v_mov_b64 v[56:57], 0
    v_mov_b64 v[58:59], 0
    v_mov_b32 v63, 0
    s_nop 1
    v_mfma_f32_16x16x32_bf16 v[48:51], v[60:63], v[120:123], 0
    v_smfmac_f32_16x16x32_bf16 v[52:55], v[62:63], v[130:133], v131
    v_smfmac_f32_16x16x32_bf16 v[56:59], v[62:63], v[134:137], v131
    v_smfmac_f32_16x16x32_bf16 v[52:55], v[60:61], v[96:99], v131 abid:2
    v_smfmac_f32_16x16x32_bf16 v[56:59], v[60:61], v[100:103], v131 abid:2
    s_nop 3
    v_add_f32 v48, v48, v50
    v_add_f32 v49, v49, v51
    v_rcp_f32 v50, v48
    v_rcp_f32 v51, v49
    v_pk_add_f32 v[52:53], v[52:53], v[54:55]
    v_pk_mul_f32 v[52:53], v[52:53], v[50:51]
    v_max3_f32 v126, v48, v49, v50
    v_pk_add_f32 v[56:57], v[56:57], v[58:59]
    v_pk_mul_f32 v[56:57], v[56:57], v[50:51]
    v_cvt_pk_bf16_f32 v52, v52, v56
    v_cvt_pk_bf16_f32 v53, v53, v57
    ds_write2_b32 v141, v52, v53 offset0:0 offset1:136
    ds_read_b128 v[48:51], v142 offset:128
    v_mfma_f32_16x16x16_bf16 v[80:83], v[128:129], v[128:129], 0
    v_mfma_f32_16x16x16_bf16 v[84:87], v[128:129], v[128:129], 0
    v_mfma_f32_16x16x16_bf16 v[76:79], v[128:129], v[128:129], 0
    s_branch L_tslow20_back
L_tslow21_noflag:
    s_waitcnt vmcnt(0)
L_poll_28:
    buffer_load_dword v143, v129, s[4:7], s51 offen offset:0 sc1
    s_movk_i32 s3, 18
    s_sub_u32 s24, s24, 1
    s_cbranch_scc1 L_timeout
    s_waitcnt vmcnt(0)
    v_cmp_gt_u32 vcc, 16843009, v143
    s_cbranch_vccnz L_poll_28
    s_branch L_tslow21_flag
L_tslow21_miss:
    s_waitcnt lgkmcnt(0)
    v_max3_u32 v132, v0, v1, v2
    v_max3_u32 v130, v3, v4, v5
    v_max3_u32 v132, v132, v6, v7
    v_max_u32 v132, v132, v130
    v_cmpx_eq_u32 vcc, -1, v132
    s_cbranch_execz L_tslow21_whole
L_tslow21_reload:
    buffer_load_dwordx4 v[0:3], v133, s[4:7], s26 offen sc1
    buffer_load_dwordx4 v[4:7], v133, s[4:7], s27 offen sc1
    s_movk_i32 s3, 16
    s_sub_u32 s24, s24, 1
    s_cbranch_scc1 L_timeout
    v_max3_u32 v132, v0, v1, v2
    v_max3_u32 v130, v3, v4, v5
    v_max3_u32 v132, v132, v6, v7
    v_max_u32 v132, v132, v130
    v_cmpx_eq_u32 vcc, -1, v132
    s_cbranch_execnz L_tslow21_reload
L_tslow21_whole:
    s_mov_b64 exec, -1
    s_mov_b64 s[16:17], 0
    ds_read_b128 v[32:35], v138 offset:0
    ds_read_b128 v[36:39], v138 offset:1024
    ds_read_b128 v[40:43], v138 offset:2048
    ds_read_b128 v[44:47], v138 offset:3072
    ds_read_b128 v[48:51], v138 offset:4096
    ds_read_b128 v[52:55], v138 offset:5120
    ds_read_b128 v[56:59], v138 offset:6144
    ds_read_b128 v[60:63], v138 offset:7168
    v_mov_b64 v[64:65], 0
    v_mov_b64 v[66:67], 0
    v_mov_b64 v[68:69], 0
    v_mov_b64 v[70:71], 0
    v_mov_b64 v[72:73], 0
    v_mov_b64 v[74:75], 0
    v_mov_b64 v[76:77], 0
    v_mov_b64 v[78:79], 0
    v_mov_b64 v[80:81], 0
    v_mov_b64 v[82:83], 0
    v_mov_b64 v[84:85], 0
    v_mov_b64 v[86:87], 0
    s_waitcnt vmcnt(0)
    ds_write_b128 v133, v[4:7] offset:5120
    s_branch L_tslow21_again
L_tslow21_big:
    ds_write_b32 v133, v72 offset:13576
    s_waitcnt lgkmcnt(0)
    s_barrier
    ds_read_b128 v[60:63], v133 offset:13568
    s_waitcnt lgkmcnt(0)
    v_max3_f32 v126, v60, v61, v62
    v_max3_f32 v126, v126, v63, v124
    s_nop 1
    v_max_f32_dpp v126, v126, v126 quad_perm:[2,3,0,1] row_mask:0xf bank_mask:0xf
    v_mov_b32 v127, v126
    s_nop 1
    v_permlane16_swap_b32 v126, v127
    v_max_f32 v126, v126, v127
    v_mov_b32 v127, v126
    s_nop 1
    v_permlane32_swap_b32 v126, v127
    v_max_f32 v126, v126, v127
    v_sub_f32 v60, v60, v126
    v_exp_f32 v60, v60
    v_sub_f32 v61, v61, v126
    v_exp_f32 v61, v61
    v_sub_f32 v62, v62, v126
    v_exp_f32 v62, v62
    v_sub_f32 v63, v63, v126
    v_exp_f32 v63, v63
    v_sub_f32 v124, v124, v126
    v_exp_f32 v124, v124
    v_cvt_pk_bf16_f32 v60, v60, v61
    v_cvt_pk_bf16_f32 v61, v62, v63
    v_cvt_pk_bf16_f32 v62, v124, 0
    v_mov_b64 v[52:53], 0
    v_mov_b64 v[54:55], 0
    v_mov_b64 v[56:57], 0
    v_mov_b64 v[58:59], 0
    v_mov_b32 v63, 0
    s_nop 1
    v_mfma_f32_16x16x32_bf16 v[48:51], v[60:63], v[120:123], 0
    v_smfmac_f32_16x16x32_bf16 v[52:55], v[62:63], v[130:133], v131
    v_smfmac_f32_16x16x32_bf16 v[56:59], v[62:63], v[134:137], v131
    v_smfmac_f32_16x16x32_bf16 v[52:55], v[60:61], v[112:115], v131 abid:2
    v_smfmac_f32_16x16x32_bf16 v[56:59], v[60:61], v[116:119], v131 abid:2
    s_nop 3
    v_add_f32 v48, v48, v50
    v_add_f32 v49, v49, v51
    v_rcp_f32 v50, v48
    v_rcp_f32 v51, v49
    v_pk_add_f32 v[52:53], v[52:53], v[54:55]
    v_pk_mul_f32 v[52:53], v[52:53], v[50:51]
    v_max3_f32 v126, v48, v49, v50
    v_pk_add_f32 v[56:57], v[56:57], v[58:59]
    v_pk_mul_f32 v[56:57], v[56:57], v[50:51]
    v_cvt_pk_bf16_f32 v52, v52, v56
    v_cvt_pk_bf16_f32 v53, v53, v57
    ds_write2_b32 v141, v52, v53 offset0:0 offset1:136
    ds_read_b128 v[48:51], v142 offset:128
    v_mfma_f32_16x16x16_bf16 v[80:83], v[128:129], v[128:129], 0
    v_mfma_f32_16x16x16_bf16 v[84:87], v[128:129], v[128:129], 0
    v_mfma_f32_16x16x16_bf16 v[76:79], v[128:129], v[128:129], 0
    s_branch L_tslow21_back
.p2align 6
L_tslow30_again:
    s_waitcnt vmcnt(5) lgkmcnt(0)
    v_smfmac_f32_16x16x64_bf16 v[72:75], v[0:3], v[32:39], v131 abid:1
    ds_write_b128 v133, v[0:3] offset:6144
    v_smfmac_f32_16x16x64_bf16 v[76:79], v[0:3], v[40:47], v131 abid:1
    v_smfmac_f32_16x16x64_bf16 v[80:83], v[0:3], a[24:31], v131 abid:1
    v_smfmac_f32_16x16x64_bf16 v[84:87], v[0:3], a[64:71], v131 abid:1
    s_waitcnt vmcnt(4)
    ds_read_b128 v[4:7], v133 offset:7168
    v_smfmac_f32_16x16x64_bf16 v[64:67], v[0:3], a[128:135], v131 abid:1
    v_smfmac_f32_16x16x64_bf16 v[68:71], v[0:3], a[192:199], v131 abid:1
    s_waitcnt lgkmcnt(1)
    s_barrier
    s_waitcnt lgkmcnt(0)
    v_smfmac_f32_16x16x64_bf16 v[72:75], v[4:7], v[48:55], v131 abid:1
    ds_read_b128 v[8:11], v133 offset:4096
    v_smfmac_f32_16x16x64_bf16 v[76:79], v[4:7], v[56:63], v131 abid:1
    ds_read_b128 v[12:15], v133 offset:5120
    v_smfmac_f32_16x16x64_bf16 v[80:83], v[4:7], a[32:39], v131 abid:1
    ds_read_b128 v[16:19], v133 offset:2048
    v_smfmac_f32_16x16x64_bf16 v[84:87], v[4:7], a[72:79], v131 abid:1
    ds_read_b128 v[20:23], v133 offset:3072
    s_waitcnt lgkmcnt(3)
    v_smfmac_f32_16x16x64_bf16 v[72:75], v[8:11], v[192:199], v131 abid:1
    ds_read_b128 v[24:27], v133 offset:0
    v_smfmac_f32_16x16x64_bf16 v[76:79], v[8:11], v[240:247], v131 abid:1
    ds_read_b128 v[28:31], v133 offset:1024
    s_waitcnt lgkmcnt(4)
    v_smfmac_f32_16x16x64_bf16 v[72:75], v[12:15], v[200:207], v131 abid:1
    ds_read_b128 v[32:35], v138 offset:8192
    v_smfmac_f32_16x16x64_bf16 v[76:79], v[12:15], v[248:255], v131 abid:1
    ds_read_b128 v[36:39], v138 offset:9216
    s_waitcnt lgkmcnt(5)
    v_smfmac_f32_16x16x64_bf16 v[72:75], v[16:19], v[208:215], v131 abid:1
    ds_read_b128 v[40:43], v138 offset:10240
    s_waitcnt lgkmcnt(5)
    v_smfmac_f32_16x16x64_bf16 v[72:75], v[20:23], v[216:223], v131 abid:1
    ds_read_b128 v[44:47], v138 offset:11264
    s_waitcnt lgkmcnt(5)
    v_smfmac_f32_16x16x64_bf16 v[72:75], v[24:27], v[224:231], v131 abid:1
    ds_read_b128 v[48:51], v138 offset:12288
    s_waitcnt lgkmcnt(5)
    v_smfmac_f32_16x16x64_bf16 v[72:75], v[28:31], v[232:239], v131 abid:1
    s_nop 1
    ds_read_b128 v[52:55], v138 offset:13312
    v_smfmac_f32_16x16x64_bf16 v[76:79], v[16:19], a[0:7], v131 abid:1
    s_nop 1
    ds_read_b128 v[56:59], v138 offset:14336
    v_smfmac_f32_16x16x64_bf16 v[76:79], v[20:23], a[8:15], v131 abid:1
    ds_read_b128 v[60:63], v138 offset:15360
    v_add_f32 v72, v72, v74
    v_smfmac_f32_16x16x64_bf16 v[76:79], v[24:27], a[16:23], v131 abid:1
    s_waitcnt lgkmcnt(3)
    v_add_f32 v73, v73, v75
    v_smfmac_f32_16x16x64_bf16 v[76:79], v[28:31], v[32:39], v131 abid:1
    s_nop 2
    v_smfmac_f32_16x16x64_bf16 v[80:83], v[8:11], a[40:47], v131 abid:1
    s_nop 1
    v_cmp_u_f32 vcc, v72, v73
    v_smfmac_f32_16x16x64_bf16 v[80:83], v[12:15], v[40:47], v131 abid:1
    v_add_f32 v76, v76, v78
    v_add_f32 v77, v77, v79
    v_smfmac_f32_16x16x64_bf16 v[80:83], v[16:19], a[48:55], v131 abid:1
    s_waitcnt lgkmcnt(1)
    v_cvt_pk_bf16_f32 v76, v72, v76
    v_cvt_pk_bf16_f32 v77, v73, v77
    v_smfmac_f32_16x16x64_bf16 v[80:83], v[20:23], v[48:55], v131 abid:1
    ds_write2_b32 v141, v76, v77 offset0:0 offset1:136
    v_smfmac_f32_16x16x64_bf16 v[80:83], v[24:27], a[56:63], v131 abid:1
    s_waitcnt lgkmcnt(1)
    v_mov_b64 v[52:53], 0
    v_smfmac_f32_16x16x64_bf16 v[80:83], v[28:31], v[56:63], v131 abid:1
    s_nop 1
    v_mov_b64 v[54:55], 0
    v_smfmac_f32_16x16x64_bf16 v[84:87], v[8:11], a[80:87], v131 abid:1
    s_nop 1
    v_mov_b64 v[56:57], 0
    v_smfmac_f32_16x16x64_bf16 v[84:87], v[12:15], a[88:95], v131 abid:1
    s_and_b64 vcc, vcc, s[16:17]
    v_add_f32 v80, v80, v82
    v_smfmac_f32_16x16x64_bf16 v[84:87], v[16:19], a[96:103], v131 abid:1
    s_waitcnt lgkmcnt(0)
    s_barrier
    v_smfmac_f32_16x16x64_bf16 v[84:87], v[20:23], a[104:111], v131 abid:1
    ds_read_b128 v[32:35], v137 offset:0
    v_add_f32 v81, v81, v83
    v_smfmac_f32_16x16x64_bf16 v[84:87], v[24:27], a[112:119], v131 abid:1
    ds_read_b128 v[36:39], v137 offset:64
    v_mov_b64 v[58:59], 0
    v_smfmac_f32_16x16x64_bf16 v[84:87], v[28:31], a[120:127], v131 abid:1
    s_cbranch_scc1 L_tslow30_miss
    s_add_u32 s26, s28, s54
    v_smfmac_f32_16x16x64_bf16 v[64:67], v[4:7], a[136:143], v131 abid:1
    s_add_u32 s25, s25, 1
    s_add_u32 s27, s28, s55
    s_waitcnt lgkmcnt(1)
    v_mfma_f32_16x16x32_bf16 v[72:75], v[88:91], v[32:35], 0
    s_waitcnt lgkmcnt(0)
    v_add_f32 v84, v84, v86
    v_add_f32 v85, v85, v87
    v_mfma_f32_16x16x32_bf16 v[72:75], v[92:95], v[36:39], v[72:75]
    s_nop 0
    v_cvt_pk_bf16_f32 v84, v80, v84
    v_cvt_pk_bf16_f32 v85, v81, v85
    v_smfmac_f32_16x16x64_bf16 v[64:67], v[8:11], a[144:151], v131 abid:1
    ds_write2_b32 v141, v84, v85 offset0:64 offset1:200
    v_smfmac_f32_16x16x64_bf16 v[64:67], v[12:15], a[152:159], v131 abid:1
    s_nop 1
    v_cndmask_b32 v73, v73, v74, s[58:59]
    v_cndmask_b32 v72, v72, v75, s[58:59]
    v_smfmac_f32_16x16x64_bf16 v[64:67], v[16:19], a[160:167], v131 abid:1
    ds_read_b128 v[88:91], v138 offset:16384
    v_add_f32_dpp v72, v73, v72 quad_perm:[2,3,0,1] row_mask:0xf bank_mask:0xf
    v_mul_f32 v72, s56, v72
    v_smfmac_f32_16x16x64_bf16 v[64:67], v[20:23], a[168:175], v131 abid:1
    ds_read_b128 v[92:95], v138 offset:17408
    v_exp_f32 v73, v72
    v_smfmac_f32_16x16x64_bf16 v[64:67], v[24:27], a[176:183], v131 abid:1
    ds_write_b32 v133, v73 offset:12556
    v_smfmac_f32_16x16x64_bf16 v[64:67], v[28:31], a[184:191], v131 abid:1
    s_waitcnt lgkmcnt(3)
    s_barrier
    v_smfmac_f32_16x16x64_bf16 v[68:71], v[4:7], a[200:207], v131 abid:1
    ds_read_b128 v[40:43], v137 offset:256
    v_mov_b32 v63, 0
    v_smfmac_f32_16x16x64_bf16 v[68:71], v[8:11], a[208:215], v131 abid:1
    ds_read_b128 v[44:47], v137 offset:320
    v_mov_b32 v143, s25
    v_smfmac_f32_16x16x64_bf16 v[68:71], v[12:15], a[216:223], v131 abid:1
    ds_read_b128 v[0:3], v138 offset:18432
    v_add_f32 v64, v64, v66
    v_smfmac_f32_16x16x64_bf16 v[68:71], v[16:19], a[224:231], v131 abid:1
    s_waitcnt lgkmcnt(3)
    s_barrier
    s_waitcnt lgkmcnt(2)
    v_mfma_f32_16x16x32_bf16 v[124:127], v[40:43], v[32:35], 0
    ds_read_b128 v[80:83], v133 offset:12544
    s_waitcnt lgkmcnt(2)
    v_mfma_f32_16x16x32_bf16 v[124:127], v[44:47], v[36:39], v[124:127]
    s_nop 0
    v_add_f32 v65, v65, v67
    v_cvt_pk_bf16_f32 v130, v64, v65
    v_smfmac_f32_16x16x64_bf16 v[68:71], v[20:23], a[232:239], v131 abid:1
    ds_read_b128 v[4:7], v138 offset:19456
    ds_read_b128 v[8:11], v138 offset:20480
    v_smfmac_f32_16x16x64_bf16 v[68:71], v[24:27], a[240:247], v131 abid:1
    ds_read_b128 v[12:15], v138 offset:21504
    v_cndmask_b32 v125, v125, v126, s[58:59]
    v_cndmask_b32 v124, v124, v127, s[58:59]
    v_smfmac_f32_16x16x64_bf16 v[68:71], v[28:31], a[248:255], v131 abid:1
    s_waitcnt lgkmcnt(3)
    v_cvt_pk_bf16_f32 v60, v80, v81
    v_cvt_pk_bf16_f32 v61, v82, v83
    v_add_f32_dpp v124, v125, v124 quad_perm:[2,3,0,1] row_mask:0xf bank_mask:0xf
    v_mul_f32 v124, s56, v124
    v_smfmac_f32_16x16x32_bf16 v[52:55], v[60:61], v[96:99], v131 abid:2
    v_exp_f32 v125, v124
    v_smfmac_f32_16x16x32_bf16 v[56:59], v[60:61], v[100:103], v131 abid:2
    v_cvt_pk_bf16_f32 v62, v125, 0
    v_add_f32 v68, v68, v70
    v_add_f32 v69, v69, v71
    v_mfma_f32_16x16x32_bf16 v[48:51], v[60:63], v[120:123], 0
    ds_read_b128 v[32:35], v138 offset:22528
    v_cvt_pk_bf16_f32 v134, v68, v69
    v_smfmac_f32_16x16x32_bf16 v[52:55], v[62:63], v[130:133], v131
    s_nop 0
    ds_read_b128 v[36:39], v138 offset:23552
    ds_read_b128 v[40:43], v138 offset:24576
    v_smfmac_f32_16x16x32_bf16 v[56:59], v[62:63], v[134:137], v131
    s_nop 0
    v_add_f32 v48, v48, v50
    v_add_f32 v49, v49, v51
    v_rcp_f32 v50, v48
    v_rcp_f32 v51, v49
    v_pk_add_f32 v[52:53], v[52:53], v[54:55]
    v_pk_mul_f32 v[52:53], v[52:53], v[50:51]
    v_max3_f32 v126, v48, v49, v50
    v_pk_add_f32 v[56:57], v[56:57], v[58:59]
    v_pk_mul_f32 v[56:57], v[56:57], v[50:51]
    v_cvt_pk_bf16_f32 v52, v52, v56
    v_cvt_pk_bf16_f32 v53, v53, v57
    v_mfma_f32_16x16x16_bf16 v[80:83], v[128:129], v[128:129], 0
    ds_write2_b32 v141, v52, v53 offset0:0 offset1:136
    v_mfma_f32_16x16x16_bf16 v[84:87], v[128:129], v[128:129], 0
    v_max_f32 v126, v126, v51
    v_cmp_nge_f32 vcc, 0x4f800000, v126
    v_mfma_f32_16x16x16_bf16 v[76:79], v[128:129], v[128:129], 0
    ds_read_b128 v[48:51], v142 offset:192
    s_cbranch_vccnz L_tslow30_big
L_tslow30_back:
    v_mfma_f32_16x16x16_bf16 v[72:75], v[128:129], v[128:129], 0
    buffer_store_dword v143, v140, s[4:7], s47 offen sc1
    s_waitcnt lgkmcnt(1)
    s_barrier
    ds_read_b128 v[52:55], v142 offset:128
    s_waitcnt lgkmcnt(1)
    v_smfmac_f32_16x16x64_bf16 v[80:83], v[48:51], v[88:95], v131 abid:1
    ds_read_b128 v[56:59], v142 offset:64
    v_smfmac_f32_16x16x64_bf16 v[84:87], v[48:51], v[0:7], v131 abid:1
    ds_read_b128 v[60:63], v142 offset:0
    v_smfmac_f32_16x16x64_bf16 v[76:79], v[48:51], v[8:15], v131 abid:1
    ds_read_b128 v[44:47], v138 offset:25600
    s_waitcnt lgkmcnt(3)
    v_smfmac_f32_16x16x64_bf16 v[80:83], v[52:55], v[144:151], v131 abid:1
    ds_read_b128 v[16:19], v138 offset:26624
    s_waitcnt lgkmcnt(3)
    v_smfmac_f32_16x16x64_bf16 v[80:83], v[56:59], v[152:159], v131 abid:1
    ds_read_b128 v[20:23], v138 offset:27648
    s_waitcnt lgkmcnt(3)
    v_smfmac_f32_16x16x64_bf16 v[80:83], v[60:63], v[160:167], v131 abid:1
    s_nop 1
    ds_read_b128 v[24:27], v138 offset:28672
    v_smfmac_f32_16x16x64_bf16 v[84:87], v[52:55], v[32:39], v131 abid:1
    ds_read_b128 v[28:31], v138 offset:29696
    s_waitcnt lgkmcnt(4)
    v_smfmac_f32_16x16x64_bf16 v[84:87], v[56:59], v[40:47], v131 abid:1
    ds_read_b128 v[64:67], v138 offset:30720
    v_cvt_pk_bf16_f32 v80, v80, v82
    v_cvt_pk_bf16_f32 v81, v81, v83
    v_and_b32 v80, -2, v80
    v_smfmac_f32_16x16x64_bf16 v[84:87], v[60:63], v[168:175], v131 abid:1
    buffer_store_dwordx2 v[80:81], v139, s[4:7], s30 offen sc1
    ds_read_b128 v[68:71], v138 offset:31744
    s_waitcnt lgkmcnt(4)
    v_smfmac_f32_16x16x64_bf16 v[76:79], v[52:55], v[16:23], v131 abid:1
    ds_read_b128 v[0:3], v138 offset:32768
    s_waitcnt lgkmcnt(3)
    v_smfmac_f32_16x16x64_bf16 v[76:79], v[56:59], v[176:183], v131 abid:1
    ds_read_b128 v[4:7], v138 offset:33792
    v_cvt_pk_bf16_f32 v84, v84, v86
    v_cvt_pk_bf16_f32 v85, v85, v87
    v_and_b32 v84, -2, v84
    v_smfmac_f32_16x16x64_bf16 v[76:79], v[60:63], v[24:31], v131 abid:1
    buffer_store_dwordx2 v[84:85], v139, s[4:7], s31 offen sc1
    ds_read_b128 v[8:11], v138 offset:34816
    s_nop 0
    v_smfmac_f32_16x16x64_bf16 v[72:75], v[48:51], v[184:191], v131 abid:1
    ds_read_b128 v[12:15], v138 offset:35840
    s_waitcnt lgkmcnt(4)
    v_smfmac_f32_16x16x64_bf16 v[72:75], v[52:55], v[64:71], v131 abid:1
    s_waitcnt lgkmcnt(2)
    v_cvt_pk_bf16_f32 v76, v76, v78
    v_cvt_pk_bf16_f32 v77, v77, v79
    v_and_b32 v76, -2, v76
    v_smfmac_f32_16x16x64_bf16 v[72:75], v[56:59], v[0:7], v131 abid:1
    buffer_store_dwordx2 v[76:77], v139, s[4:7], s32 offen sc1
    s_waitcnt lgkmcnt(0)
    v_smfmac_f32_16x16x64_bf16 v[72:75], v[60:63], v[8:15], v131 abid:1
    s_nop 7
    v_cvt_pk_bf16_f32 v72, v72, v74
    v_cvt_pk_bf16_f32 v73, v73, v75
    v_and_b32 v72, -2, v72
    buffer_store_dwordx2 v[72:73], v139, s[4:7], s33 offen sc1
    s_cmp_eq_u32 s25, 63
    s_cbranch_scc1 L_end
    s_barrier
    v_mov_b64 v[64:65], 0
    v_mov_b64 v[66:67], 0
    v_mov_b64 v[68:69], 0
    v_mov_b64 v[70:71], 0
    v_mov_b64 v[72:73], 0
    v_mov_b64 v[74:75], 0
    v_mov_b64 v[76:77], 0
    v_mov_b64 v[78:79], 0
    v_mov_b64 v[80:81], 0
    v_mov_b64 v[82:83], 0
    v_mov_b64 v[84:85], 0
    v_mov_b64 v[86:87], 0
    ds_read_b128 v[32:35], v138 offset:0
    ds_read_b128 v[36:39], v138 offset:1024
    ds_read_b128 v[40:43], v138 offset:2048
    ds_read_b128 v[44:47], v138 offset:3072
    ds_read_b128 v[48:51], v138 offset:4096
    ds_read_b128 v[52:55], v138 offset:5120
    ds_read_b128 v[56:59], v138 offset:6144
    ds_read_b128 v[60:63], v138 offset:7168
    s_cmp_lt_u32 s25, 62
    s_cselect_b32 s57, 0x80000, 0
    s_add_u32 s34, s34, s57
    s_add_u32 s35, s35, s57
    s_add_u32 s36, s36, s57
    s_add_u32 s37, s37, s57
    s_mov_b32 s28, s29
    s_add_u32 s29, s29, 0x2000
    s_bitset0_b32 s29, 15
    s_mov_b64 s[16:17], -1
    s_barrier
    buffer_load_dwordx4 v[0:3], v133, s[4:7], s26 offen sc1
    s_barrier
    buffer_load_dwordx4 v133, s[4:7], s27 offen sc1 lds
    s_barrier
    buffer_load_dwordx4 v[88:91], v133, s[4:7], s34 offen sc1
    buffer_load_dwordx4 v[92:95], v133, s[4:7], s35 offen sc1
    buffer_load_dwordx4 v[96:99], v133, s[4:7], s36 offen sc1
    buffer_load_dwordx4 v[100:103], v133, s[4:7], s37 offen sc1
L_tslow31_again:
    s_waitcnt vmcnt(5) lgkmcnt(0)
    v_smfmac_f32_16x16x64_bf16 v[72:75], v[0:3], v[32:39], v131 abid:1
    ds_write_b128 v133, v[0:3] offset:6144
    v_smfmac_f32_16x16x64_bf16 v[76:79], v[0:3], v[40:47], v131 abid:1
    v_smfmac_f32_16x16x64_bf16 v[80:83], v[0:3], a[24:31], v131 abid:1
    v_smfmac_f32_16x16x64_bf16 v[84:87], v[0:3], a[64:71], v131 abid:1
    s_waitcnt vmcnt(4)
    ds_read_b128 v[4:7], v133 offset:7168
    v_smfmac_f32_16x16x64_bf16 v[64:67], v[0:3], a[128:135], v131 abid:1
    v_smfmac_f32_16x16x64_bf16 v[68:71], v[0:3], a[192:199], v131 abid:1
    s_waitcnt lgkmcnt(1)
    s_barrier
    s_waitcnt lgkmcnt(0)
    v_smfmac_f32_16x16x64_bf16 v[72:75], v[4:7], v[48:55], v131 abid:1
    ds_read_b128 v[8:11], v133 offset:4096
    v_smfmac_f32_16x16x64_bf16 v[76:79], v[4:7], v[56:63], v131 abid:1
    ds_read_b128 v[12:15], v133 offset:5120
    v_smfmac_f32_16x16x64_bf16 v[80:83], v[4:7], a[32:39], v131 abid:1
    ds_read_b128 v[16:19], v133 offset:2048
    v_smfmac_f32_16x16x64_bf16 v[84:87], v[4:7], a[72:79], v131 abid:1
    ds_read_b128 v[20:23], v133 offset:3072
    s_waitcnt lgkmcnt(3)
    v_smfmac_f32_16x16x64_bf16 v[72:75], v[8:11], v[192:199], v131 abid:1
    ds_read_b128 v[24:27], v133 offset:0
    v_smfmac_f32_16x16x64_bf16 v[76:79], v[8:11], v[240:247], v131 abid:1
    ds_read_b128 v[28:31], v133 offset:1024
    s_waitcnt lgkmcnt(4)
    v_smfmac_f32_16x16x64_bf16 v[72:75], v[12:15], v[200:207], v131 abid:1
    ds_read_b128 v[32:35], v138 offset:8192
    v_smfmac_f32_16x16x64_bf16 v[76:79], v[12:15], v[248:255], v131 abid:1
    ds_read_b128 v[36:39], v138 offset:9216
    s_waitcnt lgkmcnt(5)
    v_smfmac_f32_16x16x64_bf16 v[72:75], v[16:19], v[208:215], v131 abid:1
    ds_read_b128 v[40:43], v138 offset:10240
    s_waitcnt lgkmcnt(5)
    v_smfmac_f32_16x16x64_bf16 v[72:75], v[20:23], v[216:223], v131 abid:1
    ds_read_b128 v[44:47], v138 offset:11264
    s_waitcnt lgkmcnt(5)
    v_smfmac_f32_16x16x64_bf16 v[72:75], v[24:27], v[224:231], v131 abid:1
    ds_read_b128 v[48:51], v138 offset:12288
    s_waitcnt lgkmcnt(5)
    v_smfmac_f32_16x16x64_bf16 v[72:75], v[28:31], v[232:239], v131 abid:1
    s_nop 1
    ds_read_b128 v[52:55], v138 offset:13312
    v_smfmac_f32_16x16x64_bf16 v[76:79], v[16:19], a[0:7], v131 abid:1
    s_nop 1
    ds_read_b128 v[56:59], v138 offset:14336
    v_smfmac_f32_16x16x64_bf16 v[76:79], v[20:23], a[8:15], v131 abid:1
    ds_read_b128 v[60:63], v138 offset:15360
    v_add_f32 v72, v72, v74
    v_smfmac_f32_16x16x64_bf16 v[76:79], v[24:27], a[16:23], v131 abid:1
    s_waitcnt lgkmcnt(3)
    v_add_f32 v73, v73, v75
    v_smfmac_f32_16x16x64_bf16 v[76:79], v[28:31], v[32:39], v131 abid:1
    s_nop 2
    v_smfmac_f32_16x16x64_bf16 v[80:83], v[8:11], a[40:47], v131 abid:1
    s_nop 1
    v_cmp_u_f32 vcc, v72, v73
    v_smfmac_f32_16x16x64_bf16 v[80:83], v[12:15], v[40:47], v131 abid:1
    v_add_f32 v76, v76, v78
    v_add_f32 v77, v77, v79
    v_smfmac_f32_16x16x64_bf16 v[80:83], v[16:19], a[48:55], v131 abid:1
    s_waitcnt lgkmcnt(1)
    v_cvt_pk_bf16_f32 v76, v72, v76
    v_cvt_pk_bf16_f32 v77, v73, v77
    v_smfmac_f32_16x16x64_bf16 v[80:83], v[20:23], v[48:55], v131 abid:1
    ds_write2_b32 v141, v76, v77 offset0:0 offset1:136
    v_smfmac_f32_16x16x64_bf16 v[80:83], v[24:27], a[56:63], v131 abid:1
    s_waitcnt lgkmcnt(1)
    v_mov_b64 v[52:53], 0
    v_smfmac_f32_16x16x64_bf16 v[80:83], v[28:31], v[56:63], v131 abid:1
    s_nop 1
    v_mov_b64 v[54:55], 0
    v_smfmac_f32_16x16x64_bf16 v[84:87], v[8:11], a[80:87], v131 abid:1
    s_nop 1
    v_mov_b64 v[56:57], 0
    v_smfmac_f32_16x16x64_bf16 v[84:87], v[12:15], a[88:95], v131 abid:1
    s_and_b64 vcc, vcc, s[16:17]
    v_add_f32 v80, v80, v82
    v_smfmac_f32_16x16x64_bf16 v[84:87], v[16:19], a[96:103], v131 abid:1
    s_waitcnt lgkmcnt(0)
    s_barrier
    v_smfmac_f32_16x16x64_bf16 v[84:87], v[20:23], a[104:111], v131 abid:1
    ds_read_b128 v[32:35], v137 offset:0
    v_add_f32 v81, v81, v83
    v_smfmac_f32_16x16x64_bf16 v[84:87], v[24:27], a[112:119], v131 abid:1
    ds_read_b128 v[36:39], v137 offset:64
    v_mov_b64 v[58:59], 0
    v_smfmac_f32_16x16x64_bf16 v[84:87], v[28:31], a[120:127], v131 abid:1
    s_cbranch_scc1 L_tslow31_miss
    s_add_u32 s26, s28, s54
    v_smfmac_f32_16x16x64_bf16 v[64:67], v[4:7], a[136:143], v131 abid:1
    s_add_u32 s25, s25, 1
    s_add_u32 s27, s28, s55
    s_waitcnt lgkmcnt(1)
    v_mfma_f32_16x16x32_bf16 v[72:75], v[104:107], v[32:35], 0
    s_waitcnt lgkmcnt(0)
    v_add_f32 v84, v84, v86
    v_add_f32 v85, v85, v87
    v_mfma_f32_16x16x32_bf16 v[72:75], v[108:111], v[36:39], v[72:75]
    s_nop 0
    v_cvt_pk_bf16_f32 v84, v80, v84
    v_cvt_pk_bf16_f32 v85, v81, v85
    v_smfmac_f32_16x16x64_bf16 v[64:67], v[8:11], a[144:151], v131 abid:1
    ds_write2_b32 v141, v84, v85 offset0:64 offset1:200
    v_smfmac_f32_16x16x64_bf16 v[64:67], v[12:15], a[152:159], v131 abid:1
    s_nop 1
    v_cndmask_b32 v73, v73, v74, s[58:59]
    v_cndmask_b32 v72, v72, v75, s[58:59]
    v_smfmac_f32_16x16x64_bf16 v[64:67], v[16:19], a[160:167], v131 abid:1
    ds_read_b128 v[104:107], v138 offset:16384
    v_add_f32_dpp v72, v73, v72 quad_perm:[2,3,0,1] row_mask:0xf bank_mask:0xf
    v_mul_f32 v72, s56, v72
    v_smfmac_f32_16x16x64_bf16 v[64:67], v[20:23], a[168:175], v131 abid:1
    ds_read_b128 v[108:111], v138 offset:17408
    v_exp_f32 v73, v72
    v_smfmac_f32_16x16x64_bf16 v[64:67], v[24:27], a[176:183], v131 abid:1
    ds_write_b32 v133, v73 offset:12556
    v_smfmac_f32_16x16x64_bf16 v[64:67], v[28:31], a[184:191], v131 abid:1
    s_waitcnt lgkmcnt(3)
    s_barrier
    v_smfmac_f32_16x16x64_bf16 v[68:71], v[4:7], a[200:207], v131 abid:1
    ds_read_b128 v[40:43], v137 offset:256
    v_mov_b32 v63, 0
    v_smfmac_f32_16x16x64_bf16 v[68:71], v[8:11], a[208:215], v131 abid:1
    ds_read_b128 v[44:47], v137 offset:320
    v_mov_b32 v143, s25
    v_smfmac_f32_16x16x64_bf16 v[68:71], v[12:15], a[216:223], v131 abid:1
    ds_read_b128 v[0:3], v138 offset:18432
    v_add_f32 v64, v64, v66
    v_smfmac_f32_16x16x64_bf16 v[68:71], v[16:19], a[224:231], v131 abid:1
    s_waitcnt lgkmcnt(3)
    s_barrier
    s_waitcnt lgkmcnt(2)
    v_mfma_f32_16x16x32_bf16 v[124:127], v[40:43], v[32:35], 0
    ds_read_b128 v[80:83], v133 offset:12544
    s_waitcnt lgkmcnt(2)
    v_mfma_f32_16x16x32_bf16 v[124:127], v[44:47], v[36:39], v[124:127]
    s_nop 0
    v_add_f32 v65, v65, v67
    v_cvt_pk_bf16_f32 v130, v64, v65
    v_smfmac_f32_16x16x64_bf16 v[68:71], v[20:23], a[232:239], v131 abid:1
    ds_read_b128 v[4:7], v138 offset:19456
    ds_read_b128 v[8:11], v138 offset:20480
    v_smfmac_f32_16x16x64_bf16 v[68:71], v[24:27], a[240:247], v131 abid:1
    ds_read_b128 v[12:15], v138 offset:21504
    v_cndmask_b32 v125, v125, v126, s[58:59]
    v_cndmask_b32 v124, v124, v127, s[58:59]
    v_smfmac_f32_16x16x64_bf16 v[68:71], v[28:31], a[248:255], v131 abid:1
    s_waitcnt lgkmcnt(3)
    v_cvt_pk_bf16_f32 v60, v80, v81
    v_cvt_pk_bf16_f32 v61, v82, v83
    v_add_f32_dpp v124, v125, v124 quad_perm:[2,3,0,1] row_mask:0xf bank_mask:0xf
    v_mul_f32 v124, s56, v124
    v_smfmac_f32_16x16x32_bf16 v[52:55], v[60:61], v[112:115], v131 abid:2
    v_exp_f32 v125, v124
    v_smfmac_f32_16x16x32_bf16 v[56:59], v[60:61], v[116:119], v131 abid:2
    v_cvt_pk_bf16_f32 v62, v125, 0
    v_add_f32 v68, v68, v70
    v_add_f32 v69, v69, v71
    v_mfma_f32_16x16x32_bf16 v[48:51], v[60:63], v[120:123], 0
    ds_read_b128 v[32:35], v138 offset:22528
    v_cvt_pk_bf16_f32 v134, v68, v69
    v_smfmac_f32_16x16x32_bf16 v[52:55], v[62:63], v[130:133], v131
    s_nop 0
    ds_read_b128 v[36:39], v138 offset:23552
    ds_read_b128 v[40:43], v138 offset:24576
    v_smfmac_f32_16x16x32_bf16 v[56:59], v[62:63], v[134:137], v131
    s_nop 0
    v_add_f32 v48, v48, v50
    v_add_f32 v49, v49, v51
    v_rcp_f32 v50, v48
    v_rcp_f32 v51, v49
    v_pk_add_f32 v[52:53], v[52:53], v[54:55]
    v_pk_mul_f32 v[52:53], v[52:53], v[50:51]
    v_max3_f32 v126, v48, v49, v50
    v_pk_add_f32 v[56:57], v[56:57], v[58:59]
    v_pk_mul_f32 v[56:57], v[56:57], v[50:51]
    v_cvt_pk_bf16_f32 v52, v52, v56
    v_cvt_pk_bf16_f32 v53, v53, v57
    v_mfma_f32_16x16x16_bf16 v[80:83], v[128:129], v[128:129], 0
    ds_write2_b32 v141, v52, v53 offset0:0 offset1:136
    v_mfma_f32_16x16x16_bf16 v[84:87], v[128:129], v[128:129], 0
    v_max_f32 v126, v126, v51
    v_cmp_nge_f32 vcc, 0x4f800000, v126
    v_mfma_f32_16x16x16_bf16 v[76:79], v[128:129], v[128:129], 0
    ds_read_b128 v[48:51], v142 offset:192
    s_cbranch_vccnz L_tslow31_big
L_tslow31_back:
    v_mfma_f32_16x16x16_bf16 v[72:75], v[128:129], v[128:129], 0
    buffer_store_dword v143, v140, s[4:7], s47 offen sc1
    s_waitcnt lgkmcnt(1)
    s_barrier
    ds_read_b128 v[52:55], v142 offset:128
    s_waitcnt lgkmcnt(1)
    v_smfmac_f32_16x16x64_bf16 v[80:83], v[48:51], v[104:111], v131 abid:1
    ds_read_b128 v[56:59], v142 offset:64
    v_smfmac_f32_16x16x64_bf16 v[84:87], v[48:51], v[0:7], v131 abid:1
    ds_read_b128 v[60:63], v142 offset:0
    v_smfmac_f32_16x16x64_bf16 v[76:79], v[48:51], v[8:15], v131 abid:1
    ds_read_b128 v[44:47], v138 offset:25600
    s_waitcnt lgkmcnt(3)
    v_smfmac_f32_16x16x64_bf16 v[80:83], v[52:55], v[144:151], v131 abid:1
    ds_read_b128 v[16:19], v138 offset:26624
    s_waitcnt lgkmcnt(3)
    v_smfmac_f32_16x16x64_bf16 v[80:83], v[56:59], v[152:159], v131 abid:1
    ds_read_b128 v[20:23], v138 offset:27648
    s_waitcnt lgkmcnt(3)
    v_smfmac_f32_16x16x64_bf16 v[80:83], v[60:63], v[160:167], v131 abid:1
    s_nop 1
    ds_read_b128 v[24:27], v138 offset:28672
    v_smfmac_f32_16x16x64_bf16 v[84:87], v[52:55], v[32:39], v131 abid:1
    ds_read_b128 v[28:31], v138 offset:29696
    s_waitcnt lgkmcnt(4)
    v_smfmac_f32_16x16x64_bf16 v[84:87], v[56:59], v[40:47], v131 abid:1
    ds_read_b128 v[64:67], v138 offset:30720
    v_cvt_pk_bf16_f32 v80, v80, v82
    v_cvt_pk_bf16_f32 v81, v81, v83
    v_or_b32 v80, 1, v80
    v_smfmac_f32_16x16x64_bf16 v[84:87], v[60:63], v[168:175], v131 abid:1
    buffer_store_dwordx2 v[80:81], v139, s[4:7], s30 offen sc1
    ds_read_b128 v[68:71], v138 offset:31744
    s_waitcnt lgkmcnt(4)
    v_smfmac_f32_16x16x64_bf16 v[76:79], v[52:55], v[16:23], v131 abid:1
    ds_read_b128 v[0:3], v138 offset:32768
    s_waitcnt lgkmcnt(3)
    v_smfmac_f32_16x16x64_bf16 v[76:79], v[56:59], v[176:183], v131 abid:1
    ds_read_b128 v[4:7], v138 offset:33792
    v_cvt_pk_bf16_f32 v84, v84, v86
    v_cvt_pk_bf16_f32 v85, v85, v87
    v_or_b32 v84, 1, v84
    v_smfmac_f32_16x16x64_bf16 v[76:79], v[60:63], v[24:31], v131 abid:1
    buffer_store_dwordx2 v[84:85], v139, s[4:7], s31 offen sc1
    ds_read_b128 v[8:11], v138 offset:34816
    s_nop 0
    v_smfmac_f32_16x16x64_bf16 v[72:75], v[48:51], v[184:191], v131 abid:1
    ds_read_b128 v[12:15], v138 offset:35840
    s_waitcnt lgkmcnt(4)
    v_smfmac_f32_16x16x64_bf16 v[72:75], v[52:55], v[64:71], v131 abid:1
    s_waitcnt lgkmcnt(2)
    v_cvt_pk_bf16_f32 v76, v76, v78
    v_cvt_pk_bf16_f32 v77, v77, v79
    v_or_b32 v76, 1, v76
    v_smfmac_f32_16x16x64_bf16 v[72:75], v[56:59], v[0:7], v131 abid:1
    buffer_store_dwordx2 v[76:77], v139, s[4:7], s32 offen sc1
    s_waitcnt lgkmcnt(0)
    v_smfmac_f32_16x16x64_bf16 v[72:75], v[60:63], v[8:15], v131 abid:1
    s_nop 7
    v_cvt_pk_bf16_f32 v72, v72, v74
    v_cvt_pk_bf16_f32 v73, v73, v75
    v_or_b32 v72, 1, v72
    buffer_store_dwordx2 v[72:73], v139, s[4:7], s33 offen sc1
    s_barrier
    v_mov_b64 v[64:65], 0
    v_mov_b64 v[66:67], 0
    v_mov_b64 v[68:69], 0
    v_mov_b64 v[70:71], 0
    v_mov_b64 v[72:73], 0
    v_mov_b64 v[74:75], 0
    v_mov_b64 v[76:77], 0
    v_mov_b64 v[78:79], 0
    v_mov_b64 v[80:81], 0
    v_mov_b64 v[82:83], 0
    v_mov_b64 v[84:85], 0
    v_mov_b64 v[86:87], 0
    ds_read_b128 v[32:35], v138 offset:0
    ds_read_b128 v[36:39], v138 offset:1024
    ds_read_b128 v[40:43], v138 offset:2048
    ds_read_b128 v[44:47], v138 offset:3072
    ds_read_b128 v[48:51], v138 offset:4096
    ds_read_b128 v[52:55], v138 offset:5120
    ds_read_b128 v[56:59], v138 offset:6144
    ds_read_b128 v[60:63], v138 offset:7168
    s_cmp_lt_u32 s25, 62
    s_cselect_b32 s57, 0x80000, 0
    s_add_u32 s34, s34, s57
    s_add_u32 s35, s35, s57
    s_add_u32 s36, s36, s57
    s_add_u32 s37, s37, s57
    s_mov_b32 s28, s29
    s_add_u32 s29, s29, 0x2000
    s_bitset0_b32 s29, 15
    s_mov_b64 s[16:17], -1
    s_barrier
    buffer_load_dwordx4 v[0:3], v133, s[4:7], s26 offen sc1
    s_barrier
    buffer_load_dwordx4 v133, s[4:7], s27 offen sc1 lds
    s_barrier
    buffer_load_dwordx4 v[104:107], v133, s[4:7], s34 offen sc1
    buffer_load_dwordx4 v[108:111], v133, s[4:7], s35 offen sc1
    buffer_load_dwordx4 v[112:115], v133, s[4:7], s36 offen sc1
    buffer_load_dwordx4 v[116:119], v133, s[4:7], s37 offen sc1
    s_branch L_tslow30_again
L_tslow30_miss:
    s_waitcnt lgkmcnt(0)
    v_max3_u32 v132, v0, v1, v2
    v_max3_u32 v130, v3, v4, v5
    v_max3_u32 v132, v132, v6, v7
    v_max_u32 v132, v132, v130
    v_cmpx_eq_u32 vcc, -1, v132
    s_cbranch_execz L_tslow30_whole
L_tslow30_reload:
    buffer_load_dwordx4 v[0:3], v133, s[4:7], s26 offen sc1
    buffer_load_dwordx4 v[4:7], v133, s[4:7], s27 offen sc1
    s_movk_i32 s3, 16
    s_sub_u32 s24, s24, 1
    s_cbranch_scc1 L_timeout
    v_max3_u32 v132, v0, v1, v2
    v_max3_u32 v130, v3, v4, v5
    v_max3_u32 v132, v132, v6, v7
    v_max_u32 v132, v132, v130
    v_cmpx_eq_u32 vcc, -1, v132
    s_cbranch_execnz L_tslow30_reload
L_tslow30_whole:
    s_mov_b64 exec, -1
    s_mov_b64 s[16:17], 0
    ds_read_b128 v[32:35], v138 offset:0
    ds_read_b128 v[36:39], v138 offset:1024
    ds_read_b128 v[40:43], v138 offset:2048
    ds_read_b128 v[44:47], v138 offset:3072
    ds_read_b128 v[48:51], v138 offset:4096
    ds_read_b128 v[52:55], v138 offset:5120
    ds_read_b128 v[56:59], v138 offset:6144
    ds_read_b128 v[60:63], v138 offset:7168
    v_mov_b64 v[64:65], 0
    v_mov_b64 v[66:67], 0
    v_mov_b64 v[68:69], 0
    v_mov_b64 v[70:71], 0
    v_mov_b64 v[72:73], 0
    v_mov_b64 v[74:75], 0
    v_mov_b64 v[76:77], 0
    v_mov_b64 v[78:79], 0
    v_mov_b64 v[80:81], 0
    v_mov_b64 v[82:83], 0
    v_mov_b64 v[84:85], 0
    v_mov_b64 v[86:87], 0
    s_waitcnt vmcnt(0)
    ds_write_b128 v133, v[4:7] offset:7168
    s_branch L_tslow30_again
L_tslow30_big:
    ds_write_b32 v133, v72 offset:13580
    s_waitcnt lgkmcnt(0)
    s_barrier
    ds_read_b128 v[60:63], v133 offset:13568
    s_waitcnt lgkmcnt(0)
    v_max3_f32 v126, v60, v61, v62
    v_max3_f32 v126, v126, v63, v124
    s_nop 1
    v_max_f32_dpp v126, v126, v126 quad_perm:[2,3,0,1] row_mask:0xf bank_mask:0xf
    v_mov_b32 v127, v126
    s_nop 1
    v_permlane16_swap_b32 v126, v127
    v_max_f32 v126, v126, v127
    v_mov_b32 v127, v126
    s_nop 1
    v_permlane32_swap_b32 v126, v127
    v_max_f32 v126, v126, v127
    v_sub_f32 v60, v60, v126
    v_exp_f32 v60, v60
    v_sub_f32 v61, v61, v126
    v_exp_f32 v61, v61
    v_sub_f32 v62, v62, v126
    v_exp_f32 v62, v62
    v_sub_f32 v63, v63, v126
    v_exp_f32 v63, v63
    v_sub_f32 v124, v124, v126
    v_exp_f32 v124, v124
    v_cvt_pk_bf16_f32 v60, v60, v61
    v_cvt_pk_bf16_f32 v61, v62, v63
    v_cvt_pk_bf16_f32 v62, v124, 0
    v_mov_b64 v[52:53], 0
    v_mov_b64 v[54:55], 0
    v_mov_b64 v[56:57], 0
    v_mov_b64 v[58:59], 0
    v_mov_b32 v63, 0
    s_nop 1
    v_mfma_f32_16x16x32_bf16 v[48:51], v[60:63], v[120:123], 0
    v_smfmac_f32_16x16x32_bf16 v[52:55], v[62:63], v[130:133], v131
    v_smfmac_f32_16x16x32_bf16 v[56:59], v[62:63], v[134:137], v131
    v_smfmac_f32_16x16x32_bf16 v[52:55], v[60:61], v[96:99], v131 abid:2
    v_smfmac_f32_16x16x32_bf16 v[56:59], v[60:61], v[100:103], v131 abid:2
    s_nop 3
    v_add_f32 v48, v48, v50
    v_add_f32 v49, v49, v51
    v_rcp_f32 v50, v48
    v_rcp_f32 v51, v49
    v_pk_add_f32 v[52:53], v[52:53], v[54:55]
    v_pk_mul_f32 v[52:53], v[52:53], v[50:51]
    v_max3_f32 v126, v48, v49, v50
    v_pk_add_f32 v[56:57], v[56:57], v[58:59]
    v_pk_mul_f32 v[56:57], v[56:57], v[50:51]
    v_cvt_pk_bf16_f32 v52, v52, v56
    v_cvt_pk_bf16_f32 v53, v53, v57
    ds_write2_b32 v141, v52, v53 offset0:0 offset1:136
    ds_read_b128 v[48:51], v142 offset:192
    v_mfma_f32_16x16x16_bf16 v[80:83], v[128:129], v[128:129], 0
    v_mfma_f32_16x16x16_bf16 v[84:87], v[128:129], v[128:129], 0
    v_mfma_f32_16x16x16_bf16 v[76:79], v[128:129], v[128:129], 0
    s_branch L_tslow30_back
L_tslow31_miss:
    s_waitcnt lgkmcnt(0)
    v_max3_u32 v132, v0, v1, v2
    v_max3_u32 v130, v3, v4, v5
    v_max3_u32 v132, v132, v6, v7
    v_max_u32 v132, v132, v130
    v_cmpx_eq_u32 vcc, -1, v132
    s_cbranch_execz L_tslow31_whole
L_tslow31_reload:
    buffer_load_dwordx4 v[0:3], v133, s[4:7], s26 offen sc1
    buffer_load_dwordx4 v[4:7], v133, s[4:7], s27 offen sc1
    s_movk_i32 s3, 16
    s_sub_u32 s24, s24, 1
    s_cbranch_scc1 L_timeout
    v_max3_u32 v132, v0, v1, v2
    v_max3_u32 v130, v3, v4, v5
    v_max3_u32 v132, v132, v6, v7
    v_max_u32 v132, v132, v130
    v_cmpx_eq_u32 vcc, -1, v132
    s_cbranch_execnz L_tslow31_reload
L_tslow31_whole:
    s_mov_b64 exec, -1
    s_mov_b64 s[16:17], 0
    ds_read_b128 v[32:35], v138 offset:0
    ds_read_b128 v[36:39], v138 offset:1024
    ds_read_b128 v[40:43], v138 offset:2048
    ds_read_b128 v[44:47], v138 offset:3072
    ds_read_b128 v[48:51], v138 offset:4096
    ds_read_b128 v[52:55], v138 offset:5120
    ds_read_b128 v[56:59], v138 offset:6144
    ds_read_b128 v[60:63], v138 offset:7168
    v_mov_b64 v[64:65], 0
    v_mov_b64 v[66:67], 0
    v_mov_b64 v[68:69], 0
    v_mov_b64 v[70:71], 0
    v_mov_b64 v[72:73], 0
    v_mov_b64 v[74:75], 0
    v_mov_b64 v[76:77], 0
    v_mov_b64 v[78:79], 0
    v_mov_b64 v[80:81], 0
    v_mov_b64 v[82:83], 0
    v_mov_b64 v[84:85], 0
    v_mov_b64 v[86:87], 0
    s_waitcnt vmcnt(0)
    ds_write_b128 v133, v[4:7] offset:7168
    s_branch L_tslow31_again
L_tslow31_big:
    ds_write_b32 v133, v72 offset:13580
    s_waitcnt lgkmcnt(0)
    s_barrier
    ds_read_b128 v[60:63], v133 offset:13568
    s_waitcnt lgkmcnt(0)
    v_max3_f32 v126, v60, v61, v62
    v_max3_f32 v126, v126, v63, v124
    s_nop 1
    v_max_f32_dpp v126, v126, v126 quad_perm:[2,3,0,1] row_mask:0xf bank_mask:0xf
    v_mov_b32 v127, v126
    s_nop 1
    v_permlane16_swap_b32 v126, v127
    v_max_f32 v126, v126, v127
    v_mov_b32 v127, v126
    s_nop 1
    v_permlane32_swap_b32 v126, v127
    v_max_f32 v126, v126, v127
    v_sub_f32 v60, v60, v126
    v_exp_f32 v60, v60
    v_sub_f32 v61, v61, v126
    v_exp_f32 v61, v61
    v_sub_f32 v62, v62, v126
    v_exp_f32 v62, v62
    v_sub_f32 v63, v63, v126
    v_exp_f32 v63, v63
    v_sub_f32 v124, v124, v126
    v_exp_f32 v124, v124
    v_cvt_pk_bf16_f32 v60, v60, v61
    v_cvt_pk_bf16_f32 v61, v62, v63
    v_cvt_pk_bf16_f32 v62, v124, 0
    v_mov_b64 v[52:53], 0
    v_mov_b64 v[54:55], 0
    v_mov_b64 v[56:57], 0
    v_mov_b64 v[58:59], 0
    v_mov_b32 v63, 0
    s_nop 1
    v_mfma_f32_16x16x32_bf16 v[48:51], v[60:63], v[120:123], 0
    v_smfmac_f32_16x16x32_bf16 v[52:55], v[62:63], v[130:133], v131
    v_smfmac_f32_16x16x32_bf16 v[56:59], v[62:63], v[134:137], v131
    v_smfmac_f32_16x16x32_bf16 v[52:55], v[60:61], v[112:115], v131 abid:2
    v_smfmac_f32_16x16x32_bf16 v[56:59], v[60:61], v[116:119], v131 abid:2
    s_nop 3
    v_add_f32 v48, v48, v50
    v_add_f32 v49, v49, v51
    v_rcp_f32 v50, v48
    v_rcp_f32 v51, v49
    v_pk_add_f32 v[52:53], v[52:53], v[54:55]
    v_pk_mul_f32 v[52:53], v[52:53], v[50:51]
    v_max3_f32 v126, v48, v49, v50
    v_pk_add_f32 v[56:57], v[56:57], v[58:59]
    v_pk_mul_f32 v[56:57], v[56:57], v[50:51]
    v_cvt_pk_bf16_f32 v52, v52, v56
    v_cvt_pk_bf16_f32 v53, v53, v57
    ds_write2_b32 v141, v52, v53 offset0:0 offset1:136
    ds_read_b128 v[48:51], v142 offset:192
    v_mfma_f32_16x16x16_bf16 v[80:83], v[128:129], v[128:129], 0
    v_mfma_f32_16x16x16_bf16 v[84:87], v[128:129], v[128:129], 0
    v_mfma_f32_16x16x16_bf16 v[76:79], v[128:129], v[128:129], 0
    s_branch L_tslow31_back
L_team_slow_end:
L_proj:
    s_getpc_b64 s[98:99]
L_pc_29:
    v_lshlrev_b32 v100, 7, v0
    v_add_u32 v100, 0, v100
    v_min_u32 v100, L_proj_end-L_pc_29-4, v100
    v_mov_b32 v101, s99
    v_add_co_u32 v100, vcc, s98, v100
    s_nop 1
    v_addc_co_u32 v101, vcc, 0, v101, vcc
    global_load_dword v102, v[100:101], off
    s_lshl_b32 s30, s22, 20
    s_lshl_b32 s3, s21, 8
    s_add_u32 s30, s30, s3
    s_add_u32 s31, s30, 0x80000
    s_lshl_b32 s33, s22, 12
    v_bfe_u32 v2, v0, 0, 4
    v_mul_u32_u24 v2, 16, v2
    v_bfe_u32 v16, v0, 4, 2
    v_mul_u32_u24 v16, 32, v16
    v_xor_b32 v2, v2, v16
    v_bfe_u32 v16, v0, 4, 1
    v_mul_u32_u24 v16, 131072, v16
    v_add_u32 v2, v2, v16
    v_bfe_u32 v16, v0, 5, 1
    v_mul_u32_u24 v16, 8192, v16
    v_add_u32 v2, v2, v16
    v_bfe_u32 v3, v0, 0, 4
    v_mul_u32_u24 v3, 16, v3
    v_bfe_u32 v16, v0, 4, 2
    v_mul_u32_u24 v16, 32, v16
    v_xor_b32 v3, v3, v16
    v_xor_b32 v3, 128, v3
    v_bfe_u32 v16, v0, 4, 1
    v_mul_u32_u24 v16, 131072, v16
    v_add_u32 v3, v3, v16
    v_bfe_u32 v16, v0, 5, 1
    v_mul_u32_u24 v16, 8192, v16
    v_add_u32 v3, v3, v16
    s_waitcnt lgkmcnt(0)
    s_barrier
    s_mov_b32 s8, s70
    s_mov_b32 s9, s71
    s_mov_b32 s10, 0x400000
    s_mov_b32 s11, 0x20000
    s_add_u32 m0, s33, 114688
    s_add_u32 s34, s30, 0x0
    buffer_load_dwordx4 v2, s[8:11], s34 offen  lds
    s_add_u32 m0, s33, 115712
    s_add_u32 s34, s30, 0x8000
    buffer_load_dwordx4 v3, s[8:11], s34 offen  lds
    s_add_u32 m0, s33, 116736
    s_add_u32 s34, s30, 0x10000
    buffer_load_dwordx4 v2, s[8:11], s34 offen  lds
    s_add_u32 m0, s33, 117760
    s_add_u32 s34, s30, 0x18000
    buffer_load_dwordx4 v3, s[8:11], s34 offen  lds
    s_add_u32 m0, s33, 131072
    s_add_u32 s34, s30, 0x4000
    buffer_load_dwordx4 v2, s[8:11], s34 offen  lds
    s_add_u32 m0, s33, 132096
    s_add_u32 s34, s30, 0xc000
    buffer_load_dwordx4 v3, s[8:11], s34 offen  lds
    s_add_u32 m0, s33, 133120
    s_add_u32 s34, s30, 0x14000
    buffer_load_dwordx4 v2, s[8:11], s34 offen  lds
    s_add_u32 m0, s33, 134144
    s_add_u32 s34, s30, 0x1c000
    buffer_load_dwordx4 v3, s[8:11], s34 offen  lds
    s_add_u32 m0, s33, 147456
    s_add_u32 s34, s30, 0x40000
    buffer_load_dwordx4 v2, s[8:11], s34 offen  lds
    s_add_u32 m0, s33, 148480
    s_add_u32 s34, s30, 0x48000
    buffer_load_dwordx4 v3, s[8:11], s34 offen  lds
    s_add_u32 m0, s33, 149504
    s_add_u32 s34, s30, 0x50000
    buffer_load_dwordx4 v2, s[8:11], s34 offen  lds
    s_add_u32 m0, s33, 150528
    s_add_u32 s34, s30, 0x58000
    buffer_load_dwordx4 v3, s[8:11], s34 offen  lds
    v_bfe_u32 v4, v0, 0, 1
    v_mul_u32_u24 v4, 8, v4
    v_bfe_u32 v16, v0, 1, 1
    v_mul_u32_u24 v16, 16, v16
    v_xor_b32 v4, v4, v16
    v_bfe_u32 v16, v0, 2, 2
    v_mul_u32_u24 v16, 256, v16
    v_xor_b32 v4, v4, v16
    v_bfe_u32 v16, v0, 2, 2
    v_mul_u32_u24 v16, 32, v16
    v_xor_b32 v4, v4, v16
    v_bfe_u32 v16, v0, 4, 1
    v_mul_u32_u24 v16, 128, v16
    v_xor_b32 v4, v4, v16
    v_bfe_u32 v16, v0, 4, 2
    v_mul_u32_u24 v16, 1024, v16
    v_xor_b32 v4, v4, v16
    v_bfe_u32 v16, v0, 6, 2
    v_mul_u32_u24 v16, 64, v16
    v_xor_b32 v4, v4, v16
    v_xor_b32 v5, 32, v4
    v_xor_b32 v6, 4096, v4
    v_xor_b32 v7, 4128, v4
    v_xor_b32 v8, 8192, v4
    v_xor_b32 v9, 8224, v4
    v_xor_b32 v10, 12288, v4
    v_xor_b32 v11, 12320, v4
    v_add_u32 v4, 114688, v4
    v_add_u32 v5, 114688, v5
    v_add_u32 v6, 114688, v6
    v_add_u32 v7, 114688, v7
    v_add_u32 v8, 114688, v8
    v_add_u32 v9, 114688, v9
    v_add_u32 v10, 114688, v10
    v_add_u32 v11, 114688, v11
    v_bfe_u32 v116, v0, 0, 6
    v_mul_u32_u24 v116, 16, v116
    v_bfe_u32 v120, v0, 0, 6
    v_mul_u32_u24 v120, 16, v120
    v_bfe_u32 v16, v0, 6, 2
    v_mul_u32_u24 v16, 2048, v16
    v_add_u32 v120, v120, v16
    v_add_u32 v120, 139264, v120
    v_bfe_u32 v121, v0, 0, 6
    v_mul_u32_u24 v121, 16, v121
    v_add_u32 v121, 139264, v121
    v_bfe_u32 v122, v0, 0, 4
    v_mul_u32_u24 v122, 4, v122
    v_bfe_u32 v16, v0, 4, 2
    v_mul_u32_u24 v16, 576, v16
    v_add_u32 v122, v122, v16
    v_bfe_u32 v16, v0, 6, 2
    v_mul_u32_u24 v16, 64, v16
    v_add_u32 v122, v122, v16
    v_add_u32 v122, 147456, v122
    v_bfe_u32 v123, v0, 0, 1
    v_mul_u32_u24 v123, 288, v123
    v_bfe_u32 v16, v0, 2, 2
    v_mul_u32_u24 v16, 576, v16
    v_add_u32 v123, v123, v16
    v_bfe_u32 v16, v0, 4, 2
    v_mul_u32_u24 v16, 16, v16
    v_add_u32 v123, v123, v16
    v_add_u32 v123, 147456, v123
    v_bfe_u32 v119, v0, 1, 1
    v_mul_u32_u24 v119, 43690, v119
    v_add_u32 v119, 17476, v119
    v_bfe_u32 v127, v0, 0, 1
    v_mul_u32_u24 v127, 4096, v127
    v_bfe_u32 v16, v0, 1, 1
    v_mul_u32_u24 v16, 2048, v16
    v_add_u32 v127, v127, v16
    v_bfe_u32 v16, v0, 2, 2
    v_mul_u32_u24 v16, 64, v16
    v_add_u32 v127, v127, v16
    v_bfe_u32 v16, v0, 4, 2
    v_mul_u32_u24 v16, 256, v16
    v_add_u32 v127, v127, v16
    v_bfe_u32 v16, v0, 6, 2
    v_mul_u32_u24 v16, 16, v16
    v_add_u32 v127, v127, v16
    v_mov_b32 v117, 0
    s_mov_b32 s35, 0x3e0293ee
    v_bfe_u32 v20, v0, 4, 2
    v_mul_u32_u24 v20, 4, v20
    v_bfe_u32 v21, v0, 0, 4
    v_add_u32 v22, 0, v20
    v_cmp_gt_u32 s[40:41], v22, v21
    v_add_u32 v22, 1, v20
    v_cmp_gt_u32 s[42:43], v22, v21
    v_add_u32 v22, 2, v20
    v_cmp_gt_u32 s[44:45], v22, v21
    v_add_u32 v22, 3, v20
    v_cmp_gt_u32 s[46:47], v22, v21
    s_sub_u32 s25, s20, 1
    s_mov_b32 s26, s25
    s_mov_b32 s27, 0
    s_mov_b32 s28, 65536
    s_mov_b32 s29, 65536
    s_waitcnt vmcnt(8)
    s_barrier
    ds_read_b64_tr_b16 v[128:129], v4 offset:0
    ds_read_b64_tr_b16 v[192:193], v5 offset:0
    ds_read_b64_tr_b16 v[144:145], v6 offset:0
    ds_read_b64_tr_b16 v[208:209], v7 offset:0
    ds_read_b64_tr_b16 v[160:161], v8 offset:0
    ds_read_b64_tr_b16 v[224:225], v9 offset:0
    ds_read_b64_tr_b16 v[176:177], v10 offset:0
    ds_read_b64_tr_b16 v[240:241], v11 offset:0
    s_waitcnt lgkmcnt(0)
    s_barrier
    s_add_u32 m0, s33, 114688
    s_add_u32 s34, s30, 0x44000
    buffer_load_dwordx4 v2, s[8:11], s34 offen  lds
    s_add_u32 m0, s33, 115712
    s_add_u32 s34, s30, 0x4c000
    buffer_load_dwordx4 v3, s[8:11], s34 offen  lds
    s_add_u32 m0, s33, 116736
    s_add_u32 s34, s30, 0x54000
    buffer_load_dwordx4 v2, s[8:11], s34 offen  lds
    s_add_u32 m0, s33, 117760
    s_add_u32 s34, s30, 0x5c000
    buffer_load_dwordx4 v3, s[8:11], s34 offen  lds
    s_waitcnt vmcnt(8)
    s_barrier
    ds_read_b64_tr_b16 v[130:131], v4 offset:16384
    ds_read_b64_tr_b16 v[194:195], v5 offset:16384
    ds_read_b64_tr_b16 v[146:147], v6 offset:16384
    ds_read_b64_tr_b16 v[210:211], v7 offset:16384
    ds_read_b64_tr_b16 v[162:163], v8 offset:16384
    ds_read_b64_tr_b16 v[226:227], v9 offset:16384
    ds_read_b64_tr_b16 v[178:179], v10 offset:16384
    ds_read_b64_tr_b16 v[242:243], v11 offset:16384
    s_waitcnt lgkmcnt(0)
    s_barrier
    s_add_u32 m0, s33, 131072
    s_add_u32 s34, s31, 0x0
    buffer_load_dwordx4 v2, s[8:11], s34 offen  lds
    s_add_u32 m0, s33, 132096
    s_add_u32 s34, s31, 0x8000
    buffer_load_dwordx4 v3, s[8:11], s34 offen  lds
    s_add_u32 m0, s33, 133120
    s_add_u32 s34, s31, 0x10000
    buffer_load_dwordx4 v2, s[8:11], s34 offen  lds
    s_add_u32 m0, s33, 134144
    s_add_u32 s34, s31, 0x18000
    buffer_load_dwordx4 v3, s[8:11], s34 offen  lds
    s_waitcnt vmcnt(8)
    s_barrier
    ds_read_b64_tr_b16 v[132:133], v4 offset:32768
    ds_read_b64_tr_b16 v[196:197], v5 offset:32768
    ds_read_b64_tr_b16 v[148:149], v6 offset:32768
    ds_read_b64_tr_b16 v[212:213], v7 offset:32768
    ds_read_b64_tr_b16 v[164:165], v8 offset:32768
    ds_read_b64_tr_b16 v[228:229], v9 offset:32768
    ds_read_b64_tr_b16 v[180:181], v10 offset:32768
    ds_read_b64_tr_b16 v[244:245], v11 offset:32768
    s_waitcnt lgkmcnt(0)
    s_barrier
    s_add_u32 m0, s33, 147456
    s_add_u32 s34, s31, 0x4000
    buffer_load_dwordx4 v2, s[8:11], s34 offen  lds
    s_add_u32 m0, s33, 148480
    s_add_u32 s34, s31, 0xc000
    buffer_load_dwordx4 v3, s[8:11], s34 offen  lds
    s_add_u32 m0, s33, 149504
    s_add_u32 s34, s31, 0x14000
    buffer_load_dwordx4 v2, s[8:11], s34 offen  lds
    s_add_u32 m0, s33, 150528
    s_add_u32 s34, s31, 0x1c000
    buffer_load_dwordx4 v3, s[8:11], s34 offen  lds
    s_or_b32 s3, s2, s22
    s_cbranch_scc1 L_asked_30
    s_mov_b64 exec, 1
    s_lshl_b32 s3, 1, s21
    v_mov_b32 v98, s3
    v_mov_b32 v99, s23
    s_add_u32 s3, s20, 4
    s_lshr_b32 s3, s3, 2
    s_lshl_b32 s3, s3, 3
    s_add_u32 s3, s3, s20
    s_lshl_b32 s3, s3, 3
    s_cmp_eq_u32 s20, 0
    s_cselect_b32 s3, 0, s3
    buffer_atomic_or_x2 v[98:99], off, s[12:15], s3 sc0 sc1
    s_mov_b64 exec, -1
L_asked_30:
    s_waitcnt vmcnt(8)
    s_barrier
    ds_read_b64_tr_b16 v[134:135], v4 offset:0
    ds_read_b64_tr_b16 v[198:199], v5 offset:0
    ds_read_b64_tr_b16 v[150:151], v6 offset:0
    ds_read_b64_tr_b16 v[214:215], v7 offset:0
    ds_read_b64_tr_b16 v[166:167], v8 offset:0
    ds_read_b64_tr_b16 v[230:231], v9 offset:0
    ds_read_b64_tr_b16 v[182:183], v10 offset:0
    ds_read_b64_tr_b16 v[246:247], v11 offset:0
    s_waitcnt lgkmcnt(0)
    s_barrier
    s_add_u32 m0, s33, 114688
    s_add_u32 s34, s31, 0x40000
    buffer_load_dwordx4 v2, s[8:11], s34 offen  lds
    s_add_u32 m0, s33, 115712
    s_add_u32 s34, s31, 0x48000
    buffer_load_dwordx4 v3, s[8:11], s34 offen  lds
    s_add_u32 m0, s33, 116736
    s_add_u32 s34, s31, 0x50000
    buffer_load_dwordx4 v2, s[8:11], s34 offen  lds
    s_add_u32 m0, s33, 117760
    s_add_u32 s34, s31, 0x58000
    buffer_load_dwordx4 v3, s[8:11], s34 offen  lds
    s_waitcnt vmcnt(8)
    s_barrier
    ds_read_b64_tr_b16 v[136:137], v4 offset:16384
    ds_read_b64_tr_b16 v[200:201], v5 offset:16384
    ds_read_b64_tr_b16 v[152:153], v6 offset:16384
    ds_read_b64_tr_b16 v[216:217], v7 offset:16384
    ds_read_b64_tr_b16 v[168:169], v8 offset:16384
    ds_read_b64_tr_b16 v[232:233], v9 offset:16384
    ds_read_b64_tr_b16 v[184:185], v10 offset:16384
    ds_read_b64_tr_b16 v[248:249], v11 offset:16384
    s_waitcnt lgkmcnt(0)
    s_barrier
    s_add_u32 m0, s33, 131072
    s_add_u32 s34, s31, 0x44000
    buffer_load_dwordx4 v2, s[8:11], s34 offen  lds
    s_add_u32 m0, s33, 132096
    s_add_u32 s34, s31, 0x4c000
    buffer_load_dwordx4 v3, s[8:11], s34 offen  lds
    s_add_u32 m0, s33, 133120
    s_add_u32 s34, s31, 0x54000
    buffer_load_dwordx4 v2, s[8:11], s34 offen  lds
    s_add_u32 m0, s33, 134144
    s_add_u32 s34, s31, 0x5c000
    buffer_load_dwordx4 v3, s[8:11], s34 offen  lds
    s_waitcnt vmcnt(8)
    s_barrier
    ds_read_b64_tr_b16 v[138:139], v4 offset:32768
    ds_read_b64_tr_b16 v[202:203], v5 offset:32768
    ds_read_b64_tr_b16 v[154:155], v6 offset:32768
    ds_read_b64_tr_b16 v[218:219], v7 offset:32768
    ds_read_b64_tr_b16 v[170:171], v8 offset:32768
    ds_read_b64_tr_b16 v[234:235], v9 offset:32768
    ds_read_b64_tr_b16 v[186:187], v10 offset:32768
    ds_read_b64_tr_b16 v[250:251], v11 offset:32768
    s_waitcnt lgkmcnt(0)
    s_barrier
    s_mov_b32 s8, s72
    s_mov_b32 s9, s73
    s_mov_b32 s10, 0x400000
    s_mov_b32 s11, 0x20000
    s_add_u32 m0, s33, 147456
    s_add_u32 s34, s30, 0x0
    buffer_load_dwordx4 v2, s[8:11], s34 offen  lds
    s_add_u32 m0, s33, 148480
    s_add_u32 s34, s30, 0x8000
    buffer_load_dwordx4 v3, s[8:11], s34 offen  lds
    s_add_u32 m0, s33, 149504
    s_add_u32 s34, s30, 0x10000
    buffer_load_dwordx4 v2, s[8:11], s34 offen  lds
    s_add_u32 m0, s33, 150528
    s_add_u32 s34, s30, 0x18000
    buffer_load_dwordx4 v3, s[8:11], s34 offen  lds
    s_waitcnt vmcnt(8)
    s_barrier
    ds_read_b64_tr_b16 v[140:141], v4 offset:0
    ds_read_b64_tr_b16 v[204:205], v5 offset:0
    ds_read_b64_tr_b16 v[156:157], v6 offset:0
    ds_read_b64_tr_b16 v[220:221], v7 offset:0
    ds_read_b64_tr_b16 v[172:173], v8 offset:0
    ds_read_b64_tr_b16 v[236:237], v9 offset:0
    ds_read_b64_tr_b16 v[188:189], v10 offset:0
    ds_read_b64_tr_b16 v[252:253], v11 offset:0
    s_cmp_lg_u32 s2, 0
    s_cbranch_scc1 L_sure_32
    v_mov_b32 v16, 65536
    s_cmp_lg_u32 s22, 0
    s_cbranch_scc1 L_told_31
    s_waitcnt vmcnt(8)
    s_mov_b64 exec, 1
    ds_write_b32 v16, v98
    s_mov_b64 exec, -1
    s_waitcnt lgkmcnt(0)
L_told_31:
    s_barrier
    ds_read_b32 v1, v16
    s_waitcnt lgkmcnt(0)
    v_readfirstlane_b32 s3, v1
    s_nop 0
    s_bitcmp1_b32 s3, s21
    s_cbranch_scc1 L_search
L_sure_32:
    s_waitcnt lgkmcnt(0)
    s_barrier
    s_add_u32 m0, s33, 114688
    s_add_u32 s34, s30, 0x4000
    buffer_load_dwordx4 v2, s[8:11], s34 offen  lds
    s_add_u32 m0, s33, 115712
    s_add_u32 s34, s30, 0xc000
    buffer_load_dwordx4 v3, s[8:11], s34 offen  lds
    s_add_u32 m0, s33, 116736
    s_add_u32 s34, s30, 0x14000
    buffer_load_dwordx4 v2, s[8:11], s34 offen  lds
    s_add_u32 m0, s33, 117760
    s_add_u32 s34, s30, 0x1c000
    buffer_load_dwordx4 v3, s[8:11], s34 offen  lds
    s_waitcnt vmcnt(8)
    s_barrier
    ds_read_b64_tr_b16 v[142:143], v4 offset:16384
    ds_read_b64_tr_b16 v[206:207], v5 offset:16384
    ds_read_b64_tr_b16 v[158:159], v6 offset:16384
    ds_read_b64_tr_b16 v[222:223], v7 offset:16384
    ds_read_b64_tr_b16 v[174:175], v8 offset:16384
    ds_read_b64_tr_b16 v[238:239], v9 offset:16384
    ds_read_b64_tr_b16 v[190:191], v10 offset:16384
    ds_read_b64_tr_b16 v[254:255], v11 offset:16384
    s_waitcnt lgkmcnt(0)
    s_barrier
    s_add_u32 m0, s33, 131072
    s_add_u32 s34, s30, 0x40000
    buffer_load_dwordx4 v2, s[8:11], s34 offen  lds
    s_add_u32 m0, s33, 132096
    s_add_u32 s34, s30, 0x48000
    buffer_load_dwordx4 v3, s[8:11], s34 offen  lds
    s_add_u32 m0, s33, 133120
    s_add_u32 s34, s30, 0x50000
    buffer_load_dwordx4 v2, s[8:11], s34 offen  lds
    s_add_u32 m0, s33, 134144
    s_add_u32 s34, s30, 0x58000
    buffer_load_dwordx4 v3, s[8:11], s34 offen  lds
    s_waitcnt vmcnt(8)
    s_barrier
    ds_read_b64_tr_b16 a[0:1], v4 offset:32768
    ds_read_b64_tr_b16 a[64:65], v5 offset:32768
    ds_read_b64_tr_b16 a[16:17], v6 offset:32768
    ds_read_b64_tr_b16 a[80:81], v7 offset:32768
    ds_read_b64_tr_b16 a[32:33], v8 offset:32768
    ds_read_b64_tr_b16 a[96:97], v9 offset:32768
    ds_read_b64_tr_b16 a[48:49], v10 offset:32768
    ds_read_b64_tr_b16 a[112:113], v11 offset:32768
    s_waitcnt lgkmcnt(0)
    s_barrier
    s_add_u32 m0, s33, 147456
    s_add_u32 s34, s30, 0x44000
    buffer_load_dwordx4 v2, s[8:11], s34 offen  lds
    s_add_u32 m0, s33, 148480
    s_add_u32 s34, s30, 0x4c000
    buffer_load_dwordx4 v3, s[8:11], s34 offen  lds
    s_add_u32 m0, s33, 149504
    s_add_u32 s34, s30, 0x54000
    buffer_load_dwordx4 v2, s[8:11], s34 offen  lds
    s_add_u32 m0, s33, 150528
    s_add_u32 s34, s30, 0x5c000
    buffer_load_dwordx4 v3, s[8:11], s34 offen  lds
    s_waitcnt vmcnt(8)
    s_barrier
    ds_read_b64_tr_b16 a[2:3], v4 offset:0
    ds_read_b64_tr_b16 a[66:67], v5 offset:0
    ds_read_b64_tr_b16 a[18:19], v6 offset:0
    ds_read_b64_tr_b16 a[82:83], v7 offset:0
    ds_read_b64_tr_b16 a[34:35], v8 offset:0
    ds_read_b64_tr_b16 a[98:99], v9 offset:0
    ds_read_b64_tr_b16 a[50:51], v10 offset:0
    ds_read_b64_tr_b16 a[114:115], v11 offset:0
    s_waitcnt lgkmcnt(0)
    s_barrier
    s_add_u32 m0, s33, 114688
    s_add_u32 s34, s31, 0x0
    buffer_load_dwordx4 v2, s[8:11], s34 offen  lds
    s_add_u32 m0, s33, 115712
    s_add_u32 s34, s31, 0x8000
    buffer_load_dwordx4 v3, s[8:11], s34 offen  lds
    s_add_u32 m0, s33, 116736
    s_add_u32 s34, s31, 0x10000
    buffer_load_dwordx4 v2, s[8:11], s34 offen  lds
    s_add_u32 m0, s33, 117760
    s_add_u32 s34, s31, 0x18000
    buffer_load_dwordx4 v3, s[8:11], s34 offen  lds
    buffer_load_dword v20, v117, s[12:15], 0 offen offset:192 sc1
    s_waitcnt vmcnt(9)
    s_barrier
    ds_read_b64_tr_b16 a[4:5], v4 offset:16384
    ds_read_b64_tr_b16 a[68:69], v5 offset:16384
    ds_read_b64_tr_b16 a[20:21], v6 offset:16384
    ds_read_b64_tr_b16 a[84:85], v7 offset:16384
    ds_read_b64_tr_b16 a[36:37], v8 offset:16384
    ds_read_b64_tr_b16 a[100:101], v9 offset:16384
    ds_read_b64_tr_b16 a[52:53], v10 offset:16384
    ds_read_b64_tr_b16 a[116:117], v11 offset:16384
    s_waitcnt lgkmcnt(0)
    s_barrier
    s_add_u32 m0, s33, 131072
    s_add_u32 s34, s31, 0x4000
    buffer_load_dwordx4 v2, s[8:11], s34 offen  lds
    s_add_u32 m0, s33, 132096
    s_add_u32 s34, s31, 0xc000
    buffer_load_dwordx4 v3, s[8:11], s34 offen  lds
    s_add_u32 m0, s33, 133120
    s_add_u32 s34, s31, 0x14000
    buffer_load_dwordx4 v2, s[8:11], s34 offen  lds
    s_add_u32 m0, s33, 134144
    s_add_u32 s34, s31, 0x1c000
    buffer_load_dwordx4 v3, s[8:11], s34 offen  lds
    s_waitcnt vmcnt(9)
    s_barrier
    ds_read_b64_tr_b16 a[6:7], v4 offset:32768
    ds_read_b64_tr_b16 a[70:71], v5 offset:32768
    ds_read_b64_tr_b16 a[22:23], v6 offset:32768
    ds_read_b64_tr_b16 a[86:87], v7 offset:32768
    ds_read_b64_tr_b16 a[38:39], v8 offset:32768
    ds_read_b64_tr_b16 a[102:103], v9 offset:32768
    ds_read_b64_tr_b16 a[54:55], v10 offset:32768
    ds_read_b64_tr_b16 a[118:119], v11 offset:32768
    s_waitcnt lgkmcnt(0)
    s_barrier
    s_add_u32 m0, s33, 147456
    s_add_u32 s34, s31, 0x40000
    buffer_load_dwordx4 v2, s[8:11], s34 offen  lds
    s_add_u32 m0, s33, 148480
    s_add_u32 s34, s31, 0x48000
    buffer_load_dwordx4 v3, s[8:11], s34 offen  lds
    s_add_u32 m0, s33, 149504
    s_add_u32 s34, s31, 0x50000
    buffer_load_dwordx4 v2, s[8:11], s34 offen  lds
    s_add_u32 m0, s33, 150528
    s_add_u32 s34, s31, 0x58000
    buffer_load_dwordx4 v3, s[8:11], s34 offen  lds
    s_waitcnt vmcnt(9)
    s_barrier
    ds_read_b64_tr_b16 a[8:9], v4 offset:0
    ds_read_b64_tr_b16 a[72:73], v5 offset:0
    ds_read_b64_tr_b16 a[24:25], v6 offset:0
    ds_read_b64_tr_b16 a[88:89], v7 offset:0
    ds_read_b64_tr_b16 a[40:41], v8 offset:0
    ds_read_b64_tr_b16 a[104:105], v9 offset:0
    ds_read_b64_tr_b16 a[56:57], v10 offset:0
    ds_read_b64_tr_b16 a[120:121], v11 offset:0
    s_waitcnt lgkmcnt(0)
    s_barrier
    s_add_u32 m0, s33, 114688
    s_add_u32 s34, s31, 0x44000
    buffer_load_dwordx4 v2, s[8:11], s34 offen  lds
    s_add_u32 m0, s33, 115712
    s_add_u32 s34, s31, 0x4c000
    buffer_load_dwordx4 v3, s[8:11], s34 offen  lds
    s_add_u32 m0, s33, 116736
    s_add_u32 s34, s31, 0x54000
    buffer_load_dwordx4 v2, s[8:11], s34 offen  lds
    s_add_u32 m0, s33, 117760
    s_add_u32 s34, s31, 0x5c000
    buffer_load_dwordx4 v3, s[8:11], s34 offen  lds
    s_waitcnt vmcnt(8)
    s_barrier
    ds_read_b64_tr_b16 a[10:11], v4 offset:16384
    ds_read_b64_tr_b16 a[74:75], v5 offset:16384
    ds_read_b64_tr_b16 a[26:27], v6 offset:16384
    ds_read_b64_tr_b16 a[90:91], v7 offset:16384
    ds_read_b64_tr_b16 a[42:43], v8 offset:16384
    ds_read_b64_tr_b16 a[106:107], v9 offset:16384
    ds_read_b64_tr_b16 a[58:59], v10 offset:16384
    ds_read_b64_tr_b16 a[122:123], v11 offset:16384
    v_cmp_gt_u32 vcc, 128, v20
    s_nop 0
    s_mov_b32 s50, vcc_lo
    s_add_u32 s36, s25, 0
    s_mov_b32 s27, 0
    s_cmp_eq_u32 s50, 0
    s_cselect_b32 s36, s36, 2048
    s_lshl_b32 s34, s36, 15
    s_lshl_b32 s3, s22, 13
    s_add_u32 s34, s34, s3
    s_add_u32 s34, s34, 0x200000
    s_add_u32 s3, s3, s27
    s_add_u32 m0, s3, 0
    s_nop 0
    buffer_load_dwordx4 v116, s[4:7], s34 offen offset:0 sc1 lds
    buffer_load_dwordx4 v116, s[4:7], s34 offen offset:1024 sc1 lds
    buffer_load_dwordx4 v116, s[4:7], s34 offen offset:2048 sc1 lds
    buffer_load_dwordx4 v116, s[4:7], s34 offen offset:3072 sc1 lds
    s_add_u32 m0, s3, 4096
    s_add_u32 s34, s34, 4096
    buffer_load_dwordx4 v116, s[4:7], s34 offen offset:0 sc1 lds
    buffer_load_dwordx4 v116, s[4:7], s34 offen offset:1024 sc1 lds
    buffer_load_dwordx4 v116, s[4:7], s34 offen offset:2048 sc1 lds
    buffer_load_dwordx4 v116, s[4:7], s34 offen offset:3072 sc1 lds
    s_add_u32 s36, s25, 3
    s_mov_b32 s27, 32768
    s_cmp_eq_u32 s50, 0
    s_cselect_b32 s36, s36, 2048
    s_lshl_b32 s34, s36, 15
    s_lshl_b32 s3, s22, 13
    s_add_u32 s34, s34, s3
    s_add_u32 s34, s34, 0x200000
    s_add_u32 s3, s3, s27
    s_add_u32 m0, s3, 0
    s_nop 0
    buffer_load_dwordx4 v116, s[4:7], s34 offen offset:0 sc1 lds
    buffer_load_dwordx4 v116, s[4:7], s34 offen offset:1024 sc1 lds
    buffer_load_dwordx4 v116, s[4:7], s34 offen offset:2048 sc1 lds
    buffer_load_dwordx4 v116, s[4:7], s34 offen offset:3072 sc1 lds
    s_add_u32 m0, s3, 4096
    s_add_u32 s34, s34, 4096
    buffer_load_dwordx4 v116, s[4:7], s34 offen offset:0 sc1 lds
    buffer_load_dwordx4 v116, s[4:7], s34 offen offset:1024 sc1 lds
    buffer_load_dwordx4 v116, s[4:7], s34 offen offset:2048 sc1 lds
    buffer_load_dwordx4 v116, s[4:7], s34 offen offset:3072 sc1 lds
    s_waitcnt lgkmcnt(0)
    s_barrier
    s_mov_b32 s8, s68
    s_mov_b32 s9, s69
    s_mov_b32 s10, 0x400000
    s_mov_b32 s11, 0x20000
    s_add_u32 m0, s33, 131072
    s_add_u32 s34, s30, 0x0
    buffer_load_dwordx4 v2, s[8:11], s34 offen  lds
    s_add_u32 m0, s33, 132096
    s_add_u32 s34, s30, 0x8000
    buffer_load_dwordx4 v3, s[8:11], s34 offen  lds
    s_add_u32 m0, s33, 133120
    s_add_u32 s34, s30, 0x10000
    buffer_load_dwordx4 v2, s[8:11], s34 offen  lds
    s_add_u32 m0, s33, 134144
    s_add_u32 s34, s30, 0x18000
    buffer_load_dwordx4 v3, s[8:11], s34 offen  lds
    s_waitcnt vmcnt(24)
    s_barrier
    ds_read_b64_tr_b16 a[12:13], v4 offset:32768
    ds_read_b64_tr_b16 a[76:77], v5 offset:32768
    ds_read_b64_tr_b16 a[28:29], v6 offset:32768
    ds_read_b64_tr_b16 a[92:93], v7 offset:32768
    ds_read_b64_tr_b16 a[44:45], v8 offset:32768
    ds_read_b64_tr_b16 a[108:109], v9 offset:32768
    ds_read_b64_tr_b16 a[60:61], v10 offset:32768
    ds_read_b64_tr_b16 a[124:125], v11 offset:32768
    s_waitcnt lgkmcnt(0)
    s_barrier
    s_add_u32 m0, s33, 147456
    s_add_u32 s34, s30, 0x4000
    buffer_load_dwordx4 v2, s[8:11], s34 offen  lds
    s_add_u32 m0, s33, 148480
    s_add_u32 s34, s30, 0xc000
    buffer_load_dwordx4 v3, s[8:11], s34 offen  lds
    s_add_u32 m0, s33, 149504
    s_add_u32 s34, s30, 0x14000
    buffer_load_dwordx4 v2, s[8:11], s34 offen  lds
    s_add_u32 m0, s33, 150528
    s_add_u32 s34, s30, 0x1c000
    buffer_load_dwordx4 v3, s[8:11], s34 offen  lds
    s_waitcnt vmcnt(24)
    s_barrier
    ds_read_b64_tr_b16 a[14:15], v4 offset:0
    ds_read_b64_tr_b16 a[78:79], v5 offset:0
    ds_read_b64_tr_b16 a[30:31], v6 offset:0
    ds_read_b64_tr_b16 a[94:95], v7 offset:0
    ds_read_b64_tr_b16 a[46:47], v8 offset:0
    ds_read_b64_tr_b16 a[110:111], v9 offset:0
    ds_read_b64_tr_b16 a[62:63], v10 offset:0
    ds_read_b64_tr_b16 a[126:127], v11 offset:0
    s_waitcnt lgkmcnt(0)
    s_barrier
    s_add_u32 m0, s33, 114688
    s_add_u32 s34, s30, 0x40000
    buffer_load_dwordx4 v2, s[8:11], s34 offen  lds
    s_add_u32 m0, s33, 115712
    s_add_u32 s34, s30, 0x48000
    buffer_load_dwordx4 v3, s[8:11], s34 offen  lds
    s_add_u32 m0, s33, 116736
    s_add_u32 s34, s30, 0x50000
    buffer_load_dwordx4 v2, s[8:11], s34 offen  lds
    s_add_u32 m0, s33, 117760
    s_add_u32 s34, s30, 0x58000
    buffer_load_dwordx4 v3, s[8:11], s34 offen  lds
    s_waitcnt vmcnt(12)
    s_cmp_eq_u32 s50, 0
    s_cbranch_scc1 L_proj_tok
    s_waitcnt vmcnt(0)
L_poll_33:
    buffer_load_dword v20, v117, s[12:15], 0 offen offset:192 sc1
    s_movk_i32 s3, 32
    s_sub_u32 s24, s24, 1
    s_cbranch_scc1 L_timeout
    s_waitcnt vmcnt(0)
    v_cmp_gt_u32 vcc, 128, v20
    s_cbranch_vccz L_seen_34
    s_sleep 2
    s_branch L_poll_33
L_seen_34:
    s_add_u32 s36, s25, 0
    s_mov_b32 s27, 0
    s_lshl_b32 s34, s36, 15
    s_lshl_b32 s3, s22, 13
    s_add_u32 s34, s34, s3
    s_add_u32 s34, s34, 0x200000
    s_add_u32 s3, s3, s27
    s_add_u32 m0, s3, 0
    s_nop 0
    buffer_load_dwordx4 v116, s[4:7], s34 offen offset:0 sc1 lds
    buffer_load_dwordx4 v116, s[4:7], s34 offen offset:1024 sc1 lds
    buffer_load_dwordx4 v116, s[4:7], s34 offen offset:2048 sc1 lds
    buffer_load_dwordx4 v116, s[4:7], s34 offen offset:3072 sc1 lds
    s_add_u32 m0, s3, 4096
    s_add_u32 s34, s34, 4096
    buffer_load_dwordx4 v116, s[4:7], s34 offen offset:0 sc1 lds
    buffer_load_dwordx4 v116, s[4:7], s34 offen offset:1024 sc1 lds
    buffer_load_dwordx4 v116, s[4:7], s34 offen offset:2048 sc1 lds
    buffer_load_dwordx4 v116, s[4:7], s34 offen offset:3072 sc1 lds
    s_add_u32 s36, s25, 3
    s_mov_b32 s27, 32768
    s_lshl_b32 s34, s36, 15
    s_lshl_b32 s3, s22, 13
    s_add_u32 s34, s34, s3
    s_add_u32 s34, s34, 0x200000
    s_add_u32 s3, s3, s27
    s_add_u32 m0, s3, 0
    s_nop 0
    buffer_load_dwordx4 v116, s[4:7], s34 offen offset:0 sc1 lds
    buffer_load_dwordx4 v116, s[4:7], s34 offen offset:1024 sc1 lds
    buffer_load_dwordx4 v116, s[4:7], s34 offen offset:2048 sc1 lds
    buffer_load_dwordx4 v116, s[4:7], s34 offen offset:3072 sc1 lds
    s_add_u32 m0, s3, 4096
    s_add_u32 s34, s34, 4096
    buffer_load_dwordx4 v116, s[4:7], s34 offen offset:0 sc1 lds
    buffer_load_dwordx4 v116, s[4:7], s34 offen offset:1024 sc1 lds
    buffer_load_dwordx4 v116, s[4:7], s34 offen offset:2048 sc1 lds
    buffer_load_dwordx4 v116, s[4:7], s34 offen offset:3072 sc1 lds
    s_waitcnt vmcnt(0)
L_proj_tok:
    s_barrier
    v_mov_b32 v124, v116
    ds_read_b128 v[48:51], v124 offset:0
    ds_read_b128 v[52:55], v124 offset:1024
    s_waitcnt lgkmcnt(1)
    v_mfma_f32_16x16x32_bf16 v[16:19], v[128:131], v[48:51], 0
    ds_read_b128 v[56:59], v124 offset:2048
    v_mfma_f32_16x16x32_bf16 v[32:35], v[48:51], a[0:3], 0
    ds_read_b128 v[60:63], v124 offset:3072
    v_mfma_f32_16x16x32_bf16 v[20:23], v[192:195], v[48:51], 0
    v_mfma_f32_16x16x32_bf16 v[40:43], v[48:51], a[64:67], 0
    s_waitcnt lgkmcnt(2)
    v_mfma_f32_16x16x32_bf16 v[24:27], v[128:131], v[52:55], 0
    v_mfma_f32_16x16x32_bf16 v[36:39], v[52:55], a[0:3], 0
    v_mfma_f32_16x16x32_bf16 v[28:31], v[192:195], v[52:55], 0
    v_mfma_f32_16x16x32_bf16 v[44:47], v[52:55], a[64:67], 0
    s_waitcnt lgkmcnt(1)
    v_mfma_f32_16x16x32_bf16 v[16:19], v[132:135], v[56:59], v[16:19]
    ds_read_b128 v[48:51], v124 offset:4096
    v_mfma_f32_16x16x32_bf16 v[32:35], v[56:59], a[4:7], v[32:35]
    ds_read_b128 v[52:55], v124 offset:5120
    v_mfma_f32_16x16x32_bf16 v[20:23], v[196:199], v[56:59], v[20:23]
    v_mfma_f32_16x16x32_bf16 v[40:43], v[56:59], a[68:71], v[40:43]
    s_waitcnt lgkmcnt(2)
    v_mfma_f32_16x16x32_bf16 v[24:27], v[132:135], v[60:63], v[24:27]
    v_mfma_f32_16x16x32_bf16 v[36:39], v[60:63], a[4:7], v[36:39]
    v_mfma_f32_16x16x32_bf16 v[28:31], v[196:199], v[60:63], v[28:31]
    v_mfma_f32_16x16x32_bf16 v[44:47], v[60:63], a[68:71], v[44:47]
    s_waitcnt lgkmcnt(1)
    v_mfma_f32_16x16x32_bf16 v[16:19], v[136:139], v[48:51], v[16:19]
    ds_read_b128 v[56:59], v124 offset:6144
    v_mfma_f32_16x16x32_bf16 v[32:35], v[48:51], a[8:11], v[32:35]
    ds_read_b128 v[60:63], v124 offset:7168
    v_mfma_f32_16x16x32_bf16 v[20:23], v[200:203], v[48:51], v[20:23]
    v_mfma_f32_16x16x32_bf16 v[40:43], v[48:51], a[72:75], v[40:43]
    s_waitcnt lgkmcnt(2)
    v_mfma_f32_16x16x32_bf16 v[24:27], v[136:139], v[52:55], v[24:27]
    v_mfma_f32_16x16x32_bf16 v[36:39], v[52:55], a[8:11], v[36:39]
    v_mfma_f32_16x16x32_bf16 v[28:31], v[200:203], v[52:55], v[28:31]
    v_mfma_f32_16x16x32_bf16 v[44:47], v[52:55], a[72:75], v[44:47]
    s_waitcnt lgkmcnt(1)
    v_mfma_f32_16x16x32_bf16 v[16:19], v[140:143], v[56:59], v[16:19]
    ds_read_b128 v[48:51], v124 offset:8192
    v_mfma_f32_16x16x32_bf16 v[32:35], v[56:59], a[12:15], v[32:35]
    ds_read_b128 v[52:55], v124 offset:9216
    v_mfma_f32_16x16x32_bf16 v[20:23], v[204:207], v[56:59], v[20:23]
    v_mfma_f32_16x16x32_bf16 v[40:43], v[56:59], a[76:79], v[40:43]
    s_waitcnt lgkmcnt(2)
    v_mfma_f32_16x16x32_bf16 v[24:27], v[140:143], v[60:63], v[24:27]
    v_mfma_f32_16x16x32_bf16 v[36:39], v[60:63], a[12:15], v[36:39]
    v_mfma_f32_16x16x32_bf16 v[28:31], v[204:207], v[60:63], v[28:31]
    v_mfma_f32_16x16x32_bf16 v[44:47], v[60:63], a[76:79], v[44:47]
    s_waitcnt lgkmcnt(1)
    v_mfma_f32_16x16x32_bf16 v[16:19], v[144:147], v[48:51], v[16:19]
    ds_read_b128 v[56:59], v124 offset:10240
    v_mfma_f32_16x16x32_bf16 v[32:35], v[48:51], a[16:19], v[32:35]
    ds_read_b128 v[60:63], v124 offset:11264
    v_mfma_f32_16x16x32_bf16 v[20:23], v[208:211], v[48:51], v[20:23]
    v_mfma_f32_16x16x32_bf16 v[40:43], v[48:51], a[80:83], v[40:43]
    s_waitcnt lgkmcnt(2)
    v_mfma_f32_16x16x32_bf16 v[24:27], v[144:147], v[52:55], v[24:27]
    v_mfma_f32_16x16x32_bf16 v[36:39], v[52:55], a[16:19], v[36:39]
    v_mfma_f32_16x16x32_bf16 v[28:31], v[208:211], v[52:55], v[28:31]
    v_mfma_f32_16x16x32_bf16 v[44:47], v[52:55], a[80:83], v[44:47]
    s_waitcnt lgkmcnt(1)
    v_mfma_f32_16x16x32_bf16 v[16:19], v[148:151], v[56:59], v[16:19]
    ds_read_b128 v[48:51], v124 offset:12288
    v_mfma_f32_16x16x32_bf16 v[32:35], v[56:59], a[20:23], v[32:35]
    ds_read_b128 v[52:55], v124 offset:13312
    v_mfma_f32_16x16x32_bf16 v[20:23], v[212:215], v[56:59], v[20:23]
    v_mfma_f32_16x16x32_bf16 v[40:43], v[56:59], a[84:87], v[40:43]
    s_waitcnt lgkmcnt(2)
    v_mfma_f32_16x16x32_bf16 v[24:27], v[148:151], v[60:63], v[24:27]
    v_mfma_f32_16x16x32_bf16 v[36:39], v[60:63], a[20:23], v[36:39]
    v_mfma_f32_16x16x32_bf16 v[28:31], v[212:215], v[60:63], v[28:31]
    v_mfma_f32_16x16x32_bf16 v[44:47], v[60:63], a[84:87], v[44:47]
    s_waitcnt lgkmcnt(1)
    v_mfma_f32_16x16x32_bf16 v[16:19], v[152:155], v[48:51], v[16:19]
    ds_read_b128 v[56:59], v124 offset:14336
    v_mfma_f32_16x16x32_bf16 v[32:35], v[48:51], a[24:27], v[32:35]
    ds_read_b128 v[60:63], v124 offset:15360
    v_mfma_f32_16x16x32_bf16 v[20:23], v[216:219], v[48:51], v[20:23]
    v_mfma_f32_16x16x32_bf16 v[40:43], v[48:51], a[88:91], v[40:43]
    s_waitcnt lgkmcnt(2)
    v_mfma_f32_16x16x32_bf16 v[24:27], v[152:155], v[52:55], v[24:27]
    v_mfma_f32_16x16x32_bf16 v[36:39], v[52:55], a[24:27], v[36:39]
    v_mfma_f32_16x16x32_bf16 v[28:31], v[216:219], v[52:55], v[28:31]
    v_mfma_f32_16x16x32_bf16 v[44:47], v[52:55], a[88:91], v[44:47]
    s_waitcnt lgkmcnt(1)
    v_mfma_f32_16x16x32_bf16 v[16:19], v[156:159], v[56:59], v[16:19]
    ds_read_b128 v[48:51], v124 offset:16384
    v_mfma_f32_16x16x32_bf16 v[32:35], v[56:59], a[28:31], v[32:35]
    ds_read_b128 v[52:55], v124 offset:17408
    v_mfma_f32_16x16x32_bf16 v[20:23], v[220:223], v[56:59], v[20:23]
    v_mfma_f32_16x16x32_bf16 v[40:43], v[56:59], a[92:95], v[40:43]
    s_waitcnt lgkmcnt(2)
    v_mfma_f32_16x16x32_bf16 v[24:27], v[156:159], v[60:63], v[24:27]
    v_mfma_f32_16x16x32_bf16 v[36:39], v[60:63], a[28:31], v[36:39]
    v_mfma_f32_16x16x32_bf16 v[28:31], v[220:223], v[60:63], v[28:31]
    v_mfma_f32_16x16x32_bf16 v[44:47], v[60:63], a[92:95], v[44:47]
    s_waitcnt lgkmcnt(1)
    v_mfma_f32_16x16x32_bf16 v[16:19], v[160:163], v[48:51], v[16:19]
    ds_read_b128 v[56:59], v124 offset:18432
    v_mfma_f32_16x16x32_bf16 v[32:35], v[48:51], a[32:35], v[32:35]
    ds_read_b128 v[60:63], v124 offset:19456
    v_mfma_f32_16x16x32_bf16 v[20:23], v[224:227], v[48:51], v[20:23]
    v_mfma_f32_16x16x32_bf16 v[40:43], v[48:51], a[96:99], v[40:43]
    s_waitcnt lgkmcnt(2)
    v_mfma_f32_16x16x32_bf16 v[24:27], v[160:163], v[52:55], v[24:27]
    v_mfma_f32_16x16x32_bf16 v[36:39], v[52:55], a[32:35], v[36:39]
    v_mfma_f32_16x16x32_bf16 v[28:31], v[224:227], v[52:55], v[28:31]
    v_mfma_f32_16x16x32_bf16 v[44:47], v[52:55], a[96:99], v[44:47]
    s_waitcnt lgkmcnt(1)
    v_mfma_f32_16x16x32_bf16 v[16:19], v[164:167], v[56:59], v[16:19]
    ds_read_b128 v[48:51], v124 offset:20480
    v_mfma_f32_16x16x32_bf16 v[32:35], v[56:59], a[36:39], v[32:35]
    ds_read_b128 v[52:55], v124 offset:21504
    v_mfma_f32_16x16x32_bf16 v[20:23], v[228:231], v[56:59], v[20:23]
    v_mfma_f32_16x16x32_bf16 v[40:43], v[56:59], a[100:103], v[40:43]
    s_waitcnt lgkmcnt(2)
    v_mfma_f32_16x16x32_bf16 v[24:27], v[164:167], v[60:63], v[24:27]
    v_mfma_f32_16x16x32_bf16 v[36:39], v[60:63], a[36:39], v[36:39]
    v_mfma_f32_16x16x32_bf16 v[28:31], v[228:231], v[60:63], v[28:31]
    v_mfma_f32_16x16x32_bf16 v[44:47], v[60:63], a[100:103], v[44:47]
    s_waitcnt lgkmcnt(1)
    v_mfma_f32_16x16x32_bf16 v[16:19], v[168:171], v[48:51], v[16:19]
    ds_read_b128 v[56:59], v124 offset:22528
    v_mfma_f32_16x16x32_bf16 v[32:35], v[48:51], a[40:43], v[32:35]
    ds_read_b128 v[60:63], v124 offset:23552
    v_mfma_f32_16x16x32_bf16 v[20:23], v[232:235], v[48:51], v[20:23]
    v_mfma_f32_16x16x32_bf16 v[40:43], v[48:51], a[104:107], v[40:43]
    s_waitcnt lgkmcnt(2)
    v_mfma_f32_16x16x32_bf16 v[24:27], v[168:171], v[52:55], v[24:27]
    v_mfma_f32_16x16x32_bf16 v[36:39], v[52:55], a[40:43], v[36:39]
    v_mfma_f32_16x16x32_bf16 v[28:31], v[232:235], v[52:55], v[28:31]
    v_mfma_f32_16x16x32_bf16 v[44:47], v[52:55], a[104:107], v[44:47]
    s_waitcnt lgkmcnt(1)
    v_mfma_f32_16x16x32_bf16 v[16:19], v[172:175], v[56:59], v[16:19]
    ds_read_b128 v[48:51], v124 offset:24576
    v_mfma_f32_16x16x32_bf16 v[32:35], v[56:59], a[44:47], v[32:35]
    ds_read_b128 v[52:55], v124 offset:25600
    v_mfma_f32_16x16x32_bf16 v[20:23], v[236:239], v[56:59], v[20:23]
    v_mfma_f32_16x16x32_bf16 v[40:43], v[56:59], a[108:111], v[40:43]
    s_waitcnt lgkmcnt(2)
    v_mfma_f32_16x16x32_bf16 v[24:27], v[172:175], v[60:63], v[24:27]
    v_mfma_f32_16x16x32_bf16 v[36:39], v[60:63], a[44:47], v[36:39]
    v_mfma_f32_16x16x32_bf16 v[28:31], v[236:239], v[60:63], v[28:31]
    v_mfma_f32_16x16x32_bf16 v[44:47], v[60:63], a[108:111], v[44:47]
    s_waitcnt lgkmcnt(1)
    v_mfma_f32_16x16x32_bf16 v[16:19], v[176:179], v[48:51], v[16:19]
    ds_read_b128 v[56:59], v124 offset:26624
    v_mfma_f32_16x16x32_bf16 v[32:35], v[48:51], a[48:51], v[32:35]
    ds_read_b128 v[60:63], v124 offset:27648
    v_mfma_f32_16x16x32_bf16 v[20:23], v[240:243], v[48:51], v[20:23]
    v_mfma_f32_16x16x32_bf16 v[40:43], v[48:51], a[112:115], v[40:43]
    s_waitcnt lgkmcnt(2)
    v_mfma_f32_16x16x32_bf16 v[24:27], v[176:179], v[52:55], v[24:27]
    v_mfma_f32_16x16x32_bf16 v[36:39], v[52:55], a[48:51], v[36:39]
    v_mfma_f32_16x16x32_bf16 v[28:31], v[240:243], v[52:55], v[28:31]
    v_mfma_f32_16x16x32_bf16 v[44:47], v[52:55], a[112:115], v[44:47]
    s_waitcnt lgkmcnt(1)
    v_mfma_f32_16x16x32_bf16 v[16:19], v[180:183], v[56:59], v[16:19]
    ds_read_b128 v[48:51], v124 offset:28672
    v_mfma_f32_16x16x32_bf16 v[32:35], v[56:59], a[52:55], v[32:35]
    ds_read_b128 v[52:55], v124 offset:29696
    v_mfma_f32_16x16x32_bf16 v[20:23], v[244:247], v[56:59], v[20:23]
    v_mfma_f32_16x16x32_bf16 v[40:43], v[56:59], a[116:119], v[40:43]
    s_waitcnt lgkmcnt(2)
    v_mfma_f32_16x16x32_bf16 v[24:27], v[180:183], v[60:63], v[24:27]
    v_mfma_f32_16x16x32_bf16 v[36:39], v[60:63], a[52:55], v[36:39]
    v_mfma_f32_16x16x32_bf16 v[28:31], v[244:247], v[60:63], v[28:31]
    v_mfma_f32_16x16x32_bf16 v[44:47], v[60:63], a[116:119], v[44:47]
    s_waitcnt lgkmcnt(1)
    v_mfma_f32_16x16x32_bf16 v[16:19], v[184:187], v[48:51], v[16:19]
    ds_read_b128 v[56:59], v124 offset:30720
    v_mfma_f32_16x16x32_bf16 v[32:35], v[48:51], a[56:59], v[32:35]
    ds_read_b128 v[60:63], v124 offset:31744
    v_mfma_f32_16x16x32_bf16 v[20:23], v[248:251], v[48:51], v[20:23]
    v_mfma_f32_16x16x32_bf16 v[40:43], v[48:51], a[120:123], v[40:43]
    s_waitcnt lgkmcnt(2)
    v_mfma_f32_16x16x32_bf16 v[24:27], v[184:187], v[52:55], v[24:27]
    v_mfma_f32_16x16x32_bf16 v[36:39], v[52:55], a[56:59], v[36:39]
    v_mfma_f32_16x16x32_bf16 v[28:31], v[248:251], v[52:55], v[28:31]
    v_mfma_f32_16x16x32_bf16 v[44:47], v[52:55], a[120:123], v[44:47]
    s_waitcnt lgkmcnt(1)
    v_mfma_f32_16x16x32_bf16 v[16:19], v[188:191], v[56:59], v[16:19]
    v_mfma_f32_16x16x32_bf16 v[32:35], v[56:59], a[60:63], v[32:35]
    v_mfma_f32_16x16x32_bf16 v[20:23], v[252:255], v[56:59], v[20:23]
    v_mfma_f32_16x16x32_bf16 v[40:43], v[56:59], a[124:127], v[40:43]
    s_waitcnt lgkmcnt(0)
    v_mfma_f32_16x16x32_bf16 v[24:27], v[188:191], v[60:63], v[24:27]
    v_mfma_f32_16x16x32_bf16 v[36:39], v[60:63], a[60:63], v[36:39]
    v_mfma_f32_16x16x32_bf16 v[28:31], v[252:255], v[60:63], v[28:31]
    v_mfma_f32_16x16x32_bf16 v[44:47], v[60:63], a[124:127], v[44:47]
    s_lshl_b32 s3, s22, 10
    s_add_u32 s3, s3, s28
    v_add_u32 v124, s3, v116
    s_lshl_b32 s3, s22, 11
    s_add_u32 s3, s3, s28
    v_add_u32 v125, s3, v116
    s_lshl_b32 s34, s25, 5
    s_add_u32 s34, s34, s21
    s_lshl_b32 s34, s34, 14
    s_add_u32 s34, s34, 0x2000000
    s_lshl_b32 s3, s22, 10
    s_add_u32 s37, s34, s3
    s_add_u32 s38, s37, 8192
    s_add_u32 s48, s37, 4096
    s_add_u32 s49, s38, 4096
    v_cvt_pk_bf16_f32 v48, v16, v20
    v_cvt_pk_bf16_f32 v49, v17, v21
    v_cvt_pk_bf16_f32 v50, v18, v22
    v_cvt_pk_bf16_f32 v51, v19, v23
    ds_write_b128 v124, v[48:51] offset:8192
    v_cvt_pk_bf16_f32 v52, v24, v28
    v_cvt_pk_bf16_f32 v53, v25, v29
    v_cvt_pk_bf16_f32 v54, v26, v30
    v_cvt_pk_bf16_f32 v55, v27, v31
    ds_write_b128 v124, v[52:55] offset:12288
    v_cvt_pk_bf16_f32 v80, v32, v33
    v_cvt_pk_bf16_f32 v81, v36, v37
    v_cvt_pk_bf16_f32 v82, v34, v35
    v_cvt_pk_bf16_f32 v83, v38, v39
    buffer_store_dwordx4 v[80:83], v116, s[4:7], s48 offen sc1
    v_cvt_pk_bf16_f32 v84, v40, v41
    v_cvt_pk_bf16_f32 v85, v44, v45
    v_cvt_pk_bf16_f32 v86, v42, v43
    v_cvt_pk_bf16_f32 v87, v46, v47
    buffer_store_dwordx4 v[84:87], v116, s[4:7], s49 offen sc1
    ds_write_b128 v125, v[80:83] offset:16384
    ds_write_b128 v125, v[84:87] offset:17408
    v_add_u32 v125, s28, v127
    s_waitcnt lgkmcnt(2)
    s_barrier
    ds_read_b128 v[88:91], v125 offset:8192
    ds_read_b128 v[92:95], v125 offset:9216
    s_waitcnt lgkmcnt(1)
    buffer_store_dwordx4 v[88:91], v116, s[4:7], s37 offen sc1
    s_waitcnt lgkmcnt(0)
    buffer_store_dwordx4 v[92:95], v116, s[4:7], s38 offen sc1
    s_lshl_b32 s34, s21, 6
    s_add_u32 s34, s34, s25
    s_lshl_b32 s34, s34, 2
    s_add_u32 s34, s34, s22
    s_add_u32 s51, s34, 0x90000
    s_waitcnt vmcnt(12)
    s_barrier
    ds_read_b64_tr_b16 a[128:129], v4 offset:16384
    ds_read_b64_tr_b16 a[192:193], v5 offset:16384
    ds_read_b64_tr_b16 a[144:145], v6 offset:16384
    ds_read_b64_tr_b16 a[208:209], v7 offset:16384
    ds_read_b64_tr_b16 a[160:161], v8 offset:16384
    ds_read_b64_tr_b16 a[224:225], v9 offset:16384
    ds_read_b64_tr_b16 a[176:177], v10 offset:16384
    ds_read_b64_tr_b16 a[240:241], v11 offset:16384
    s_waitcnt lgkmcnt(0)
    s_barrier
    s_add_u32 m0, s33, 131072
    s_add_u32 s34, s30, 0x44000
    buffer_load_dwordx4 v2, s[8:11], s34 offen  lds
    s_add_u32 m0, s33, 132096
    s_add_u32 s34, s30, 0x4c000
    buffer_load_dwordx4 v3, s[8:11], s34 offen  lds
    s_add_u32 m0, s33, 133120
    s_add_u32 s34, s30, 0x54000
    buffer_load_dwordx4 v2, s[8:11], s34 offen  lds
    s_add_u32 m0, s33, 134144
    s_add_u32 s34, s30, 0x5c000
    buffer_load_dwordx4 v3, s[8:11], s34 offen  lds
    s_waitcnt vmcnt(12)
    s_barrier
    ds_read_b64_tr_b16 a[130:131], v4 offset:32768
    ds_read_b64_tr_b16 a[194:195], v5 offset:32768
    ds_read_b64_tr_b16 a[146:147], v6 offset:32768
    ds_read_b64_tr_b16 a[210:211], v7 offset:32768
    ds_read_b64_tr_b16 a[162:163], v8 offset:32768
    ds_read_b64_tr_b16 a[226:227], v9 offset:32768
    ds_read_b64_tr_b16 a[178:179], v10 offset:32768
    ds_read_b64_tr_b16 a[242:243], v11 offset:32768
    s_waitcnt lgkmcnt(0)
    s_barrier
    s_add_u32 m0, s33, 147456
    s_add_u32 s34, s31, 0x0
    buffer_load_dwordx4 v2, s[8:11], s34 offen  lds
    s_add_u32 m0, s33, 148480
    s_add_u32 s34, s31, 0x8000
    buffer_load_dwordx4 v3, s[8:11], s34 offen  lds
    s_add_u32 m0, s33, 149504
    s_add_u32 s34, s31, 0x10000
    buffer_load_dwordx4 v2, s[8:11], s34 offen  lds
    s_add_u32 m0, s33, 150528
    s_add_u32 s34, s31, 0x18000
    buffer_load_dwordx4 v3, s[8:11], s34 offen  lds
    s_waitcnt vmcnt(12)
    s_barrier
    ds_read_b64_tr_b16 a[132:133], v4 offset:0
    ds_read_b64_tr_b16 a[196:197], v5 offset:0
    ds_read_b64_tr_b16 a[148:149], v6 offset:0
    ds_read_b64_tr_b16 a[212:213], v7 offset:0
    ds_read_b64_tr_b16 a[164:165], v8 offset:0
    ds_read_b64_tr_b16 a[228:229], v9 offset:0
    ds_read_b64_tr_b16 a[180:181], v10 offset:0
    ds_read_b64_tr_b16 a[244:245], v11 offset:0
    s_waitcnt lgkmcnt(0)
    s_barrier
    s_add_u32 m0, s33, 114688
    s_add_u32 s34, s31, 0x4000
    buffer_load_dwordx4 v2, s[8:11], s34 offen  lds
    s_add_u32 m0, s33, 115712
    s_add_u32 s34, s31, 0xc000
    buffer_load_dwordx4 v3, s[8:11], s34 offen  lds
    s_add_u32 m0, s33, 116736
    s_add_u32 s34, s31, 0x14000
    buffer_load_dwordx4 v2, s[8:11], s34 offen  lds
    s_add_u32 m0, s33, 117760
    s_add_u32 s34, s31, 0x1c000
    buffer_load_dwordx4 v3, s[8:11], s34 offen  lds
    s_add_u32 s25, s25, 3
    s_add_u32 s28, s28, 24576
    v_add_u32 v124, 32768, v116
    ds_read_b128 v[48:51], v124 offset:0
    ds_read_b128 v[52:55], v124 offset:1024
    s_waitcnt lgkmcnt(1)
    v_mfma_f32_16x16x32_bf16 v[16:19], v[128:131], v[48:51], 0
    ds_read_b128 v[56:59], v124 offset:2048
    v_mfma_f32_16x16x32_bf16 v[32:35], v[48:51], a[0:3], 0
    ds_read_b128 v[60:63], v124 offset:3072
    v_mfma_f32_16x16x32_bf16 v[20:23], v[192:195], v[48:51], 0
    v_mfma_f32_16x16x32_bf16 v[40:43], v[48:51], a[64:67], 0
    s_waitcnt lgkmcnt(2)
    v_mfma_f32_16x16x32_bf16 v[24:27], v[128:131], v[52:55], 0
    v_mfma_f32_16x16x32_bf16 v[36:39], v[52:55], a[0:3], 0
    v_mfma_f32_16x16x32_bf16 v[28:31], v[192:195], v[52:55], 0
    v_mfma_f32_16x16x32_bf16 v[44:47], v[52:55], a[64:67], 0
    s_waitcnt lgkmcnt(1)
    v_mfma_f32_16x16x32_bf16 v[16:19], v[132:135], v[56:59], v[16:19]
    ds_read_b128 v[48:51], v124 offset:4096
    v_mfma_f32_16x16x32_bf16 v[32:35], v[56:59], a[4:7], v[32:35]
    ds_read_b128 v[52:55], v124 offset:5120
    v_mfma_f32_16x16x32_bf16 v[20:23], v[196:199], v[56:59], v[20:23]
    v_mfma_f32_16x16x32_bf16 v[40:43], v[56:59], a[68:71], v[40:43]
    s_waitcnt lgkmcnt(2)
    v_mfma_f32_16x16x32_bf16 v[24:27], v[132:135], v[60:63], v[24:27]
    v_mfma_f32_16x16x32_bf16 v[36:39], v[60:63], a[4:7], v[36:39]
    v_mfma_f32_16x16x32_bf16 v[28:31], v[196:199], v[60:63], v[28:31]
    v_mfma_f32_16x16x32_bf16 v[44:47], v[60:63], a[68:71], v[44:47]
    s_waitcnt lgkmcnt(1)
    v_mfma_f32_16x16x32_bf16 v[16:19], v[136:139], v[48:51], v[16:19]
    ds_read_b128 v[56:59], v124 offset:6144
    v_mfma_f32_16x16x32_bf16 v[32:35], v[48:51], a[8:11], v[32:35]
    ds_read_b128 v[60:63], v124 offset:7168
    v_mfma_f32_16x16x32_bf16 v[20:23], v[200:203], v[48:51], v[20:23]
    v_mfma_f32_16x16x32_bf16 v[40:43], v[48:51], a[72:75], v[40:43]
    s_waitcnt lgkmcnt(2)
    v_mfma_f32_16x16x32_bf16 v[24:27], v[136:139], v[52:55], v[24:27]
    v_mfma_f32_16x16x32_bf16 v[36:39], v[52:55], a[8:11], v[36:39]
    v_mfma_f32_16x16x32_bf16 v[28:31], v[200:203], v[52:55], v[28:31]
    v_mfma_f32_16x16x32_bf16 v[44:47], v[52:55], a[72:75], v[44:47]
    s_waitcnt lgkmcnt(1)
    v_mfma_f32_16x16x32_bf16 v[16:19], v[140:143], v[56:59], v[16:19]
    ds_read_b128 v[48:51], v124 offset:8192
    v_mfma_f32_16x16x32_bf16 v[32:35], v[56:59], a[12:15], v[32:35]
    ds_read_b128 v[52:55], v124 offset:9216
    v_mfma_f32_16x16x32_bf16 v[20:23], v[204:207], v[56:59], v[20:23]
    v_mov_b32 v96, 1
    s_waitcnt vmcnt(12)
    s_mov_b64 exec, 1
    buffer_store_byte v96, v117, s[4:7], s51 offen sc1
    s_mov_b64 exec, -1
    v_mfma_f32_16x16x32_bf16 v[40:43], v[56:59], a[76:79], v[40:43]
    s_waitcnt lgkmcnt(2)
    v_mfma_f32_16x16x32_bf16 v[24:27], v[140:143], v[60:63], v[24:27]
    v_mfma_f32_16x16x32_bf16 v[36:39], v[60:63], a[12:15], v[36:39]
    v_mfma_f32_16x16x32_bf16 v[28:31], v[204:207], v[60:63], v[28:31]
    v_mfma_f32_16x16x32_bf16 v[44:47], v[60:63], a[76:79], v[44:47]
    s_waitcnt lgkmcnt(1)
    v_mfma_f32_16x16x32_bf16 v[16:19], v[144:147], v[48:51], v[16:19]
    ds_read_b128 v[56:59], v124 offset:10240
    v_mfma_f32_16x16x32_bf16 v[32:35], v[48:51], a[16:19], v[32:35]
    ds_read_b128 v[60:63], v124 offset:11264
    v_mfma_f32_16x16x32_bf16 v[20:23], v[208:211], v[48:51], v[20:23]
    v_mfma_f32_16x16x32_bf16 v[40:43], v[48:51], a[80:83], v[40:43]
    s_waitcnt lgkmcnt(2)
    v_mfma_f32_16x16x32_bf16 v[24:27], v[144:147], v[52:55], v[24:27]
    v_mfma_f32_16x16x32_bf16 v[36:39], v[52:55], a[16:19], v[36:39]
    v_mfma_f32_16x16x32_bf16 v[28:31], v[208:211], v[52:55], v[28:31]
    v_mfma_f32_16x16x32_bf16 v[44:47], v[52:55], a[80:83], v[44:47]
    s_waitcnt lgkmcnt(1)
    v_mfma_f32_16x16x32_bf16 v[16:19], v[148:151], v[56:59], v[16:19]
    ds_read_b128 v[48:51], v124 offset:12288
    v_mfma_f32_16x16x32_bf16 v[32:35], v[56:59], a[20:23], v[32:35]
    ds_read_b128 v[52:55], v124 offset:13312
    v_mfma_f32_16x16x32_bf16 v[20:23], v[212:215], v[56:59], v[20:23]
    v_mfma_f32_16x16x32_bf16 v[40:43], v[56:59], a[84:87], v[40:43]
    s_waitcnt lgkmcnt(2)
    v_mfma_f32_16x16x32_bf16 v[24:27], v[148:151], v[60:63], v[24:27]
    v_mfma_f32_16x16x32_bf16 v[36:39], v[60:63], a[20:23], v[36:39]
    v_mfma_f32_16x16x32_bf16 v[28:31], v[212:215], v[60:63], v[28:31]
    v_mfma_f32_16x16x32_bf16 v[44:47], v[60:63], a[84:87], v[44:47]
    s_waitcnt lgkmcnt(1)
    v_mfma_f32_16x16x32_bf16 v[16:19], v[152:155], v[48:51], v[16:19]
    ds_read_b128 v[56:59], v124 offset:14336
    v_mfma_f32_16x16x32_bf16 v[32:35], v[48:51], a[24:27], v[32:35]
    ds_read_b128 v[60:63], v124 offset:15360
    v_mfma_f32_16x16x32_bf16 v[20:23], v[216:219], v[48:51], v[20:23]
    v_mfma_f32_16x16x32_bf16 v[40:43], v[48:51], a[88:91], v[40:43]
    s_waitcnt lgkmcnt(2)
    v_mfma_f32_16x16x32_bf16 v[24:27], v[152:155], v[52:55], v[24:27]
    v_mfma_f32_16x16x32_bf16 v[36:39], v[52:55], a[24:27], v[36:39]
    v_mfma_f32_16x16x32_bf16 v[28:31], v[216:219], v[52:55], v[28:31]
    v_mfma_f32_16x16x32_bf16 v[44:47], v[52:55], a[88:91], v[44:47]
    s_waitcnt lgkmcnt(1)
    v_mfma_f32_16x16x32_bf16 v[16:19], v[156:159], v[56:59], v[16:19]
    ds_read_b128 v[48:51], v124 offset:16384
    v_mfma_f32_16x16x32_bf16 v[32:35], v[56:59], a[28:31], v[32:35]
    ds_read_b128 v[52:55], v124 offset:17408
    v_mfma_f32_16x16x32_bf16 v[20:23], v[220:223], v[56:59], v[20:23]
    v_mfma_f32_16x16x32_bf16 v[40:43], v[56:59], a[92:95], v[40:43]
    s_waitcnt lgkmcnt(2)
    v_mfma_f32_16x16x32_bf16 v[24:27], v[156:159], v[60:63], v[24:27]
    v_mfma_f32_16x16x32_bf16 v[36:39], v[60:63], a[28:31], v[36:39]
    v_mfma_f32_16x16x32_bf16 v[28:31], v[220:223], v[60:63], v[28:31]
    v_mfma_f32_16x16x32_bf16 v[44:47], v[60:63], a[92:95], v[44:47]
    s_waitcnt lgkmcnt(1)
    v_mfma_f32_16x16x32_bf16 v[16:19], v[160:163], v[48:51], v[16:19]
    ds_read_b128 v[56:59], v124 offset:18432
    v_mfma_f32_16x16x32_bf16 v[32:35], v[48:51], a[32:35], v[32:35]
    ds_read_b128 v[60:63], v124 offset:19456
    v_mfma_f32_16x16x32_bf16 v[20:23], v[224:227], v[48:51], v[20:23]
    v_mfma_f32_16x16x32_bf16 v[40:43], v[48:51], a[96:99], v[40:43]
    s_waitcnt lgkmcnt(2)
    v_mfma_f32_16x16x32_bf16 v[24:27], v[160:163], v[52:55], v[24:27]
    v_mfma_f32_16x16x32_bf16 v[36:39], v[52:55], a[32:35], v[36:39]
    v_mfma_f32_16x16x32_bf16 v[28:31], v[224:227], v[52:55], v[28:31]
    v_mfma_f32_16x16x32_bf16 v[44:47], v[52:55], a[96:99], v[44:47]
    s_waitcnt lgkmcnt(1)
    v_mfma_f32_16x16x32_bf16 v[16:19], v[164:167], v[56:59], v[16:19]
    ds_read_b128 v[48:51], v124 offset:20480
    v_mfma_f32_16x16x32_bf16 v[32:35], v[56:59], a[36:39], v[32:35]
    ds_read_b128 v[52:55], v124 offset:21504
    v_mfma_f32_16x16x32_bf16 v[20:23], v[228:231], v[56:59], v[20:23]
    v_mfma_f32_16x16x32_bf16 v[40:43], v[56:59], a[100:103], v[40:43]
    s_waitcnt lgkmcnt(2)
    v_mfma_f32_16x16x32_bf16 v[24:27], v[164:167], v[60:63], v[24:27]
    v_mfma_f32_16x16x32_bf16 v[36:39], v[60:63], a[36:39], v[36:39]
    v_mfma_f32_16x16x32_bf16 v[28:31], v[228:231], v[60:63], v[28:31]
    v_mfma_f32_16x16x32_bf16 v[44:47], v[60:63], a[100:103], v[44:47]
    s_waitcnt lgkmcnt(1)
    v_mfma_f32_16x16x32_bf16 v[16:19], v[168:171], v[48:51], v[16:19]
    ds_read_b128 v[56:59], v124 offset:22528
    v_mfma_f32_16x16x32_bf16 v[32:35], v[48:51], a[40:43], v[32:35]
    ds_read_b128 v[60:63], v124 offset:23552
    v_mfma_f32_16x16x32_bf16 v[20:23], v[232:235], v[48:51], v[20:23]
    v_mfma_f32_16x16x32_bf16 v[40:43], v[48:51], a[104:107], v[40:43]
    s_waitcnt lgkmcnt(2)
    v_mfma_f32_16x16x32_bf16 v[24:27], v[168:171], v[52:55], v[24:27]
    v_mfma_f32_16x16x32_bf16 v[36:39], v[52:55], a[40:43], v[36:39]
    v_mfma_f32_16x16x32_bf16 v[28:31], v[232:235], v[52:55], v[28:31]
    v_mfma_f32_16x16x32_bf16 v[44:47], v[52:55], a[104:107], v[44:47]
    s_waitcnt lgkmcnt(1)
    v_mfma_f32_16x16x32_bf16 v[16:19], v[172:175], v[56:59], v[16:19]
    ds_read_b128 v[48:51], v124 offset:24576
    v_mfma_f32_16x16x32_bf16 v[32:35], v[56:59], a[44:47], v[32:35]
    ds_read_b128 v[52:55], v124 offset:25600
    v_mfma_f32_16x16x32_bf16 v[20:23], v[236:239], v[56:59], v[20:23]
    v_mfma_f32_16x16x32_bf16 v[40:43], v[56:59], a[108:111], v[40:43]
    s_waitcnt lgkmcnt(2)
    v_mfma_f32_16x16x32_bf16 v[24:27], v[172:175], v[60:63], v[24:27]
    v_mfma_f32_16x16x32_bf16 v[36:39], v[60:63], a[44:47], v[36:39]
    v_mfma_f32_16x16x32_bf16 v[28:31], v[236:239], v[60:63], v[28:31]
    v_mfma_f32_16x16x32_bf16 v[44:47], v[60:63], a[108:111], v[44:47]
    s_waitcnt lgkmcnt(1)
    v_mfma_f32_16x16x32_bf16 v[16:19], v[176:179], v[48:51], v[16:19]
    ds_read_b128 v[56:59], v124 offset:26624
    v_mfma_f32_16x16x32_bf16 v[32:35], v[48:51], a[48:51], v[32:35]
    ds_read_b128 v[60:63], v124 offset:27648
    v_mfma_f32_16x16x32_bf16 v[20:23], v[240:243], v[48:51], v[20:23]
    v_mfma_f32_16x16x32_bf16 v[40:43], v[48:51], a[112:115], v[40:43]
    s_waitcnt lgkmcnt(2)
    v_mfma_f32_16x16x32_bf16 v[24:27], v[176:179], v[52:55], v[24:27]
    v_mfma_f32_16x16x32_bf16 v[36:39], v[52:55], a[48:51], v[36:39]
    v_mfma_f32_16x16x32_bf16 v[28:31], v[240:243], v[52:55], v[28:31]
    v_mfma_f32_16x16x32_bf16 v[44:47], v[52:55], a[112:115], v[44:47]
    s_waitcnt lgkmcnt(1)
    v_mfma_f32_16x16x32_bf16 v[16:19], v[180:183], v[56:59], v[16:19]
    ds_read_b128 v[48:51], v124 offset:28672
    v_mfma_f32_16x16x32_bf16 v[32:35], v[56:59], a[52:55], v[32:35]
    ds_read_b128 v[52:55], v124 offset:29696
    v_mfma_f32_16x16x32_bf16 v[20:23], v[244:247], v[56:59], v[20:23]
    v_mfma_f32_16x16x32_bf16 v[40:43], v[56:59], a[116:119], v[40:43]
    s_waitcnt lgkmcnt(2)
    v_mfma_f32_16x16x32_bf16 v[24:27], v[180:183], v[60:63], v[24:27]
    v_mfma_f32_16x16x32_bf16 v[36:39], v[60:63], a[52:55], v[36:39]
    v_mfma_f32_16x16x32_bf16 v[28:31], v[244:247], v[60:63], v[28:31]
    v_mfma_f32_16x16x32_bf16 v[44:47], v[60:63], a[116:119], v[44:47]
    s_waitcnt lgkmcnt(1)
    v_mfma_f32_16x16x32_bf16 v[16:19], v[184:187], v[48:51], v[16:19]
    ds_read_b128 v[56:59], v124 offset:30720
    v_mfma_f32_16x16x32_bf16 v[32:35], v[48:51], a[56:59], v[32:35]
    ds_read_b128 v[60:63], v124 offset:31744
    v_mfma_f32_16x16x32_bf16 v[20:23], v[248:251], v[48:51], v[20:23]
    v_mfma_f32_16x16x32_bf16 v[40:43], v[48:51], a[120:123], v[40:43]
    s_waitcnt lgkmcnt(2)
    v_mfma_f32_16x16x32_bf16 v[24:27], v[184:187], v[52:55], v[24:27]
    v_mfma_f32_16x16x32_bf16 v[36:39], v[52:55], a[56:59], v[36:39]
    v_mfma_f32_16x16x32_bf16 v[28:31], v[248:251], v[52:55], v[28:31]
    v_mfma_f32_16x16x32_bf16 v[44:47], v[52:55], a[120:123], v[44:47]
    s_waitcnt lgkmcnt(1)
    v_mfma_f32_16x16x32_bf16 v[16:19], v[188:191], v[56:59], v[16:19]
    v_mfma_f32_16x16x32_bf16 v[32:35], v[56:59], a[60:63], v[32:35]
    v_mfma_f32_16x16x32_bf16 v[20:23], v[252:255], v[56:59], v[20:23]
    v_mfma_f32_16x16x32_bf16 v[40:43], v[56:59], a[124:127], v[40:43]
    s_waitcnt lgkmcnt(0)
    v_mfma_f32_16x16x32_bf16 v[24:27], v[188:191], v[60:63], v[24:27]
    v_mfma_f32_16x16x32_bf16 v[36:39], v[60:63], a[60:63], v[36:39]
    v_mfma_f32_16x16x32_bf16 v[28:31], v[252:255], v[60:63], v[28:31]
    v_mfma_f32_16x16x32_bf16 v[44:47], v[60:63], a[124:127], v[44:47]
    s_lshl_b32 s3, s22, 10
    s_add_u32 s3, s3, s28
    v_add_u32 v124, s3, v116
    s_lshl_b32 s3, s22, 11
    s_add_u32 s3, s3, s28
    v_add_u32 v125, s3, v116
    s_lshl_b32 s34, s25, 5
    s_add_u32 s34, s34, s21
    s_lshl_b32 s34, s34, 14
    s_add_u32 s34, s34, 0x2000000
    s_lshl_b32 s3, s22, 10
    s_add_u32 s37, s34, s3
    s_add_u32 s38, s37, 8192
    s_add_u32 s48, s37, 4096
    s_add_u32 s49, s38, 4096
    v_cvt_pk_bf16_f32 v48, v16, v20
    v_cvt_pk_bf16_f32 v49, v17, v21
    v_cvt_pk_bf16_f32 v50, v18, v22
    v_cvt_pk_bf16_f32 v51, v19, v23
    ds_write_b128 v124, v[48:51] offset:8192
    v_cvt_pk_bf16_f32 v52, v24, v28
    v_cvt_pk_bf16_f32 v53, v25, v29
    v_cvt_pk_bf16_f32 v54, v26, v30
    v_cvt_pk_bf16_f32 v55, v27, v31
    ds_write_b128 v124, v[52:55] offset:12288
    v_cvt_pk_bf16_f32 v80, v32, v33
    v_cvt_pk_bf16_f32 v81, v36, v37
    v_cvt_pk_bf16_f32 v82, v34, v35
    v_cvt_pk_bf16_f32 v83, v38, v39
    buffer_store_dwordx4 v[80:83], v116, s[4:7], s48 offen sc1
    v_cvt_pk_bf16_f32 v84, v40, v41
    v_cvt_pk_bf16_f32 v85, v44, v45
    v_cvt_pk_bf16_f32 v86, v42, v43
    v_cvt_pk_bf16_f32 v87, v46, v47
    buffer_store_dwordx4 v[84:87], v116, s[4:7], s49 offen sc1
    ds_write_b128 v125, v[80:83] offset:16384
    ds_write_b128 v125, v[84:87] offset:17408
    v_add_u32 v125, s28, v127
    s_waitcnt lgkmcnt(2)
    s_barrier
    ds_read_b128 v[88:91], v125 offset:8192
    ds_read_b128 v[92:95], v125 offset:9216
    s_waitcnt lgkmcnt(1)
    buffer_store_dwordx4 v[88:91], v116, s[4:7], s37 offen sc1
    s_waitcnt lgkmcnt(0)
    buffer_store_dwordx4 v[92:95], v116, s[4:7], s38 offen sc1
    s_lshl_b32 s34, s21, 6
    s_add_u32 s34, s34, s25
    s_lshl_b32 s34, s34, 2
    s_add_u32 s34, s34, s22
    s_add_u32 s51, s34, 0x90000
    s_waitcnt vmcnt(13)
    s_barrier
    ds_read_b64_tr_b16 a[134:135], v4 offset:16384
    ds_read_b64_tr_b16 a[198:199], v5 offset:16384
    ds_read_b64_tr_b16 a[150:151], v6 offset:16384
    ds_read_b64_tr_b16 a[214:215], v7 offset:16384
    ds_read_b64_tr_b16 a[166:167], v8 offset:16384
    ds_read_b64_tr_b16 a[230:231], v9 offset:16384
    ds_read_b64_tr_b16 a[182:183], v10 offset:16384
    ds_read_b64_tr_b16 a[246:247], v11 offset:16384
    s_waitcnt lgkmcnt(0)
    s_barrier
    s_add_u32 m0, s33, 131072
    s_add_u32 s34, s31, 0x40000
    buffer_load_dwordx4 v2, s[8:11], s34 offen  lds
    s_add_u32 m0, s33, 132096
    s_add_u32 s34, s31, 0x48000
    buffer_load_dwordx4 v3, s[8:11], s34 offen  lds
    s_add_u32 m0, s33, 133120
    s_add_u32 s34, s31, 0x50000
    buffer_load_dwordx4 v2, s[8:11], s34 offen  lds
    s_add_u32 m0, s33, 134144
    s_add_u32 s34, s31, 0x58000
    buffer_load_dwordx4 v3, s[8:11], s34 offen  lds
    s_waitcnt vmcnt(13)
    s_barrier
    ds_read_b64_tr_b16 a[136:137], v4 offset:32768
    ds_read_b64_tr_b16 a[200:201], v5 offset:32768
    ds_read_b64_tr_b16 a[152:153], v6 offset:32768
    ds_read_b64_tr_b16 a[216:217], v7 offset:32768
    ds_read_b64_tr_b16 a[168:169], v8 offset:32768
    ds_read_b64_tr_b16 a[232:233], v9 offset:32768
    ds_read_b64_tr_b16 a[184:185], v10 offset:32768
    ds_read_b64_tr_b16 a[248:249], v11 offset:32768
    s_waitcnt lgkmcnt(0)
    s_barrier
    s_add_u32 m0, s33, 147456
    s_add_u32 s34, s31, 0x44000
    buffer_load_dwordx4 v2, s[8:11], s34 offen  lds
    s_add_u32 m0, s33, 148480
    s_add_u32 s34, s31, 0x4c000
    buffer_load_dwordx4 v3, s[8:11], s34 offen  lds
    s_add_u32 m0, s33, 149504
    s_add_u32 s34, s31, 0x54000
    buffer_load_dwordx4 v2, s[8:11], s34 offen  lds
    s_add_u32 m0, s33, 150528
    s_add_u32 s34, s31, 0x5c000
    buffer_load_dwordx4 v3, s[8:11], s34 offen  lds
    s_waitcnt vmcnt(13)
    s_barrier
    ds_read_b64_tr_b16 a[138:139], v4 offset:0
    ds_read_b64_tr_b16 a[202:203], v5 offset:0
    ds_read_b64_tr_b16 a[154:155], v6 offset:0
    ds_read_b64_tr_b16 a[218:219], v7 offset:0
    ds_read_b64_tr_b16 a[170:171], v8 offset:0
    ds_read_b64_tr_b16 a[234:235], v9 offset:0
    ds_read_b64_tr_b16 a[186:187], v10 offset:0
    ds_read_b64_tr_b16 a[250:251], v11 offset:0
    s_waitcnt lgkmcnt(0)
    s_waitcnt vmcnt(4)
    s_barrier
    ds_read_b64_tr_b16 a[140:141], v4 offset:16384
    ds_read_b64_tr_b16 a[204:205], v5 offset:16384
    ds_read_b64_tr_b16 a[156:157], v6 offset:16384
    ds_read_b64_tr_b16 a[220:221], v7 offset:16384
    ds_read_b64_tr_b16 a[172:173], v8 offset:16384
    ds_read_b64_tr_b16 a[236:237], v9 offset:16384
    ds_read_b64_tr_b16 a[188:189], v10 offset:16384
    ds_read_b64_tr_b16 a[252:253], v11 offset:16384
    s_waitcnt lgkmcnt(0)
    s_waitcnt vmcnt(0)
    s_barrier
    ds_read_b64_tr_b16 a[142:143], v4 offset:32768
    ds_read_b64_tr_b16 a[206:207], v5 offset:32768
    ds_read_b64_tr_b16 a[158:159], v6 offset:32768
    ds_read_b64_tr_b16 a[222:223], v7 offset:32768
    ds_read_b64_tr_b16 a[174:175], v8 offset:32768
    ds_read_b64_tr_b16 a[238:239], v9 offset:32768
    ds_read_b64_tr_b16 a[190:191], v10 offset:32768
    ds_read_b64_tr_b16 a[254:255], v11 offset:32768
    s_waitcnt lgkmcnt(0)
    s_waitcnt lgkmcnt(0)
    s_barrier
    v_mov_b32 v96, 1
    s_waitcnt vmcnt(0)
    s_mov_b64 exec, 1
    buffer_store_byte v96, v117, s[4:7], s51 offen sc1
    s_mov_b64 exec, -1
    s_mov_b32 s51, 0x4000000
    s_mov_b32 s28, 65536
    v_mov_b32 v124, v116
    ds_read_b128 v[48:51], v124 offset:0
    ds_read_b128 v[52:55], v124 offset:1024
    s_waitcnt lgkmcnt(1)
    v_mfma_f32_16x16x32_bf16 v[64:67], a[128:131], v[48:51], 0
    ds_read_b128 v[56:59], v124 offset:2048
    v_mfma_f32_16x16x32_bf16 v[68:71], a[192:195], v[48:51], 0
    ds_read_b128 v[60:63], v124 offset:3072
    s_waitcnt lgkmcnt(2)
    v_mfma_f32_16x16x32_bf16 v[72:75], a[128:131], v[52:55], 0
    v_mfma_f32_16x16x32_bf16 v[76:79], a[192:195], v[52:55], 0
    s_waitcnt lgkmcnt(1)
    v_mfma_f32_16x16x32_bf16 v[64:67], a[132:135], v[56:59], v[64:67]
    ds_read_b128 v[48:51], v124 offset:4096
    v_mfma_f32_16x16x32_bf16 v[68:71], a[196:199], v[56:59], v[68:71]
    ds_read_b128 v[52:55], v124 offset:5120
    s_waitcnt lgkmcnt(2)
    v_mfma_f32_16x16x32_bf16 v[72:75], a[132:135], v[60:63], v[72:75]
    v_mfma_f32_16x16x32_bf16 v[76:79], a[196:199], v[60:63], v[76:79]
    s_waitcnt lgkmcnt(1)
    v_mfma_f32_16x16x32_bf16 v[64:67], a[136:139], v[48:51], v[64:67]
    ds_read_b128 v[56:59], v124 offset:6144
    v_mfma_f32_16x16x32_bf16 v[68:71], a[200:203], v[48:51], v[68:71]
    ds_read_b128 v[60:63], v124 offset:7168
    s_waitcnt lgkmcnt(2)
    v_mfma_f32_16x16x32_bf16 v[72:75], a[136:139], v[52:55], v[72:75]
    v_mfma_f32_16x16x32_bf16 v[76:79], a[200:203], v[52:55], v[76:79]
    s_waitcnt lgkmcnt(1)
    v_mfma_f32_16x16x32_bf16 v[64:67], a[140:143], v[56:59], v[64:67]
    ds_read_b128 v[48:51], v124 offset:8192
    v_mfma_f32_16x16x32_bf16 v[68:71], a[204:207], v[56:59], v[68:71]
    ds_read_b128 v[52:55], v124 offset:9216
    s_waitcnt lgkmcnt(2)
    v_mfma_f32_16x16x32_bf16 v[72:75], a[140:143], v[60:63], v[72:75]
    v_mfma_f32_16x16x32_bf16 v[76:79], a[204:207], v[60:63], v[76:79]
    s_waitcnt lgkmcnt(1)
    v_mfma_f32_16x16x32_bf16 v[64:67], a[144:147], v[48:51], v[64:67]
    ds_read_b128 v[56:59], v124 offset:10240
    v_mfma_f32_16x16x32_bf16 v[68:71], a[208:211], v[48:51], v[68:71]
    ds_read_b128 v[60:63], v124 offset:11264
    s_waitcnt lgkmcnt(2)
    v_mfma_f32_16x16x32_bf16 v[72:75], a[144:147], v[52:55], v[72:75]
    v_mfma_f32_16x16x32_bf16 v[76:79], a[208:211], v[52:55], v[76:79]
    s_waitcnt lgkmcnt(1)
    v_mfma_f32_16x16x32_bf16 v[64:67], a[148:151], v[56:59], v[64:67]
    ds_read_b128 v[48:51], v124 offset:12288
    v_mfma_f32_16x16x32_bf16 v[68:71], a[212:215], v[56:59], v[68:71]
    ds_read_b128 v[52:55], v124 offset:13312
    s_waitcnt lgkmcnt(2)
    v_mfma_f32_16x16x32_bf16 v[72:75], a[148:151], v[60:63], v[72:75]
    v_mfma_f32_16x16x32_bf16 v[76:79], a[212:215], v[60:63], v[76:79]
    s_waitcnt lgkmcnt(1)
    v_mfma_f32_16x16x32_bf16 v[64:67], a[152:155], v[48:51], v[64:67]
    ds_read_b128 v[56:59], v124 offset:14336
    v_mfma_f32_16x16x32_bf16 v[68:71], a[216:219], v[48:51], v[68:71]
    ds_read_b128 v[60:63], v124 offset:15360
    s_waitcnt lgkmcnt(2)
    v_mfma_f32_16x16x32_bf16 v[72:75], a[152:155], v[52:55], v[72:75]
    v_mfma_f32_16x16x32_bf16 v[76:79], a[216:219], v[52:55], v[76:79]
    s_waitcnt lgkmcnt(1)
    v_mfma_f32_16x16x32_bf16 v[64:67], a[156:159], v[56:59], v[64:67]
    ds_read_b128 v[48:51], v124 offset:16384
    v_mfma_f32_16x16x32_bf16 v[68:71], a[220:223], v[56:59], v[68:71]
    ds_read_b128 v[52:55], v124 offset:17408
    s_waitcnt lgkmcnt(2)
    v_mfma_f32_16x16x32_bf16 v[72:75], a[156:159], v[60:63], v[72:75]
    v_mfma_f32_16x16x32_bf16 v[76:79], a[220:223], v[60:63], v[76:79]
    s_waitcnt lgkmcnt(1)
    v_mfma_f32_16x16x32_bf16 v[64:67], a[160:163], v[48:51], v[64:67]
    ds_read_b128 v[56:59], v124 offset:18432
    v_mfma_f32_16x16x32_bf16 v[68:71], a[224:227], v[48:51], v[68:71]
    ds_read_b128 v[60:63], v124 offset:19456
    s_waitcnt lgkmcnt(2)
    v_mfma_f32_16x16x32_bf16 v[72:75], a[160:163], v[52:55], v[72:75]
    v_mfma_f32_16x16x32_bf16 v[76:79], a[224:227], v[52:55], v[76:79]
    s_waitcnt lgkmcnt(1)
    v_mfma_f32_16x16x32_bf16 v[64:67], a[164:167], v[56:59], v[64:67]
    ds_read_b128 v[48:51], v124 offset:20480
    v_mfma_f32_16x16x32_bf16 v[68:71], a[228:231], v[56:59], v[68:71]
    ds_read_b128 v[52:55], v124 offset:21504
    s_waitcnt lgkmcnt(2)
    v_mfma_f32_16x16x32_bf16 v[72:75], a[164:167], v[60:63], v[72:75]
    v_mfma_f32_16x16x32_bf16 v[76:79], a[228:231], v[60:63], v[76:79]
    s_waitcnt lgkmcnt(1)
    v_mfma_f32_16x16x32_bf16 v[64:67], a[168:171], v[48:51], v[64:67]
    ds_read_b128 v[56:59], v124 offset:22528
    v_mfma_f32_16x16x32_bf16 v[68:71], a[232:235], v[48:51], v[68:71]
    ds_read_b128 v[60:63], v124 offset:23552
    s_waitcnt lgkmcnt(2)
    v_mfma_f32_16x16x32_bf16 v[72:75], a[168:171], v[52:55], v[72:75]
    v_mfma_f32_16x16x32_bf16 v[76:79], a[232:235], v[52:55], v[76:79]
    s_waitcnt lgkmcnt(1)
    v_mfma_f32_16x16x32_bf16 v[64:67], a[172:175], v[56:59], v[64:67]
    ds_read_b128 v[48:51], v124 offset:24576
    v_mfma_f32_16x16x32_bf16 v[68:71], a[236:239], v[56:59], v[68:71]
    ds_read_b128 v[52:55], v124 offset:25600
    s_waitcnt lgkmcnt(2)
    v_mfma_f32_16x16x32_bf16 v[72:75], a[172:175], v[60:63], v[72:75]
    v_mfma_f32_16x16x32_bf16 v[76:79], a[236:239], v[60:63], v[76:79]
    s_waitcnt lgkmcnt(1)
    v_mfma_f32_16x16x32_bf16 v[64:67], a[176:179], v[48:51], v[64:67]
    ds_read_b128 v[56:59], v124 offset:26624
    v_mfma_f32_16x16x32_bf16 v[68:71], a[240:243], v[48:51], v[68:71]
    ds_read_b128 v[60:63], v124 offset:27648
    s_waitcnt lgkmcnt(2)
    v_mfma_f32_16x16x32_bf16 v[72:75], a[176:179], v[52:55], v[72:75]
    v_mfma_f32_16x16x32_bf16 v[76:79], a[240:243], v[52:55], v[76:79]
    s_waitcnt lgkmcnt(1)
    v_mfma_f32_16x16x32_bf16 v[64:67], a[180:183], v[56:59], v[64:67]
    ds_read_b128 v[48:51], v124 offset:28672
    v_mfma_f32_16x16x32_bf16 v[68:71], a[244:247], v[56:59], v[68:71]
    ds_read_b128 v[52:55], v124 offset:29696
    s_waitcnt lgkmcnt(2)
    v_mfma_f32_16x16x32_bf16 v[72:75], a[180:183], v[60:63], v[72:75]
    v_mfma_f32_16x16x32_bf16 v[76:79], a[244:247], v[60:63], v[76:79]
    s_waitcnt lgkmcnt(1)
    v_mfma_f32_16x16x32_bf16 v[64:67], a[184:187], v[48:51], v[64:67]
    ds_read_b128 v[56:59], v124 offset:30720
    v_mfma_f32_16x16x32_bf16 v[68:71], a[248:251], v[48:51], v[68:71]
    ds_read_b128 v[60:63], v124 offset:31744
    s_waitcnt lgkmcnt(2)
    v_mfma_f32_16x16x32_bf16 v[72:75], a[184:187], v[52:55], v[72:75]
    v_mfma_f32_16x16x32_bf16 v[76:79], a[248:251], v[52:55], v[76:79]
    s_waitcnt lgkmcnt(1)
    v_mfma_f32_16x16x32_bf16 v[64:67], a[188:191], v[56:59], v[64:67]
    v_mfma_f32_16x16x32_bf16 v[68:71], a[252:255], v[56:59], v[68:71]
    s_waitcnt lgkmcnt(0)
    v_mfma_f32_16x16x32_bf16 v[72:75], a[188:191], v[60:63], v[72:75]
    v_mfma_f32_16x16x32_bf16 v[76:79], a[252:255], v[60:63], v[76:79]
    s_lshl_b32 s3, s22, 10
    s_add_u32 s3, s3, s28
    v_add_u32 v124, s3, v116
    s_nop 1
    v_cvt_pk_bf16_f32 v56, v64, v68
    v_cvt_pk_bf16_f32 v57, v65, v69
    v_cvt_pk_bf16_f32 v58, v66, v70
    v_cvt_pk_bf16_f32 v59, v67, v71
    v_cvt_pk_bf16_f32 v60, v72, v76
    v_cvt_pk_bf16_f32 v61, v73, v77
    v_cvt_pk_bf16_f32 v62, v74, v78
    v_cvt_pk_bf16_f32 v63, v75, v79
    ds_write_b128 v124, v[56:59] offset:0
    ds_write_b128 v124, v[60:63] offset:4096
    s_add_u32 s25, s25, 3
    s_mov_b32 s27, 0
    s_barrier
    s_lshl_b32 s34, s25, 15
    s_lshl_b32 s3, s22, 13
    s_add_u32 s34, s34, s3
    s_add_u32 s34, s34, 0x200000
    s_add_u32 s3, s3, s27
    s_add_u32 m0, s3, 0
    s_nop 0
    buffer_load_dwordx4 v116, s[4:7], s34 offen offset:0 sc1 lds
    buffer_load_dwordx4 v116, s[4:7], s34 offen offset:1024 sc1 lds
    buffer_load_dwordx4 v116, s[4:7], s34 offen offset:2048 sc1 lds
    buffer_load_dwordx4 v116, s[4:7], s34 offen offset:3072 sc1 lds
    s_add_u32 m0, s3, 4096
    s_add_u32 s34, s34, 4096
    buffer_load_dwordx4 v116, s[4:7], s34 offen offset:0 sc1 lds
    buffer_load_dwordx4 v116, s[4:7], s34 offen offset:1024 sc1 lds
    buffer_load_dwordx4 v116, s[4:7], s34 offen offset:2048 sc1 lds
    buffer_load_dwordx4 v116, s[4:7], s34 offen offset:3072 sc1 lds
    s_add_u32 s28, s28, 24576
    v_add_u32 v124, 32768, v116
    ds_read_b128 v[48:51], v124 offset:0
    ds_read_b128 v[52:55], v124 offset:1024
    s_waitcnt lgkmcnt(1)
    v_mfma_f32_16x16x32_bf16 v[64:67], a[128:131], v[48:51], 0
    ds_read_b128 v[56:59], v124 offset:2048
    v_mfma_f32_16x16x32_bf16 v[68:71], a[192:195], v[48:51], 0
    ds_read_b128 v[60:63], v124 offset:3072
    s_waitcnt lgkmcnt(2)
    v_mfma_f32_16x16x32_bf16 v[72:75], a[128:131], v[52:55], 0
    v_mfma_f32_16x16x32_bf16 v[76:79], a[192:195], v[52:55], 0
    s_waitcnt lgkmcnt(1)
    v_mfma_f32_16x16x32_bf16 v[64:67], a[132:135], v[56:59], v[64:67]
    ds_read_b128 v[48:51], v124 offset:4096
    v_mfma_f32_16x16x32_bf16 v[68:71], a[196:199], v[56:59], v[68:71]
    ds_read_b128 v[52:55], v124 offset:5120
    s_waitcnt lgkmcnt(2)
    v_mfma_f32_16x16x32_bf16 v[72:75], a[132:135], v[60:63], v[72:75]
    v_mfma_f32_16x16x32_bf16 v[76:79], a[196:199], v[60:63], v[76:79]
    s_waitcnt lgkmcnt(1)
    v_mfma_f32_16x16x32_bf16 v[64:67], a[136:139], v[48:51], v[64:67]
    ds_read_b128 v[56:59], v124 offset:6144
    v_mfma_f32_16x16x32_bf16 v[68:71], a[200:203], v[48:51], v[68:71]
    ds_read_b128 v[60:63], v124 offset:7168
    s_waitcnt lgkmcnt(2)
    v_mfma_f32_16x16x32_bf16 v[72:75], a[136:139], v[52:55], v[72:75]
    v_mfma_f32_16x16x32_bf16 v[76:79], a[200:203], v[52:55], v[76:79]
    s_waitcnt lgkmcnt(1)
    v_mfma_f32_16x16x32_bf16 v[64:67], a[140:143], v[56:59], v[64:67]
    ds_read_b128 v[48:51], v124 offset:8192
    v_mfma_f32_16x16x32_bf16 v[68:71], a[204:207], v[56:59], v[68:71]
    ds_read_b128 v[52:55], v124 offset:9216
    s_waitcnt lgkmcnt(2)
    v_mfma_f32_16x16x32_bf16 v[72:75], a[140:143], v[60:63], v[72:75]
    v_mfma_f32_16x16x32_bf16 v[76:79], a[204:207], v[60:63], v[76:79]
    s_waitcnt lgkmcnt(1)
    v_mfma_f32_16x16x32_bf16 v[64:67], a[144:147], v[48:51], v[64:67]
    ds_read_b128 v[56:59], v124 offset:10240
    v_mfma_f32_16x16x32_bf16 v[68:71], a[208:211], v[48:51], v[68:71]
    ds_read_b128 v[60:63], v124 offset:11264
    s_waitcnt lgkmcnt(2)
    v_mfma_f32_16x16x32_bf16 v[72:75], a[144:147], v[52:55], v[72:75]
    v_mfma_f32_16x16x32_bf16 v[76:79], a[208:211], v[52:55], v[76:79]
    s_waitcnt lgkmcnt(1)
    v_mfma_f32_16x16x32_bf16 v[64:67], a[148:151], v[56:59], v[64:67]
    ds_read_b128 v[48:51], v124 offset:12288
    v_mfma_f32_16x16x32_bf16 v[68:71], a[212:215], v[56:59], v[68:71]
    ds_read_b128 v[52:55], v124 offset:13312
    s_waitcnt lgkmcnt(2)
    v_mfma_f32_16x16x32_bf16 v[72:75], a[148:151], v[60:63], v[72:75]
    v_mfma_f32_16x16x32_bf16 v[76:79], a[212:215], v[60:63], v[76:79]
    s_waitcnt lgkmcnt(1)
    v_mfma_f32_16x16x32_bf16 v[64:67], a[152:155], v[48:51], v[64:67]
    ds_read_b128 v[56:59], v124 offset:14336
    v_mfma_f32_16x16x32_bf16 v[68:71], a[216:219], v[48:51], v[68:71]
    ds_read_b128 v[60:63], v124 offset:15360
    s_waitcnt lgkmcnt(2)
    v_mfma_f32_16x16x32_bf16 v[72:75], a[152:155], v[52:55], v[72:75]
    v_mfma_f32_16x16x32_bf16 v[76:79], a[216:219], v[52:55], v[76:79]
    s_waitcnt lgkmcnt(1)
    v_mfma_f32_16x16x32_bf16 v[64:67], a[156:159], v[56:59], v[64:67]
    ds_read_b128 v[48:51], v124 offset:16384
    v_mfma_f32_16x16x32_bf16 v[68:71], a[220:223], v[56:59], v[68:71]
    ds_read_b128 v[52:55], v124 offset:17408
    s_waitcnt lgkmcnt(2)
    v_mfma_f32_16x16x32_bf16 v[72:75], a[156:159], v[60:63], v[72:75]
    v_mfma_f32_16x16x32_bf16 v[76:79], a[220:223], v[60:63], v[76:79]
    s_waitcnt lgkmcnt(1)
    v_mfma_f32_16x16x32_bf16 v[64:67], a[160:163], v[48:51], v[64:67]
    ds_read_b128 v[56:59], v124 offset:18432
    v_mfma_f32_16x16x32_bf16 v[68:71], a[224:227], v[48:51], v[68:71]
    ds_read_b128 v[60:63], v124 offset:19456
    s_waitcnt lgkmcnt(2)
    v_mfma_f32_16x16x32_bf16 v[72:75], a[160:163], v[52:55], v[72:75]
    v_mfma_f32_16x16x32_bf16 v[76:79], a[224:227], v[52:55], v[76:79]
    s_waitcnt lgkmcnt(1)
    v_mfma_f32_16x16x32_bf16 v[64:67], a[164:167], v[56:59], v[64:67]
    ds_read_b128 v[48:51], v124 offset:20480
    v_mfma_f32_16x16x32_bf16 v[68:71], a[228:231], v[56:59], v[68:71]
    ds_read_b128 v[52:55], v124 offset:21504
    s_waitcnt lgkmcnt(2)
    v_mfma_f32_16x16x32_bf16 v[72:75], a[164:167], v[60:63], v[72:75]
    v_mfma_f32_16x16x32_bf16 v[76:79], a[228:231], v[60:63], v[76:79]
    s_waitcnt lgkmcnt(1)
    v_mfma_f32_16x16x32_bf16 v[64:67], a[168:171], v[48:51], v[64:67]
    ds_read_b128 v[56:59], v124 offset:22528
    v_mfma_f32_16x16x32_bf16 v[68:71], a[232:235], v[48:51], v[68:71]
    ds_read_b128 v[60:63], v124 offset:23552
    s_waitcnt lgkmcnt(2)
    v_mfma_f32_16x16x32_bf16 v[72:75], a[168:171], v[52:55], v[72:75]
    v_mfma_f32_16x16x32_bf16 v[76:79], a[232:235], v[52:55], v[76:79]
    s_waitcnt lgkmcnt(1)
    v_mfma_f32_16x16x32_bf16 v[64:67], a[172:175], v[56:59], v[64:67]
    ds_read_b128 v[48:51], v124 offset:24576
    v_mfma_f32_16x16x32_bf16 v[68:71], a[236:239], v[56:59], v[68:71]
    ds_read_b128 v[52:55], v124 offset:25600
    s_waitcnt lgkmcnt(2)
    v_mfma_f32_16x16x32_bf16 v[72:75], a[172:175], v[60:63], v[72:75]
    v_mfma_f32_16x16x32_bf16 v[76:79], a[236:239], v[60:63], v[76:79]
    s_waitcnt lgkmcnt(1)
    v_mfma_f32_16x16x32_bf16 v[64:67], a[176:179], v[48:51], v[64:67]
    ds_read_b128 v[56:59], v124 offset:26624
    v_mfma_f32_16x16x32_bf16 v[68:71], a[240:243], v[48:51], v[68:71]
    ds_read_b128 v[60:63], v124 offset:27648
    s_waitcnt lgkmcnt(2)
    v_mfma_f32_16x16x32_bf16 v[72:75], a[176:179], v[52:55], v[72:75]
    v_mfma_f32_16x16x32_bf16 v[76:79], a[240:243], v[52:55], v[76:79]
    s_waitcnt lgkmcnt(1)
    v_mfma_f32_16x16x32_bf16 v[64:67], a[180:183], v[56:59], v[64:67]
    ds_read_b128 v[48:51], v124 offset:28672
    v_mfma_f32_16x16x32_bf16 v[68:71], a[244:247], v[56:59], v[68:71]
    ds_read_b128 v[52:55], v124 offset:29696
    s_waitcnt lgkmcnt(2)
    v_mfma_f32_16x16x32_bf16 v[72:75], a[180:183], v[60:63], v[72:75]
    v_mfma_f32_16x16x32_bf16 v[76:79], a[244:247], v[60:63], v[76:79]
    s_waitcnt lgkmcnt(1)
    v_mfma_f32_16x16x32_bf16 v[64:67], a[184:187], v[48:51], v[64:67]
    ds_read_b128 v[56:59], v124 offset:30720
    v_mfma_f32_16x16x32_bf16 v[68:71], a[248:251], v[48:51], v[68:71]
    ds_read_b128 v[60:63], v124 offset:31744
    s_waitcnt lgkmcnt(2)
    v_mfma_f32_16x16x32_bf16 v[72:75], a[184:187], v[52:55], v[72:75]
    v_mfma_f32_16x16x32_bf16 v[76:79], a[248:251], v[52:55], v[76:79]
    s_waitcnt lgkmcnt(1)
    v_mfma_f32_16x16x32_bf16 v[64:67], a[188:191], v[56:59], v[64:67]
    v_mfma_f32_16x16x32_bf16 v[68:71], a[252:255], v[56:59], v[68:71]
    s_waitcnt lgkmcnt(0)
    v_mfma_f32_16x16x32_bf16 v[72:75], a[188:191], v[60:63], v[72:75]
    v_mfma_f32_16x16x32_bf16 v[76:79], a[252:255], v[60:63], v[76:79]
    s_lshl_b32 s3, s22, 10
    s_add_u32 s3, s3, s28
    v_add_u32 v124, s3, v116
    s_nop 1
    v_cvt_pk_bf16_f32 v56, v64, v68
    v_cvt_pk_bf16_f32 v57, v65, v69
    v_cvt_pk_bf16_f32 v58, v66, v70
    v_cvt_pk_bf16_f32 v59, v67, v71
    v_cvt_pk_bf16_f32 v60, v72, v76
    v_cvt_pk_bf16_f32 v61, v73, v77
    v_cvt_pk_bf16_f32 v62, v74, v78
    v_cvt_pk_bf16_f32 v63, v75, v79
    ds_write_b128 v124, v[56:59] offset:0
    ds_write_b128 v124, v[60:63] offset:4096
    s_add_u32 s28, s28, 24576
    s_waitcnt vmcnt(0) lgkmcnt(0)
    s_mov_b32 s52, 0
    s_mov_b32 s92, 0
L_proj_loop:
    s_cmp_ge_u32 s25, 64
    s_cbranch_scc1 L_proj_none
    s_barrier
    v_add_u32 v124, s27, v116
    s_xor_b32 s27, s27, 32768
    s_add_u32 s36, s25, 3
    s_min_u32 s36, s36, 63
    s_lshl_b32 s34, s36, 15
    s_lshl_b32 s3, s22, 13
    s_add_u32 s34, s34, s3
    s_add_u32 s34, s34, 0x200000
    s_add_u32 s3, s3, s27
    s_add_u32 m0, s3, 0
    s_nop 0
    buffer_load_dwordx4 v116, s[4:7], s34 offen offset:0 sc1 lds
    buffer_load_dwordx4 v116, s[4:7], s34 offen offset:1024 sc1 lds
    buffer_load_dwordx4 v116, s[4:7], s34 offen offset:2048 sc1 lds
    buffer_load_dwordx4 v116, s[4:7], s34 offen offset:3072 sc1 lds
    s_add_u32 m0, s3, 4096
    s_add_u32 s34, s34, 4096
    buffer_load_dwordx4 v116, s[4:7], s34 offen offset:0 sc1 lds
    buffer_load_dwordx4 v116, s[4:7], s34 offen offset:1024 sc1 lds
    buffer_load_dwordx4 v116, s[4:7], s34 offen offset:2048 sc1 lds
    buffer_load_dwordx4 v116, s[4:7], s34 offen offset:3072 sc1 lds
    ds_read_b128 v[48:51], v124 offset:0
    ds_read_b128 v[52:55], v124 offset:1024
    s_waitcnt lgkmcnt(1)
    v_mfma_f32_16x16x32_bf16 v[16:19], v[128:131], v[48:51], 0
    ds_read_b128 v[56:59], v124 offset:2048
    v_mfma_f32_16x16x32_bf16 v[32:35], v[48:51], a[0:3], 0
    ds_read_b128 v[60:63], v124 offset:3072
    v_mfma_f32_16x16x32_bf16 v[64:67], a[128:131], v[48:51], 0
    v_mfma_f32_16x16x32_bf16 v[20:23], v[192:195], v[48:51], 0
    v_mfma_f32_16x16x32_bf16 v[40:43], v[48:51], a[64:67], 0
    v_mfma_f32_16x16x32_bf16 v[68:71], a[192:195], v[48:51], 0
    s_waitcnt lgkmcnt(2)
    v_mfma_f32_16x16x32_bf16 v[24:27], v[128:131], v[52:55], 0
    v_mfma_f32_16x16x32_bf16 v[36:39], v[52:55], a[0:3], 0
    v_mfma_f32_16x16x32_bf16 v[72:75], a[128:131], v[52:55], 0
    v_mfma_f32_16x16x32_bf16 v[28:31], v[192:195], v[52:55], 0
    v_mfma_f32_16x16x32_bf16 v[44:47], v[52:55], a[64:67], 0
    v_mfma_f32_16x16x32_bf16 v[76:79], a[192:195], v[52:55], 0
    s_waitcnt lgkmcnt(1)
    v_mfma_f32_16x16x32_bf16 v[16:19], v[132:135], v[56:59], v[16:19]
    ds_read_b128 v[48:51], v124 offset:4096
    v_mfma_f32_16x16x32_bf16 v[32:35], v[56:59], a[4:7], v[32:35]
    ds_read_b128 v[52:55], v124 offset:5120
    v_mfma_f32_16x16x32_bf16 v[64:67], a[132:135], v[56:59], v[64:67]
    v_mfma_f32_16x16x32_bf16 v[20:23], v[196:199], v[56:59], v[20:23]
    v_mfma_f32_16x16x32_bf16 v[40:43], v[56:59], a[68:71], v[40:43]
    v_mfma_f32_16x16x32_bf16 v[68:71], a[196:199], v[56:59], v[68:71]
    s_waitcnt lgkmcnt(2)
    v_mfma_f32_16x16x32_bf16 v[24:27], v[132:135], v[60:63], v[24:27]
    v_mfma_f32_16x16x32_bf16 v[36:39], v[60:63], a[4:7], v[36:39]
    v_mfma_f32_16x16x32_bf16 v[72:75], a[132:135], v[60:63], v[72:75]
    v_mfma_f32_16x16x32_bf16 v[28:31], v[196:199], v[60:63], v[28:31]
    v_mfma_f32_16x16x32_bf16 v[44:47], v[60:63], a[68:71], v[44:47]
    v_mfma_f32_16x16x32_bf16 v[76:79], a[196:199], v[60:63], v[76:79]
    s_waitcnt lgkmcnt(1)
    v_mfma_f32_16x16x32_bf16 v[16:19], v[136:139], v[48:51], v[16:19]
    ds_read_b128 v[56:59], v124 offset:6144
    v_mfma_f32_16x16x32_bf16 v[32:35], v[48:51], a[8:11], v[32:35]
    ds_read_b128 v[60:63], v124 offset:7168
    v_mfma_f32_16x16x32_bf16 v[64:67], a[136:139], v[48:51], v[64:67]
    v_mfma_f32_16x16x32_bf16 v[20:23], v[200:203], v[48:51], v[20:23]
    v_mfma_f32_16x16x32_bf16 v[40:43], v[48:51], a[72:75], v[40:43]
    v_mfma_f32_16x16x32_bf16 v[68:71], a[200:203], v[48:51], v[68:71]
    s_waitcnt lgkmcnt(2)
    v_mfma_f32_16x16x32_bf16 v[24:27], v[136:139], v[52:55], v[24:27]
    v_mfma_f32_16x16x32_bf16 v[36:39], v[52:55], a[8:11], v[36:39]
    v_mfma_f32_16x16x32_bf16 v[72:75], a[136:139], v[52:55], v[72:75]
    v_mfma_f32_16x16x32_bf16 v[28:31], v[200:203], v[52:55], v[28:31]
    v_mfma_f32_16x16x32_bf16 v[44:47], v[52:55], a[72:75], v[44:47]
    v_mfma_f32_16x16x32_bf16 v[76:79], a[200:203], v[52:55], v[76:79]
    s_waitcnt lgkmcnt(1)
    v_mfma_f32_16x16x32_bf16 v[16:19], v[140:143], v[56:59], v[16:19]
    ds_read_b128 v[48:51], v124 offset:8192
    v_mfma_f32_16x16x32_bf16 v[32:35], v[56:59], a[12:15], v[32:35]
    ds_read_b128 v[52:55], v124 offset:9216
    v_mfma_f32_16x16x32_bf16 v[64:67], a[140:143], v[56:59], v[64:67]
    v_mfma_f32_16x16x32_bf16 v[20:23], v[204:207], v[56:59], v[20:23]
    v_mfma_f32_16x16x32_bf16 v[40:43], v[56:59], a[76:79], v[40:43]
    v_mfma_f32_16x16x32_bf16 v[68:71], a[204:207], v[56:59], v[68:71]
    s_waitcnt lgkmcnt(2)
    v_mfma_f32_16x16x32_bf16 v[24:27], v[140:143], v[60:63], v[24:27]
    v_mfma_f32_16x16x32_bf16 v[36:39], v[60:63], a[12:15], v[36:39]
    v_mfma_f32_16x16x32_bf16 v[72:75], a[140:143], v[60:63], v[72:75]
    v_mfma_f32_16x16x32_bf16 v[28:31], v[204:207], v[60:63], v[28:31]
    v_mfma_f32_16x16x32_bf16 v[44:47], v[60:63], a[76:79], v[44:47]
    v_mfma_f32_16x16x32_bf16 v[76:79], a[204:207], v[60:63], v[76:79]
    s_waitcnt lgkmcnt(1)
    v_mfma_f32_16x16x32_bf16 v[16:19], v[144:147], v[48:51], v[16:19]
    ds_read_b128 v[56:59], v124 offset:10240
    v_mfma_f32_16x16x32_bf16 v[32:35], v[48:51], a[16:19], v[32:35]
    ds_read_b128 v[60:63], v124 offset:11264
    v_mfma_f32_16x16x32_bf16 v[64:67], a[144:147], v[48:51], v[64:67]
    v_mfma_f32_16x16x32_bf16 v[20:23], v[208:211], v[48:51], v[20:23]
    v_mfma_f32_16x16x32_bf16 v[40:43], v[48:51], a[80:83], v[40:43]
    v_mfma_f32_16x16x32_bf16 v[68:71], a[208:211], v[48:51], v[68:71]
    s_waitcnt lgkmcnt(2)
    v_mfma_f32_16x16x32_bf16 v[24:27], v[144:147], v[52:55], v[24:27]
    v_mfma_f32_16x16x32_bf16 v[36:39], v[52:55], a[16:19], v[36:39]
    v_mfma_f32_16x16x32_bf16 v[72:75], a[144:147], v[52:55], v[72:75]
    v_mfma_f32_16x16x32_bf16 v[28:31], v[208:211], v[52:55], v[28:31]
    v_mfma_f32_16x16x32_bf16 v[44:47], v[52:55], a[80:83], v[44:47]
    v_mfma_f32_16x16x32_bf16 v[76:79], a[208:211], v[52:55], v[76:79]
    s_waitcnt lgkmcnt(1)
    v_mfma_f32_16x16x32_bf16 v[16:19], v[148:151], v[56:59], v[16:19]
    ds_read_b128 v[48:51], v124 offset:12288
    v_mfma_f32_16x16x32_bf16 v[32:35], v[56:59], a[20:23], v[32:35]
    ds_read_b128 v[52:55], v124 offset:13312
    v_mfma_f32_16x16x32_bf16 v[64:67], a[148:151], v[56:59], v[64:67]
    v_mfma_f32_16x16x32_bf16 v[20:23], v[212:215], v[56:59], v[20:23]
    v_mfma_f32_16x16x32_bf16 v[40:43], v[56:59], a[84:87], v[40:43]
    v_mfma_f32_16x16x32_bf16 v[68:71], a[212:215], v[56:59], v[68:71]
    s_waitcnt lgkmcnt(2)
    v_mfma_f32_16x16x32_bf16 v[24:27], v[148:151], v[60:63], v[24:27]
    v_mfma_f32_16x16x32_bf16 v[36:39], v[60:63], a[20:23], v[36:39]
    v_mfma_f32_16x16x32_bf16 v[72:75], a[148:151], v[60:63], v[72:75]
    v_mfma_f32_16x16x32_bf16 v[28:31], v[212:215], v[60:63], v[28:31]
    v_mfma_f32_16x16x32_bf16 v[44:47], v[60:63], a[84:87], v[44:47]
    v_mfma_f32_16x16x32_bf16 v[76:79], a[212:215], v[60:63], v[76:79]
    s_waitcnt lgkmcnt(1)
    v_mfma_f32_16x16x32_bf16 v[16:19], v[152:155], v[48:51], v[16:19]
    ds_read_b128 v[56:59], v124 offset:14336
    v_mfma_f32_16x16x32_bf16 v[32:35], v[48:51], a[24:27], v[32:35]
    ds_read_b128 v[60:63], v124 offset:15360
    v_mfma_f32_16x16x32_bf16 v[64:67], a[152:155], v[48:51], v[64:67]
    v_mfma_f32_16x16x32_bf16 v[20:23], v[216:219], v[48:51], v[20:23]
    v_mfma_f32_16x16x32_bf16 v[40:43], v[48:51], a[88:91], v[40:43]
    v_mfma_f32_16x16x32_bf16 v[68:71], a[216:219], v[48:51], v[68:71]
    s_waitcnt lgkmcnt(2)
    v_mfma_f32_16x16x32_bf16 v[24:27], v[152:155], v[52:55], v[24:27]
    v_mfma_f32_16x16x32_bf16 v[36:39], v[52:55], a[24:27], v[36:39]
    v_mfma_f32_16x16x32_bf16 v[72:75], a[152:155], v[52:55], v[72:75]
    v_mfma_f32_16x16x32_bf16 v[28:31], v[216:219], v[52:55], v[28:31]
    v_mfma_f32_16x16x32_bf16 v[44:47], v[52:55], a[88:91], v[44:47]
    v_mfma_f32_16x16x32_bf16 v[76:79], a[216:219], v[52:55], v[76:79]
    s_waitcnt lgkmcnt(1)
    v_mfma_f32_16x16x32_bf16 v[16:19], v[156:159], v[56:59], v[16:19]
    ds_read_b128 v[48:51], v124 offset:16384
    v_mfma_f32_16x16x32_bf16 v[32:35], v[56:59], a[28:31], v[32:35]
    ds_read_b128 v[52:55], v124 offset:17408
    v_mfma_f32_16x16x32_bf16 v[64:67], a[156:159], v[56:59], v[64:67]
    v_mov_b32 v96, 1
    s_waitcnt vmcnt(8)
    s_mov_b64 exec, 1
    buffer_store_byte v96, v117, s[4:7], s51 offen sc1
    s_mov_b64 exec, -1
    v_mfma_f32_16x16x32_bf16 v[20:23], v[220:223], v[56:59], v[20:23]
    v_mfma_f32_16x16x32_bf16 v[40:43], v[56:59], a[92:95], v[40:43]
    v_mfma_f32_16x16x32_bf16 v[68:71], a[220:223], v[56:59], v[68:71]
    s_waitcnt lgkmcnt(2)
    v_mfma_f32_16x16x32_bf16 v[24:27], v[156:159], v[60:63], v[24:27]
    v_mfma_f32_16x16x32_bf16 v[36:39], v[60:63], a[28:31], v[36:39]
    v_mfma_f32_16x16x32_bf16 v[72:75], a[156:159], v[60:63], v[72:75]
    v_mfma_f32_16x16x32_bf16 v[28:31], v[220:223], v[60:63], v[28:31]
    v_mfma_f32_16x16x32_bf16 v[44:47], v[60:63], a[92:95], v[44:47]
    v_mfma_f32_16x16x32_bf16 v[76:79], a[220:223], v[60:63], v[76:79]
    s_waitcnt lgkmcnt(1)
    v_mfma_f32_16x16x32_bf16 v[16:19], v[160:163], v[48:51], v[16:19]
    ds_read_b128 v[56:59], v124 offset:18432
    v_mfma_f32_16x16x32_bf16 v[32:35], v[48:51], a[32:35], v[32:35]
    ds_read_b128 v[60:63], v124 offset:19456
    v_mfma_f32_16x16x32_bf16 v[64:67], a[160:163], v[48:51], v[64:67]
    v_mfma_f32_16x16x32_bf16 v[20:23], v[224:227], v[48:51], v[20:23]
    v_mfma_f32_16x16x32_bf16 v[40:43], v[48:51], a[96:99], v[40:43]
    v_mfma_f32_16x16x32_bf16 v[68:71], a[224:227], v[48:51], v[68:71]
    s_waitcnt lgkmcnt(2)
    v_mfma_f32_16x16x32_bf16 v[24:27], v[160:163], v[52:55], v[24:27]
    v_mfma_f32_16x16x32_bf16 v[36:39], v[52:55], a[32:35], v[36:39]
    v_mfma_f32_16x16x32_bf16 v[72:75], a[160:163], v[52:55], v[72:75]
    v_mfma_f32_16x16x32_bf16 v[28:31], v[224:227], v[52:55], v[28:31]
    v_mfma_f32_16x16x32_bf16 v[44:47], v[52:55], a[96:99], v[44:47]
    v_mfma_f32_16x16x32_bf16 v[76:79], a[224:227], v[52:55], v[76:79]
    s_waitcnt lgkmcnt(1)
    v_mfma_f32_16x16x32_bf16 v[16:19], v[164:167], v[56:59], v[16:19]
    ds_read_b128 v[48:51], v124 offset:20480
    v_mfma_f32_16x16x32_bf16 v[32:35], v[56:59], a[36:39], v[32:35]
    ds_read_b128 v[52:55], v124 offset:21504
    v_mfma_f32_16x16x32_bf16 v[64:67], a[164:167], v[56:59], v[64:67]
    v_mfma_f32_16x16x32_bf16 v[20:23], v[228:231], v[56:59], v[20:23]
    v_mfma_f32_16x16x32_bf16 v[40:43], v[56:59], a[100:103], v[40:43]
    v_mfma_f32_16x16x32_bf16 v[68:71], a[228:231], v[56:59], v[68:71]
    s_waitcnt lgkmcnt(2)
    v_mfma_f32_16x16x32_bf16 v[24:27], v[164:167], v[60:63], v[24:27]
    v_mfma_f32_16x16x32_bf16 v[36:39], v[60:63], a[36:39], v[36:39]
    v_mfma_f32_16x16x32_bf16 v[72:75], a[164:167], v[60:63], v[72:75]
    v_mfma_f32_16x16x32_bf16 v[28:31], v[228:231], v[60:63], v[28:31]
    v_mfma_f32_16x16x32_bf16 v[44:47], v[60:63], a[100:103], v[44:47]
    v_mfma_f32_16x16x32_bf16 v[76:79], a[228:231], v[60:63], v[76:79]
    s_waitcnt lgkmcnt(1)
    v_mfma_f32_16x16x32_bf16 v[16:19], v[168:171], v[48:51], v[16:19]
    ds_read_b128 v[56:59], v124 offset:22528
    v_mfma_f32_16x16x32_bf16 v[32:35], v[48:51], a[40:43], v[32:35]
    ds_read_b128 v[60:63], v124 offset:23552
    v_mfma_f32_16x16x32_bf16 v[64:67], a[168:171], v[48:51], v[64:67]
    v_mfma_f32_16x16x32_bf16 v[20:23], v[232:235], v[48:51], v[20:23]
    v_mfma_f32_16x16x32_bf16 v[40:43], v[48:51], a[104:107], v[40:43]
    v_mfma_f32_16x16x32_bf16 v[68:71], a[232:235], v[48:51], v[68:71]
    s_waitcnt lgkmcnt(2)
    v_mfma_f32_16x16x32_bf16 v[24:27], v[168:171], v[52:55], v[24:27]
    v_mfma_f32_16x16x32_bf16 v[36:39], v[52:55], a[40:43], v[36:39]
    v_mfma_f32_16x16x32_bf16 v[72:75], a[168:171], v[52:55], v[72:75]
    v_mfma_f32_16x16x32_bf16 v[28:31], v[232:235], v[52:55], v[28:31]
    v_mfma_f32_16x16x32_bf16 v[44:47], v[52:55], a[104:107], v[44:47]
    v_mfma_f32_16x16x32_bf16 v[76:79], a[232:235], v[52:55], v[76:79]
    s_waitcnt lgkmcnt(1)
    v_mfma_f32_16x16x32_bf16 v[16:19], v[172:175], v[56:59], v[16:19]
    ds_read_b128 v[48:51], v124 offset:24576
    v_mfma_f32_16x16x32_bf16 v[32:35], v[56:59], a[44:47], v[32:35]
    ds_read_b128 v[52:55], v124 offset:25600
    v_mfma_f32_16x16x32_bf16 v[64:67], a[172:175], v[56:59], v[64:67]
    v_mfma_f32_16x16x32_bf16 v[20:23], v[236:239], v[56:59], v[20:23]
    v_mfma_f32_16x16x32_bf16 v[40:43], v[56:59], a[108:111], v[40:43]
    v_mfma_f32_16x16x32_bf16 v[68:71], a[236:239], v[56:59], v[68:71]
    s_waitcnt lgkmcnt(2)
    v_mfma_f32_16x16x32_bf16 v[24:27], v[172:175], v[60:63], v[24:27]
    v_mfma_f32_16x16x32_bf16 v[36:39], v[60:63], a[44:47], v[36:39]
    v_mfma_f32_16x16x32_bf16 v[72:75], a[172:175], v[60:63], v[72:75]
    v_mfma_f32_16x16x32_bf16 v[28:31], v[236:239], v[60:63], v[28:31]
    v_mfma_f32_16x16x32_bf16 v[44:47], v[60:63], a[108:111], v[44:47]
    v_mfma_f32_16x16x32_bf16 v[76:79], a[236:239], v[60:63], v[76:79]
    s_waitcnt lgkmcnt(1)
    v_mfma_f32_16x16x32_bf16 v[16:19], v[176:179], v[48:51], v[16:19]
    ds_read_b128 v[56:59], v124 offset:26624
    v_mfma_f32_16x16x32_bf16 v[32:35], v[48:51], a[48:51], v[32:35]
    ds_read_b128 v[60:63], v124 offset:27648
    v_mfma_f32_16x16x32_bf16 v[64:67], a[176:179], v[48:51], v[64:67]
    v_mfma_f32_16x16x32_bf16 v[20:23], v[240:243], v[48:51], v[20:23]
    v_mfma_f32_16x16x32_bf16 v[40:43], v[48:51], a[112:115], v[40:43]
    v_mfma_f32_16x16x32_bf16 v[68:71], a[240:243], v[48:51], v[68:71]
    s_waitcnt lgkmcnt(2)
    v_mfma_f32_16x16x32_bf16 v[24:27], v[176:179], v[52:55], v[24:27]
    v_mfma_f32_16x16x32_bf16 v[36:39], v[52:55], a[48:51], v[36:39]
    v_mfma_f32_16x16x32_bf16 v[72:75], a[176:179], v[52:55], v[72:75]
    v_mfma_f32_16x16x32_bf16 v[28:31], v[240:243], v[52:55], v[28:31]
    v_mfma_f32_16x16x32_bf16 v[44:47], v[52:55], a[112:115], v[44:47]
    v_mfma_f32_16x16x32_bf16 v[76:79], a[240:243], v[52:55], v[76:79]
    s_waitcnt lgkmcnt(1)
    v_mfma_f32_16x16x32_bf16 v[16:19], v[180:183], v[56:59], v[16:19]
    ds_read_b128 v[48:51], v124 offset:28672
    v_mfma_f32_16x16x32_bf16 v[32:35], v[56:59], a[52:55], v[32:35]
    ds_read_b128 v[52:55], v124 offset:29696
    v_mfma_f32_16x16x32_bf16 v[64:67], a[180:183], v[56:59], v[64:67]
    v_mfma_f32_16x16x32_bf16 v[20:23], v[244:247], v[56:59], v[20:23]
    v_mfma_f32_16x16x32_bf16 v[40:43], v[56:59], a[116:119], v[40:43]
    v_mfma_f32_16x16x32_bf16 v[68:71], a[244:247], v[56:59], v[68:71]
    s_waitcnt lgkmcnt(2)
    v_mfma_f32_16x16x32_bf16 v[24:27], v[180:183], v[60:63], v[24:27]
    v_mfma_f32_16x16x32_bf16 v[36:39], v[60:63], a[52:55], v[36:39]
    v_mfma_f32_16x16x32_bf16 v[72:75], a[180:183], v[60:63], v[72:75]
    v_mfma_f32_16x16x32_bf16 v[28:31], v[244:247], v[60:63], v[28:31]
    v_mfma_f32_16x16x32_bf16 v[44:47], v[60:63], a[116:119], v[44:47]
    v_mfma_f32_16x16x32_bf16 v[76:79], a[244:247], v[60:63], v[76:79]
    s_waitcnt lgkmcnt(1)
    v_mfma_f32_16x16x32_bf16 v[16:19], v[184:187], v[48:51], v[16:19]
    ds_read_b128 v[56:59], v124 offset:30720
    v_mfma_f32_16x16x32_bf16 v[32:35], v[48:51], a[56:59], v[32:35]
    ds_read_b128 v[60:63], v124 offset:31744
    v_mfma_f32_16x16x32_bf16 v[64:67], a[184:187], v[48:51], v[64:67]
    v_mfma_f32_16x16x32_bf16 v[20:23], v[248:251], v[48:51], v[20:23]
    v_mfma_f32_16x16x32_bf16 v[40:43], v[48:51], a[120:123], v[40:43]
    v_mfma_f32_16x16x32_bf16 v[68:71], a[248:251], v[48:51], v[68:71]
    s_waitcnt lgkmcnt(2)
    v_mfma_f32_16x16x32_bf16 v[24:27], v[184:187], v[52:55], v[24:27]
    v_mfma_f32_16x16x32_bf16 v[36:39], v[52:55], a[56:59], v[36:39]
    v_mfma_f32_16x16x32_bf16 v[72:75], a[184:187], v[52:55], v[72:75]
    v_mfma_f32_16x16x32_bf16 v[28:31], v[248:251], v[52:55], v[28:31]
    v_mfma_f32_16x16x32_bf16 v[44:47], v[52:55], a[120:123], v[44:47]
    v_mfma_f32_16x16x32_bf16 v[76:79], a[248:251], v[52:55], v[76:79]
    s_waitcnt lgkmcnt(1)
    v_mfma_f32_16x16x32_bf16 v[16:19], v[188:191], v[56:59], v[16:19]
    v_mfma_f32_16x16x32_bf16 v[32:35], v[56:59], a[60:63], v[32:35]
    v_mfma_f32_16x16x32_bf16 v[64:67], a[188:191], v[56:59], v[64:67]
    v_mfma_f32_16x16x32_bf16 v[20:23], v[252:255], v[56:59], v[20:23]
    v_mfma_f32_16x16x32_bf16 v[40:43], v[56:59], a[124:127], v[40:43]
    v_mfma_f32_16x16x32_bf16 v[68:71], a[252:255], v[56:59], v[68:71]
    s_waitcnt lgkmcnt(0)
    v_mfma_f32_16x16x32_bf16 v[24:27], v[188:191], v[60:63], v[24:27]
    v_mfma_f32_16x16x32_bf16 v[36:39], v[60:63], a[60:63], v[36:39]
    v_mfma_f32_16x16x32_bf16 v[72:75], a[188:191], v[60:63], v[72:75]
    v_mfma_f32_16x16x32_bf16 v[28:31], v[252:255], v[60:63], v[28:31]
    v_mfma_f32_16x16x32_bf16 v[44:47], v[60:63], a[124:127], v[44:47]
    v_mfma_f32_16x16x32_bf16 v[76:79], a[252:255], v[60:63], v[76:79]
    s_lshl_b32 s39, s26, 13
    s_lshl_b32 s3, s22, 11
    s_add_u32 s39, s39, s3
    s_add_u32 s39, s39, 0x100000
    buffer_load_dwordx4 v[108:111], v116, s[4:7], s39 offen offset:0 sc1
    buffer_load_dwordx4 v[112:115], v116, s[4:7], s39 offen offset:1024 sc1
    s_lshl_b32 s3, s22, 10
    s_add_u32 s3, s3, s28
    v_add_u32 v124, s3, v116
    s_lshl_b32 s3, s22, 11
    s_add_u32 s3, s3, s28
    v_add_u32 v125, s3, v116
    s_lshl_b32 s34, s25, 5
    s_add_u32 s34, s34, s21
    s_lshl_b32 s34, s34, 14
    s_add_u32 s34, s34, 0x2000000
    s_lshl_b32 s3, s22, 10
    s_add_u32 s37, s34, s3
    s_add_u32 s38, s37, 8192
    s_add_u32 s48, s37, 4096
    s_add_u32 s49, s38, 4096
    v_cvt_pk_bf16_f32 v48, v16, v20
    v_cvt_pk_bf16_f32 v49, v17, v21
    v_cvt_pk_bf16_f32 v50, v18, v22
    v_cvt_pk_bf16_f32 v51, v19, v23
    ds_write_b128 v124, v[48:51] offset:8192
    v_cvt_pk_bf16_f32 v52, v24, v28
    v_cvt_pk_bf16_f32 v53, v25, v29
    v_cvt_pk_bf16_f32 v54, v26, v30
    v_cvt_pk_bf16_f32 v55, v27, v31
    ds_write_b128 v124, v[52:55] offset:12288
    v_cvt_pk_bf16_f32 v80, v32, v33
    v_cvt_pk_bf16_f32 v81, v36, v37
    v_cvt_pk_bf16_f32 v82, v34, v35
    v_cvt_pk_bf16_f32 v83, v38, v39
    buffer_store_dwordx4 v[80:83], v116, s[4:7], s48 offen sc1
    v_cvt_pk_bf16_f32 v84, v40, v41
    v_cvt_pk_bf16_f32 v85, v44, v45
    v_cvt_pk_bf16_f32 v86, v42, v43
    v_cvt_pk_bf16_f32 v87, v46, v47
    buffer_store_dwordx4 v[84:87], v116, s[4:7], s49 offen sc1
    v_cvt_pk_bf16_f32 v56, v64, v68
    v_cvt_pk_bf16_f32 v57, v65, v69
    v_cvt_pk_bf16_f32 v58, v66, v70
    v_cvt_pk_bf16_f32 v59, v67, v71
    v_cvt_pk_bf16_f32 v60, v72, v76
    v_cvt_pk_bf16_f32 v61, v73, v77
    v_cvt_pk_bf16_f32 v62, v74, v78
    v_cvt_pk_bf16_f32 v63, v75, v79
    ds_write_b128 v125, v[80:83] offset:16384
    ds_write_b128 v124, v[56:59] offset:0
    ds_write_b128 v125, v[84:87] offset:17408
    ds_write_b128 v124, v[60:63] offset:4096
    v_add_u32 v125, s28, v127
    s_waitcnt lgkmcnt(4)
    s_barrier
    ds_read_b128 v[88:91], v125 offset:8192
    ds_read_b128 v[92:95], v125 offset:9216
    s_waitcnt lgkmcnt(1)
    buffer_store_dwordx4 v[88:91], v116, s[4:7], s37 offen sc1
    s_waitcnt lgkmcnt(0)
    buffer_store_dwordx4 v[92:95], v116, s[4:7], s38 offen sc1
    s_lshl_b32 s34, s21, 6
    s_add_u32 s34, s34, s25
    s_lshl_b32 s34, s34, 2
    s_add_u32 s34, s34, s22
    s_add_u32 s51, s34, 0x90000
    s_add_u32 s28, s28, 24576
    s_cmp_eq_u32 s28, 139264
    s_cselect_b32 s28, 65536, s28
    s_add_u32 s25, s25, 3
    s_branch L_proj_fin
L_proj_none:
    s_lshl_b32 s39, s26, 13
    s_lshl_b32 s3, s22, 11
    s_add_u32 s39, s39, s3
    s_add_u32 s39, s39, 0x100000
    buffer_load_dwordx4 v[108:111], v116, s[4:7], s39 offen offset:0 sc1
    buffer_load_dwordx4 v[112:115], v116, s[4:7], s39 offen offset:1024 sc1
    v_mov_b32 v96, 1
    s_waitcnt vmcnt(0)
    s_mov_b64 exec, 1
    buffer_store_byte v96, v117, s[4:7], s51 offen sc1
    s_mov_b64 exec, -1
    s_mov_b32 s51, 0x4000000
L_proj_fin:
    s_xor_b32 s53, s26, 63
    v_add_u32 v124, s29, v116
    s_lshl_b32 s3, s22, 11
    v_add_u32 v125, s3, v124
    ds_read_b128 v[64:67], v124 offset:0
    ds_read_b128 v[0:3], v124 offset:8192
    ds_read_b128 v[80:83], v124 offset:4096
    ds_read_b128 v[16:19], v124 offset:12288
    ds_read_b128 v[68:71], v124 offset:1024
    ds_read_b128 v[4:7], v124 offset:9216
    ds_read_b128 v[84:87], v124 offset:5120
    ds_read_b128 v[20:23], v124 offset:13312
    ds_read_b128 v[72:75], v124 offset:2048
    ds_read_b128 v[8:11], v124 offset:10240
    ds_read_b128 v[88:91], v124 offset:6144
    ds_read_b128 v[24:27], v124 offset:14336
    ds_read_b128 v[76:79], v124 offset:3072
    ds_read_b128 v[12:15], v124 offset:11264
    ds_read_b128 v[92:95], v124 offset:7168
    ds_read_b128 v[28:31], v124 offset:15360
    s_waitcnt lgkmcnt(14)
    v_mfma_f32_16x16x32_bf16 v[96:99], v[0:3], v[64:67], 0
    s_waitcnt lgkmcnt(13)
    v_mfma_f32_16x16x32_bf16 v[100:103], v[0:3], v[80:83], 0
    s_waitcnt lgkmcnt(12)
    v_mfma_f32_16x16x32_bf16 v[104:107], v[16:19], v[80:83], 0
    s_waitcnt lgkmcnt(10)
    v_mfma_f32_16x16x32_bf16 v[96:99], v[4:7], v[68:71], v[96:99]
    s_waitcnt lgkmcnt(9)
    v_mfma_f32_16x16x32_bf16 v[100:103], v[4:7], v[84:87], v[100:103]
    s_waitcnt lgkmcnt(8)
    v_mfma_f32_16x16x32_bf16 v[104:107], v[20:23], v[84:87], v[104:107]
    s_waitcnt lgkmcnt(6)
    v_mfma_f32_16x16x32_bf16 v[96:99], v[8:11], v[72:75], v[96:99]
    s_waitcnt lgkmcnt(5)
    v_mfma_f32_16x16x32_bf16 v[100:103], v[8:11], v[88:91], v[100:103]
    s_waitcnt lgkmcnt(4)
    v_mfma_f32_16x16x32_bf16 v[104:107], v[24:27], v[88:91], v[104:107]
    s_waitcnt lgkmcnt(2)
    v_mfma_f32_16x16x32_bf16 v[96:99], v[12:15], v[76:79], v[96:99]
    s_waitcnt lgkmcnt(1)
    v_mfma_f32_16x16x32_bf16 v[100:103], v[12:15], v[92:95], v[100:103]
    s_waitcnt lgkmcnt(0)
    v_mfma_f32_16x16x32_bf16 v[104:107], v[28:31], v[92:95], v[104:107]
    v_mov_b64 v[32:33], 0
    v_mov_b64 v[34:35], 0
    v_mov_b64 v[36:37], 0
    v_mov_b64 v[38:39], 0
    v_mov_b64 v[40:41], 0
    v_mov_b64 v[42:43], 0
    v_mov_b64 v[44:45], 0
    v_mov_b64 v[46:47], 0
    v_mov_b32 v48, 0xff800000
    v_cndmask_b32 v96, v96, v48, s[40:41]
    v_cndmask_b32 v104, v104, v48, s[40:41]
    v_cndmask_b32 v97, v97, v48, s[42:43]
    v_cndmask_b32 v105, v105, v48, s[42:43]
    v_cndmask_b32 v98, v98, v48, s[44:45]
    v_cndmask_b32 v106, v106, v48, s[44:45]
    v_cndmask_b32 v99, v99, v48, s[46:47]
    v_cndmask_b32 v107, v107, v48, s[46:47]
    s_waitcnt vmcnt(4)
    v_max3_u32 v8, v108, v109, v110
    v_max3_u32 v9, v111, v112, v113
    v_max3_u32 v8, v8, v114, v115
    v_max_u32 v8, v8, v9
    v_cmp_eq_u32 vcc, -1, v8
    s_cbranch_vccz L_proj_got
    buffer_load_dwordx4 v[108:111], v116, s[4:7], s39 offen offset:0 sc1
    buffer_load_dwordx4 v[112:115], v116, s[4:7], s39 offen offset:1024 sc1
    v_mov_b32 v10, 1
    s_waitcnt vmcnt(0)
    s_mov_b64 exec, 1
    buffer_store_byte v10, v117, s[4:7], s51 offen sc1
    s_mov_b64 exec, -1
    s_mov_b32 s51, 0x4000000
    s_branch L_proj_look
L_proj_poll:
    buffer_load_dwordx4 v[108:111], v116, s[4:7], s39 offen offset:0 sc1
    buffer_load_dwordx4 v[112:115], v116, s[4:7], s39 offen offset:1024 sc1
    s_movk_i32 s3, 33
    s_sub_u32 s24, s24, 1
    s_cbranch_scc1 L_timeout
    s_waitcnt vmcnt(0)
L_proj_look:
    v_max3_u32 v8, v108, v109, v110
    v_max3_u32 v9, v111, v112, v113
    v_max3_u32 v8, v8, v114, v115
    v_max_u32 v8, v8, v9
    v_cmp_eq_u32 vcc, -1, v8
    s_cbranch_vccnz L_proj_poll
L_proj_got:
    ds_write_b128 v120, v[108:111]
    ds_write_b128 v120, v[112:115] offset:1024
    s_waitcnt lgkmcnt(0)
    s_barrier
    ds_read_b128 v[0:3], v121 offset:0
    ds_read_b128 v[4:7], v121 offset:1024
    ds_read_b128 v[8:11], v121 offset:2048
    ds_read_b128 v[12:15], v121 offset:3072
    ds_read_b128 v[16:19], v121 offset:4096
    ds_read_b128 v[20:23], v121 offset:5120
    ds_read_b128 v[24:27], v121 offset:6144
    ds_read_b128 v[28:31], v121 offset:7168
    s_waitcnt lgkmcnt(7)
    v_smfmac_f32_16x16x64_bf16 v[32:35], v[0:3], v[128:135], v119
    v_smfmac_f32_16x16x64_bf16 v[36:39], v[0:3], v[192:199], v119
    s_waitcnt lgkmcnt(6)
    v_smfmac_f32_16x16x64_bf16 v[32:35], v[4:7], v[136:143], v119
    v_smfmac_f32_16x16x64_bf16 v[36:39], v[4:7], v[200:207], v119
    s_waitcnt lgkmcnt(5)
    v_smfmac_f32_16x16x64_bf16 v[32:35], v[8:11], v[144:151], v119
    v_smfmac_f32_16x16x64_bf16 v[36:39], v[8:11], v[208:215], v119
    s_waitcnt lgkmcnt(4)
    v_smfmac_f32_16x16x64_bf16 v[32:35], v[12:15], v[152:159], v119
    v_smfmac_f32_16x16x64_bf16 v[36:39], v[12:15], v[216:223], v119
    s_waitcnt lgkmcnt(3)
    v_smfmac_f32_16x16x64_bf16 v[32:35], v[16:19], v[160:167], v119
    v_smfmac_f32_16x16x64_bf16 v[36:39], v[16:19], v[224:231], v119
    s_waitcnt lgkmcnt(2)
    v_smfmac_f32_16x16x64_bf16 v[32:35], v[20:23], v[168:175], v119
    v_smfmac_f32_16x16x64_bf16 v[36:39], v[20:23], v[232:239], v119
    s_waitcnt lgkmcnt(1)
    v_smfmac_f32_16x16x64_bf16 v[32:35], v[24:27], v[176:183], v119
    v_smfmac_f32_16x16x64_bf16 v[36:39], v[24:27], v[240:247], v119
    s_waitcnt lgkmcnt(0)
    v_smfmac_f32_16x16x64_bf16 v[32:35], v[28:31], v[184:191], v119
    v_smfmac_f32_16x16x64_bf16 v[36:39], v[28:31], v[248:255], v119
    v_smfmac_f32_16x16x64_bf16 v[40:43], v[0:3], a[0:7], v119
    s_nop 2
    v_smfmac_f32_16x16x64_bf16 v[44:47], v[0:3], a[64:71], v119
    s_nop 2
    v_smfmac_f32_16x16x64_bf16 v[40:43], v[4:7], a[8:15], v119
    v_add_f32 v32, v32, v34
    v_smfmac_f32_16x16x64_bf16 v[44:47], v[4:7], a[72:79], v119
    v_add_f32 v33, v33, v35
    v_smfmac_f32_16x16x64_bf16 v[40:43], v[8:11], a[16:23], v119
    v_add_f32 v36, v36, v38
    v_smfmac_f32_16x16x64_bf16 v[44:47], v[8:11], a[80:87], v119
    v_add_f32 v37, v37, v39
    v_smfmac_f32_16x16x64_bf16 v[40:43], v[12:15], a[24:31], v119
    v_cvt_pk_bf16_f32 v32, v32, v36
    v_smfmac_f32_16x16x64_bf16 v[44:47], v[12:15], a[88:95], v119
    v_cvt_pk_bf16_f32 v33, v33, v37
    v_smfmac_f32_16x16x64_bf16 v[40:43], v[16:19], a[32:39], v119
    ds_write2_b32 v122, v32, v33 offset0:0 offset1:72
    v_smfmac_f32_16x16x64_bf16 v[44:47], v[16:19], a[96:103], v119
    v_smfmac_f32_16x16x64_bf16 v[40:43], v[20:23], a[40:47], v119
    v_smfmac_f32_16x16x64_bf16 v[44:47], v[20:23], a[104:111], v119
    v_smfmac_f32_16x16x64_bf16 v[40:43], v[24:27], a[48:55], v119
    s_waitcnt lgkmcnt(0)
    s_barrier
    v_smfmac_f32_16x16x64_bf16 v[44:47], v[24:27], a[112:119], v119
    ds_read_b128 v[48:51], v123 offset:0
    v_smfmac_f32_16x16x64_bf16 v[40:43], v[28:31], a[56:63], v119
    ds_read_b128 v[52:55], v123 offset:64
    v_smfmac_f32_16x16x64_bf16 v[44:47], v[28:31], a[120:127], v119
    ds_read_b128 v[56:59], v123 offset:128
    ds_read_b128 v[60:63], v123 offset:192
    ds_read_b128 v[0:3], v125 offset:16384
    ds_read_b128 v[4:7], v125 offset:17408
    s_waitcnt lgkmcnt(5)
    v_mfma_f32_16x16x32_bf16 v[108:111], v[48:51], v[64:67], 0
    v_mfma_f32_16x16x32_bf16 v[112:115], v[48:51], v[80:83], 0
    s_waitcnt lgkmcnt(4)
    v_mfma_f32_16x16x32_bf16 v[108:111], v[52:55], v[68:71], v[108:111]
    v_mfma_f32_16x16x32_bf16 v[112:115], v[52:55], v[84:87], v[112:115]
    s_waitcnt lgkmcnt(3)
    v_mfma_f32_16x16x32_bf16 v[108:111], v[56:59], v[72:75], v[108:111]
    v_mfma_f32_16x16x32_bf16 v[112:115], v[56:59], v[88:91], v[112:115]
    s_waitcnt lgkmcnt(2)
    v_mfma_f32_16x16x32_bf16 v[108:111], v[60:63], v[76:79], v[108:111]
    v_mfma_f32_16x16x32_bf16 v[112:115], v[60:63], v[92:95], v[112:115]
    v_add_f32 v40, v40, v42
    v_add_f32 v41, v41, v43
    v_cvt_pk_bf16_f32 v118, v40, v41
    v_add_f32 v44, v44, v46
    v_add_f32 v45, v45, v47
    v_cvt_pk_bf16_f32 v126, v44, v45
    v_mov_b32 v8, 0x3f803f80
    v_mov_b32 v9, 0x3f803f80
    v_mov_b32 v10, 0x3f803f80
    v_mov_b32 v11, 0x3f803f80
    v_max_f32 v12, v96, v97
    v_max3_f32 v12, v12, v98, v99
    v_max3_f32 v12, v12, v108, v109
    v_max_f32 v14, v100, v101
    v_max3_f32 v14, v14, v102, v103
    v_max3_f32 v14, v14, v104, v105
    v_max3_f32 v14, v14, v106, v107
    v_max3_f32 v14, v14, v112, v113
    v_mov_b32 v13, v12
    v_mov_b32 v15, v14
    s_nop 0
    v_permlane16_swap_b32 v12, v13
    v_permlane16_swap_b32 v14, v15
    v_max_f32 v12, v12, v13
    v_max_f32 v14, v14, v15
    v_mov_b32 v13, v12
    v_mov_b32 v15, v14
    s_nop 0
    v_permlane32_swap_b32 v12, v13
    v_permlane32_swap_b32 v14, v15
    v_max_f32 v12, v12, v13
    v_max_f32 v14, v14, v15
    v_mul_f32 v12, s35, v12
    v_mul_f32 v14, s35, v14
    s_or_b32 s3, s22, s53
    s_cbranch_scc1 L_en_35
    v_mov_b32 v29, 0x1010101
    s_and_b32 s3, s21, 1
    s_lshl_b32 s3, s3, 6
    s_add_u32 s3, s3, s21
    s_lshl_b32 s3, s3, 7
    s_add_u32 s3, s3, 0xc0040
    s_mov_b64 exec, 1
    buffer_store_dword v29, v117, s[4:7], s3 offen sc1
    s_mov_b64 exec, -1
L_en_35:
    v_fma_f32 v96, v96, s35, -v12
    v_fma_f32 v97, v97, s35, -v12
    v_fma_f32 v98, v98, s35, -v12
    v_fma_f32 v99, v99, s35, -v12
    v_fma_f32 v108, v108, s35, -v12
    v_fma_f32 v109, v109, s35, -v12
    v_exp_f32 v96, v96
    v_exp_f32 v97, v97
    v_exp_f32 v98, v98
    v_exp_f32 v99, v99
    v_exp_f32 v108, v108
    v_exp_f32 v109, v109
    v_mov_b32 v25, 0
    v_mov_b32 v17, 0
    v_mov_b32 v19, 0
    v_cvt_pk_bf16_f32 v16, v96, v97
    v_cvt_pk_bf16_f32 v18, v98, v99
    v_cvt_pk_bf16_f32 v24, v108, v109
    s_nop 0
    v_mfma_f32_16x16x32_bf16 v[48:51], v[8:11], v[16:19], 0
    s_nop 1
    s_waitcnt lgkmcnt(1)
    v_mfma_f32_16x16x32_bf16 v[52:55], v[0:3], v[16:19], 0
    s_nop 1
    s_waitcnt lgkmcnt(0)
    v_mfma_f32_16x16x32_bf16 v[56:59], v[4:7], v[16:19], 0
    s_nop 1
    v_mfma_f32_16x16x16_bf16 v[48:51], v[8:9], v[24:25], v[48:51]
    v_mfma_f32_16x16x16_bf16 v[52:55], v[118:119], v[24:25], v[52:55]
    s_nop 1
    v_mfma_f32_16x16x16_bf16 v[56:59], v[126:127], v[24:25], v[56:59]
    v_fma_f32 v100, v100, s35, -v14
    v_fma_f32 v101, v101, s35, -v14
    v_fma_f32 v102, v102, s35, -v14
    v_fma_f32 v103, v103, s35, -v14
    v_fma_f32 v104, v104, s35, -v14
    v_fma_f32 v105, v105, s35, -v14
    v_fma_f32 v106, v106, s35, -v14
    v_fma_f32 v107, v107, s35, -v14
    v_fma_f32 v112, v112, s35, -v14
    v_fma_f32 v113, v113, s35, -v14
    v_exp_f32 v100, v100
    v_exp_f32 v101, v101
    v_exp_f32 v102, v102
    v_exp_f32 v103, v103
    v_exp_f32 v104, v104
    v_exp_f32 v105, v105
    v_exp_f32 v106, v106
    v_exp_f32 v107, v107
    v_exp_f32 v112, v112
    v_exp_f32 v113, v113
    v_mov_b32 v27, 0
    v_cvt_pk_bf16_f32 v20, v100, v101
    v_cvt_pk_bf16_f32 v21, v104, v105
    v_cvt_pk_bf16_f32 v22, v102, v103
    v_cvt_pk_bf16_f32 v23, v106, v107
    v_cvt_pk_bf16_f32 v26, v112, v113
    s_nop 0
    v_mfma_f32_16x16x32_bf16 v[60:63], v[8:11], v[20:23], 0
    s_nop 1
    v_mfma_f32_16x16x32_bf16 v[64:67], v[0:3], v[20:23], 0
    s_nop 1
    v_mfma_f32_16x16x32_bf16 v[68:71], v[4:7], v[20:23], 0
    s_nop 1
    v_mfma_f32_16x16x16_bf16 v[60:63], v[8:9], v[26:27], v[60:63]
    v_mfma_f32_16x16x16_bf16 v[64:67], v[118:119], v[26:27], v[64:67]
    s_nop 1
    v_mfma_f32_16x16x16_bf16 v[68:71], v[126:127], v[26:27], v[68:71]
    s_cmp_eq_u32 s53, 0
    s_cbranch_scc1 L_nopend_36
    v_mov_b32 v28, 1
    s_waitcnt vmcnt(0)
    s_mov_b64 exec, 1
    buffer_store_byte v28, v117, s[4:7], s51 offen sc1
    s_mov_b64 exec, -1
L_nopend_36:
    s_lshl_b32 s34, s26, 18
    s_lshl_b32 s3, s21, 12
    s_add_u32 s34, s34, s3
    s_lshl_b32 s3, s22, 10
    s_add_u32 s34, s34, s3
    s_add_u32 s34, s34, 0x1000000
    v_rcp_f32 v48, v48
    s_nop 0
    v_mul_f32 v52, v52, v48
    v_mul_f32 v53, v53, v48
    v_mul_f32 v54, v54, v48
    v_mul_f32 v55, v55, v48
    v_mul_f32 v56, v56, v48
    v_mul_f32 v57, v57, v48
    v_mul_f32 v58, v58, v48
    v_mul_f32 v59, v59, v48
    v_cvt_pk_bf16_f32 v52, v52, v56
    v_cvt_pk_bf16_f32 v53, v53, v57
    v_cvt_pk_bf16_f32 v54, v54, v58
    v_cvt_pk_bf16_f32 v55, v55, v59
    buffer_store_dwordx4 v[52:55], v116, s[4:7], s34 offen sc1
    s_add_u32 s34, s34, 0x20000
    v_rcp_f32 v60, v60
    s_nop 0
    v_mul_f32 v64, v64, v60
    v_mul_f32 v65, v65, v60
    v_mul_f32 v66, v66, v60
    v_mul_f32 v67, v67, v60
    v_mul_f32 v68, v68, v60
    v_mul_f32 v69, v69, v60
    v_mul_f32 v70, v70, v60
    v_mul_f32 v71, v71, v60
    v_cvt_pk_bf16_f32 v64, v64, v68
    v_cvt_pk_bf16_f32 v65, v65, v69
    v_cvt_pk_bf16_f32 v66, v66, v70
    v_cvt_pk_bf16_f32 v67, v67, v71
    buffer_store_dwordx4 v[64:67], v116, s[4:7], s34 offen sc1
    s_add_u32 s34, s34, 0x20000
    s_lshl_b32 s34, s26, 5
    s_add_u32 s34, s34, s21
    s_lshl_b32 s34, s34, 7
    s_add_u32 s34, s34, s22
    s_add_u32 s51, s34, 0xc0000
    s_add_u32 s29, s29, 24576
    s_cmp_eq_u32 s29, 139264
    s_cselect_b32 s29, 65536, s29
    s_add_u32 s26, s26, 3
    s_cmp_lt_u32 s26, 64
    s_cbranch_scc1 L_proj_loop
    s_waitcnt vmcnt(0) lgkmcnt(0)
    s_barrier
    s_cmp_lg_u32 s22, 0
    s_cbranch_scc1 L_flag_37
    v_mov_b32 v20, 0x1010101
    s_mov_b64 exec, 1
    buffer_store_dword v20, v117, s[4:7], s51 offen sc1
    s_mov_b64 exec, -1
L_flag_37:
    s_branch L_exit
L_proj_end:
L_ffn:
    s_or_b32 s3, s2, s22
    s_cbranch_scc1 L_asked_38
    s_mov_b64 exec, 1
    s_lshl_b32 s3, 1, s21
    v_mov_b32 v98, s3
    v_mov_b32 v99, s23
    s_add_u32 s3, s20, 4
    s_lshr_b32 s3, s3, 2
    s_lshl_b32 s3, s3, 3
    s_add_u32 s3, s3, s20
    s_lshl_b32 s3, s3, 3
    s_cmp_eq_u32 s20, 0
    s_cselect_b32 s3, 0, s3
    buffer_atomic_or_x2 v[98:99], off, s[12:15], s3 sc0 sc1
    s_mov_b64 exec, -1
L_asked_38:
    s_getpc_b64 s[98:99]
L_pc_39:
    v_lshlrev_b32 v100, 7, v0
    v_add_u32 v100, 0, v100
    v_min_u32 v100, L_col_end-L_pc_39-4, v100
    v_mov_b32 v101, s99
    v_add_co_u32 v100, vcc, s98, v100
    s_nop 1
    v_addc_co_u32 v101, vcc, 0, v101, vcc
    global_load_dword v102, v[100:101], off
    s_cmp_lg_u32 s2, 0
    s_cbranch_scc1 L_sure_41
    v_mov_b32 v3, 131072
    s_cmp_lg_u32 s22, 0
    s_cbranch_scc1 L_told_40
    s_waitcnt vmcnt(1)
    s_mov_b64 exec, 1
    ds_write_b32 v3, v98
    s_mov_b64 exec, -1
    s_waitcnt lgkmcnt(0)
L_told_40:
    s_barrier
    ds_read_b32 v1, v3
    s_waitcnt lgkmcnt(0)
    v_readfirstlane_b32 s3, v1
    s_nop 0
    s_bitcmp1_b32 s3, s21
    s_cbranch_scc1 L_search
L_sure_41:
    s_sub_u32 s25, s20, 4
    s_lshl_b32 s25, s25, 5
    s_add_u32 s25, s25, s21
    s_mov_b32 s16, s64
    s_mov_b32 s17, s65
    s_mov_b32 s18, 0x200000
    s_mov_b32 s19, 0x20000
    s_mov_b32 s8, s66
    s_mov_b32 s9, s67
    s_mov_b32 s10, 0x2000
    s_mov_b32 s11, 0x20000
    v_bfe_u32 v1, v0, 0, 4
    v_mul_u32_u24 v1, 1024, v1
    v_bfe_u32 v3, v0, 4, 2
    v_mul_u32_u24 v3, 8, v3
    v_add_u32 v1, v1, v3
    v_bfe_u32 v3, v0, 6, 2
    v_mul_u32_u24 v3, 256, v3
    v_add_u32 v1, v1, v3
    v_bfe_u32 v2, v0, 0, 6
    v_mul_u32_u24 v2, 16, v2
    s_lshl_b32 s26, s25, 14
    buffer_load_dwordx2 v[16:17], v1, s[16:19], s26 offen offset:0
    buffer_load_dwordx2 v[18:19], v1, s[16:19], s26 offen offset:32
    buffer_load_dwordx2 v[20:21], v1, s[16:19], s26 offen offset:64
    buffer_load_dwordx2 v[22:23], v1, s[16:19], s26 offen offset:96
    buffer_load_dwordx2 v[24:25], v1, s[16:19], s26 offen offset:128
    buffer_load_dwordx2 v[26:27], v1, s[16:19], s26 offen offset:160
    buffer_load_dwordx2 v[28:29], v1, s[16:19], s26 offen offset:192
    buffer_load_dwordx2 v[30:31], v1, s[16:19], s26 offen offset:224
    v_bfe_u32 v4, v0, 0, 1
    v_mul_u32_u24 v4, 1024, v4
    v_bfe_u32 v3, v0, 2, 2
    v_mul_u32_u24 v3, 2048, v3
    v_add_u32 v4, v4, v3
    v_bfe_u32 v3, v0, 4, 1
    v_mul_u32_u24 v3, 16, v3
    v_add_u32 v4, v4, v3
    v_bfe_u32 v3, v0, 5, 1
    v_mul_u32_u24 v3, 64, v3
    v_add_u32 v4, v4, v3
    v_bfe_u32 v3, v0, 6, 2
    v_mul_u32_u24 v3, 128, v3
    v_add_u32 v4, v4, v3
    v_bfe_u32 v7, v0, 1, 1
    v_mul_u32_u24 v7, 514, v7
    v_add_u32 v7, 256, v7
    v_add_u32 v3, 0x0404, v7
    v_lshl_or_b32 v7, v3, 16, v7
    v_mov_b32 v8, -1
    v_mov_b32 v12, 0
    v_mov_b32 v9, -1
    v_mov_b32 v13, 0
    v_mov_b32 v10, -1
    v_mov_b32 v14, 0
    v_mov_b32 v11, -1
    v_mov_b32 v15, 0
    s_cmp_ge_u32 s25, 2
    s_cbranch_scc1 L_nomem0_42
    s_lshl_b32 s26, s25, 9
    buffer_load_dwordx4 v[8:11], v4, s[8:11], s26 offen
    buffer_load_dwordx4 v[32:35], v4, s[8:11], s26 offen offset:32
    s_waitcnt vmcnt(0)
    v_perm_b32 v8, v32, v8, v7
    v_perm_b32 v9, v33, v9, v7
    v_perm_b32 v10, v34, v10, v7
    v_perm_b32 v11, v35, v11, v7
L_nomem0_42:
    s_waitcnt vmcnt(0)
    s_lshl_b32 s26, s25, 2
    s_add_u32 s26, s26, s22
    s_lshl_b32 s26, s26, 10
    s_add_u32 s26, s26, 0x100000
    buffer_store_dwordx4 v[8:11], v2, s[4:7], s26 offen sc1
    s_mul_i32 s26, s25, 144
    s_add_u32 s26, s26, 0x8f800
    s_mov_b64 exec, 0x1ff
    buffer_store_dwordx4 v[12:15], v2, s[4:7], s26 offen sc1
    s_lshl_b32 s26, s25, 2
    s_add_u32 s26, s26, s22
    s_lshl_b32 s26, s26, 9
    s_add_u32 s26, s26, 0xc0000
    s_mov_b32 exec_lo, -1
    buffer_store_dwordx4 v[12:15], v2, s[4:7], s26 offen sc1
    s_mov_b64 exec, -1
    s_lshl_b32 s26, s25, 1
    s_add_u32 s26, s26, s22
    s_lshl_b32 s26, s26, 10
    s_add_u32 s26, s26, 0xe00000
    s_lshl_b32 s3, s25, 10
    s_add_u32 s3, s3, 0x80000
    s_cmp_lt_u32 s25, 32
    s_cselect_b32 s3, s3, 0x4000000
    s_cmp_lt_u32 s22, 2
    s_cselect_b32 s26, s26, s3
    v_mov_b32 v44, -1
    v_mov_b32 v45, -1
    v_mov_b32 v46, -1
    v_mov_b32 v47, -1
    buffer_store_dwordx4 v[44:47], v2, s[4:7], s26 offen sc1
    s_lshl_b32 s3, s25, 1
    s_add_u32 s3, s3, s22
    s_lshl_b32 s3, s3, 10
    s_add_u32 s26, s3, 0x1fc0000
    s_cmp_lt_u32 s22, 2
    s_cselect_b32 s26, s26, 0x4000000
    buffer_store_dwordx4 v[44:47], v2, s[4:7], s26 offen sc1
    v_lshlrev_b32 v48, 16, v16
    v_and_b32 v49, 0xffff0000, v16
    v_lshlrev_b32 v50, 16, v17
    v_and_b32 v51, 0xffff0000, v17
    v_lshlrev_b32 v52, 16, v18
    v_and_b32 v53, 0xffff0000, v18
    v_lshlrev_b32 v54, 16, v19
    v_and_b32 v55, 0xffff0000, v19
    v_lshlrev_b32 v56, 16, v20
    v_and_b32 v57, 0xffff0000, v20
    v_lshlrev_b32 v58, 16, v21
    v_and_b32 v59, 0xffff0000, v21
    v_lshlrev_b32 v60, 16, v22
    v_and_b32 v61, 0xffff0000, v22
    v_lshlrev_b32 v62, 16, v23
    v_and_b32 v63, 0xffff0000, v23
    v_lshlrev_b32 v64, 16, v24
    v_and_b32 v65, 0xffff0000, v24
    v_lshlrev_b32 v66, 16, v25
    v_and_b32 v67, 0xffff0000, v25
    v_lshlrev_b32 v68, 16, v26
    v_and_b32 v69, 0xffff0000, v26
    v_lshlrev_b32 v70, 16, v27
    v_and_b32 v71, 0xffff0000, v27
    v_lshlrev_b32 v72, 16, v28
    v_and_b32 v73, 0xffff0000, v28
    v_lshlrev_b32 v74, 16, v29
    v_and_b32 v75, 0xffff0000, v29
    v_lshlrev_b32 v76, 16, v30
    v_and_b32 v77, 0xffff0000, v30
    v_lshlrev_b32 v78, 16, v31
    v_and_b32 v79, 0xffff0000, v31
    v_bfe_u32 v5, v0, 0, 4
    v_mul_u32_u24 v5, 16, v5
    v_bfe_u32 v3, v0, 6, 2
    v_mul_u32_u24 v3, 4, v3
    v_add_u32 v5, v5, v3
    v_add_u32 v5, 64, v5
    v_bfe_u32 v6, v0, 0, 4
    v_mul_u32_u24 v6, 16, v6
    v_add_u32 v6, 64, v6
    v_add_f32 v32, v48, v49
    v_add_f32 v33, v50, v51
    v_add_f32 v32, v32, v52
    v_add_f32 v33, v33, v53
    v_add_f32 v32, v32, v54
    v_add_f32 v33, v33, v55
    v_add_f32 v32, v32, v56
    v_add_f32 v33, v33, v57
    v_add_f32 v32, v32, v58
    v_add_f32 v33, v33, v59
    v_add_f32 v32, v32, v60
    v_add_f32 v33, v33, v61
    v_add_f32 v32, v32, v62
    v_add_f32 v33, v33, v63
    v_add_f32 v32, v32, v64
    v_add_f32 v33, v33, v65
    v_add_f32 v32, v32, v66
    v_add_f32 v33, v33, v67
    v_add_f32 v32, v32, v68
    v_add_f32 v33, v33, v69
    v_add_f32 v32, v32, v70
    v_add_f32 v33, v33, v71
    v_add_f32 v32, v32, v72
    v_add_f32 v33, v33, v73
    v_add_f32 v32, v32, v74
    v_add_f32 v33, v33, v75
    v_add_f32 v32, v32, v76
    v_add_f32 v33, v33, v77
    v_add_f32 v32, v32, v78
    v_add_f32 v33, v33, v79
    v_add_f32 v32, v32, v33
    v_mov_b32 v33, v32
    s_nop 1
    v_permlane16_swap_b32 v32, v33
    v_add_f32 v32, v32, v33
    v_mov_b32 v33, v32
    s_nop 1
    v_permlane32_swap_b32 v32, v33
    v_add_f32 v32, v32, v33
    ds_write_b32 v5, v32 offset:0
    s_waitcnt lgkmcnt(0)
    s_barrier
    ds_read_b128 v[36:39], v6 offset:0
    s_waitcnt lgkmcnt(0)
    v_add_f32 v36, v36, v37
    v_add_f32 v38, v38, v39
    v_add_f32 v32, v36, v38
    v_mul_f32 v32, 0x3b000000, v32
    v_mov_b32 v34, v32
    v_mov_b32 v32, 0
    v_mov_b32 v33, 0
    v_sub_f32 v40, v48, v34
    v_fmac_f32 v32, v40, v40
    v_sub_f32 v41, v49, v34
    v_fmac_f32 v33, v41, v41
    v_sub_f32 v40, v50, v34
    v_fmac_f32 v32, v40, v40
    v_sub_f32 v41, v51, v34
    v_fmac_f32 v33, v41, v41
    v_sub_f32 v40, v52, v34
    v_fmac_f32 v32, v40, v40
    v_sub_f32 v41, v53, v34
    v_fmac_f32 v33, v41, v41
    v_sub_f32 v40, v54, v34
    v_fmac_f32 v32, v40, v40
    v_sub_f32 v41, v55, v34
    v_fmac_f32 v33, v41, v41
    v_sub_f32 v40, v56, v34
    v_fmac_f32 v32, v40, v40
    v_sub_f32 v41, v57, v34
    v_fmac_f32 v33, v41, v41
    v_sub_f32 v40, v58, v34
    v_fmac_f32 v32, v40, v40
    v_sub_f32 v41, v59, v34
    v_fmac_f32 v33, v41, v41
    v_sub_f32 v40, v60, v34
    v_fmac_f32 v32, v40, v40
    v_sub_f32 v41, v61, v34
    v_fmac_f32 v33, v41, v41
    v_sub_f32 v40, v62, v34
    v_fmac_f32 v32, v40, v40
    v_sub_f32 v41, v63, v34
    v_fmac_f32 v33, v41, v41
    v_sub_f32 v40, v64, v34
    v_fmac_f32 v32, v40, v40
    v_sub_f32 v41, v65, v34
    v_fmac_f32 v33, v41, v41
    v_sub_f32 v40, v66, v34
    v_fmac_f32 v32, v40, v40
    v_sub_f32 v41, v67, v34
    v_fmac_f32 v33, v41, v41
    v_sub_f32 v40, v68, v34
    v_fmac_f32 v32, v40, v40
    v_sub_f32 v41, v69, v34
    v_fmac_f32 v33, v41, v41
    v_sub_f32 v40, v70, v34
    v_fmac_f32 v32, v40, v40
    v_sub_f32 v41, v71, v34
    v_fmac_f32 v33, v41, v41
    v_sub_f32 v40, v72, v34
    v_fmac_f32 v32, v40, v40
    v_sub_f32 v41, v73, v34
    v_fmac_f32 v33, v41, v41
    v_sub_f32 v40, v74, v34
    v_fmac_f32 v32, v40, v40
    v_sub_f32 v41, v75, v34
    v_fmac_f32 v33, v41, v41
    v_sub_f32 v40, v76, v34
    v_fmac_f32 v32, v40, v40
    v_sub_f32 v41, v77, v34
    v_fmac_f32 v33, v41, v41
    v_sub_f32 v40, v78, v34
    v_fmac_f32 v32, v40, v40
    v_sub_f32 v41, v79, v34
    v_fmac_f32 v33, v41, v41
    v_add_f32 v32, v32, v33
    v_mov_b32 v33, v32
    s_nop 1
    v_permlane16_swap_b32 v32, v33
    v_add_f32 v32, v32, v33
    v_mov_b32 v33, v32
    s_nop 1
    v_permlane32_swap_b32 v32, v33
    v_add_f32 v32, v32, v33
    ds_write_b32 v5, v32 offset:256
    s_waitcnt lgkmcnt(0)
    s_barrier
    ds_read_b128 v[36:39], v6 offset:256
    s_waitcnt lgkmcnt(0)
    v_add_f32 v36, v36, v37
    v_add_f32 v38, v38, v39
    v_add_f32 v32, v36, v38
    v_mul_f32 v32, 0x3b000000, v32
    v_cvt_pk_bf16_f32 v34, v34, v34
    v_and_b32 v34, 0xffff0000, v34
    v_cvt_pk_bf16_f32 v32, v32, v32
    v_and_b32 v32, 0xffff0000, v32
    v_add_f32 v32, 0x3727c5ac, v32
    v_cvt_pk_bf16_f32 v32, v32, v32
    v_and_b32 v32, 0xffff0000, v32
    v_sqrt_f32 v32, v32
    s_nop 0
    v_cvt_pk_bf16_f32 v32, v32, v32
    v_and_b32 v32, 0xffff0000, v32
    v_rcp_f32 v32, v32
    v_sub_f32 v48, v48, v34
    v_sub_f32 v52, v52, v34
    v_cvt_pk_bf16_f32 v40, v48, v52
    v_lshlrev_b32 v48, 16, v40
    v_and_b32 v52, 0xffff0000, v40
    v_mul_f32 v48, v48, v32
    v_mul_f32 v52, v52, v32
    v_cvt_pk_bf16_f32 v16, v48, v52
    v_sub_f32 v49, v49, v34
    v_sub_f32 v53, v53, v34
    v_cvt_pk_bf16_f32 v40, v49, v53
    v_lshlrev_b32 v49, 16, v40
    v_and_b32 v53, 0xffff0000, v40
    v_mul_f32 v49, v49, v32
    v_mul_f32 v53, v53, v32
    v_cvt_pk_bf16_f32 v17, v49, v53
    v_sub_f32 v50, v50, v34
    v_sub_f32 v54, v54, v34
    v_cvt_pk_bf16_f32 v40, v50, v54
    v_lshlrev_b32 v50, 16, v40
    v_and_b32 v54, 0xffff0000, v40
    v_mul_f32 v50, v50, v32
    v_mul_f32 v54, v54, v32
    v_cvt_pk_bf16_f32 v18, v50, v54
    v_sub_f32 v51, v51, v34
    v_sub_f32 v55, v55, v34
    v_cvt_pk_bf16_f32 v40, v51, v55
    v_lshlrev_b32 v51, 16, v40
    v_and_b32 v55, 0xffff0000, v40
    v_mul_f32 v51, v51, v32
    v_mul_f32 v55, v55, v32
    v_cvt_pk_bf16_f32 v19, v51, v55
    v_sub_f32 v56, v56, v34
    v_sub_f32 v60, v60, v34
    v_cvt_pk_bf16_f32 v40, v56, v60
    v_lshlrev_b32 v56, 16, v40
    v_and_b32 v60, 0xffff0000, v40
    v_mul_f32 v56, v56, v32
    v_mul_f32 v60, v60, v32
    v_cvt_pk_bf16_f32 v20, v56, v60
    v_sub_f32 v57, v57, v34
    v_sub_f32 v61, v61, v34
    v_cvt_pk_bf16_f32 v40, v57, v61
    v_lshlrev_b32 v57, 16, v40
    v_and_b32 v61, 0xffff0000, v40
    v_mul_f32 v57, v57, v32
    v_mul_f32 v61, v61, v32
    v_cvt_pk_bf16_f32 v21, v57, v61
    v_sub_f32 v58, v58, v34
    v_sub_f32 v62, v62, v34
    v_cvt_pk_bf16_f32 v40, v58, v62
    v_lshlrev_b32 v58, 16, v40
    v_and_b32 v62, 0xffff0000, v40
    v_mul_f32 v58, v58, v32
    v_mul_f32 v62, v62, v32
    v_cvt_pk_bf16_f32 v22, v58, v62
    v_sub_f32 v59, v59, v34
    v_sub_f32 v63, v63, v34
    v_cvt_pk_bf16_f32 v40, v59, v63
    v_lshlrev_b32 v59, 16, v40
    v_and_b32 v63, 0xffff0000, v40
    v_mul_f32 v59, v59, v32
    v_mul_f32 v63, v63, v32
    v_cvt_pk_bf16_f32 v23, v59, v63
    v_sub_f32 v64, v64, v34
    v_sub_f32 v68, v68, v34
    v_cvt_pk_bf16_f32 v40, v64, v68
    v_lshlrev_b32 v64, 16, v40
    v_and_b32 v68, 0xffff0000, v40
    v_mul_f32 v64, v64, v32
    v_mul_f32 v68, v68, v32
    v_cvt_pk_bf16_f32 v24, v64, v68
    v_sub_f32 v65, v65, v34
    v_sub_f32 v69, v69, v34
    v_cvt_pk_bf16_f32 v40, v65, v69
    v_lshlrev_b32 v65, 16, v40
    v_and_b32 v69, 0xffff0000, v40
    v_mul_f32 v65, v65, v32
    v_mul_f32 v69, v69, v32
    v_cvt_pk_bf16_f32 v25, v65, v69
    v_sub_f32 v66, v66, v34
    v_sub_f32 v70, v70, v34
    v_cvt_pk_bf16_f32 v40, v66, v70
    v_lshlrev_b32 v66, 16, v40
    v_and_b32 v70, 0xffff0000, v40
    v_mul_f32 v66, v66, v32
    v_mul_f32 v70, v70, v32
    v_cvt_pk_bf16_f32 v26, v66, v70
    v_sub_f32 v67, v67, v34
    v_sub_f32 v71, v71, v34
    v_cvt_pk_bf16_f32 v40, v67, v71
    v_lshlrev_b32 v67, 16, v40
    v_and_b32 v71, 0xffff0000, v40
    v_mul_f32 v67, v67, v32
    v_mul_f32 v71, v71, v32
    v_cvt_pk_bf16_f32 v27, v67, v71
    v_sub_f32 v72, v72, v34
    v_sub_f32 v76, v76, v34
    v_cvt_pk_bf16_f32 v40, v72, v76
    v_lshlrev_b32 v72, 16, v40
    v_and_b32 v76, 0xffff0000, v40
    v_mul_f32 v72, v72, v32
    v_mul_f32 v76, v76, v32
    v_cvt_pk_bf16_f32 v28, v72, v76
    v_sub_f32 v73, v73, v34
    v_sub_f32 v77, v77, v34
    v_cvt_pk_bf16_f32 v40, v73, v77
    v_lshlrev_b32 v73, 16, v40
    v_and_b32 v77, 0xffff0000, v40
    v_mul_f32 v73, v73, v32
    v_mul_f32 v77, v77, v32
    v_cvt_pk_bf16_f32 v29, v73, v77
    v_sub_f32 v74, v74, v34
    v_sub_f32 v78, v78, v34
    v_cvt_pk_bf16_f32 v40, v74, v78
    v_lshlrev_b32 v74, 16, v40
    v_and_b32 v78, 0xffff0000, v40
    v_mul_f32 v74, v74, v32
    v_mul_f32 v78, v78, v32
    v_cvt_pk_bf16_f32 v30, v74, v78
    v_sub_f32 v75, v75, v34
    v_sub_f32 v79, v79, v34
    v_cvt_pk_bf16_f32 v40, v75, v79
    v_lshlrev_b32 v75, 16, v40
    v_and_b32 v79, 0xffff0000, v40
    v_mul_f32 v75, v75, v32
    v_mul_f32 v79, v79, v32
    v_cvt_pk_bf16_f32 v31, v75, v79
    s_lshr_b32 s26, s25, 1
    s_lshl_b32 s26, s26, 15
    s_and_b32 s3, s25, 1
    s_lshl_b32 s3, s3, 10
    s_add_u32 s26, s26, s3
    s_lshl_b32 s3, s22, 13
    s_add_u32 s26, s26, s3
    s_add_u32 s26, s26, 0x200000
    buffer_store_dwordx4 v[16:19], v2, s[4:7], s26 offen offset:0 sc1
    buffer_store_dwordx4 v[20:23], v2, s[4:7], s26 offen offset:2048 sc1
    s_add_u32 s26, s26, 4096
    buffer_store_dwordx4 v[24:27], v2, s[4:7], s26 offen offset:0 sc1
    buffer_store_dwordx4 v[28:31], v2, s[4:7], s26 offen offset:2048 sc1
    s_waitcnt vmcnt(0) lgkmcnt(0)
    s_barrier
    s_cmp_lg_u32 s22, 0
    s_cbranch_scc1 L_lndone_43
    v_mov_b32 v4, 1
    v_mov_b32 v5, 0
    s_mov_b64 exec, 1
    buffer_atomic_add v4, v5, s[12:15], 0 offen offset:192 sc1
    s_mov_b64 exec, -1
L_lndone_43:
    s_cmp_lt_u32 s20, 6
    s_cbranch_scc1 L_col
    s_cmp_eq_u32 s20, 7
    s_cbranch_scc1 L_exit
    s_cmp_ge_u32 s21, 22
    s_cbranch_scc1 L_col
    s_cmp_ge_u32 s21, 11
    s_cselect_b32 s25, 1, 0
    s_mul_i32 s3, s25, 11
    s_sub_u32 s28, s21, s3
    s_mul_i32 s30, s22, 352256
    s_lshl_b32 s3, s28, 8
    s_add_u32 s30, s30, s3
    s_add_u32 s31, s30, 176128
    s_lshl_b32 s33, s22, 12
    v_bfe_u32 v2, v0, 0, 4
    v_mul_u32_u24 v2, 16, v2
    v_bfe_u32 v16, v0, 4, 2
    v_mul_u32_u24 v16, 32, v16
    v_xor_b32 v2, v2, v16
    v_bfe_u32 v16, v0, 4, 1
    v_mul_u32_u24 v16, 44032, v16
    v_add_u32 v2, v2, v16
    v_bfe_u32 v16, v0, 5, 1
    v_mul_u32_u24 v16, 2752, v16
    v_add_u32 v2, v2, v16
    v_bfe_u32 v3, v0, 0, 4
    v_mul_u32_u24 v3, 16, v3
    v_bfe_u32 v16, v0, 4, 2
    v_mul_u32_u24 v16, 32, v16
    v_xor_b32 v3, v3, v16
    v_xor_b32 v3, 128, v3
    v_bfe_u32 v16, v0, 4, 1
    v_mul_u32_u24 v16, 44032, v16
    v_add_u32 v3, v3, v16
    v_bfe_u32 v16, v0, 5, 1
    v_mul_u32_u24 v16, 2752, v16
    v_add_u32 v3, v3, v16
    v_bfe_u32 v4, v0, 0, 1
    v_mul_u32_u24 v4, 8, v4
    v_bfe_u32 v16, v0, 1, 1
    v_mul_u32_u24 v16, 16, v16
    v_xor_b32 v4, v4, v16
    v_bfe_u32 v16, v0, 2, 2
    v_mul_u32_u24 v16, 256, v16
    v_xor_b32 v4, v4, v16
    v_bfe_u32 v16, v0, 2, 2
    v_mul_u32_u24 v16, 32, v16
    v_xor_b32 v4, v4, v16
    v_bfe_u32 v16, v0, 4, 1
    v_mul_u32_u24 v16, 128, v16
    v_xor_b32 v4, v4, v16
    v_bfe_u32 v16, v0, 4, 2
    v_mul_u32_u24 v16, 1024, v16
    v_xor_b32 v4, v4, v16
    v_bfe_u32 v16, v0, 6, 2
    v_mul_u32_u24 v16, 64, v16
    v_xor_b32 v4, v4, v16
    v_xor_b32 v5, 32, v4
    v_xor_b32 v6, 4096, v4
    v_xor_b32 v7, 4128, v4
    v_xor_b32 v8, 8192, v4
    v_xor_b32 v9, 8224, v4
    v_xor_b32 v10, 12288, v4
    v_xor_b32 v11, 12320, v4
    s_waitcnt lgkmcnt(0)
    s_barrier
    s_mov_b32 s8, s80
    s_mov_b32 s9, s81
    s_mov_b32 s10, 0x158000
    s_mov_b32 s11, 0x20000
    s_add_u32 m0, s33, 0
    s_add_u32 s34, s30, 0x0
    buffer_load_dwordx4 v2, s[8:11], s34 offen  lds
    s_add_u32 m0, s33, 1024
    s_add_u32 s34, s30, 0x2b00
    buffer_load_dwordx4 v3, s[8:11], s34 offen  lds
    s_add_u32 m0, s33, 2048
    s_add_u32 s34, s30, 0x5600
    buffer_load_dwordx4 v2, s[8:11], s34 offen  lds
    s_add_u32 m0, s33, 3072
    s_add_u32 s34, s30, 0x8100
    buffer_load_dwordx4 v3, s[8:11], s34 offen  lds
    s_add_u32 m0, s33, 16384
    s_add_u32 s34, s30, 0x1580
    buffer_load_dwordx4 v2, s[8:11], s34 offen  lds
    s_add_u32 m0, s33, 17408
    s_add_u32 s34, s30, 0x4080
    buffer_load_dwordx4 v3, s[8:11], s34 offen  lds
    s_add_u32 m0, s33, 18432
    s_add_u32 s34, s30, 0x6b80
    buffer_load_dwordx4 v2, s[8:11], s34 offen  lds
    s_add_u32 m0, s33, 19456
    s_add_u32 s34, s30, 0x9680
    buffer_load_dwordx4 v3, s[8:11], s34 offen  lds
    s_waitcnt vmcnt(4)
    s_barrier
    ds_read_b64_tr_b16 a[0:1], v4 offset:0
    ds_read_b64_tr_b16 a[64:65], v5 offset:0
    ds_read_b64_tr_b16 a[16:17], v6 offset:0
    ds_read_b64_tr_b16 a[80:81], v7 offset:0
    ds_read_b64_tr_b16 a[32:33], v8 offset:0
    ds_read_b64_tr_b16 a[96:97], v9 offset:0
    ds_read_b64_tr_b16 a[48:49], v10 offset:0
    ds_read_b64_tr_b16 a[112:113], v11 offset:0
    s_waitcnt lgkmcnt(0)
    s_barrier
    s_add_u32 m0, s33, 0
    s_add_u32 s34, s30, 0x15800
    buffer_load_dwordx4 v2, s[8:11], s34 offen  lds
    s_add_u32 m0, s33, 1024
    s_add_u32 s34, s30, 0x18300
    buffer_load_dwordx4 v3, s[8:11], s34 offen  lds
    s_add_u32 m0, s33, 2048
    s_add_u32 s34, s30, 0x1ae00
    buffer_load_dwordx4 v2, s[8:11], s34 offen  lds
    s_add_u32 m0, s33, 3072
    s_add_u32 s34, s30, 0x1d900
    buffer_load_dwordx4 v3, s[8:11], s34 offen  lds
    s_waitcnt vmcnt(4)
    s_barrier
    ds_read_b64_tr_b16 a[2:3], v4 offset:16384
    ds_read_b64_tr_b16 a[66:67], v5 offset:16384
    ds_read_b64_tr_b16 a[18:19], v6 offset:16384
    ds_read_b64_tr_b16 a[82:83], v7 offset:16384
    ds_read_b64_tr_b16 a[34:35], v8 offset:16384
    ds_read_b64_tr_b16 a[98:99], v9 offset:16384
    ds_read_b64_tr_b16 a[50:51], v10 offset:16384
    ds_read_b64_tr_b16 a[114:115], v11 offset:16384
    s_waitcnt lgkmcnt(0)
    s_barrier
    s_add_u32 m0, s33, 16384
    s_add_u32 s34, s30, 0x16d80
    buffer_load_dwordx4 v2, s[8:11], s34 offen  lds
    s_add_u32 m0, s33, 17408
    s_add_u32 s34, s30, 0x19880
    buffer_load_dwordx4 v3, s[8:11], s34 offen  lds
    s_add_u32 m0, s33, 18432
    s_add_u32 s34, s30, 0x1c380
    buffer_load_dwordx4 v2, s[8:11], s34 offen  lds
    s_add_u32 m0, s33, 19456
    s_add_u32 s34, s30, 0x1ee80
    buffer_load_dwordx4 v3, s[8:11], s34 offen  lds
    s_waitcnt vmcnt(4)
    s_barrier
    ds_read_b64_tr_b16 a[4:5], v4 offset:0
    ds_read_b64_tr_b16 a[68:69], v5 offset:0
    ds_read_b64_tr_b16 a[20:21], v6 offset:0
    ds_read_b64_tr_b16 a[84:85], v7 offset:0
    ds_read_b64_tr_b16 a[36:37], v8 offset:0
    ds_read_b64_tr_b16 a[100:101], v9 offset:0
    ds_read_b64_tr_b16 a[52:53], v10 offset:0
    ds_read_b64_tr_b16 a[116:117], v11 offset:0
    s_waitcnt lgkmcnt(0)
    s_barrier
    s_add_u32 m0, s33, 0
    s_add_u32 s34, s31, 0x0
    buffer_load_dwordx4 v2, s[8:11], s34 offen  lds
    s_add_u32 m0, s33, 1024
    s_add_u32 s34, s31, 0x2b00
    buffer_load_dwordx4 v3, s[8:11], s34 offen  lds
    s_add_u32 m0, s33, 2048
    s_add_u32 s34, s31, 0x5600
    buffer_load_dwordx4 v2, s[8:11], s34 offen  lds
    s_add_u32 m0, s33, 3072
    s_add_u32 s34, s31, 0x8100
    buffer_load_dwordx4 v3, s[8:11], s34 offen  lds
    s_waitcnt vmcnt(4)
    s_barrier
    ds_read_b64_tr_b16 a[6:7], v4 offset:16384
    ds_read_b64_tr_b16 a[70:71], v5 offset:16384
    ds_read_b64_tr_b16 a[22:23], v6 offset:16384
    ds_read_b64_tr_b16 a[86:87], v7 offset:16384
    ds_read_b64_tr_b16 a[38:39], v8 offset:16384
    ds_read_b64_tr_b16 a[102:103], v9 offset:16384
    ds_read_b64_tr_b16 a[54:55], v10 offset:16384
    ds_read_b64_tr_b16 a[118:119], v11 offset:16384
    s_waitcnt lgkmcnt(0)
    s_barrier
    s_add_u32 m0, s33, 16384
    s_add_u32 s34, s31, 0x1580
    buffer_load_dwordx4 v2, s[8:11], s34 offen  lds
    s_add_u32 m0, s33, 17408
    s_add_u32 s34, s31, 0x4080
    buffer_load_dwordx4 v3, s[8:11], s34 offen  lds
    s_add_u32 m0, s33, 18432
    s_add_u32 s34, s31, 0x6b80
    buffer_load_dwordx4 v2, s[8:11], s34 offen  lds
    s_add_u32 m0, s33, 19456
    s_add_u32 s34, s31, 0x9680
    buffer_load_dwordx4 v3, s[8:11], s34 offen  lds
    s_waitcnt vmcnt(4)
    s_barrier
    ds_read_b64_tr_b16 a[8:9], v4 offset:0
    ds_read_b64_tr_b16 a[72:73], v5 offset:0
    ds_read_b64_tr_b16 a[24:25], v6 offset:0
    ds_read_b64_tr_b16 a[88:89], v7 offset:0
    ds_read_b64_tr_b16 a[40:41], v8 offset:0
    ds_read_b64_tr_b16 a[104:105], v9 offset:0
    ds_read_b64_tr_b16 a[56:57], v10 offset:0
    ds_read_b64_tr_b16 a[120:121], v11 offset:0
    s_waitcnt lgkmcnt(0)
    s_barrier
    s_add_u32 m0, s33, 0
    s_add_u32 s34, s31, 0x15800
    buffer_load_dwordx4 v2, s[8:11], s34 offen  lds
    s_add_u32 m0, s33, 1024
    s_add_u32 s34, s31, 0x18300
    buffer_load_dwordx4 v3, s[8:11], s34 offen  lds
    s_add_u32 m0, s33, 2048
    s_add_u32 s34, s31, 0x1ae00
    buffer_load_dwordx4 v2, s[8:11], s34 offen  lds
    s_add_u32 m0, s33, 3072
    s_add_u32 s34, s31, 0x1d900
    buffer_load_dwordx4 v3, s[8:11], s34 offen  lds
    s_waitcnt vmcnt(4)
    s_barrier
    ds_read_b64_tr_b16 a[10:11], v4 offset:16384
    ds_read_b64_tr_b16 a[74:75], v5 offset:16384
    ds_read_b64_tr_b16 a[26:27], v6 offset:16384
    ds_read_b64_tr_b16 a[90:91], v7 offset:16384
    ds_read_b64_tr_b16 a[42:43], v8 offset:16384
    ds_read_b64_tr_b16 a[106:107], v9 offset:16384
    ds_read_b64_tr_b16 a[58:59], v10 offset:16384
    ds_read_b64_tr_b16 a[122:123], v11 offset:16384
    s_waitcnt lgkmcnt(0)
    s_barrier
    s_add_u32 m0, s33, 16384
    s_add_u32 s34, s31, 0x16d80
    buffer_load_dwordx4 v2, s[8:11], s34 offen  lds
    s_add_u32 m0, s33, 17408
    s_add_u32 s34, s31, 0x19880
    buffer_load_dwordx4 v3, s[8:11], s34 offen  lds
    s_add_u32 m0, s33, 18432
    s_add_u32 s34, s31, 0x1c380
    buffer_load_dwordx4 v2, s[8:11], s34 offen  lds
    s_add_u32 m0, s33, 19456
    s_add_u32 s34, s31, 0x1ee80
    buffer_load_dwordx4 v3, s[8:11], s34 offen  lds
    s_waitcnt vmcnt(4)
    s_barrier
    ds_read_b64_tr_b16 a[12:13], v4 offset:0
    ds_read_b64_tr_b16 a[76:77], v5 offset:0
    ds_read_b64_tr_b16 a[28:29], v6 offset:0
    ds_read_b64_tr_b16 a[92:93], v7 offset:0
    ds_read_b64_tr_b16 a[44:45], v8 offset:0
    ds_read_b64_tr_b16 a[108:109], v9 offset:0
    ds_read_b64_tr_b16 a[60:61], v10 offset:0
    ds_read_b64_tr_b16 a[124:125], v11 offset:0
    s_waitcnt lgkmcnt(0)
    s_barrier
    s_mov_b32 s8, s82
    s_mov_b32 s9, s83
    s_mov_b32 s10, 0x158000
    s_mov_b32 s11, 0x20000
    s_add_u32 m0, s33, 0
    s_add_u32 s34, s30, 0x0
    buffer_load_dwordx4 v2, s[8:11], s34 offen  lds
    s_add_u32 m0, s33, 1024
    s_add_u32 s34, s30, 0x2b00
    buffer_load_dwordx4 v3, s[8:11], s34 offen  lds
    s_add_u32 m0, s33, 2048
    s_add_u32 s34, s30, 0x5600
    buffer_load_dwordx4 v2, s[8:11], s34 offen  lds
    s_add_u32 m0, s33, 3072
    s_add_u32 s34, s30, 0x8100
    buffer_load_dwordx4 v3, s[8:11], s34 offen  lds
    s_waitcnt vmcnt(4)
    s_barrier
    ds_read_b64_tr_b16 a[14:15], v4 offset:16384
    ds_read_b64_tr_b16 a[78:79], v5 offset:16384
    ds_read_b64_tr_b16 a[30:31], v6 offset:16384
    ds_read_b64_tr_b16 a[94:95], v7 offset:16384
    ds_read_b64_tr_b16 a[46:47], v8 offset:16384
    ds_read_b64_tr_b16 a[110:111], v9 offset:16384
    ds_read_b64_tr_b16 a[62:63], v10 offset:16384
    ds_read_b64_tr_b16 a[126:127], v11 offset:16384
    s_waitcnt lgkmcnt(0)
    s_barrier
    s_add_u32 m0, s33, 16384
    s_add_u32 s34, s30, 0x1580
    buffer_load_dwordx4 v2, s[8:11], s34 offen  lds
    s_add_u32 m0, s33, 17408
    s_add_u32 s34, s30, 0x4080
    buffer_load_dwordx4 v3, s[8:11], s34 offen  lds
    s_add_u32 m0, s33, 18432
    s_add_u32 s34, s30, 0x6b80
    buffer_load_dwordx4 v2, s[8:11], s34 offen  lds
    s_add_u32 m0, s33, 19456
    s_add_u32 s34, s30, 0x9680
    buffer_load_dwordx4 v3, s[8:11], s34 offen  lds
    s_waitcnt vmcnt(4)
    s_barrier
    ds_read_b64_tr_b16 a[128:129], v4 offset:0
    ds_read_b64_tr_b16 a[192:193], v5 offset:0
    ds_read_b64_tr_b16 a[144:145], v6 offset:0
    ds_read_b64_tr_b16 a[208:209], v7 offset:0
    ds_read_b64_tr_b16 a[160:161], v8 offset:0
    ds_read_b64_tr_b16 a[224:225], v9 offset:0
    ds_read_b64_tr_b16 a[176:177], v10 offset:0
    ds_read_b64_tr_b16 a[240:241], v11 offset:0
    s_waitcnt lgkmcnt(0)
    s_barrier
    s_add_u32 m0, s33, 0
    s_add_u32 s34, s30, 0x15800
    buffer_load_dwordx4 v2, s[8:11], s34 offen  lds
    s_add_u32 m0, s33, 1024
    s_add_u32 s34, s30, 0x18300
    buffer_load_dwordx4 v3, s[8:11], s34 offen  lds
    s_add_u32 m0, s33, 2048
    s_add_u32 s34, s30, 0x1ae00
    buffer_load_dwordx4 v2, s[8:11], s34 offen  lds
    s_add_u32 m0, s33, 3072
    s_add_u32 s34, s30, 0x1d900
    buffer_load_dwordx4 v3, s[8:11], s34 offen  lds
    s_waitcnt vmcnt(4)
    s_barrier
    ds_read_b64_tr_b16 a[130:131], v4 offset:16384
    ds_read_b64_tr_b16 a[194:195], v5 offset:16384
    ds_read_b64_tr_b16 a[146:147], v6 offset:16384
    ds_read_b64_tr_b16 a[210:211], v7 offset:16384
    ds_read_b64_tr_b16 a[162:163], v8 offset:16384
    ds_read_b64_tr_b16 a[226:227], v9 offset:16384
    ds_read_b64_tr_b16 a[178:179], v10 offset:16384
    ds_read_b64_tr_b16 a[242:243], v11 offset:16384
    s_waitcnt lgkmcnt(0)
    s_barrier
    s_add_u32 m0, s33, 16384
    s_add_u32 s34, s30, 0x16d80
    buffer_load_dwordx4 v2, s[8:11], s34 offen  lds
    s_add_u32 m0, s33, 17408
    s_add_u32 s34, s30, 0x19880
    buffer_load_dwordx4 v3, s[8:11], s34 offen  lds
    s_add_u32 m0, s33, 18432
    s_add_u32 s34, s30, 0x1c380
    buffer_load_dwordx4 v2, s[8:11], s34 offen  lds
    s_add_u32 m0, s33, 19456
    s_add_u32 s34, s30, 0x1ee80
    buffer_load_dwordx4 v3, s[8:11], s34 offen  lds
    s_waitcnt vmcnt(4)
    s_barrier
    ds_read_b64_tr_b16 a[132:133], v4 offset:0
    ds_read_b64_tr_b16 a[196:197], v5 offset:0
    ds_read_b64_tr_b16 a[148:149], v6 offset:0
    ds_read_b64_tr_b16 a[212:213], v7 offset:0
    ds_read_b64_tr_b16 a[164:165], v8 offset:0
    ds_read_b64_tr_b16 a[228:229], v9 offset:0
    ds_read_b64_tr_b16 a[180:181], v10 offset:0
    ds_read_b64_tr_b16 a[244:245], v11 offset:0
    s_waitcnt lgkmcnt(0)
    s_barrier
    s_add_u32 m0, s33, 0
    s_add_u32 s34, s31, 0x0
    buffer_load_dwordx4 v2, s[8:11], s34 offen  lds
    s_add_u32 m0, s33, 1024
    s_add_u32 s34, s31, 0x2b00
    buffer_load_dwordx4 v3, s[8:11], s34 offen  lds
    s_add_u32 m0, s33, 2048
    s_add_u32 s34, s31, 0x5600
    buffer_load_dwordx4 v2, s[8:11], s34 offen  lds
    s_add_u32 m0, s33, 3072
    s_add_u32 s34, s31, 0x8100
    buffer_load_dwordx4 v3, s[8:11], s34 offen  lds
    s_waitcnt vmcnt(4)
    s_barrier
    ds_read_b64_tr_b16 a[134:135], v4 offset:16384
    ds_read_b64_tr_b16 a[198:199], v5 offset:16384
    ds_read_b64_tr_b16 a[150:151], v6 offset:16384
    ds_read_b64_tr_b16 a[214:215], v7 offset:16384
    ds_read_b64_tr_b16 a[166:167], v8 offset:16384
    ds_read_b64_tr_b16 a[230:231], v9 offset:16384
    ds_read_b64_tr_b16 a[182:183], v10 offset:16384
    ds_read_b64_tr_b16 a[246:247], v11 offset:16384
    s_waitcnt lgkmcnt(0)
    s_barrier
    s_add_u32 m0, s33, 16384
    s_add_u32 s34, s31, 0x1580
    buffer_load_dwordx4 v2, s[8:11], s34 offen  lds
    s_add_u32 m0, s33, 17408
    s_add_u32 s34, s31, 0x4080
    buffer_load_dwordx4 v3, s[8:11], s34 offen  lds
    s_add_u32 m0, s33, 18432
    s_add_u32 s34, s31, 0x6b80
    buffer_load_dwordx4 v2, s[8:11], s34 offen  lds
    s_add_u32 m0, s33, 19456
    s_add_u32 s34, s31, 0x9680
    buffer_load_dwordx4 v3, s[8:11], s34 offen  lds
    s_waitcnt vmcnt(4)
    s_barrier
    ds_read_b64_tr_b16 a[136:137], v4 offset:0
    ds_read_b64_tr_b16 a[200:201], v5 offset:0
    ds_read_b64_tr_b16 a[152:153], v6 offset:0
    ds_read_b64_tr_b16 a[216:217], v7 offset:0
    ds_read_b64_tr_b16 a[168:169], v8 offset:0
    ds_read_b64_tr_b16 a[232:233], v9 offset:0
    ds_read_b64_tr_b16 a[184:185], v10 offset:0
    ds_read_b64_tr_b16 a[248:249], v11 offset:0
    s_waitcnt lgkmcnt(0)
    s_barrier
    s_add_u32 m0, s33, 0
    s_add_u32 s34, s31, 0x15800
    buffer_load_dwordx4 v2, s[8:11], s34 offen  lds
    s_add_u32 m0, s33, 1024
    s_add_u32 s34, s31, 0x18300
    buffer_load_dwordx4 v3, s[8:11], s34 offen  lds
    s_add_u32 m0, s33, 2048
    s_add_u32 s34, s31, 0x1ae00
    buffer_load_dwordx4 v2, s[8:11], s34 offen  lds
    s_add_u32 m0, s33, 3072
    s_add_u32 s34, s31, 0x1d900
    buffer_load_dwordx4 v3, s[8:11], s34 offen  lds
    s_waitcnt vmcnt(4)
    s_barrier
    ds_read_b64_tr_b16 a[138:139], v4 offset:16384
    ds_read_b64_tr_b16 a[202:203], v5 offset:16384
    ds_read_b64_tr_b16 a[154:155], v6 offset:16384
    ds_read_b64_tr_b16 a[218:219], v7 offset:16384
    ds_read_b64_tr_b16 a[170:171], v8 offset:16384
    ds_read_b64_tr_b16 a[234:235], v9 offset:16384
    ds_read_b64_tr_b16 a[186:187], v10 offset:16384
    ds_read_b64_tr_b16 a[250:251], v11 offset:16384
    s_waitcnt lgkmcnt(0)
    s_barrier
    s_add_u32 m0, s33, 16384
    s_add_u32 s34, s31, 0x16d80
    buffer_load_dwordx4 v2, s[8:11], s34 offen  lds
    s_add_u32 m0, s33, 17408
    s_add_u32 s34, s31, 0x19880
    buffer_load_dwordx4 v3, s[8:11], s34 offen  lds
    s_add_u32 m0, s33, 18432
    s_add_u32 s34, s31, 0x1c380
    buffer_load_dwordx4 v2, s[8:11], s34 offen  lds
    s_add_u32 m0, s33, 19456
    s_add_u32 s34, s31, 0x1ee80
    buffer_load_dwordx4 v3, s[8:11], s34 offen  lds
    s_waitcnt vmcnt(4)
    s_barrier
    ds_read_b64_tr_b16 a[140:141], v4 offset:0
    ds_read_b64_tr_b16 a[204:205], v5 offset:0
    ds_read_b64_tr_b16 a[156:157], v6 offset:0
    ds_read_b64_tr_b16 a[220:221], v7 offset:0
    ds_read_b64_tr_b16 a[172:173], v8 offset:0
    ds_read_b64_tr_b16 a[236:237], v9 offset:0
    ds_read_b64_tr_b16 a[188:189], v10 offset:0
    ds_read_b64_tr_b16 a[252:253], v11 offset:0
    s_waitcnt lgkmcnt(0)
    s_waitcnt vmcnt(0)
    s_barrier
    ds_read_b64_tr_b16 a[142:143], v4 offset:16384
    ds_read_b64_tr_b16 a[206:207], v5 offset:16384
    ds_read_b64_tr_b16 a[158:159], v6 offset:16384
    ds_read_b64_tr_b16 a[222:223], v7 offset:16384
    ds_read_b64_tr_b16 a[174:175], v8 offset:16384
    ds_read_b64_tr_b16 a[238:239], v9 offset:16384
    ds_read_b64_tr_b16 a[190:191], v10 offset:16384
    ds_read_b64_tr_b16 a[254:255], v11 offset:16384
    s_waitcnt lgkmcnt(0)
    s_waitcnt lgkmcnt(0)
    s_barrier
    v_bfe_u32 v116, v0, 0, 6
    v_mul_u32_u24 v116, 16, v116
    v_mov_b32 v117, 0
    s_mov_b32 s27, 0
    s_mov_b32 s38, 0xbdd2d3e8
    v_mov_b32 v118, 0xc0135761
    s_waitcnt vmcnt(0)
L_poll_44:
    buffer_load_dword v20, v117, s[12:15], 0 offen offset:192 sc1
    s_movk_i32 s3, 48
    s_sub_u32 s24, s24, 1
    s_cbranch_scc1 L_timeout
    s_waitcnt vmcnt(0)
    v_cmp_gt_u32 vcc, 128, v20
    s_cbranch_vccz L_seen_45
    s_sleep 2
    s_branch L_poll_44
L_seen_45:
    s_lshl_b32 s34, s25, 15
    s_lshl_b32 s3, s22, 13
    s_add_u32 s34, s34, s3
    s_add_u32 s34, s34, 0x200000
    s_add_u32 s3, s3, s27
    s_add_u32 m0, s3, 0
    s_nop 0
    buffer_load_dwordx4 v116, s[4:7], s34 offen offset:0 sc1 lds
    buffer_load_dwordx4 v116, s[4:7], s34 offen offset:1024 sc1 lds
    buffer_load_dwordx4 v116, s[4:7], s34 offen offset:2048 sc1 lds
    buffer_load_dwordx4 v116, s[4:7], s34 offen offset:3072 sc1 lds
    s_add_u32 m0, s3, 4096
    s_add_u32 s34, s34, 4096
    buffer_load_dwordx4 v116, s[4:7], s34 offen offset:0 sc1 lds
    buffer_load_dwordx4 v116, s[4:7], s34 offen offset:1024 sc1 lds
    buffer_load_dwordx4 v116, s[4:7], s34 offen offset:2048 sc1 lds
    buffer_load_dwordx4 v116, s[4:7], s34 offen offset:3072 sc1 lds
    s_mov_b32 s37, 0x4000000
    s_waitcnt vmcnt(0)
L_ffn_loop:
    s_waitcnt vmcnt(2)
    s_barrier
    v_add_u32 v124, s27, v116
    s_xor_b32 s27, s27, 32768
    s_add_u32 s36, s25, 2
    s_min_u32 s36, s36, 63
    s_lshl_b32 s34, s36, 15
    s_lshl_b32 s3, s22, 13
    s_add_u32 s34, s34, s3
    s_add_u32 s34, s34, 0x200000
    s_add_u32 s3, s3, s27
    s_add_u32 m0, s3, 0
    s_nop 0
    buffer_load_dwordx4 v116, s[4:7], s34 offen offset:0 sc1 lds
    buffer_load_dwordx4 v116, s[4:7], s34 offen offset:1024 sc1 lds
    buffer_load_dwordx4 v116, s[4:7], s34 offen offset:2048 sc1 lds
    buffer_load_dwordx4 v116, s[4:7], s34 offen offset:3072 sc1 lds
    s_add_u32 m0, s3, 4096
    s_add_u32 s34, s34, 4096
    buffer_load_dwordx4 v116, s[4:7], s34 offen offset:0 sc1 lds
    buffer_load_dwordx4 v116, s[4:7], s34 offen offset:1024 sc1 lds
    buffer_load_dwordx4 v116, s[4:7], s34 offen offset:2048 sc1 lds
    buffer_load_dwordx4 v116, s[4:7], s34 offen offset:3072 sc1 lds
    ds_read_b128 v[48:51], v124 offset:0
    ds_read_b128 v[52:55], v124 offset:1024
    s_waitcnt lgkmcnt(1)
    v_mfma_f32_16x16x32_bf16 v[80:83], a[0:3], v[48:51], 0
    ds_read_b128 v[56:59], v124 offset:2048
    v_mfma_f32_16x16x32_bf16 v[16:19], a[128:131], v[48:51], 0
    ds_read_b128 v[60:63], v124 offset:3072
    v_mfma_f32_16x16x32_bf16 v[84:87], a[64:67], v[48:51], 0
    v_mfma_f32_16x16x32_bf16 v[20:23], a[192:195], v[48:51], 0
    s_waitcnt lgkmcnt(2)
    v_mfma_f32_16x16x32_bf16 v[88:91], a[0:3], v[52:55], 0
    v_mfma_f32_16x16x32_bf16 v[24:27], a[128:131], v[52:55], 0
    v_mfma_f32_16x16x32_bf16 v[92:95], a[64:67], v[52:55], 0
    v_mfma_f32_16x16x32_bf16 v[28:31], a[192:195], v[52:55], 0
    s_waitcnt lgkmcnt(1)
    v_mfma_f32_16x16x32_bf16 v[80:83], a[4:7], v[56:59], v[80:83]
    ds_read_b128 v[48:51], v124 offset:4096
    v_mfma_f32_16x16x32_bf16 v[16:19], a[132:135], v[56:59], v[16:19]
    ds_read_b128 v[52:55], v124 offset:5120
    v_mfma_f32_16x16x32_bf16 v[84:87], a[68:71], v[56:59], v[84:87]
    v_mfma_f32_16x16x32_bf16 v[20:23], a[196:199], v[56:59], v[20:23]
    s_waitcnt lgkmcnt(2)
    v_mfma_f32_16x16x32_bf16 v[88:91], a[4:7], v[60:63], v[88:91]
    v_mfma_f32_16x16x32_bf16 v[24:27], a[132:135], v[60:63], v[24:27]
    v_mfma_f32_16x16x32_bf16 v[92:95], a[68:71], v[60:63], v[92:95]
    v_mfma_f32_16x16x32_bf16 v[28:31], a[196:199], v[60:63], v[28:31]
    s_waitcnt lgkmcnt(1)
    v_mfma_f32_16x16x32_bf16 v[80:83], a[8:11], v[48:51], v[80:83]
    ds_read_b128 v[56:59], v124 offset:6144
    v_mfma_f32_16x16x32_bf16 v[16:19], a[136:139], v[48:51], v[16:19]
    ds_read_b128 v[60:63], v124 offset:7168
    v_mfma_f32_16x16x32_bf16 v[84:87], a[72:75], v[48:51], v[84:87]
    v_mfma_f32_16x16x32_bf16 v[20:23], a[200:203], v[48:51], v[20:23]
    s_waitcnt lgkmcnt(2)
    v_mfma_f32_16x16x32_bf16 v[88:91], a[8:11], v[52:55], v[88:91]
    v_mfma_f32_16x16x32_bf16 v[24:27], a[136:139], v[52:55], v[24:27]
    v_mfma_f32_16x16x32_bf16 v[92:95], a[72:75], v[52:55], v[92:95]
    v_mfma_f32_16x16x32_bf16 v[28:31], a[200:203], v[52:55], v[28:31]
    s_waitcnt lgkmcnt(1)
    v_mfma_f32_16x16x32_bf16 v[80:83], a[12:15], v[56:59], v[80:83]
    ds_read_b128 v[48:51], v124 offset:8192
    v_mfma_f32_16x16x32_bf16 v[16:19], a[140:143], v[56:59], v[16:19]
    ds_read_b128 v[52:55], v124 offset:9216
    v_mfma_f32_16x16x32_bf16 v[84:87], a[76:79], v[56:59], v[84:87]
    v_mfma_f32_16x16x32_bf16 v[20:23], a[204:207], v[56:59], v[20:23]
    s_waitcnt lgkmcnt(2)
    v_mfma_f32_16x16x32_bf16 v[88:91], a[12:15], v[60:63], v[88:91]
    v_mfma_f32_16x16x32_bf16 v[24:27], a[140:143], v[60:63], v[24:27]
    v_mfma_f32_16x16x32_bf16 v[92:95], a[76:79], v[60:63], v[92:95]
    v_mfma_f32_16x16x32_bf16 v[28:31], a[204:207], v[60:63], v[28:31]
    s_waitcnt lgkmcnt(1)
    v_mfma_f32_16x16x32_bf16 v[80:83], a[16:19], v[48:51], v[80:83]
    ds_read_b128 v[56:59], v124 offset:10240
    v_mfma_f32_16x16x32_bf16 v[16:19], a[144:147], v[48:51], v[16:19]
    ds_read_b128 v[60:63], v124 offset:11264
    v_mfma_f32_16x16x32_bf16 v[84:87], a[80:83], v[48:51], v[84:87]
    v_mfma_f32_16x16x32_bf16 v[20:23], a[208:211], v[48:51], v[20:23]
    s_waitcnt lgkmcnt(2)
    v_mfma_f32_16x16x32_bf16 v[88:91], a[16:19], v[52:55], v[88:91]
    v_mfma_f32_16x16x32_bf16 v[24:27], a[144:147], v[52:55], v[24:27]
    v_mfma_f32_16x16x32_bf16 v[92:95], a[80:83], v[52:55], v[92:95]
    v_mfma_f32_16x16x32_bf16 v[28:31], a[208:211], v[52:55], v[28:31]
    s_waitcnt lgkmcnt(1)
    v_mfma_f32_16x16x32_bf16 v[80:83], a[20:23], v[56:59], v[80:83]
    ds_read_b128 v[48:51], v124 offset:12288
    v_mfma_f32_16x16x32_bf16 v[16:19], a[148:151], v[56:59], v[16:19]
    ds_read_b128 v[52:55], v124 offset:13312
    v_mfma_f32_16x16x32_bf16 v[84:87], a[84:87], v[56:59], v[84:87]
    v_mfma_f32_16x16x32_bf16 v[20:23], a[212:215], v[56:59], v[20:23]
    s_waitcnt lgkmcnt(2)
    v_mfma_f32_16x16x32_bf16 v[88:91], a[20:23], v[60:63], v[88:91]
    v_mfma_f32_16x16x32_bf16 v[24:27], a[148:151], v[60:63], v[24:27]
    v_mfma_f32_16x16x32_bf16 v[92:95], a[84:87], v[60:63], v[92:95]
    v_mfma_f32_16x16x32_bf16 v[28:31], a[212:215], v[60:63], v[28:31]
    s_waitcnt lgkmcnt(1)
    v_mfma_f32_16x16x32_bf16 v[80:83], a[24:27], v[48:51], v[80:83]
    ds_read_b128 v[56:59], v124 offset:14336
    v_mfma_f32_16x16x32_bf16 v[16:19], a[152:155], v[48:51], v[16:19]
    ds_read_b128 v[60:63], v124 offset:15360
    v_mfma_f32_16x16x32_bf16 v[84:87], a[88:91], v[48:51], v[84:87]
    v_mfma_f32_16x16x32_bf16 v[20:23], a[216:219], v[48:51], v[20:23]
    s_waitcnt lgkmcnt(2)
    v_mfma_f32_16x16x32_bf16 v[88:91], a[24:27], v[52:55], v[88:91]
    v_mfma_f32_16x16x32_bf16 v[24:27], a[152:155], v[52:55], v[24:27]
    v_mfma_f32_16x16x32_bf16 v[92:95], a[88:91], v[52:55], v[92:95]
    v_mfma_f32_16x16x32_bf16 v[28:31], a[216:219], v[52:55], v[28:31]
    s_waitcnt lgkmcnt(1)
    v_mfma_f32_16x16x32_bf16 v[80:83], a[28:31], v[56:59], v[80:83]
    ds_read_b128 v[48:51], v124 offset:16384
    v_mfma_f32_16x16x32_bf16 v[16:19], a[156:159], v[56:59], v[16:19]
    ds_read_b128 v[52:55], v124 offset:17408
    v_mfma_f32_16x16x32_bf16 v[84:87], a[92:95], v[56:59], v[84:87]
    s_waitcnt vmcnt(8)
    s_barrier
    s_cmp_lg_u32 s22, 0
    s_cbranch_scc1 L_flag_46
    v_mov_b32 v40, 0x1
    s_mov_b64 exec, 1
    buffer_store_dword v40, v117, s[4:7], s37 offen sc1
    s_mov_b64 exec, -1
L_flag_46:
    v_mfma_f32_16x16x32_bf16 v[20:23], a[220:223], v[56:59], v[20:23]
    s_waitcnt lgkmcnt(2)
    v_mfma_f32_16x16x32_bf16 v[88:91], a[28:31], v[60:63], v[88:91]
    v_mfma_f32_16x16x32_bf16 v[24:27], a[156:159], v[60:63], v[24:27]
    v_mfma_f32_16x16x32_bf16 v[92:95], a[92:95], v[60:63], v[92:95]
    v_mfma_f32_16x16x32_bf16 v[28:31], a[220:223], v[60:63], v[28:31]
    s_waitcnt lgkmcnt(1)
    v_mfma_f32_16x16x32_bf16 v[80:83], a[32:35], v[48:51], v[80:83]
    ds_read_b128 v[56:59], v124 offset:18432
    v_mfma_f32_16x16x32_bf16 v[16:19], a[160:163], v[48:51], v[16:19]
    ds_read_b128 v[60:63], v124 offset:19456
    v_mfma_f32_16x16x32_bf16 v[84:87], a[96:99], v[48:51], v[84:87]
    v_mfma_f32_16x16x32_bf16 v[20:23], a[224:227], v[48:51], v[20:23]
    s_waitcnt lgkmcnt(2)
    v_mfma_f32_16x16x32_bf16 v[88:91], a[32:35], v[52:55], v[88:91]
    v_mfma_f32_16x16x32_bf16 v[24:27], a[160:163], v[52:55], v[24:27]
    v_mfma_f32_16x16x32_bf16 v[92:95], a[96:99], v[52:55], v[92:95]
    v_mfma_f32_16x16x32_bf16 v[28:31], a[224:227], v[52:55], v[28:31]
    s_waitcnt lgkmcnt(1)
    v_mfma_f32_16x16x32_bf16 v[80:83], a[36:39], v[56:59], v[80:83]
    ds_read_b128 v[48:51], v124 offset:20480
    v_mfma_f32_16x16x32_bf16 v[16:19], a[164:167], v[56:59], v[16:19]
    ds_read_b128 v[52:55], v124 offset:21504
    v_mfma_f32_16x16x32_bf16 v[84:87], a[100:103], v[56:59], v[84:87]
    v_mfma_f32_16x16x32_bf16 v[20:23], a[228:231], v[56:59], v[20:23]
    s_waitcnt lgkmcnt(2)
    v_mfma_f32_16x16x32_bf16 v[88:91], a[36:39], v[60:63], v[88:91]
    v_mfma_f32_16x16x32_bf16 v[24:27], a[164:167], v[60:63], v[24:27]
    v_mfma_f32_16x16x32_bf16 v[92:95], a[100:103], v[60:63], v[92:95]
    v_mfma_f32_16x16x32_bf16 v[28:31], a[228:231], v[60:63], v[28:31]
    s_waitcnt lgkmcnt(1)
    v_mfma_f32_16x16x32_bf16 v[80:83], a[40:43], v[48:51], v[80:83]
    ds_read_b128 v[56:59], v124 offset:22528
    v_mfma_f32_16x16x32_bf16 v[16:19], a[168:171], v[48:51], v[16:19]
    ds_read_b128 v[60:63], v124 offset:23552
    v_mfma_f32_16x16x32_bf16 v[84:87], a[104:107], v[48:51], v[84:87]
    v_mfma_f32_16x16x32_bf16 v[20:23], a[232:235], v[48:51], v[20:23]
    s_waitcnt lgkmcnt(2)
    v_mfma_f32_16x16x32_bf16 v[88:91], a[40:43], v[52:55], v[88:91]
    v_mfma_f32_16x16x32_bf16 v[24:27], a[168:171], v[52:55], v[24:27]
    v_mfma_f32_16x16x32_bf16 v[92:95], a[104:107], v[52:55], v[92:95]
    v_mfma_f32_16x16x32_bf16 v[28:31], a[232:235], v[52:55], v[28:31]
    s_waitcnt lgkmcnt(1)
    v_mfma_f32_16x16x32_bf16 v[80:83], a[44:47], v[56:59], v[80:83]
    ds_read_b128 v[48:51], v124 offset:24576
    v_mfma_f32_16x16x32_bf16 v[16:19], a[172:175], v[56:59], v[16:19]
    ds_read_b128 v[52:55], v124 offset:25600
    v_mfma_f32_16x16x32_bf16 v[84:87], a[108:111], v[56:59], v[84:87]
    v_mfma_f32_16x16x32_bf16 v[20:23], a[236:239], v[56:59], v[20:23]
    s_waitcnt lgkmcnt(2)
    v_mfma_f32_16x16x32_bf16 v[88:91], a[44:47], v[60:63], v[88:91]
    v_mfma_f32_16x16x32_bf16 v[24:27], a[172:175], v[60:63], v[24:27]
    v_mfma_f32_16x16x32_bf16 v[92:95], a[108:111], v[60:63], v[92:95]
    v_mfma_f32_16x16x32_bf16 v[28:31], a[236:239], v[60:63], v[28:31]
    s_waitcnt lgkmcnt(1)
    v_mfma_f32_16x16x32_bf16 v[80:83], a[48:51], v[48:51], v[80:83]
    ds_read_b128 v[56:59], v124 offset:26624
    v_mfma_f32_16x16x32_bf16 v[16:19], a[176:179], v[48:51], v[16:19]
    ds_read_b128 v[60:63], v124 offset:27648
    v_mfma_f32_16x16x32_bf16 v[84:87], a[112:115], v[48:51], v[84:87]
    v_mfma_f32_16x16x32_bf16 v[20:23], a[240:243], v[48:51], v[20:23]
    s_waitcnt lgkmcnt(2)
    v_mfma_f32_16x16x32_bf16 v[88:91], a[48:51], v[52:55], v[88:91]
    v_mfma_f32_16x16x32_bf16 v[24:27], a[176:179], v[52:55], v[24:27]
    v_mfma_f32_16x16x32_bf16 v[92:95], a[112:115], v[52:55], v[92:95]
    v_mfma_f32_16x16x32_bf16 v[28:31], a[240:243], v[52:55], v[28:31]
    s_waitcnt lgkmcnt(1)
    v_mfma_f32_16x16x32_bf16 v[80:83], a[52:55], v[56:59], v[80:83]
    ds_read_b128 v[48:51], v124 offset:28672
    v_mfma_f32_16x16x32_bf16 v[16:19], a[180:183], v[56:59], v[16:19]
    ds_read_b128 v[52:55], v124 offset:29696
    v_mfma_f32_16x16x32_bf16 v[84:87], a[116:119], v[56:59], v[84:87]
    v_mfma_f32_16x16x32_bf16 v[20:23], a[244:247], v[56:59], v[20:23]
    s_waitcnt lgkmcnt(2)
    v_mfma_f32_16x16x32_bf16 v[88:91], a[52:55], v[60:63], v[88:91]
    v_mfma_f32_16x16x32_bf16 v[24:27], a[180:183], v[60:63], v[24:27]
    v_mfma_f32_16x16x32_bf16 v[92:95], a[116:119], v[60:63], v[92:95]
    v_mfma_f32_16x16x32_bf16 v[28:31], a[244:247], v[60:63], v[28:31]
    s_waitcnt lgkmcnt(1)
    v_mfma_f32_16x16x32_bf16 v[80:83], a[56:59], v[48:51], v[80:83]
    ds_read_b128 v[56:59], v124 offset:30720
    v_mfma_f32_16x16x32_bf16 v[16:19], a[184:187], v[48:51], v[16:19]
    ds_read_b128 v[60:63], v124 offset:31744
    v_mfma_f32_16x16x32_bf16 v[84:87], a[120:123], v[48:51], v[84:87]
    v_mfma_f32_16x16x32_bf16 v[20:23], a[248:251], v[48:51], v[20:23]
    s_waitcnt lgkmcnt(2)
    v_mfma_f32_16x16x32_bf16 v[88:91], a[56:59], v[52:55], v[88:91]
    v_mfma_f32_16x16x32_bf16 v[24:27], a[184:187], v[52:55], v[24:27]
    v_mfma_f32_16x16x32_bf16 v[92:95], a[120:123], v[52:55], v[92:95]
    v_mfma_f32_16x16x32_bf16 v[28:31], a[248:251], v[52:55], v[28:31]
    s_waitcnt lgkmcnt(1)
    v_mfma_f32_16x16x32_bf16 v[80:83], a[60:63], v[56:59], v[80:83]
    v_mfma_f32_16x16x32_bf16 v[16:19], a[188:191], v[56:59], v[16:19]
    v_mfma_f32_16x16x32_bf16 v[84:87], a[124:127], v[56:59], v[84:87]
    v_mfma_f32_16x16x32_bf16 v[20:23], a[252:255], v[56:59], v[20:23]
    s_waitcnt lgkmcnt(0)
    v_mfma_f32_16x16x32_bf16 v[88:91], a[60:63], v[60:63], v[88:91]
    v_mfma_f32_16x16x32_bf16 v[24:27], a[188:191], v[60:63], v[24:27]
    v_mfma_f32_16x16x32_bf16 v[92:95], a[124:127], v[60:63], v[92:95]
    v_mfma_f32_16x16x32_bf16 v[28:31], a[252:255], v[60:63], v[28:31]
    s_mul_i32 s34, s25, 90112
    s_lshl_b32 s3, s28, 2
    s_add_u32 s3, s3, s22
    s_lshl_b32 s3, s3, 10
    s_add_u32 s34, s34, s3
    s_add_u32 s34, s34, 0x400000
    v_mul_f32 v64, v80, v80
    v_mul_f32 v65, v81, v81
    v_mul_f32 v66, v82, v82
    v_mul_f32 v67, v83, v83
    v_mul_f32 v68, v84, v84
    v_mul_f32 v69, v85, v85
    v_mul_f32 v70, v86, v86
    v_mul_f32 v71, v87, v87
    v_fma_f32 v64, v64, s38, v118
    v_fma_f32 v65, v65, s38, v118
    v_fma_f32 v66, v66, s38, v118
    v_fma_f32 v67, v67, s38, v118
    v_fma_f32 v68, v68, s38, v118
    v_fma_f32 v69, v69, s38, v118
    v_fma_f32 v70, v70, s38, v118
    v_fma_f32 v71, v71, s38, v118
    v_mul_f32 v64, v64, v80
    v_mul_f32 v65, v65, v81
    v_mul_f32 v66, v66, v82
    v_mul_f32 v67, v67, v83
    v_mul_f32 v68, v68, v84
    v_mul_f32 v69, v69, v85
    v_mul_f32 v70, v70, v86
    v_mul_f32 v71, v71, v87
    v_exp_f32 v64, v64
    v_exp_f32 v65, v65
    v_exp_f32 v66, v66
    v_exp_f32 v67, v67
    v_exp_f32 v68, v68
    v_exp_f32 v69, v69
    v_exp_f32 v70, v70
    v_exp_f32 v71, v71
    v_add_f32 v64, 1.0, v64
    v_add_f32 v65, 1.0, v65
    v_add_f32 v66, 1.0, v66
    v_add_f32 v67, 1.0, v67
    v_add_f32 v68, 1.0, v68
    v_add_f32 v69, 1.0, v69
    v_add_f32 v70, 1.0, v70
    v_add_f32 v71, 1.0, v71
    v_rcp_f32 v64, v64
    v_rcp_f32 v65, v65
    v_rcp_f32 v66, v66
    v_rcp_f32 v67, v67
    v_rcp_f32 v68, v68
    v_rcp_f32 v69, v69
    v_rcp_f32 v70, v70
    v_rcp_f32 v71, v71
    v_mul_f32 v64, v64, v80
    v_mul_f32 v65, v65, v81
    v_mul_f32 v66, v66, v82
    v_mul_f32 v67, v67, v83
    v_mul_f32 v68, v68, v84
    v_mul_f32 v69, v69, v85
    v_mul_f32 v70, v70, v86
    v_mul_f32 v71, v71, v87
    v_mul_f32 v64, v64, v16
    v_mul_f32 v65, v65, v17
    v_mul_f32 v66, v66, v18
    v_mul_f32 v67, v67, v19
    v_mul_f32 v68, v68, v20
    v_mul_f32 v69, v69, v21
    v_mul_f32 v70, v70, v22
    v_mul_f32 v71, v71, v23
    v_cvt_pk_bf16_f32 v64, v64, v68
    v_cvt_pk_bf16_f32 v65, v65, v69
    v_cvt_pk_bf16_f32 v66, v66, v70
    v_cvt_pk_bf16_f32 v67, v67, v71
    buffer_store_dwordx4 v[64:67], v116, s[4:7], s34 offen sc1
    s_add_u32 s34, s34, 45056
    v_mul_f32 v72, v88, v88
    v_mul_f32 v73, v89, v89
    v_mul_f32 v74, v90, v90
    v_mul_f32 v75, v91, v91
    v_mul_f32 v76, v92, v92
    v_mul_f32 v77, v93, v93
    v_mul_f32 v78, v94, v94
    v_mul_f32 v79, v95, v95
    v_fma_f32 v72, v72, s38, v118
    v_fma_f32 v73, v73, s38, v118
    v_fma_f32 v74, v74, s38, v118
    v_fma_f32 v75, v75, s38, v118
    v_fma_f32 v76, v76, s38, v118
    v_fma_f32 v77, v77, s38, v118
    v_fma_f32 v78, v78, s38, v118
    v_fma_f32 v79, v79, s38, v118
    v_mul_f32 v72, v72, v88
    v_mul_f32 v73, v73, v89
    v_mul_f32 v74, v74, v90
    v_mul_f32 v75, v75, v91
    v_mul_f32 v76, v76, v92
    v_mul_f32 v77, v77, v93
    v_mul_f32 v78, v78, v94
    v_mul_f32 v79, v79, v95
    v_exp_f32 v72, v72
    v_exp_f32 v73, v73
    v_exp_f32 v74, v74
    v_exp_f32 v75, v75
    v_exp_f32 v76, v76
    v_exp_f32 v77, v77
    v_exp_f32 v78, v78
    v_exp_f32 v79, v79
    v_add_f32 v72, 1.0, v72
    v_add_f32 v73, 1.0, v73
    v_add_f32 v74, 1.0, v74
    v_add_f32 v75, 1.0, v75
    v_add_f32 v76, 1.0, v76
    v_add_f32 v77, 1.0, v77
    v_add_f32 v78, 1.0, v78
    v_add_f32 v79, 1.0, v79
    v_rcp_f32 v72, v72
    v_rcp_f32 v73, v73
    v_rcp_f32 v74, v74
    v_rcp_f32 v75, v75
    v_rcp_f32 v76, v76
    v_rcp_f32 v77, v77
    v_rcp_f32 v78, v78
    v_rcp_f32 v79, v79
    v_mul_f32 v72, v72, v88
    v_mul_f32 v73, v73, v89
    v_mul_f32 v74, v74, v90
    v_mul_f32 v75, v75, v91
    v_mul_f32 v76, v76, v92
    v_mul_f32 v77, v77, v93
    v_mul_f32 v78, v78, v94
    v_mul_f32 v79, v79, v95
    v_mul_f32 v72, v72, v24
    v_mul_f32 v73, v73, v25
    v_mul_f32 v74, v74, v26
    v_mul_f32 v75, v75, v27
    v_mul_f32 v76, v76, v28
    v_mul_f32 v77, v77, v29
    v_mul_f32 v78, v78, v30
    v_mul_f32 v79, v79, v31
    v_cvt_pk_bf16_f32 v72, v72, v76
    v_cvt_pk_bf16_f32 v73, v73, v77
    v_cvt_pk_bf16_f32 v74, v74, v78
    v_cvt_pk_bf16_f32 v75, v75, v79
    buffer_store_dwordx4 v[72:75], v116, s[4:7], s34 offen sc1
    s_add_u32 s34, s34, 45056
    s_lshl_b32 s34, s25, 5
    s_add_u32 s34, s34, s28
    s_lshl_b32 s34, s34, 2
    s_add_u32 s37, s34, 0x92000
    s_add_u32 s25, s25, 2
    s_cmp_lt_u32 s25, 64
    s_cbranch_scc1 L_ffn_loop
    s_waitcnt vmcnt(0) lgkmcnt(0)
    s_barrier
    s_cmp_lg_u32 s22, 0
    s_cbranch_scc1 L_flag_47
    v_mov_b32 v20, 0x1
    s_mov_b64 exec, 1
    buffer_store_dword v20, v117, s[4:7], s37 offen sc1
    s_mov_b64 exec, -1
L_flag_47:
L_col:
    s_and_b32 s27, s21, 1
    s_lshr_b32 s28, s21, 1
    s_lshl_b32 s33, s22, 12
    v_bfe_u32 v2, v0, 0, 2
    v_mul_u32_u24 v2, 16, v2
    v_bfe_u32 v16, v0, 2, 1
    v_mul_u32_u24 v16, 16384, v16
    v_add_u32 v2, v2, v16
    v_bfe_u32 v16, v0, 3, 1
    v_mul_u32_u24 v16, 1024, v16
    v_add_u32 v2, v2, v16
    v_bfe_u32 v16, v0, 4, 2
    v_mul_u32_u24 v16, 4096, v16
    v_add_u32 v2, v2, v16
    v_bfe_u32 v4, v0, 0, 6
    v_mul_u32_u24 v4, 16, v4
    v_bfe_u32 v16, v0, 6, 2
    v_mul_u32_u24 v16, 4096, v16
    v_add_u32 v4, v4, v16
    s_waitcnt lgkmcnt(0)
    s_barrier
    s_mov_b32 s8, s84
    s_mov_b32 s9, s85
    s_mov_b32 s10, 0x158000
    s_mov_b32 s11, 0x20000
    s_mul_i32 s35, s22, 360448
    s_lshl_b32 s3, s28, 6
    s_add_u32 s35, s35, s3
    s_add_u32 m0, s33, 0
    s_add_u32 s34, s35, 0x0
    buffer_load_dwordx4 v2, s[8:11], s34 offen  lds
    s_add_u32 m0, s33, 1024
    s_add_u32 s34, s35, 0x800
    buffer_load_dwordx4 v2, s[8:11], s34 offen  lds
    s_add_u32 m0, s33, 2048
    s_add_u32 s34, s35, 0x8000
    buffer_load_dwordx4 v2, s[8:11], s34 offen  lds
    s_add_u32 m0, s33, 3072
    s_add_u32 s34, s35, 0x8800
    buffer_load_dwordx4 v2, s[8:11], s34 offen  lds
    s_add_u32 m0, s33, 16384
    s_add_u32 s34, s35, 0x10000
    buffer_load_dwordx4 v2, s[8:11], s34 offen  lds
    s_add_u32 m0, s33, 17408
    s_add_u32 s34, s35, 0x10800
    buffer_load_dwordx4 v2, s[8:11], s34 offen  lds
    s_add_u32 m0, s33, 18432
    s_add_u32 s34, s35, 0x18000
    buffer_load_dwordx4 v2, s[8:11], s34 offen  lds
    s_add_u32 m0, s33, 19456
    s_add_u32 s34, s35, 0x18800
    buffer_load_dwordx4 v2, s[8:11], s34 offen  lds
    s_waitcnt vmcnt(4)
    s_barrier
    ds_read_b64_tr_b16 v[168:169], v4 offset:0
    ds_read_b64_tr_b16 v[172:173], v4 offset:8
    ds_read_b64_tr_b16 v[170:171], v4 offset:1024
    ds_read_b64_tr_b16 v[174:175], v4 offset:1032
    ds_read_b64_tr_b16 v[176:177], v4 offset:2048
    ds_read_b64_tr_b16 v[180:181], v4 offset:2056
    ds_read_b64_tr_b16 v[178:179], v4 offset:3072
    ds_read_b64_tr_b16 v[182:183], v4 offset:3080
    s_waitcnt lgkmcnt(0)
    s_barrier
    s_add_u32 m0, s33, 0
    s_add_u32 s34, s35, 0x20000
    buffer_load_dwordx4 v2, s[8:11], s34 offen  lds
    s_add_u32 m0, s33, 1024
    s_add_u32 s34, s35, 0x20800
    buffer_load_dwordx4 v2, s[8:11], s34 offen  lds
    s_add_u32 m0, s33, 2048
    s_add_u32 s34, s35, 0x28000
    buffer_load_dwordx4 v2, s[8:11], s34 offen  lds
    s_add_u32 m0, s33, 3072
    s_add_u32 s34, s35, 0x28800
    buffer_load_dwordx4 v2, s[8:11], s34 offen  lds
    s_waitcnt vmcnt(4)
    s_barrier
    ds_read_b64_tr_b16 v[184:185], v4 offset:16384
    ds_read_b64_tr_b16 v[188:189], v4 offset:16392
    ds_read_b64_tr_b16 v[186:187], v4 offset:17408
    ds_read_b64_tr_b16 v[190:191], v4 offset:17416
    ds_read_b64_tr_b16 v[192:193], v4 offset:18432
    ds_read_b64_tr_b16 v[196:197], v4 offset:18440
    ds_read_b64_tr_b16 v[194:195], v4 offset:19456
    ds_read_b64_tr_b16 v[198:199], v4 offset:19464
    s_waitcnt lgkmcnt(0)
    s_barrier
    s_add_u32 m0, s33, 16384
    s_add_u32 s34, s35, 0x30000
    buffer_load_dwordx4 v2, s[8:11], s34 offen  lds
    s_add_u32 m0, s33, 17408
    s_add_u32 s34, s35, 0x30800
    buffer_load_dwordx4 v2, s[8:11], s34 offen  lds
    s_add_u32 m0, s33, 18432
    s_add_u32 s34, s35, 0x38000
    buffer_load_dwordx4 v2, s[8:11], s34 offen  lds
    s_add_u32 m0, s33, 19456
    s_add_u32 s34, s35, 0x38800
    buffer_load_dwordx4 v2, s[8:11], s34 offen  lds
    s_waitcnt vmcnt(4)
    s_barrier
    ds_read_b64_tr_b16 v[200:201], v4 offset:0
    ds_read_b64_tr_b16 v[204:205], v4 offset:8
    ds_read_b64_tr_b16 v[202:203], v4 offset:1024
    ds_read_b64_tr_b16 v[206:207], v4 offset:1032
    ds_read_b64_tr_b16 v[208:209], v4 offset:2048
    ds_read_b64_tr_b16 v[212:213], v4 offset:2056
    ds_read_b64_tr_b16 v[210:211], v4 offset:3072
    ds_read_b64_tr_b16 v[214:215], v4 offset:3080
    s_waitcnt lgkmcnt(0)
    s_barrier
    s_add_u32 m0, s33, 0
    s_add_u32 s34, s35, 0x40000
    buffer_load_dwordx4 v2, s[8:11], s34 offen  lds
    s_add_u32 m0, s33, 1024
    s_add_u32 s34, s35, 0x40800
    buffer_load_dwordx4 v2, s[8:11], s34 offen  lds
    s_add_u32 m0, s33, 2048
    s_add_u32 s34, s35, 0x48000
    buffer_load_dwordx4 v2, s[8:11], s34 offen  lds
    s_add_u32 m0, s33, 3072
    s_add_u32 s34, s35, 0x48800
    buffer_load_dwordx4 v2, s[8:11], s34 offen  lds
    s_waitcnt vmcnt(4)
    s_barrier
    ds_read_b64_tr_b16 v[216:217], v4 offset:16384
    ds_read_b64_tr_b16 v[220:221], v4 offset:16392
    ds_read_b64_tr_b16 v[218:219], v4 offset:17408
    ds_read_b64_tr_b16 v[222:223], v4 offset:17416
    ds_read_b64_tr_b16 v[224:225], v4 offset:18432
    ds_read_b64_tr_b16 v[228:229], v4 offset:18440
    ds_read_b64_tr_b16 v[226:227], v4 offset:19456
    ds_read_b64_tr_b16 v[230:231], v4 offset:19464
    s_waitcnt lgkmcnt(0)
    s_barrier
    s_add_u32 m0, s33, 16384
    s_add_u32 s34, s35, 0x50000
    buffer_load_dwordx4 v2, s[8:11], s34 offen  lds
    s_add_u32 m0, s33, 17408
    s_add_u32 s34, s35, 0x50800
    buffer_load_dwordx4 v2, s[8:11], s34 offen  lds
    s_waitcnt vmcnt(2)
    s_barrier
    ds_read_b64_tr_b16 v[232:233], v4 offset:0
    ds_read_b64_tr_b16 v[236:237], v4 offset:8
    ds_read_b64_tr_b16 v[234:235], v4 offset:1024
    ds_read_b64_tr_b16 v[238:239], v4 offset:1032
    ds_read_b64_tr_b16 v[240:241], v4 offset:2048
    ds_read_b64_tr_b16 v[244:245], v4 offset:2056
    ds_read_b64_tr_b16 v[242:243], v4 offset:3072
    ds_read_b64_tr_b16 v[246:247], v4 offset:3080
    s_waitcnt lgkmcnt(0)
    s_barrier
    s_mov_b32 s8, s74
    s_mov_b32 s9, s75
    s_mov_b32 s10, 0x400000
    s_mov_b32 s11, 0x20000
    s_lshl_b32 s35, s22, 20
    s_lshl_b32 s3, s28, 6
    s_add_u32 s35, s35, s3
    s_xor_b32 s36, s28, 0
    s_lshl_b32 s36, s36, 16
    s_add_u32 s36, s36, s35
    s_add_u32 m0, s33, 0
    s_add_u32 s34, s36, 0x0
    buffer_load_dwordx4 v2, s[8:11], s34 offen  lds
    s_add_u32 m0, s33, 1024
    s_add_u32 s34, s36, 0x800
    buffer_load_dwordx4 v2, s[8:11], s34 offen  lds
    s_add_u32 m0, s33, 2048
    s_add_u32 s34, s36, 0x8000
    buffer_load_dwordx4 v2, s[8:11], s34 offen  lds
    s_add_u32 m0, s33, 3072
    s_add_u32 s34, s36, 0x8800
    buffer_load_dwordx4 v2, s[8:11], s34 offen  lds
    s_waitcnt vmcnt(4)
    s_barrier
    ds_read_b64_tr_b16 v[248:249], v4 offset:16384
    ds_read_b64_tr_b16 v[252:253], v4 offset:16392
    ds_read_b64_tr_b16 v[250:251], v4 offset:17408
    ds_read_b64_tr_b16 v[254:255], v4 offset:17416
    s_waitcnt lgkmcnt(0)
    s_barrier
    s_xor_b32 s36, s28, 1
    s_lshl_b32 s36, s36, 16
    s_add_u32 s36, s36, s35
    s_add_u32 m0, s33, 16384
    s_add_u32 s34, s36, 0x0
    buffer_load_dwordx4 v2, s[8:11], s34 offen  lds
    s_add_u32 m0, s33, 17408
    s_add_u32 s34, s36, 0x800
    buffer_load_dwordx4 v2, s[8:11], s34 offen  lds
    s_add_u32 m0, s33, 18432
    s_add_u32 s34, s36, 0x8000
    buffer_load_dwordx4 v2, s[8:11], s34 offen  lds
    s_add_u32 m0, s33, 19456
    s_add_u32 s34, s36, 0x8800
    buffer_load_dwordx4 v2, s[8:11], s34 offen  lds
    s_waitcnt vmcnt(4)
    s_barrier
    ds_read_b64_tr_b16 a[0:1], v4 offset:0
    ds_read_b64_tr_b16 a[4:5], v4 offset:8
    ds_read_b64_tr_b16 a[2:3], v4 offset:1024
    ds_read_b64_tr_b16 a[6:7], v4 offset:1032
    ds_read_b64_tr_b16 a[8:9], v4 offset:2048
    ds_read_b64_tr_b16 a[12:13], v4 offset:2056
    ds_read_b64_tr_b16 a[10:11], v4 offset:3072
    ds_read_b64_tr_b16 a[14:15], v4 offset:3080
    s_waitcnt lgkmcnt(0)
    s_barrier
    s_xor_b32 s36, s28, 2
    s_lshl_b32 s36, s36, 16
    s_add_u32 s36, s36, s35
    s_add_u32 m0, s33, 0
    s_add_u32 s34, s36, 0x0
    buffer_load_dwordx4 v2, s[8:11], s34 offen  lds
    s_add_u32 m0, s33, 1024
    s_add_u32 s34, s36, 0x800
    buffer_load_dwordx4 v2, s[8:11], s34 offen  lds
    s_add_u32 m0, s33, 2048
    s_add_u32 s34, s36, 0x8000
    buffer_load_dwordx4 v2, s[8:11], s34 offen  lds
    s_add_u32 m0, s33, 3072
    s_add_u32 s34, s36, 0x8800
    buffer_load_dwordx4 v2, s[8:11], s34 offen  lds
    s_waitcnt vmcnt(4)
    s_barrier
    ds_read_b64_tr_b16 a[16:17], v4 offset:16384
    ds_read_b64_tr_b16 a[20:21], v4 offset:16392
    ds_read_b64_tr_b16 a[18:19], v4 offset:17408
    ds_read_b64_tr_b16 a[22:23], v4 offset:17416
    ds_read_b64_tr_b16 a[24:25], v4 offset:18432
    ds_read_b64_tr_b16 a[28:29], v4 offset:18440
    ds_read_b64_tr_b16 a[26:27], v4 offset:19456
    ds_read_b64_tr_b16 a[30:31], v4 offset:19464
    s_waitcnt lgkmcnt(0)
    s_barrier
    s_xor_b32 s36, s28, 3
    s_lshl_b32 s36, s36, 16
    s_add_u32 s36, s36, s35
    s_add_u32 m0, s33, 16384
    s_add_u32 s34, s36, 0x0
    buffer_load_dwordx4 v2, s[8:11], s34 offen  lds
    s_add_u32 m0, s33, 17408
    s_add_u32 s34, s36, 0x800
    buffer_load_dwordx4 v2, s[8:11], s34 offen  lds
    s_add_u32 m0, s33, 18432
    s_add_u32 s34, s36, 0x8000
    buffer_load_dwordx4 v2, s[8:11], s34 offen  lds
    s_add_u32 m0, s33, 19456
    s_add_u32 s34, s36, 0x8800
    buffer_load_dwordx4 v2, s[8:11], s34 offen  lds
    s_waitcnt vmcnt(4)
    s_barrier
    ds_read_b64_tr_b16 a[32:33], v4 offset:0
    ds_read_b64_tr_b16 a[36:37], v4 offset:8
    ds_read_b64_tr_b16 a[34:35], v4 offset:1024
    ds_read_b64_tr_b16 a[38:39], v4 offset:1032
    ds_read_b64_tr_b16 a[40:41], v4 offset:2048
    ds_read_b64_tr_b16 a[44:45], v4 offset:2056
    ds_read_b64_tr_b16 a[42:43], v4 offset:3072
    ds_read_b64_tr_b16 a[46:47], v4 offset:3080
    s_waitcnt lgkmcnt(0)
    s_barrier
    s_xor_b32 s36, s28, 4
    s_lshl_b32 s36, s36, 16
    s_add_u32 s36, s36, s35
    s_add_u32 m0, s33, 0
    s_add_u32 s34, s36, 0x0
    buffer_load_dwordx4 v2, s[8:11], s34 offen  lds
    s_add_u32 m0, s33, 1024
    s_add_u32 s34, s36, 0x800
    buffer_load_dwordx4 v2, s[8:11], s34 offen  lds
    s_add_u32 m0, s33, 2048
    s_add_u32 s34, s36, 0x8000
    buffer_load_dwordx4 v2, s[8:11], s34 offen  lds
    s_add_u32 m0, s33, 3072
    s_add_u32 s34, s36, 0x8800
    buffer_load_dwordx4 v2, s[8:11], s34 offen  lds
    s_waitcnt vmcnt(4)
    s_barrier
    ds_read_b64_tr_b16 a[48:49], v4 offset:16384
    ds_read_b64_tr_b16 a[52:53], v4 offset:16392
    ds_read_b64_tr_b16 a[50:51], v4 offset:17408
    ds_read_b64_tr_b16 a[54:55], v4 offset:17416
    ds_read_b64_tr_b16 a[56:57], v4 offset:18432
    ds_read_b64_tr_b16 a[60:61], v4 offset:18440
    ds_read_b64_tr_b16 a[58:59], v4 offset:19456
    ds_read_b64_tr_b16 a[62:63], v4 offset:19464
    s_waitcnt lgkmcnt(0)
    s_barrier
    s_xor_b32 s36, s28, 5
    s_lshl_b32 s36, s36, 16
    s_add_u32 s36, s36, s35
    s_add_u32 m0, s33, 16384
    s_add_u32 s34, s36, 0x0
    buffer_load_dwordx4 v2, s[8:11], s34 offen  lds
    s_add_u32 m0, s33, 17408
    s_add_u32 s34, s36, 0x800
    buffer_load_dwordx4 v2, s[8:11], s34 offen  lds
    s_add_u32 m0, s33, 18432
    s_add_u32 s34, s36, 0x8000
    buffer_load_dwordx4 v2, s[8:11], s34 offen  lds
    s_add_u32 m0, s33, 19456
    s_add_u32 s34, s36, 0x8800
    buffer_load_dwordx4 v2, s[8:11], s34 offen  lds
    s_waitcnt vmcnt(4)
    s_barrier
    ds_read_b64_tr_b16 a[64:65], v4 offset:0
    ds_read_b64_tr_b16 a[68:69], v4 offset:8
    ds_read_b64_tr_b16 a[66:67], v4 offset:1024
    ds_read_b64_tr_b16 a[70:71], v4 offset:1032
    ds_read_b64_tr_b16 a[72:73], v4 offset:2048
    ds_read_b64_tr_b16 a[76:77], v4 offset:2056
    ds_read_b64_tr_b16 a[74:75], v4 offset:3072
    ds_read_b64_tr_b16 a[78:79], v4 offset:3080
    s_waitcnt lgkmcnt(0)
    s_barrier
    s_xor_b32 s36, s28, 6
    s_lshl_b32 s36, s36, 16
    s_add_u32 s36, s36, s35
    s_add_u32 m0, s33, 0
    s_add_u32 s34, s36, 0x0
    buffer_load_dwordx4 v2, s[8:11], s34 offen  lds
    s_add_u32 m0, s33, 1024
    s_add_u32 s34, s36, 0x800
    buffer_load_dwordx4 v2, s[8:11], s34 offen  lds
    s_add_u32 m0, s33, 2048
    s_add_u32 s34, s36, 0x8000
    buffer_load_dwordx4 v2, s[8:11], s34 offen  lds
    s_add_u32 m0, s33, 3072
    s_add_u32 s34, s36, 0x8800
    buffer_load_dwordx4 v2, s[8:11], s34 offen  lds
    s_waitcnt vmcnt(4)
    s_barrier
    ds_read_b64_tr_b16 a[80:81], v4 offset:16384
    ds_read_b64_tr_b16 a[84:85], v4 offset:16392
    ds_read_b64_tr_b16 a[82:83], v4 offset:17408
    ds_read_b64_tr_b16 a[86:87], v4 offset:17416
    ds_read_b64_tr_b16 a[88:89], v4 offset:18432
    ds_read_b64_tr_b16 a[92:93], v4 offset:18440
    ds_read_b64_tr_b16 a[90:91], v4 offset:19456
    ds_read_b64_tr_b16 a[94:95], v4 offset:19464
    s_waitcnt lgkmcnt(0)
    s_barrier
    s_xor_b32 s36, s28, 7
    s_lshl_b32 s36, s36, 16
    s_add_u32 s36, s36, s35
    s_add_u32 m0, s33, 16384
    s_add_u32 s34, s36, 0x0
    buffer_load_dwordx4 v2, s[8:11], s34 offen  lds
    s_add_u32 m0, s33, 17408
    s_add_u32 s34, s36, 0x800
    buffer_load_dwordx4 v2, s[8:11], s34 offen  lds
    s_add_u32 m0, s33, 18432
    s_add_u32 s34, s36, 0x8000
    buffer_load_dwordx4 v2, s[8:11], s34 offen  lds
    s_add_u32 m0, s33, 19456
    s_add_u32 s34, s36, 0x8800
    buffer_load_dwordx4 v2, s[8:11], s34 offen  lds
    s_waitcnt vmcnt(4)
    s_barrier
    ds_read_b64_tr_b16 a[96:97], v4 offset:0
    ds_read_b64_tr_b16 a[100:101], v4 offset:8
    ds_read_b64_tr_b16 a[98:99], v4 offset:1024
    ds_read_b64_tr_b16 a[102:103], v4 offset:1032
    ds_read_b64_tr_b16 a[104:105], v4 offset:2048
    ds_read_b64_tr_b16 a[108:109], v4 offset:2056
    ds_read_b64_tr_b16 a[106:107], v4 offset:3072
    ds_read_b64_tr_b16 a[110:111], v4 offset:3080
    s_waitcnt lgkmcnt(0)
    s_barrier
    s_xor_b32 s36, s28, 8
    s_lshl_b32 s36, s36, 16
    s_add_u32 s36, s36, s35
    s_add_u32 m0, s33, 0
    s_add_u32 s34, s36, 0x0
    buffer_load_dwordx4 v2, s[8:11], s34 offen  lds
    s_add_u32 m0, s33, 1024
    s_add_u32 s34, s36, 0x800
    buffer_load_dwordx4 v2, s[8:11], s34 offen  lds
    s_add_u32 m0, s33, 2048
    s_add_u32 s34, s36, 0x8000
    buffer_load_dwordx4 v2, s[8:11], s34 offen  lds
    s_add_u32 m0, s33, 3072
    s_add_u32 s34, s36, 0x8800
    buffer_load_dwordx4 v2, s[8:11], s34 offen  lds
    s_waitcnt vmcnt(4)
    s_barrier
    ds_read_b64_tr_b16 a[112:113], v4 offset:16384
    ds_read_b64_tr_b16 a[116:117], v4 offset:16392
    ds_read_b64_tr_b16 a[114:115], v4 offset:17408
    ds_read_b64_tr_b16 a[118:119], v4 offset:17416
    ds_read_b64_tr_b16 a[120:121], v4 offset:18432
    ds_read_b64_tr_b16 a[124:125], v4 offset:18440
    ds_read_b64_tr_b16 a[122:123], v4 offset:19456
    ds_read_b64_tr_b16 a[126:127], v4 offset:19464
    s_waitcnt lgkmcnt(0)
    s_barrier
    s_xor_b32 s36, s28, 9
    s_lshl_b32 s36, s36, 16
    s_add_u32 s36, s36, s35
    s_add_u32 m0, s33, 16384
    s_add_u32 s34, s36, 0x0
    buffer_load_dwordx4 v2, s[8:11], s34 offen  lds
    s_add_u32 m0, s33, 17408
    s_add_u32 s34, s36, 0x800
    buffer_load_dwordx4 v2, s[8:11], s34 offen  lds
    s_add_u32 m0, s33, 18432
    s_add_u32 s34, s36, 0x8000
    buffer_load_dwordx4 v2, s[8:11], s34 offen  lds
    s_add_u32 m0, s33, 19456
    s_add_u32 s34, s36, 0x8800
    buffer_load_dwordx4 v2, s[8:11], s34 offen  lds
    s_waitcnt vmcnt(4)
    s_barrier
    ds_read_b64_tr_b16 a[128:129], v4 offset:0
    ds_read_b64_tr_b16 a[132:133], v4 offset:8
    ds_read_b64_tr_b16 a[130:131], v4 offset:1024
    ds_read_b64_tr_b16 a[134:135], v4 offset:1032
    ds_read_b64_tr_b16 a[136:137], v4 offset:2048
    ds_read_b64_tr_b16 a[140:141], v4 offset:2056
    ds_read_b64_tr_b16 a[138:139], v4 offset:3072
    ds_read_b64_tr_b16 a[142:143], v4 offset:3080
    s_waitcnt lgkmcnt(0)
    s_barrier
    s_xor_b32 s36, s28, 10
    s_lshl_b32 s36, s36, 16
    s_add_u32 s36, s36, s35
    s_add_u32 m0, s33, 0
    s_add_u32 s34, s36, 0x0
    buffer_load_dwordx4 v2, s[8:11], s34 offen  lds
    s_add_u32 m0, s33, 1024
    s_add_u32 s34, s36, 0x800
    buffer_load_dwordx4 v2, s[8:11], s34 offen  lds
    s_add_u32 m0, s33, 2048
    s_add_u32 s34, s36, 0x8000
    buffer_load_dwordx4 v2, s[8:11], s34 offen  lds
    s_add_u32 m0, s33, 3072
    s_add_u32 s34, s36, 0x8800
    buffer_load_dwordx4 v2, s[8:11], s34 offen  lds
    s_waitcnt vmcnt(4)
    s_barrier
    ds_read_b64_tr_b16 a[144:145], v4 offset:16384
    ds_read_b64_tr_b16 a[148:149], v4 offset:16392
    ds_read_b64_tr_b16 a[146:147], v4 offset:17408
    ds_read_b64_tr_b16 a[150:151], v4 offset:17416
    ds_read_b64_tr_b16 a[152:153], v4 offset:18432
    ds_read_b64_tr_b16 a[156:157], v4 offset:18440
    ds_read_b64_tr_b16 a[154:155], v4 offset:19456
    ds_read_b64_tr_b16 a[158:159], v4 offset:19464
    s_waitcnt lgkmcnt(0)
    s_barrier
    s_xor_b32 s36, s28, 11
    s_lshl_b32 s36, s36, 16
    s_add_u32 s36, s36, s35
    s_add_u32 m0, s33, 16384
    s_add_u32 s34, s36, 0x0
    buffer_load_dwordx4 v2, s[8:11], s34 offen  lds
    s_add_u32 m0, s33, 17408
    s_add_u32 s34, s36, 0x800
    buffer_load_dwordx4 v2, s[8:11], s34 offen  lds
    s_add_u32 m0, s33, 18432
    s_add_u32 s34, s36, 0x8000
    buffer_load_dwordx4 v2, s[8:11], s34 offen  lds
    s_add_u32 m0, s33, 19456
    s_add_u32 s34, s36, 0x8800
    buffer_load_dwordx4 v2, s[8:11], s34 offen  lds
    s_waitcnt vmcnt(4)
    s_barrier
    ds_read_b64_tr_b16 a[160:161], v4 offset:0
    ds_read_b64_tr_b16 a[164:165], v4 offset:8
    ds_read_b64_tr_b16 a[162:163], v4 offset:1024
    ds_read_b64_tr_b16 a[166:167], v4 offset:1032
    ds_read_b64_tr_b16 a[168:169], v4 offset:2048
    ds_read_b64_tr_b16 a[172:173], v4 offset:2056
    ds_read_b64_tr_b16 a[170:171], v4 offset:3072
    ds_read_b64_tr_b16 a[174:175], v4 offset:3080
    s_waitcnt lgkmcnt(0)
    s_barrier
    s_xor_b32 s36, s28, 12
    s_lshl_b32 s36, s36, 16
    s_add_u32 s36, s36, s35
    s_add_u32 m0, s33, 0
    s_add_u32 s34, s36, 0x0
    buffer_load_dwordx4 v2, s[8:11], s34 offen  lds
    s_add_u32 m0, s33, 1024
    s_add_u32 s34, s36, 0x800
    buffer_load_dwordx4 v2, s[8:11], s34 offen  lds
    s_add_u32 m0, s33, 2048
    s_add_u32 s34, s36, 0x8000
    buffer_load_dwordx4 v2, s[8:11], s34 offen  lds
    s_add_u32 m0, s33, 3072
    s_add_u32 s34, s36, 0x8800
    buffer_load_dwordx4 v2, s[8:11], s34 offen  lds
    s_waitcnt vmcnt(4)
    s_barrier
    ds_read_b64_tr_b16 a[176:177], v4 offset:16384
    ds_read_b64_tr_b16 a[180:181], v4 offset:16392
    ds_read_b64_tr_b16 a[178:179], v4 offset:17408
    ds_read_b64_tr_b16 a[182:183], v4 offset:17416
    ds_read_b64_tr_b16 a[184:185], v4 offset:18432
    ds_read_b64_tr_b16 a[188:189], v4 offset:18440
    ds_read_b64_tr_b16 a[186:187], v4 offset:19456
    ds_read_b64_tr_b16 a[190:191], v4 offset:19464
    s_waitcnt lgkmcnt(0)
    s_barrier
    s_xor_b32 s36, s28, 13
    s_lshl_b32 s36, s36, 16
    s_add_u32 s36, s36, s35
    s_add_u32 m0, s33, 16384
    s_add_u32 s34, s36, 0x0
    buffer_load_dwordx4 v2, s[8:11], s34 offen  lds
    s_add_u32 m0, s33, 17408
    s_add_u32 s34, s36, 0x800
    buffer_load_dwordx4 v2, s[8:11], s34 offen  lds
    s_add_u32 m0, s33, 18432
    s_add_u32 s34, s36, 0x8000
    buffer_load_dwordx4 v2, s[8:11], s34 offen  lds
    s_add_u32 m0, s33, 19456
    s_add_u32 s34, s36, 0x8800
    buffer_load_dwordx4 v2, s[8:11], s34 offen  lds
    s_waitcnt vmcnt(4)
    s_barrier
    ds_read_b64_tr_b16 a[192:193], v4 offset:0
    ds_read_b64_tr_b16 a[196:197], v4 offset:8
    ds_read_b64_tr_b16 a[194:195], v4 offset:1024
    ds_read_b64_tr_b16 a[198:199], v4 offset:1032
    ds_read_b64_tr_b16 a[200:201], v4 offset:2048
    ds_read_b64_tr_b16 a[204:205], v4 offset:2056
    ds_read_b64_tr_b16 a[202:203], v4 offset:3072
    ds_read_b64_tr_b16 a[206:207], v4 offset:3080
    s_waitcnt lgkmcnt(0)
    s_barrier
    s_xor_b32 s36, s28, 14
    s_lshl_b32 s36, s36, 16
    s_add_u32 s36, s36, s35
    s_add_u32 m0, s33, 0
    s_add_u32 s34, s36, 0x0
    buffer_load_dwordx4 v2, s[8:11], s34 offen  lds
    s_add_u32 m0, s33, 1024
    s_add_u32 s34, s36, 0x800
    buffer_load_dwordx4 v2, s[8:11], s34 offen  lds
    s_add_u32 m0, s33, 2048
    s_add_u32 s34, s36, 0x8000
    buffer_load_dwordx4 v2, s[8:11], s34 offen  lds
    s_add_u32 m0, s33, 3072
    s_add_u32 s34, s36, 0x8800
    buffer_load_dwordx4 v2, s[8:11], s34 offen  lds
    s_waitcnt vmcnt(4)
    s_barrier
    ds_read_b64_tr_b16 a[208:209], v4 offset:16384
    ds_read_b64_tr_b16 a[212:213], v4 offset:16392
    ds_read_b64_tr_b16 a[210:211], v4 offset:17408
    ds_read_b64_tr_b16 a[214:215], v4 offset:17416
    ds_read_b64_tr_b16 a[216:217], v4 offset:18432
    ds_read_b64_tr_b16 a[220:221], v4 offset:18440
    ds_read_b64_tr_b16 a[218:219], v4 offset:19456
    ds_read_b64_tr_b16 a[222:223], v4 offset:19464
    s_waitcnt lgkmcnt(0)
    s_barrier
    s_xor_b32 s36, s28, 15
    s_lshl_b32 s36, s36, 16
    s_add_u32 s36, s36, s35
    s_add_u32 m0, s33, 16384
    s_add_u32 s34, s36, 0x0
    buffer_load_dwordx4 v2, s[8:11], s34 offen  lds
    s_add_u32 m0, s33, 17408
    s_add_u32 s34, s36, 0x800
    buffer_load_dwordx4 v2, s[8:11], s34 offen  lds
    s_add_u32 m0, s33, 18432
    s_add_u32 s34, s36, 0x8000
    buffer_load_dwordx4 v2, s[8:11], s34 offen  lds
    s_add_u32 m0, s33, 19456
    s_add_u32 s34, s36, 0x8800
    buffer_load_dwordx4 v2, s[8:11], s34 offen  lds
    s_waitcnt vmcnt(4)
    s_barrier
    ds_read_b64_tr_b16 a[224:225], v4 offset:0
    ds_read_b64_tr_b16 a[228:229], v4 offset:8
    ds_read_b64_tr_b16 a[226:227], v4 offset:1024
    ds_read_b64_tr_b16 a[230:231], v4 offset:1032
    ds_read_b64_tr_b16 a[232:233], v4 offset:2048
    ds_read_b64_tr_b16 a[236:237], v4 offset:2056
    ds_read_b64_tr_b16 a[234:235], v4 offset:3072
    ds_read_b64_tr_b16 a[238:239], v4 offset:3080
    s_waitcnt lgkmcnt(0)
    s_waitcnt vmcnt(0)
    s_barrier
    ds_read_b64_tr_b16 a[240:241], v4 offset:16384
    ds_read_b64_tr_b16 a[244:245], v4 offset:16392
    ds_read_b64_tr_b16 a[242:243], v4 offset:17408
    ds_read_b64_tr_b16 a[246:247], v4 offset:17416
    ds_read_b64_tr_b16 a[248:249], v4 offset:18432
    ds_read_b64_tr_b16 a[252:253], v4 offset:18440
    ds_read_b64_tr_b16 a[250:251], v4 offset:19456
    ds_read_b64_tr_b16 a[254:255], v4 offset:19464
    s_waitcnt lgkmcnt(0)
    s_waitcnt lgkmcnt(0)
    s_barrier
    v_bfe_u32 v156, v0, 0, 6
    v_mul_u32_u24 v156, 16, v156
    v_bfe_u32 v161, v0, 0, 6
    v_mul_u32_u24 v161, 16, v161
    v_bfe_u32 v16, v0, 6, 2
    v_mul_u32_u24 v16, 2048, v16
    v_add_u32 v161, v161, v16
    v_bfe_u32 v163, v0, 0, 6
    v_mul_u32_u24 v163, 16, v163
    v_bfe_u32 v16, v0, 6, 1
    v_mul_u32_u24 v16, 8, v16
    v_add_u32 v163, v163, v16
    v_bfe_u32 v16, v0, 7, 1
    v_mul_u32_u24 v16, 1024, v16
    v_add_u32 v163, v163, v16
    v_bfe_u32 v159, v0, 0, 3
    v_mul_u32_u24 v159, 128, v159
    v_bfe_u32 v16, v0, 6, 2
    v_mul_u32_u24 v16, 1024, v16
    v_add_u32 v159, v159, v16
    v_bfe_u32 v158, v0, 0, 4
    v_mul_u32_u24 v158, 4, v158
    v_bfe_u32 v160, v0, 0, 4
    v_mul_u32_u24 v160, 1024, v160
    v_bfe_u32 v16, v0, 4, 2
    v_mul_u32_u24 v16, 16, v16
    v_add_u32 v160, v160, v16
    v_bfe_u32 v16, v0, 6, 2
    v_mul_u32_u24 v16, 4, v16
    v_add_u32 v160, v160, v16
    v_min_u32 v158, 40, v158
    v_mov_b32 v157, 0
    s_lshl_b32 s3, s27, 14
    s_lshl_b32 s34, s28, 6
    s_add_u32 s3, s3, s34
    v_add_u32 v160, s3, v160
    s_mov_b32 s16, s64
    s_mov_b32 s17, s65
    s_mov_b32 s18, 0x200000
    s_mov_b32 s19, 0x20000
    s_mov_b32 s8, s86
    s_mov_b32 s9, s87
    s_mov_b32 s10, 0x200000
    s_mov_b32 s11, 0x20000
    s_sub_u32 s25, s20, 4
    s_cmp_eq_u32 s20, 6
    s_cselect_b32 s25, 58, s25
    s_lshl_b32 s35, s27, 17
    s_lshl_b32 s3, s22, 15
    s_add_u32 s35, s35, s3
    s_lshl_b32 s3, s25, 18
    s_add_u32 s35, s35, s3
    s_add_u32 s35, s35, 0x1000000
    s_xor_b32 s3, s28, 0
    s_lshl_b32 s3, s3, 11
    s_add_u32 s40, s35, s3
    s_xor_b32 s3, s28, 1
    s_lshl_b32 s3, s3, 11
    s_add_u32 s41, s35, s3
    s_xor_b32 s3, s28, 2
    s_lshl_b32 s3, s3, 11
    s_add_u32 s42, s35, s3
    s_xor_b32 s3, s28, 3
    s_lshl_b32 s3, s3, 11
    s_add_u32 s43, s35, s3
    s_xor_b32 s3, s28, 4
    s_lshl_b32 s3, s3, 11
    s_add_u32 s44, s35, s3
    s_xor_b32 s3, s28, 5
    s_lshl_b32 s3, s3, 11
    s_add_u32 s45, s35, s3
    s_xor_b32 s3, s28, 6
    s_lshl_b32 s3, s3, 11
    s_add_u32 s46, s35, s3
    s_xor_b32 s3, s28, 7
    s_lshl_b32 s3, s3, 11
    s_add_u32 s47, s35, s3
    s_xor_b32 s3, s28, 8
    s_lshl_b32 s3, s3, 11
    s_add_u32 s48, s35, s3
    s_xor_b32 s3, s28, 9
    s_lshl_b32 s3, s3, 11
    s_add_u32 s49, s35, s3
    s_xor_b32 s3, s28, 10
    s_lshl_b32 s3, s3, 11
    s_add_u32 s50, s35, s3
    s_xor_b32 s3, s28, 11
    s_lshl_b32 s3, s3, 11
    s_add_u32 s51, s35, s3
    s_xor_b32 s3, s28, 12
    s_lshl_b32 s3, s3, 11
    s_add_u32 s52, s35, s3
    s_xor_b32 s3, s28, 13
    s_lshl_b32 s3, s3, 11
    s_add_u32 s53, s35, s3
    s_xor_b32 s3, s28, 14
    s_lshl_b32 s3, s3, 11
    s_add_u32 s54, s35, s3
    s_xor_b32 s3, s28, 15
    s_lshl_b32 s3, s3, 11
    s_add_u32 s55, s35, s3
    s_waitcnt vmcnt(0)
L_poll_48:
    buffer_load_dword v162, v157, s[12:15], 0 offen offset:192 sc1
    s_movk_i32 s3, 64
    s_sub_u32 s24, s24, 1
    s_cbranch_scc1 L_timeout
    s_waitcnt vmcnt(0)
    v_cmp_gt_u32 vcc, 128, v162
    s_cbranch_vccz L_seen_49
    s_sleep 2
    s_branch L_poll_48
L_seen_49:
L_col_first:
    s_lshl_b32 s37, s25, 1
    s_add_u32 s37, s37, s27
    s_lshl_b32 s37, s37, 2
    s_add_u32 s37, s37, s22
    s_mul_i32 s37, s37, 11264
    s_add_u32 s37, s37, 0x400000
    s_lshl_b32 s36, s25, 12
    s_add_u32 s36, s36, 0xc0000
    s_add_u32 s38, s25, 0
    s_or_b32 s3, s25, 62
    s_min_u32 s38, s38, s3
    s_lshl_b32 s38, s38, 7
    s_add_u32 s38, s38, 0x92000
    s_waitcnt vmcnt(0)
L_poll_50:
    buffer_load_dword v162, v158, s[4:7], s38 offen offset:0 sc1
    s_movk_i32 s3, 65
    s_sub_u32 s24, s24, 1
    s_cbranch_scc1 L_timeout
    s_waitcnt vmcnt(0)
    v_cmp_gt_u32 vcc, 1, v162
    s_cbranch_vccz L_seen_51
    s_sleep 8
    s_branch L_poll_50
L_seen_51:
    v_mov_b32 v162, 0
    s_add_u32 s34, s25, 4
    s_or_b32 s3, s25, 62
    s_min_u32 s34, s34, s3
    s_lshl_b32 s34, s34, 7
    s_add_u32 s34, s34, 0x92000
    buffer_load_dword v164, v158, s[4:7], s34 offen sc1
    s_lshl_b32 s34, s25, 15
    buffer_load_dword v152, v160, s[16:19], s34 offen
    buffer_load_dwordx4 v[0:3], v156, s[4:7], s37 offen offset:0 sc1
    buffer_load_dwordx4 v[4:7], v156, s[4:7], s37 offen offset:1024 sc1
    buffer_load_dwordx4 v[8:11], v156, s[4:7], s37 offen offset:2048 sc1
    buffer_load_dwordx4 v[12:15], v156, s[4:7], s37 offen offset:3072 sc1
    s_add_u32 s37, s37, 4096
    buffer_load_dwordx4 v[16:19], v156, s[4:7], s37 offen offset:0 sc1
    buffer_load_dwordx4 v[20:23], v156, s[4:7], s37 offen offset:1024 sc1
    buffer_load_dwordx4 v[24:27], v156, s[4:7], s37 offen offset:2048 sc1
    buffer_load_dwordx4 v[28:31], v156, s[4:7], s37 offen offset:3072 sc1
    s_add_u32 s37, s37, 4096
    buffer_load_dwordx4 v[32:35], v156, s[4:7], s37 offen offset:0 sc1
    buffer_load_dwordx4 v[36:39], v156, s[4:7], s37 offen offset:1024 sc1
    buffer_load_dwordx4 v[40:43], v156, s[4:7], s37 offen offset:2048 sc1
    s_cmp_eq_u32 s20, 6
    s_cbranch_scc1 L_col_last
L_col_loop:
    s_cmp_eq_u32 s25, 56
    s_cselect_b32 s31, 4, 2
    s_add_u32 s39, s25, s31
    s_min_u32 s39, s39, 63
    s_lshl_b32 s31, s31, 18
    s_lshl_b32 s37, s39, 1
    s_add_u32 s37, s37, s27
    s_lshl_b32 s37, s37, 2
    s_add_u32 s37, s37, s22
    s_mul_i32 s37, s37, 11264
    s_add_u32 s37, s37, 0x400000
    v_cmp_ne_u32 vcc, 0x1010101, v162
    s_cbranch_vccnz L_col_wait
L_col_now:
    buffer_load_dwordx4 v[44:47], v156, s[4:7], s40 offen offset:0 sc1
    buffer_load_dwordx4 v[48:51], v156, s[4:7], s40 offen offset:1024 sc1
    s_add_u32 s40, s40, s31
    buffer_load_dwordx4 v[52:55], v156, s[4:7], s41 offen offset:0 sc1
    buffer_load_dwordx4 v[56:59], v156, s[4:7], s41 offen offset:1024 sc1
    s_add_u32 s41, s41, s31
    buffer_load_dwordx4 v[60:63], v156, s[4:7], s42 offen offset:0 sc1
    buffer_load_dwordx4 v[64:67], v156, s[4:7], s42 offen offset:1024 sc1
    s_add_u32 s42, s42, s31
    buffer_load_dwordx4 v[68:71], v156, s[4:7], s43 offen offset:0 sc1
    buffer_load_dwordx4 v[72:75], v156, s[4:7], s43 offen offset:1024 sc1
    s_add_u32 s43, s43, s31
    buffer_load_dwordx4 v[76:79], v156, s[4:7], s44 offen offset:0 sc1
    buffer_load_dwordx4 v[80:83], v156, s[4:7], s44 offen offset:1024 sc1
    s_add_u32 s44, s44, s31
    s_waitcnt vmcnt(10)
    v_mfma_f32_16x16x32_bf16 v[136:139], v[168:171], v[0:3], 0
    v_mfma_f32_16x16x32_bf16 v[140:143], v[172:175], v[0:3], 0
    v_mfma_f32_16x16x32_bf16 v[136:139], v[176:179], v[4:7], v[136:139]
    v_mfma_f32_16x16x32_bf16 v[140:143], v[180:183], v[4:7], v[140:143]
    v_mfma_f32_16x16x32_bf16 v[136:139], v[184:187], v[8:11], v[136:139]
    v_mfma_f32_16x16x32_bf16 v[140:143], v[188:191], v[8:11], v[140:143]
    v_mfma_f32_16x16x32_bf16 v[136:139], v[192:195], v[12:15], v[136:139]
    v_mfma_f32_16x16x32_bf16 v[140:143], v[196:199], v[12:15], v[140:143]
    v_mfma_f32_16x16x32_bf16 v[136:139], v[200:203], v[16:19], v[136:139]
    v_mfma_f32_16x16x32_bf16 v[140:143], v[204:207], v[16:19], v[140:143]
    v_mfma_f32_16x16x32_bf16 v[136:139], v[208:211], v[20:23], v[136:139]
    v_mfma_f32_16x16x32_bf16 v[140:143], v[212:215], v[20:23], v[140:143]
    v_mfma_f32_16x16x32_bf16 v[136:139], v[216:219], v[24:27], v[136:139]
    v_mfma_f32_16x16x32_bf16 v[140:143], v[220:223], v[24:27], v[140:143]
    v_mfma_f32_16x16x32_bf16 v[136:139], v[224:227], v[28:31], v[136:139]
    v_mfma_f32_16x16x32_bf16 v[140:143], v[228:231], v[28:31], v[140:143]
    v_mfma_f32_16x16x32_bf16 v[136:139], v[232:235], v[32:35], v[136:139]
    v_mfma_f32_16x16x32_bf16 v[140:143], v[236:239], v[32:35], v[140:143]
    v_mfma_f32_16x16x32_bf16 v[136:139], v[240:243], v[36:39], v[136:139]
    v_mfma_f32_16x16x32_bf16 v[140:143], v[244:247], v[36:39], v[140:143]
    v_mfma_f32_16x16x32_bf16 v[136:139], v[248:251], v[40:43], v[136:139]
    v_mfma_f32_16x16x32_bf16 v[140:143], v[252:255], v[40:43], v[140:143]
    s_nop 6
    ds_write_b128 v161, v[136:139] offset:0
    ds_write_b128 v161, v[140:143] offset:1024
    s_waitcnt lgkmcnt(0)
    s_barrier
    ds_read_b64 v[112:113], v163 offset:0
    ds_read_b64 v[114:115], v163 offset:2048
    ds_read_b64 v[116:117], v163 offset:4096
    ds_read_b64 v[118:119], v163 offset:6144
    s_waitcnt lgkmcnt(2)
    v_pk_add_f32 v[112:113], v[112:113], v[114:115]
    s_waitcnt lgkmcnt(0)
    v_pk_add_f32 v[116:117], v[116:117], v[118:119]
    v_pk_add_f32 v[112:113], v[112:113], v[116:117]
    v_mul_f32 v144, 0xbfb8aa3b, v112
    v_mul_f32 v145, 0xbfb8aa3b, v113
    v_exp_f32 v144, v144
    v_exp_f32 v145, v145
    v_add_f32 v144, 1.0, v144
    v_add_f32 v145, 1.0, v145
    v_rcp_f32 v144, v144
    v_rcp_f32 v145, v145
    v_mul_f32 v144, v144, v112
    v_mul_f32 v145, v145, v113
    s_branch L_col_o
L_col_wait:
    buffer_load_dword v162, v159, s[4:7], s36 offen sc1
    s_waitcnt vmcnt(0)
    v_cmp_ne_u32 vcc, 0x1010101, v162
    s_cbranch_vccz L_col_now
    buffer_load_dword v162, v159, s[4:7], s36 offen sc1
    v_mfma_f32_16x16x32_bf16 v[136:139], v[168:171], v[0:3], 0
    v_mfma_f32_16x16x32_bf16 v[140:143], v[172:175], v[0:3], 0
    v_mfma_f32_16x16x32_bf16 v[136:139], v[176:179], v[4:7], v[136:139]
    v_mfma_f32_16x16x32_bf16 v[140:143], v[180:183], v[4:7], v[140:143]
    v_mfma_f32_16x16x32_bf16 v[136:139], v[184:187], v[8:11], v[136:139]
    v_mfma_f32_16x16x32_bf16 v[140:143], v[188:191], v[8:11], v[140:143]
    v_mfma_f32_16x16x32_bf16 v[136:139], v[192:195], v[12:15], v[136:139]
    v_mfma_f32_16x16x32_bf16 v[140:143], v[196:199], v[12:15], v[140:143]
    v_mfma_f32_16x16x32_bf16 v[136:139], v[200:203], v[16:19], v[136:139]
    v_mfma_f32_16x16x32_bf16 v[140:143], v[204:207], v[16:19], v[140:143]
    v_mfma_f32_16x16x32_bf16 v[136:139], v[208:211], v[20:23], v[136:139]
    v_mfma_f32_16x16x32_bf16 v[140:143], v[212:215], v[20:23], v[140:143]
    v_mfma_f32_16x16x32_bf16 v[136:139], v[216:219], v[24:27], v[136:139]
    v_mfma_f32_16x16x32_bf16 v[140:143], v[220:223], v[24:27], v[140:143]
    v_mfma_f32_16x16x32_bf16 v[136:139], v[224:227], v[28:31], v[136:139]
    v_mfma_f32_16x16x32_bf16 v[140:143], v[228:231], v[28:31], v[140:143]
    v_mfma_f32_16x16x32_bf16 v[136:139], v[232:235], v[32:35], v[136:139]
    v_mfma_f32_16x16x32_bf16 v[140:143], v[236:239], v[32:35], v[140:143]
    v_mfma_f32_16x16x32_bf16 v[136:139], v[240:243], v[36:39], v[136:139]
    v_mfma_f32_16x16x32_bf16 v[140:143], v[244:247], v[36:39], v[140:143]
    v_mfma_f32_16x16x32_bf16 v[136:139], v[248:251], v[40:43], v[136:139]
    v_mfma_f32_16x16x32_bf16 v[140:143], v[252:255], v[40:43], v[140:143]
    s_nop 6
    ds_write_b128 v161, v[136:139] offset:0
    ds_write_b128 v161, v[140:143] offset:1024
    s_waitcnt lgkmcnt(0)
    s_barrier
    ds_read_b64 v[112:113], v163 offset:0
    ds_read_b64 v[114:115], v163 offset:2048
    ds_read_b64 v[116:117], v163 offset:4096
    ds_read_b64 v[118:119], v163 offset:6144
    s_waitcnt lgkmcnt(2)
    v_pk_add_f32 v[112:113], v[112:113], v[114:115]
    s_waitcnt lgkmcnt(0)
    v_pk_add_f32 v[116:117], v[116:117], v[118:119]
    v_pk_add_f32 v[112:113], v[112:113], v[116:117]
    v_mul_f32 v144, 0xbfb8aa3b, v112
    v_mul_f32 v145, 0xbfb8aa3b, v113
    v_exp_f32 v144, v144
    v_exp_f32 v145, v145
    v_add_f32 v144, 1.0, v144
    v_add_f32 v145, 1.0, v145
    v_rcp_f32 v144, v144
    v_rcp_f32 v145, v145
    v_mul_f32 v144, v144, v112
    v_mul_f32 v145, v145, v113
    s_waitcnt vmcnt(0)
    v_cmp_ne_u32 vcc, 0x1010101, v162
    s_cbranch_vccz L_col_go
    s_waitcnt vmcnt(0)
L_poll_52:
    buffer_load_dword v162, v159, s[4:7], s36 offen offset:0 sc1
    s_movk_i32 s3, 66
    s_sub_u32 s24, s24, 1
    s_cbranch_scc1 L_timeout
    s_waitcnt vmcnt(0)
    v_cmp_gt_u32 vcc, 16843009, v162
    s_cbranch_vccnz L_poll_52
L_col_go:
    buffer_load_dwordx4 v[44:47], v156, s[4:7], s40 offen offset:0 sc1
    buffer_load_dwordx4 v[48:51], v156, s[4:7], s40 offen offset:1024 sc1
    s_add_u32 s40, s40, s31
    buffer_load_dwordx4 v[52:55], v156, s[4:7], s41 offen offset:0 sc1
    buffer_load_dwordx4 v[56:59], v156, s[4:7], s41 offen offset:1024 sc1
    s_add_u32 s41, s41, s31
    buffer_load_dwordx4 v[60:63], v156, s[4:7], s42 offen offset:0 sc1
    buffer_load_dwordx4 v[64:67], v156, s[4:7], s42 offen offset:1024 sc1
    s_add_u32 s42, s42, s31
    buffer_load_dwordx4 v[68:71], v156, s[4:7], s43 offen offset:0 sc1
    buffer_load_dwordx4 v[72:75], v156, s[4:7], s43 offen offset:1024 sc1
    s_add_u32 s43, s43, s31
    buffer_load_dwordx4 v[76:79], v156, s[4:7], s44 offen offset:0 sc1
    buffer_load_dwordx4 v[80:83], v156, s[4:7], s44 offen offset:1024 sc1
    s_add_u32 s44, s44, s31
L_col_o:
    v_lshlrev_b32 v154, 16, v152
    v_and_b32 v155, 0xffff0000, v152
    v_cmp_eq_u32 vcc, 0, v164
    s_mov_b32 s29, s37
    s_cmp_ge_u32 s25, 61
    s_cselect_b32 s37, 0x4000000, s37
    s_cselect_b32 s30, 0, vcc_lo
    s_cmp_lg_u32 s30, 0
    s_cselect_b32 s37, 0x4000000, s37
    s_lshl_b32 s36, s39, 12
    s_add_u32 s36, s36, 0xc0000
    s_waitcnt vmcnt(9)
    v_mfma_f32_16x16x32_bf16 v[128:131], a[0:3], v[44:47], 0
    v_mfma_f32_16x16x32_bf16 v[132:135], a[4:7], v[44:47], 0
    buffer_load_dwordx4 v[84:87], v156, s[4:7], s45 offen offset:0 sc1
    s_waitcnt vmcnt(9)
    v_mfma_f32_16x16x32_bf16 v[128:131], a[8:11], v[48:51], v[128:131]
    v_mfma_f32_16x16x32_bf16 v[132:135], a[12:15], v[48:51], v[132:135]
    buffer_load_dwordx4 v[88:91], v156, s[4:7], s45 offen offset:1024 sc1
    s_add_u32 s45, s45, s31
    s_waitcnt vmcnt(9)
    v_mfma_f32_16x16x32_bf16 v[128:131], a[16:19], v[52:55], v[128:131]
    v_mfma_f32_16x16x32_bf16 v[132:135], a[20:23], v[52:55], v[132:135]
    buffer_load_dwordx4 v[92:95], v156, s[4:7], s46 offen offset:0 sc1
    s_waitcnt vmcnt(9)
    v_mfma_f32_16x16x32_bf16 v[128:131], a[24:27], v[56:59], v[128:131]
    v_mfma_f32_16x16x32_bf16 v[132:135], a[28:31], v[56:59], v[132:135]
    buffer_load_dwordx4 v[96:99], v156, s[4:7], s46 offen offset:1024 sc1
    s_add_u32 s46, s46, s31
    s_waitcnt vmcnt(9)
    v_mfma_f32_16x16x32_bf16 v[128:131], a[32:35], v[60:63], v[128:131]
    v_mfma_f32_16x16x32_bf16 v[132:135], a[36:39], v[60:63], v[132:135]
    buffer_load_dwordx4 v[100:103], v156, s[4:7], s47 offen offset:0 sc1
    s_waitcnt vmcnt(9)
    v_mfma_f32_16x16x32_bf16 v[128:131], a[40:43], v[64:67], v[128:131]
    v_mfma_f32_16x16x32_bf16 v[132:135], a[44:47], v[64:67], v[132:135]
    buffer_load_dwordx4 v[104:107], v156, s[4:7], s47 offen offset:1024 sc1
    s_add_u32 s47, s47, s31
    s_waitcnt vmcnt(9)
    v_mfma_f32_16x16x32_bf16 v[128:131], a[48:51], v[68:71], v[128:131]
    v_mfma_f32_16x16x32_bf16 v[132:135], a[52:55], v[68:71], v[132:135]
    buffer_load_dwordx4 v[44:47], v156, s[4:7], s48 offen offset:0 sc1
    s_waitcnt vmcnt(9)
    v_mfma_f32_16x16x32_bf16 v[128:131], a[56:59], v[72:75], v[128:131]
    v_mfma_f32_16x16x32_bf16 v[132:135], a[60:63], v[72:75], v[132:135]
    buffer_load_dwordx4 v[48:51], v156, s[4:7], s48 offen offset:1024 sc1
    s_add_u32 s48, s48, s31
    s_waitcnt vmcnt(9)
    v_mfma_f32_16x16x32_bf16 v[128:131], a[64:67], v[76:79], v[128:131]
    v_mfma_f32_16x16x32_bf16 v[132:135], a[68:71], v[76:79], v[132:135]
    buffer_load_dwordx4 v[52:55], v156, s[4:7], s49 offen offset:0 sc1
    s_waitcnt vmcnt(9)
    v_mfma_f32_16x16x32_bf16 v[128:131], a[72:75], v[80:83], v[128:131]
    v_mfma_f32_16x16x32_bf16 v[132:135], a[76:79], v[80:83], v[132:135]
    buffer_load_dwordx4 v[56:59], v156, s[4:7], s49 offen offset:1024 sc1
    s_add_u32 s49, s49, s31
    s_waitcnt vmcnt(9)
    v_mfma_f32_16x16x32_bf16 v[128:131], a[80:83], v[84:87], v[128:131]
    v_mfma_f32_16x16x32_bf16 v[132:135], a[84:87], v[84:87], v[132:135]
    buffer_load_dwordx4 v[60:63], v156, s[4:7], s50 offen offset:0 sc1
    s_waitcnt vmcnt(9)
    v_mfma_f32_16x16x32_bf16 v[128:131], a[88:91], v[88:91], v[128:131]
    v_mfma_f32_16x16x32_bf16 v[132:135], a[92:95], v[88:91], v[132:135]
    buffer_load_dwordx4 v[64:67], v156, s[4:7], s50 offen offset:1024 sc1
    s_add_u32 s50, s50, s31
    s_waitcnt vmcnt(9)
    v_mfma_f32_16x16x32_bf16 v[128:131], a[96:99], v[92:95], v[128:131]
    v_mfma_f32_16x16x32_bf16 v[132:135], a[100:103], v[92:95], v[132:135]
    buffer_load_dwordx4 v[68:71], v156, s[4:7], s51 offen offset:0 sc1
    s_waitcnt vmcnt(9)
    v_mfma_f32_16x16x32_bf16 v[128:131], a[104:107], v[96:99], v[128:131]
    v_mfma_f32_16x16x32_bf16 v[132:135], a[108:111], v[96:99], v[132:135]
    buffer_load_dwordx4 v[72:75], v156, s[4:7], s51 offen offset:1024 sc1
    s_add_u32 s51, s51, s31
    s_waitcnt vmcnt(9)
    v_mfma_f32_16x16x32_bf16 v[128:131], a[112:115], v[100:103], v[128:131]
    v_mfma_f32_16x16x32_bf16 v[132:135], a[116:119], v[100:103], v[132:135]
    buffer_load_dwordx4 v[76:79], v156, s[4:7], s52 offen offset:0 sc1
    s_waitcnt vmcnt(9)
    v_mfma_f32_16x16x32_bf16 v[128:131], a[120:123], v[104:107], v[128:131]
    v_mfma_f32_16x16x32_bf16 v[132:135], a[124:127], v[104:107], v[132:135]
    buffer_load_dwordx4 v[80:83], v156, s[4:7], s52 offen offset:1024 sc1
    s_add_u32 s52, s52, s31
    s_waitcnt vmcnt(9)
    v_mfma_f32_16x16x32_bf16 v[128:131], a[128:131], v[44:47], v[128:131]
    v_mfma_f32_16x16x32_bf16 v[132:135], a[132:135], v[44:47], v[132:135]
    buffer_load_dwordx4 v[84:87], v156, s[4:7], s53 offen offset:0 sc1
    s_waitcnt vmcnt(9)
    v_mfma_f32_16x16x32_bf16 v[128:131], a[136:139], v[48:51], v[128:131]
    v_mfma_f32_16x16x32_bf16 v[132:135], a[140:143], v[48:51], v[132:135]
    buffer_load_dwordx4 v[88:91], v156, s[4:7], s53 offen offset:1024 sc1
    s_add_u32 s53, s53, s31
    s_waitcnt vmcnt(9)
    v_mfma_f32_16x16x32_bf16 v[128:131], a[144:147], v[52:55], v[128:131]
    v_mfma_f32_16x16x32_bf16 v[132:135], a[148:151], v[52:55], v[132:135]
    buffer_load_dwordx4 v[92:95], v156, s[4:7], s54 offen offset:0 sc1
    s_waitcnt vmcnt(9)
    v_mfma_f32_16x16x32_bf16 v[128:131], a[152:155], v[56:59], v[128:131]
    v_mfma_f32_16x16x32_bf16 v[132:135], a[156:159], v[56:59], v[132:135]
    buffer_load_dwordx4 v[96:99], v156, s[4:7], s54 offen offset:1024 sc1
    s_add_u32 s54, s54, s31
    s_waitcnt vmcnt(9)
    v_mfma_f32_16x16x32_bf16 v[128:131], a[160:163], v[60:63], v[128:131]
    v_mfma_f32_16x16x32_bf16 v[132:135], a[164:167], v[60:63], v[132:135]
    buffer_load_dwordx4 v[100:103], v156, s[4:7], s55 offen offset:0 sc1
    s_waitcnt vmcnt(9)
    v_mfma_f32_16x16x32_bf16 v[128:131], a[168:171], v[64:67], v[128:131]
    v_mfma_f32_16x16x32_bf16 v[132:135], a[172:175], v[64:67], v[132:135]
    buffer_load_dwordx4 v[104:107], v156, s[4:7], s55 offen offset:1024 sc1
    s_add_u32 s55, s55, s31
    s_waitcnt vmcnt(9)
    v_mfma_f32_16x16x32_bf16 v[128:131], a[176:179], v[68:71], v[128:131]
    v_mfma_f32_16x16x32_bf16 v[132:135], a[180:183], v[68:71], v[132:135]
    buffer_load_dword v162, v159, s[4:7], s36 offen sc1
    s_waitcnt vmcnt(9)
    v_mfma_f32_16x16x32_bf16 v[128:131], a[184:187], v[72:75], v[128:131]
    v_mfma_f32_16x16x32_bf16 v[132:135], a[188:191], v[72:75], v[132:135]
    s_add_u32 s34, s39, 4
    s_or_b32 s3, s39, 62
    s_min_u32 s34, s34, s3
    s_lshl_b32 s34, s34, 7
    s_add_u32 s34, s34, 0x92000
    buffer_load_dword v164, v158, s[4:7], s34 offen sc1
    s_lshl_b32 s34, s39, 15
    buffer_load_dword v152, v160, s[16:19], s34 offen
    s_waitcnt vmcnt(10)
    v_mfma_f32_16x16x32_bf16 v[128:131], a[192:195], v[76:79], v[128:131]
    v_mfma_f32_16x16x32_bf16 v[132:135], a[196:199], v[76:79], v[132:135]
    buffer_load_dwordx4 v[0:3], v156, s[4:7], s37 offen offset:0 sc1
    s_waitcnt vmcnt(10)
    v_mfma_f32_16x16x32_bf16 v[128:131], a[200:203], v[80:83], v[128:131]
    v_mfma_f32_16x16x32_bf16 v[132:135], a[204:207], v[80:83], v[132:135]
    buffer_load_dwordx4 v[4:7], v156, s[4:7], s37 offen offset:1024 sc1
    s_waitcnt vmcnt(10)
    v_mfma_f32_16x16x32_bf16 v[128:131], a[208:211], v[84:87], v[128:131]
    v_mfma_f32_16x16x32_bf16 v[132:135], a[212:215], v[84:87], v[132:135]
    buffer_load_dwordx4 v[8:11], v156, s[4:7], s37 offen offset:2048 sc1
    s_waitcnt vmcnt(10)
    v_mfma_f32_16x16x32_bf16 v[128:131], a[216:219], v[88:91], v[128:131]
    v_mfma_f32_16x16x32_bf16 v[132:135], a[220:223], v[88:91], v[132:135]
    buffer_load_dwordx4 v[12:15], v156, s[4:7], s37 offen offset:3072 sc1
    s_waitcnt vmcnt(10)
    v_mfma_f32_16x16x32_bf16 v[128:131], a[224:227], v[92:95], v[128:131]
    v_mfma_f32_16x16x32_bf16 v[132:135], a[228:231], v[92:95], v[132:135]
    s_add_u32 s37, s37, 4096
    buffer_load_dwordx4 v[16:19], v156, s[4:7], s37 offen offset:0 sc1
    s_waitcnt vmcnt(10)
    v_mfma_f32_16x16x32_bf16 v[128:131], a[232:235], v[96:99], v[128:131]
    v_mfma_f32_16x16x32_bf16 v[132:135], a[236:239], v[96:99], v[132:135]
    buffer_load_dwordx4 v[20:23], v156, s[4:7], s37 offen offset:1024 sc1
    s_waitcnt vmcnt(10)
    v_mfma_f32_16x16x32_bf16 v[128:131], a[240:243], v[100:103], v[128:131]
    v_mfma_f32_16x16x32_bf16 v[132:135], a[244:247], v[100:103], v[132:135]
    buffer_load_dwordx4 v[24:27], v156, s[4:7], s37 offen offset:2048 sc1
    s_waitcnt vmcnt(10)
    v_mfma_f32_16x16x32_bf16 v[128:131], a[248:251], v[104:107], v[128:131]
    v_mfma_f32_16x16x32_bf16 v[132:135], a[252:255], v[104:107], v[132:135]
    buffer_load_dwordx4 v[28:31], v156, s[4:7], s37 offen offset:3072 sc1
    s_nop 5
    ds_write_b128 v161, v[128:131] offset:8192
    ds_write_b128 v161, v[132:135] offset:9216
    s_add_u32 s37, s37, 4096
    buffer_load_dwordx4 v[32:35], v156, s[4:7], s37 offen offset:0 sc1
    buffer_load_dwordx4 v[36:39], v156, s[4:7], s37 offen offset:1024 sc1
    buffer_load_dwordx4 v[40:43], v156, s[4:7], s37 offen offset:2048 sc1
    s_waitcnt lgkmcnt(0)
    s_barrier
    ds_read_b64 v[112:113], v163 offset:8192
    ds_read_b64 v[114:115], v163 offset:10240
    ds_read_b64 v[116:117], v163 offset:12288
    ds_read_b64 v[118:119], v163 offset:14336
    s_waitcnt lgkmcnt(2)
    v_pk_add_f32 v[112:113], v[112:113], v[114:115]
    s_waitcnt lgkmcnt(0)
    v_pk_add_f32 v[116:117], v[116:117], v[118:119]
    v_pk_add_f32 v[112:113], v[112:113], v[116:117]
    v_pk_fma_f32 v[112:113], v[112:113], v[144:145], v[154:155]
    v_cvt_pk_bf16_f32 v112, v112, v113
    s_lshl_b32 s34, s25, 15
    buffer_store_dword v112, v160, s[8:11], s34 offen
    s_mov_b32 s25, s39
    s_cmp_ge_u32 s25, 63
    s_cbranch_scc1 L_exit
    s_waitcnt vmcnt(14)
    s_cmp_eq_u32 s30, 0
    s_cbranch_scc1 L_col_loop
    s_add_u32 s38, s25, 0
    s_or_b32 s3, s25, 62
    s_min_u32 s38, s38, s3
    s_lshl_b32 s38, s38, 7
    s_add_u32 s38, s38, 0x92000
    s_waitcnt vmcnt(0)
L_poll_53:
    buffer_load_dword v114, v158, s[4:7], s38 offen offset:0 sc1
    s_movk_i32 s3, 67
    s_sub_u32 s24, s24, 1
    s_cbranch_scc1 L_timeout
    s_waitcnt vmcnt(0)
    v_cmp_gt_u32 vcc, 1, v114
    s_cbranch_vccz L_seen_54
    s_sleep 2
    s_branch L_poll_53
L_seen_54:
    s_mov_b32 s37, s29
    buffer_load_dwordx4 v[0:3], v156, s[4:7], s37 offen offset:0 sc1
    buffer_load_dwordx4 v[4:7], v156, s[4:7], s37 offen offset:1024 sc1
    buffer_load_dwordx4 v[8:11], v156, s[4:7], s37 offen offset:2048 sc1
    buffer_load_dwordx4 v[12:15], v156, s[4:7], s37 offen offset:3072 sc1
    s_add_u32 s37, s37, 4096
    buffer_load_dwordx4 v[16:19], v156, s[4:7], s37 offen offset:0 sc1
    buffer_load_dwordx4 v[20:23], v156, s[4:7], s37 offen offset:1024 sc1
    buffer_load_dwordx4 v[24:27], v156, s[4:7], s37 offen offset:2048 sc1
    buffer_load_dwordx4 v[28:31], v156, s[4:7], s37 offen offset:3072 sc1
    s_add_u32 s37, s37, 4096
    buffer_load_dwordx4 v[32:35], v156, s[4:7], s37 offen offset:0 sc1
    buffer_load_dwordx4 v[36:39], v156, s[4:7], s37 offen offset:1024 sc1
    buffer_load_dwordx4 v[40:43], v156, s[4:7], s37 offen offset:2048 sc1
    s_branch L_col_loop
L_col_last:
    s_waitcnt vmcnt(0)
    v_mfma_f32_16x16x32_bf16 v[136:139], v[168:171], v[0:3], 0
    v_mfma_f32_16x16x32_bf16 v[140:143], v[172:175], v[0:3], 0
    v_mfma_f32_16x16x32_bf16 v[136:139], v[176:179], v[4:7], v[136:139]
    v_mfma_f32_16x16x32_bf16 v[140:143], v[180:183], v[4:7], v[140:143]
    v_mfma_f32_16x16x32_bf16 v[136:139], v[184:187], v[8:11], v[136:139]
    v_mfma_f32_16x16x32_bf16 v[140:143], v[188:191], v[8:11], v[140:143]
    v_mfma_f32_16x16x32_bf16 v[136:139], v[192:195], v[12:15], v[136:139]
    v_mfma_f32_16x16x32_bf16 v[140:143], v[196:199], v[12:15], v[140:143]
    v_mfma_f32_16x16x32_bf16 v[136:139], v[200:203], v[16:19], v[136:139]
    v_mfma_f32_16x16x32_bf16 v[140:143], v[204:207], v[16:19], v[140:143]
    v_mfma_f32_16x16x32_bf16 v[136:139], v[208:211], v[20:23], v[136:139]
    v_mfma_f32_16x16x32_bf16 v[140:143], v[212:215], v[20:23], v[140:143]
    v_mfma_f32_16x16x32_bf16 v[136:139], v[216:219], v[24:27], v[136:139]
    v_mfma_f32_16x16x32_bf16 v[140:143], v[220:223], v[24:27], v[140:143]
    v_mfma_f32_16x16x32_bf16 v[136:139], v[224:227], v[28:31], v[136:139]
    v_mfma_f32_16x16x32_bf16 v[140:143], v[228:231], v[28:31], v[140:143]
    v_mfma_f32_16x16x32_bf16 v[136:139], v[232:235], v[32:35], v[136:139]
    v_mfma_f32_16x16x32_bf16 v[140:143], v[236:239], v[32:35], v[140:143]
    v_mfma_f32_16x16x32_bf16 v[136:139], v[240:243], v[36:39], v[136:139]
    v_mfma_f32_16x16x32_bf16 v[140:143], v[244:247], v[36:39], v[140:143]
    v_mfma_f32_16x16x32_bf16 v[136:139], v[248:251], v[40:43], v[136:139]
    v_mfma_f32_16x16x32_bf16 v[140:143], v[252:255], v[40:43], v[140:143]
    s_nop 6
    ds_write_b128 v161, v[136:139] offset:0
    ds_write_b128 v161, v[140:143] offset:1024
    s_waitcnt lgkmcnt(0)
    s_barrier
    ds_read_b64 v[112:113], v163 offset:0
    ds_read_b64 v[114:115], v163 offset:2048
    ds_read_b64 v[116:117], v163 offset:4096
    ds_read_b64 v[118:119], v163 offset:6144
    s_waitcnt lgkmcnt(2)
    v_pk_add_f32 v[112:113], v[112:113], v[114:115]
    s_waitcnt lgkmcnt(0)
    v_pk_add_f32 v[116:117], v[116:117], v[118:119]
    v_pk_add_f32 v[112:113], v[112:113], v[116:117]
    v_mul_f32 v144, 0xbfb8aa3b, v112
    v_mul_f32 v145, 0xbfb8aa3b, v113
    v_exp_f32 v144, v144
    v_exp_f32 v145, v145
    v_add_f32 v144, 1.0, v144
    v_add_f32 v145, 1.0, v145
    v_rcp_f32 v144, v144
    v_rcp_f32 v145, v145
    v_mul_f32 v144, v144, v112
    v_mul_f32 v145, v145, v113
    v_lshlrev_b32 v154, 16, v152
    v_and_b32 v155, 0xffff0000, v152
    s_sub_u32 s37, s36, 8192
    s_mov_b32 s31, 0x140000
    s_waitcnt vmcnt(0)
L_poll_55:
    buffer_load_dword v162, v159, s[4:7], s37 offen offset:0 sc1
    s_movk_i32 s3, 70
    s_sub_u32 s24, s24, 1
    s_cbranch_scc1 L_timeout
    s_waitcnt vmcnt(0)
    v_cmp_gt_u32 vcc, 16843009, v162
    s_cbranch_vccz L_seen_56
    s_sleep 8
    s_branch L_poll_55
L_seen_56:
    s_cmp_eq_u32 s25, 63
    s_cselect_b32 s37, 0xc0040, s36
    s_cselect_b64 s[56:57], -1, 0
    s_cselect_b32 s31, 0, s31
L_col_take:
    s_and_b32 s3, s56, 128
    v_and_b32 v164, s3, v159
    v_lshl_add_u32 v164, v164, 6, v159
    s_waitcnt vmcnt(0)
L_poll_57:
    buffer_load_dword v162, v164, s[4:7], s37 offen offset:0 sc1
    s_movk_i32 s3, 69
    s_sub_u32 s24, s24, 1
    s_cbranch_scc1 L_timeout
    s_waitcnt vmcnt(0)
    v_cmp_gt_u32 vcc, 16843009, v162
    s_cbranch_vccnz L_poll_57
    buffer_load_dwordx4 v[44:47], v156, s[4:7], s40 offen offset:0 sc1
    buffer_load_dwordx4 v[48:51], v156, s[4:7], s40 offen offset:1024 sc1
    s_add_u32 s40, s40, s31
    buffer_load_dwordx4 v[52:55], v156, s[4:7], s41 offen offset:0 sc1
    buffer_load_dwordx4 v[56:59], v156, s[4:7], s41 offen offset:1024 sc1
    s_add_u32 s41, s41, s31
    buffer_load_dwordx4 v[60:63], v156, s[4:7], s42 offen offset:0 sc1
    buffer_load_dwordx4 v[64:67], v156, s[4:7], s42 offen offset:1024 sc1
    s_add_u32 s42, s42, s31
    buffer_load_dwordx4 v[68:71], v156, s[4:7], s43 offen offset:0 sc1
    buffer_load_dwordx4 v[72:75], v156, s[4:7], s43 offen offset:1024 sc1
    s_add_u32 s43, s43, s31
    s_waitcnt vmcnt(7)
    v_mfma_f32_16x16x32_bf16 v[128:131], a[0:3], v[44:47], 0
    v_mfma_f32_16x16x32_bf16 v[132:135], a[4:7], v[44:47], 0
    buffer_load_dwordx4 v[76:79], v156, s[4:7], s44 offen offset:0 sc1
    s_waitcnt vmcnt(7)
    v_mfma_f32_16x16x32_bf16 v[128:131], a[8:11], v[48:51], v[128:131]
    v_mfma_f32_16x16x32_bf16 v[132:135], a[12:15], v[48:51], v[132:135]
    buffer_load_dwordx4 v[80:83], v156, s[4:7], s44 offen offset:1024 sc1
    s_add_u32 s44, s44, s31
    s_waitcnt vmcnt(7)
    v_mfma_f32_16x16x32_bf16 v[128:131], a[16:19], v[52:55], v[128:131]
    v_mfma_f32_16x16x32_bf16 v[132:135], a[20:23], v[52:55], v[132:135]
    buffer_load_dwordx4 v[84:87], v156, s[4:7], s45 offen offset:0 sc1
    s_waitcnt vmcnt(7)
    v_mfma_f32_16x16x32_bf16 v[128:131], a[24:27], v[56:59], v[128:131]
    v_mfma_f32_16x16x32_bf16 v[132:135], a[28:31], v[56:59], v[132:135]
    buffer_load_dwordx4 v[88:91], v156, s[4:7], s45 offen offset:1024 sc1
    s_add_u32 s45, s45, s31
    s_waitcnt vmcnt(7)
    v_mfma_f32_16x16x32_bf16 v[128:131], a[32:35], v[60:63], v[128:131]
    v_mfma_f32_16x16x32_bf16 v[132:135], a[36:39], v[60:63], v[132:135]
    buffer_load_dwordx4 v[92:95], v156, s[4:7], s46 offen offset:0 sc1
    s_waitcnt vmcnt(7)
    v_mfma_f32_16x16x32_bf16 v[128:131], a[40:43], v[64:67], v[128:131]
    v_mfma_f32_16x16x32_bf16 v[132:135], a[44:47], v[64:67], v[132:135]
    buffer_load_dwordx4 v[96:99], v156, s[4:7], s46 offen offset:1024 sc1
    s_add_u32 s46, s46, s31
    s_waitcnt vmcnt(7)
    v_mfma_f32_16x16x32_bf16 v[128:131], a[48:51], v[68:71], v[128:131]
    v_mfma_f32_16x16x32_bf16 v[132:135], a[52:55], v[68:71], v[132:135]
    buffer_load_dwordx4 v[100:103], v156, s[4:7], s47 offen offset:0 sc1
    s_waitcnt vmcnt(7)
    v_mfma_f32_16x16x32_bf16 v[128:131], a[56:59], v[72:75], v[128:131]
    v_mfma_f32_16x16x32_bf16 v[132:135], a[60:63], v[72:75], v[132:135]
    buffer_load_dwordx4 v[104:107], v156, s[4:7], s47 offen offset:1024 sc1
    s_add_u32 s47, s47, s31
    s_waitcnt vmcnt(7)
    v_mfma_f32_16x16x32_bf16 v[128:131], a[64:67], v[76:79], v[128:131]
    v_mfma_f32_16x16x32_bf16 v[132:135], a[68:71], v[76:79], v[132:135]
    buffer_load_dwordx4 v[44:47], v156, s[4:7], s48 offen offset:0 sc1
    s_waitcnt vmcnt(7)
    v_mfma_f32_16x16x32_bf16 v[128:131], a[72:75], v[80:83], v[128:131]
    v_mfma_f32_16x16x32_bf16 v[132:135], a[76:79], v[80:83], v[132:135]
    buffer_load_dwordx4 v[48:51], v156, s[4:7], s48 offen offset:1024 sc1
    s_add_u32 s48, s48, s31
    s_waitcnt vmcnt(7)
    v_mfma_f32_16x16x32_bf16 v[128:131], a[80:83], v[84:87], v[128:131]
    v_mfma_f32_16x16x32_bf16 v[132:135], a[84:87], v[84:87], v[132:135]
    buffer_load_dwordx4 v[52:55], v156, s[4:7], s49 offen offset:0 sc1
    s_waitcnt vmcnt(7)
    v_mfma_f32_16x16x32_bf16 v[128:131], a[88:91], v[88:91], v[128:131]
    v_mfma_f32_16x16x32_bf16 v[132:135], a[92:95], v[88:91], v[132:135]
    buffer_load_dwordx4 v[56:59], v156, s[4:7], s49 offen offset:1024 sc1
    s_add_u32 s49, s49, s31
    s_waitcnt vmcnt(7)
    v_mfma_f32_16x16x32_bf16 v[128:131], a[96:99], v[92:95], v[128:131]
    v_mfma_f32_16x16x32_bf16 v[132:135], a[100:103], v[92:95], v[132:135]
    buffer_load_dwordx4 v[60:63], v156, s[4:7], s50 offen offset:0 sc1
    s_waitcnt vmcnt(7)
    v_mfma_f32_16x16x32_bf16 v[128:131], a[104:107], v[96:99], v[128:131]
    v_mfma_f32_16x16x32_bf16 v[132:135], a[108:111], v[96:99], v[132:135]
    buffer_load_dwordx4 v[64:67], v156, s[4:7], s50 offen offset:1024 sc1
    s_add_u32 s50, s50, s31
    s_waitcnt vmcnt(7)
    v_mfma_f32_16x16x32_bf16 v[128:131], a[112:115], v[100:103], v[128:131]
    v_mfma_f32_16x16x32_bf16 v[132:135], a[116:119], v[100:103], v[132:135]
    buffer_load_dwordx4 v[68:71], v156, s[4:7], s51 offen offset:0 sc1
    s_waitcnt vmcnt(7)
    v_mfma_f32_16x16x32_bf16 v[128:131], a[120:123], v[104:107], v[128:131]
    v_mfma_f32_16x16x32_bf16 v[132:135], a[124:127], v[104:107], v[132:135]
    buffer_load_dwordx4 v[72:75], v156, s[4:7], s51 offen offset:1024 sc1
    s_add_u32 s51, s51, s31
    s_waitcnt vmcnt(7)
    v_mfma_f32_16x16x32_bf16 v[128:131], a[128:131], v[44:47], v[128:131]
    v_mfma_f32_16x16x32_bf16 v[132:135], a[132:135], v[44:47], v[132:135]
    buffer_load_dwordx4 v[76:79], v156, s[4:7], s52 offen offset:0 sc1
    s_waitcnt vmcnt(7)
    v_mfma_f32_16x16x32_bf16 v[128:131], a[136:139], v[48:51], v[128:131]
    v_mfma_f32_16x16x32_bf16 v[132:135], a[140:143], v[48:51], v[132:135]
    buffer_load_dwordx4 v[80:83], v156, s[4:7], s52 offen offset:1024 sc1
    s_add_u32 s52, s52, s31
    s_waitcnt vmcnt(7)
    v_mfma_f32_16x16x32_bf16 v[128:131], a[144:147], v[52:55], v[128:131]
    v_mfma_f32_16x16x32_bf16 v[132:135], a[148:151], v[52:55], v[132:135]
    buffer_load_dwordx4 v[84:87], v156, s[4:7], s53 offen offset:0 sc1
    s_waitcnt vmcnt(7)
    v_mfma_f32_16x16x32_bf16 v[128:131], a[152:155], v[56:59], v[128:131]
    v_mfma_f32_16x16x32_bf16 v[132:135], a[156:159], v[56:59], v[132:135]
    buffer_load_dwordx4 v[88:91], v156, s[4:7], s53 offen offset:1024 sc1
    s_add_u32 s53, s53, s31
    s_waitcnt vmcnt(7)
    v_mfma_f32_16x16x32_bf16 v[128:131], a[160:163], v[60:63], v[128:131]
    v_mfma_f32_16x16x32_bf16 v[132:135], a[164:167], v[60:63], v[132:135]
    buffer_load_dwordx4 v[92:95], v156, s[4:7], s54 offen offset:0 sc1
    s_waitcnt vmcnt(7)
    v_mfma_f32_16x16x32_bf16 v[128:131], a[168:171], v[64:67], v[128:131]
    v_mfma_f32_16x16x32_bf16 v[132:135], a[172:175], v[64:67], v[132:135]
    buffer_load_dwordx4 v[96:99], v156, s[4:7], s54 offen offset:1024 sc1
    s_add_u32 s54, s54, s31
    s_waitcnt vmcnt(7)
    v_mfma_f32_16x16x32_bf16 v[128:131], a[176:179], v[68:71], v[128:131]
    v_mfma_f32_16x16x32_bf16 v[132:135], a[180:183], v[68:71], v[132:135]
    buffer_load_dwordx4 v[100:103], v156, s[4:7], s55 offen offset:0 sc1
    s_waitcnt vmcnt(7)
    v_mfma_f32_16x16x32_bf16 v[128:131], a[184:187], v[72:75], v[128:131]
    v_mfma_f32_16x16x32_bf16 v[132:135], a[188:191], v[72:75], v[132:135]
    buffer_load_dwordx4 v[104:107], v156, s[4:7], s55 offen offset:1024 sc1
    s_add_u32 s55, s55, s31
    s_waitcnt vmcnt(7)
    v_mfma_f32_16x16x32_bf16 v[128:131], a[192:195], v[76:79], v[128:131]
    v_mfma_f32_16x16x32_bf16 v[132:135], a[196:199], v[76:79], v[132:135]
    s_waitcnt vmcnt(6)
    v_mfma_f32_16x16x32_bf16 v[128:131], a[200:203], v[80:83], v[128:131]
    v_mfma_f32_16x16x32_bf16 v[132:135], a[204:207], v[80:83], v[132:135]
    s_waitcnt vmcnt(5)
    v_mfma_f32_16x16x32_bf16 v[128:131], a[208:211], v[84:87], v[128:131]
    v_mfma_f32_16x16x32_bf16 v[132:135], a[212:215], v[84:87], v[132:135]
    s_waitcnt vmcnt(4)
    v_mfma_f32_16x16x32_bf16 v[128:131], a[216:219], v[88:91], v[128:131]
    v_mfma_f32_16x16x32_bf16 v[132:135], a[220:223], v[88:91], v[132:135]
    s_waitcnt vmcnt(3)
    v_mfma_f32_16x16x32_bf16 v[128:131], a[224:227], v[92:95], v[128:131]
    v_mfma_f32_16x16x32_bf16 v[132:135], a[228:231], v[92:95], v[132:135]
    s_waitcnt vmcnt(2)
    v_mfma_f32_16x16x32_bf16 v[128:131], a[232:235], v[96:99], v[128:131]
    v_mfma_f32_16x16x32_bf16 v[132:135], a[236:239], v[96:99], v[132:135]
    s_waitcnt vmcnt(1)
    v_mfma_f32_16x16x32_bf16 v[128:131], a[240:243], v[100:103], v[128:131]
    v_mfma_f32_16x16x32_bf16 v[132:135], a[244:247], v[100:103], v[132:135]
    s_waitcnt vmcnt(0)
    v_mfma_f32_16x16x32_bf16 v[128:131], a[248:251], v[104:107], v[128:131]
    v_mfma_f32_16x16x32_bf16 v[132:135], a[252:255], v[104:107], v[132:135]
    s_nop 6
    ds_write_b128 v161, v[128:131] offset:8192
    ds_write_b128 v161, v[132:135] offset:9216
    v_cmp_u_f32 vcc, v128, v128
    s_mov_b32 s37, s36
    s_and_b64 vcc, vcc, s[56:57]
    s_mov_b64 s[56:57], 0
    s_waitcnt lgkmcnt(0)
    s_cbranch_scc1 L_col_take
    s_waitcnt lgkmcnt(0)
    s_barrier
    ds_read_b64 v[112:113], v163 offset:8192
    ds_read_b64 v[114:115], v163 offset:10240
    ds_read_b64 v[116:117], v163 offset:12288
    ds_read_b64 v[118:119], v163 offset:14336
    s_waitcnt lgkmcnt(2)
    v_pk_add_f32 v[112:113], v[112:113], v[114:115]
    s_waitcnt lgkmcnt(0)
    v_pk_add_f32 v[116:117], v[116:117], v[118:119]
    v_pk_add_f32 v[112:113], v[112:113], v[116:117]
    v_pk_fma_f32 v[112:113], v[112:113], v[144:145], v[154:155]
    v_cvt_pk_bf16_f32 v112, v112, v113
    s_lshl_b32 s34, s25, 15
    buffer_store_dword v112, v160, s[8:11], s34 offen
    s_add_u32 s25, s25, 5
    s_cmp_lt_u32 s25, 64
    s_cbranch_scc1 L_col_first
    s_endpgm
L_col_end:
.section .rodata,"a"
.p2align 6
.amdhsa_kernel recurrent_scan__memory_aug_recurrent_mem_tr__geglu_ffn__prompt_kernel
  .amdhsa_next_free_vgpr 512
  .amdhsa_next_free_sgpr 102
  .amdhsa_accum_offset 256
  .amdhsa_group_segment_fixed_size 0
  .amdhsa_kernarg_size 112
  .amdhsa_user_sgpr_count 2
  .amdhsa_user_sgpr_kernarg_segment_ptr 1
  .amdhsa_system_sgpr_workgroup_id_x 1
.end_amdhsa_kernel
```
